```python
import torch

def _softmax(x, axis=-1):
    return torch.softmax(x, dim=axis)

def _gelu(x):
    return torch.nn.functional.gelu(x, approximate='tanh')

def _silu(x):
    return torch.nn.functional.silu(x)

def _sigmoid(x):
    return torch.sigmoid(x)

def _layernorm(x, axis=-1, eps=1e-05):
    m = x.mean(dim=axis, keepdim=True)
    v = x.var(dim=axis, keepdim=True, unbiased=False)
    return (x - m) / torch.sqrt(v + eps)

def _scatter_add(tgt, idx, src, axis=0):
    return tgt.clone().index_add_(axis, idx, src)

def _segment_sum(src, seg, n):
    out = torch.zeros((n,) + src.shape[1:], dtype=src.dtype)
    return out.index_add_(0, seg, src)

def _pad(x, pw):
    flat = tuple((v for pair in reversed(pw) for v in pair))
    return torch.nn.functional.pad(x, flat)
kernel_name = 'adaLN_cond__gqa_block_cached__mixer_s_mlp__prompt'

def setup_inputs():

    _w = lambda a: (lambda t: t.to(torch.bfloat16) if t.is_floating_point() else t)(torch.as_tensor(a))

    def _A_setup():
        B, Sq, D = (1, 2048, 512)
        Hq, Hkv, Sk, Dh = (32, 8, 2048, 128)
        assert Hq % Hkv == 0, (Hq, Hkv)
        return {'x': _w((lambda *s: torch.randn(*s, dtype=torch.bfloat16) * 0.1)(B, Sq, D)), 'k_cache': _w((lambda *s: torch.randn(*s, dtype=torch.bfloat16) * 0.8)(B, Hkv, Sk, Dh)), 'v_cache': _w((lambda *s: torch.randn(*s, dtype=torch.bfloat16) * 0.8)(B, Hkv, Sk, Dh)), 'wq': _w((lambda *s: torch.randn(*s, dtype=torch.bfloat16) * 0.8)(D, Hq * Dh) * D ** (-0.5)), 'wo': _w((lambda *s: torch.randn(*s, dtype=torch.bfloat16) * 0.8)(Hq * Dh, D) * (Hq * Dh) ** (-0.5))}
    _A_in = _A_setup()

    def _B_setup():
        B, S, D, F = (1, 2048, 512, 1792)
        return {'x': _w((lambda *s: torch.randn(*s, dtype=torch.bfloat16) * 0.1)(B, S, D)), 'w1': _w((lambda *s: torch.randn(*s, dtype=torch.bfloat16) * 3.2)(D, D) * D ** (-0.5)), 'w2': _w((lambda *s: torch.randn(*s, dtype=torch.bfloat16) * 3.2)(D, D) * D ** (-0.5)), 'w3': _w((lambda *s: torch.randn(*s, dtype=torch.bfloat16) * 3.2)(D, F) * D ** (-0.5)), 'w4': _w((lambda *s: torch.randn(*s, dtype=torch.bfloat16) * 3.2)(F, D) * F ** (-0.5))}
    _B_in = _B_setup()
    return {'A_x': _A_in['x'], 'A_k_cache': _A_in['k_cache'], 'A_v_cache': _A_in['v_cache'], 'A_wq': _A_in['wq'], 'A_wo': _A_in['wo'], 'B_x': _B_in['x'], 'B_w1': _B_in['w1'], 'B_w2': _B_in['w2'], 'B_w3': _B_in['w3'], 'B_w4': _B_in['w4'], 'c': _w((lambda *s: torch.randn(*s, dtype=torch.bfloat16) * 0.2)(1, 512) * 8.0), 'w_mod': _w((lambda *s: torch.randn(*s, dtype=torch.bfloat16) * 0.2)(512, 6 * 512) * 512 ** (-0.5) * 8.0)}

def reference(A_x, A_k_cache, A_v_cache, A_wq, A_wo, B_x, B_w1, B_w2, B_w3, B_w4, c, w_mod):

    def _A_ref(x, k_cache, v_cache, wq, wo):
        B, Sq, D = x.shape
        Hq, Dh = (32, 128)
        Hkv = k_cache.shape[1]
        rep = Hq // Hkv
        q = (lambda x, *d: x.permute(*d))((x @ wq).reshape(B, Sq, Hq, Dh), 0, 2, 1, 3)
        k = (lambda x, n, axis: torch.repeat_interleave(x, n, dim=axis))(k_cache, rep, axis=1)
        v = (lambda x, n, axis: torch.repeat_interleave(x, n, dim=axis))(v_cache, rep, axis=1)
        scores = torch.einsum('bhqd,bhkd->bhqk', q, k) * Dh ** (-0.5)
        p = _softmax(scores, axis=-1)
        o = torch.einsum('bhqk,bhkd->bhqd', p, v)
        return (lambda x, *d: x.permute(*d))(o, 0, 2, 1, 3).reshape(B, Sq, Hq * Dh) @ wo

    def _B_ref(x, w1, w2, w3, w4):
        B, S, D = x.shape
        h = _gelu(_layernorm(x, axis=-1) @ w1)
        c = D // 4
        g0 = _pad(h[:, :, 0 * c:1 * c], ((0, 0), (1, 0), (0, 0)))[:, :S, :]
        g1 = _pad(h[:, :, 1 * c:2 * c], ((0, 0), (0, 1), (0, 0)))[:, 1:, :]
        g2 = _pad(h[:, :, 2 * c:3 * c], ((0, 0), (2, 0), (0, 0)))[:, :S, :]
        g3 = _pad(h[:, :, 3 * c:], ((0, 0), (0, 2), (0, 0)))[:, 2:, :]
        hs = torch.concatenate([g0, g1, g2, g3], axis=-1) @ w2
        x1 = x + hs
        h2 = _gelu(_layernorm(x1, axis=-1) @ w3) @ w4
        return x1 + h2
    x = A_x
    mod = (_silu(c) @ w_mod).reshape(c.shape[0], 6, 1, -1)
    sa, ca, ga, sb, cb, gb = (mod[:, 0].clone(), mod[:, 1].clone(), mod[:, 2].clone(), mod[:, 3].clone(), mod[:, 4].clone(), mod[:, 5].clone())
    h = _layernorm(x, axis=-1) * (1 + ca) + sa
    x = x + ga * _A_ref(h, A_k_cache, A_v_cache, A_wq, A_wo)
    h = _layernorm(x, axis=-1) * (1 + cb) + sb
    x = x + gb * _B_ref(h, B_w1, B_w2, B_w3, B_w4)
    return x
```

```asm
; @launch kernel=kf_kernel grid=(256,1,1) block=(256,1,1) lds=163840
.amdgcn_target "amdgcn-amd-amdhsa--gfx950"
.text
.globl kf_kernel
.p2align 8
.type kf_kernel,@function
kf_kernel:
    s_cmp_ge_u32 s2, 256
    s_cbranch_scc1 L_kf_end_2
    s_load_dwordx4 s[76:79], s[0:1], 80
    s_load_dwordx8 s[4:11], s[0:1], 8
    s_load_dwordx2 s[86:87], s[0:1], 0
    s_load_dwordx2 s[12:13], s[0:1], 112
    s_load_dwordx8 s[88:95], s[0:1], 48
    s_load_dwordx4 s[96:99], s[0:1], 96
    s_getpc_b64 s[48:49]
L_kf_pc_7:
    s_lshr_b32 s43, s2, 3
    s_lshl_b32 s44, s43, 12
    v_lshl_add_u32 v7, v0, 4, s44
    v_min_u32 v7, L_kf_last_1-L_kf_pc_7-4, v7
    global_load_dword v255, v7, s[48:49]
    v_lshrrev_b32 v192, 6, v0
    v_and_b32 v193, 63, v0
    s_and_b32 s42, s2, 7
    v_readfirstlane_b32 s3, v192
    v_lshlrev_b32 v1, 2, v0
    s_and_b32 s44, s2, 3
    s_lshl_b32 s44, s44, 8
    v_and_b32 v2, 0xf8, v0
    v_add_u32 v2, s44, v2
    v_lshrrev_b32 v4, 4, v0
    v_and_b32 v5, 15, v0
    s_mul_i32 s44, s43, 98304
    s_lshl_b32 s45, s42, 8
    s_add_u32 s44, s44, s45
    v_mul_u32_u24 v3, 6144, v4
    v_lshl_add_u32 v3, v5, 4, v3
    v_add_u32 v3, s44, v3
    v_lshrrev_b32 v4, 3, v0
    v_and_b32 v6, 7, v0
    v_lshlrev_b32 v4, 13, v4
    v_lshl_add_u32 v4, v6, 7, v4
    s_and_b32 s74, s42, 6
    s_and_b32 s46, s43, 1
    s_or_b32 s74, s74, s46
    s_and_b32 s75, s43, 30
    s_and_b32 s46, s42, 1
    s_or_b32 s75, s75, s46
    v_lshlrev_b32 v204, 10, v5
    s_lshl_b32 s44, s43, 3
    s_add_u32 s44, s44, s45
    v_mul_u32_u24 v5, 12288, v0
    v_add_u32 v5, s44, v5
    v_add_u32 v6, 6144, v5
    v_lshrrev_b32 v194, 4, v193
    v_lshl_add_u32 v204, v194, 4, v204
    s_lshl_b32 s46, s74, 10
    s_and_b32 s47, s43, 30
    s_lshl_b32 s47, s47, 17
    s_add_u32 s46, s46, s47
    s_lshl_b32 s47, s75, 16
    s_lshl_b32 s45, s3, 8
    s_add_u32 s47, s47, s45
    s_mov_b32 s26, 0x400000
    s_mov_b32 s27, 0x20000
    s_mov_b32 s30, 0x200000
    s_mov_b32 s31, 0x20000
    s_waitcnt lgkmcnt(0)
    global_load_dword v8, v1, s[76:77]
    global_load_dwordx2 v[10:11], v2, s[76:77]
    global_load_dword v255, v3, s[78:79]
    s_mov_b32 s24, s8
    s_mov_b32 s25, s9
    s_mov_b32 s28, s86
    s_mov_b32 s29, s87
    s_load_dword s14, s[12:13], 24576
    global_load_dwordx2 v[12:13], v5, s[78:79]
    global_load_dwordx2 v[14:15], v6, s[78:79]
    buffer_load_dwordx4 v[128:131], v204, s[28:31], s47 offen offset:0
    buffer_load_dwordx4 v[132:135], v204, s[28:31], s47 offen offset:64
    buffer_load_dwordx4 v[136:139], v204, s[28:31], s47 offen offset:128
    buffer_load_dwordx4 v[140:143], v204, s[28:31], s47 offen offset:192
    s_add_u32 s47, s47, 0x4000
    buffer_load_dwordx4 v[144:147], v204, s[28:31], s47 offen offset:0
    buffer_load_dwordx4 v[148:151], v204, s[28:31], s47 offen offset:64
    buffer_load_dwordx4 v[152:155], v204, s[28:31], s47 offen offset:128
    buffer_load_dwordx4 v[156:159], v204, s[28:31], s47 offen offset:192
    s_add_u32 s47, s47, 0x4000
    s_mov_b32 s50, s46
    v_lshlrev_b32 v250, 4, v193
    v_lshrrev_b32 v195, 3, v193
    v_and_b32 v196, 7, v193
    v_lshlrev_b32 v197, 1, v194
    v_xor_b32 v196, v196, v197
    v_lshlrev_b32 v196, 4, v196
    v_and_b32 v197, 4, v195
    v_add_u32 v197, v197, v195
    v_lshl_add_u32 v252, v197, 13, v196
    s_lshl_b32 s44, s74, 2
    s_add_u32 s44, s44, s3
    s_lshl_b32 s44, s44, 8
    v_add_u32 v252, s44, v252
    s_mul_i32 s36, s3, 40960
    s_getreg_b32 s85, hwreg(HW_REG_XCC_ID, 0, 4)
    s_mov_b32 s52, 0x10000
    s_and_b32 s85, s85, 7
    v_mov_b32 v9, 0x3f803f80
    v_mov_b32 v227, 0x3727c5ac
    s_mov_b32 s32, s12
    s_mov_b32 s33, s13
    s_mov_b32 s34, 0x200000
    s_mov_b32 s35, 0x20000
    v_accvgpr_write_b32 a216, v9
    v_accvgpr_write_b32 a217, v9
    v_accvgpr_write_b32 a218, v9
    v_accvgpr_write_b32 a219, v9
    s_lshl_b32 s44, s74, 19
    s_add_u32 s16, s4, s44
    s_addc_u32 s17, s5, 0
    s_mov_b32 s18, 0x80000
    s_mov_b32 s19, 0x20000
    s_add_u32 s20, s6, s44
    s_addc_u32 s21, s7, 0
    s_mov_b32 s22, 0x80000
    s_mov_b32 s23, 0x20000
    v_add_u32 v251, 81920, v250
    s_mov_b32 s46, 40960
    v_and_b32 v198, 15, v193
    v_bfe_u32 v199, v193, 2, 2
    v_and_b32 v200, 3, v193
    v_mul_lo_u32 v201, v199, s46
    v_lshl_add_u32 v201, v200, 8, v201
    v_xor_b32 v202, v198, v194
    v_lshl_add_u32 v201, v202, 4, v201
    v_xor_b32 v236, 0, v201
    v_xor_b32 v237, 64, v201
    v_xor_b32 v238, 128, v201
    v_xor_b32 v239, 192, v201
    v_mul_lo_u32 v201, v194, s46
    v_lshl_add_u32 v201, v199, 8, v201
    v_and_b32 v202, 1, v194
    v_lshl_add_u32 v203, v202, 2, v199
    v_lshl_add_u32 v201, v203, 5, v201
    v_lshl_add_u32 v201, v200, 3, v201
    v_xor_b32 v240, 0, v201
    v_xor_b32 v241, 32, v201
    v_xor_b32 v242, 64, v201
    v_xor_b32 v243, 96, v201
    v_xor_b32 v244, 128, v201
    v_xor_b32 v245, 160, v201
    v_xor_b32 v246, 192, v201
    v_xor_b32 v247, 224, v201
    v_lshrrev_b32 v201, 1, v194
    v_lshlrev_b32 v201, 10, v201
    v_lshl_add_u32 v201, v203, 7, v201
    v_lshrrev_b32 v203, 1, v203
    v_lshl_add_u32 v201, v203, 5, v201
    v_lshl_add_u32 v201, v200, 3, v201
    v_add_u32 v253, s36, v201
    s_lshl_b32 s44, s3, 12
    v_lshlrev_b32 v201, 8, v194
    v_add_u32 v201, s44, v201
    s_lshl_b32 s45, s3, 2
    v_or_b32 v202, s45, v194
    v_xor_b32 v202, v202, v198
    v_lshl_add_u32 v248, v202, 4, v201
    s_and_b32 s45, s45, 4
    v_or_b32 v202, s45, v194
    v_lshlrev_b32 v202, 1, v202
    v_xor_b32 v202, v202, v198
    v_lshl_add_u32 v249, v202, 4, v201
    v_mov_b32 v201, 0x3f803f80
    v_cmp_eq_u32 vcc, 0, v198
    s_nop 1
    v_cndmask_b32 v201, 0, v201, vcc
    v_mov_b32 v202, 0xff61b1e6
    v_lshl_add_u32 v226, v195, 10, v196
    s_lshl_b32 s44, s74, 19
    s_lshl_b32 s45, s3, 8
    s_add_u32 s44, s44, s45
    v_add_u32 v226, s44, v226
    v_add_u32 v254, s36, v250
    s_mov_b32 s37, 0
    s_mov_b32 s38, 0
    s_mov_b32 s41, 0
    v_accvgpr_write_b32 a128, v201
    v_accvgpr_write_b32 a196, v202
    v_accvgpr_write_b32 a129, v201
    v_accvgpr_write_b32 a197, v202
    v_accvgpr_write_b32 a130, v201
    v_accvgpr_write_b32 a198, v202
    v_accvgpr_write_b32 a131, v201
    v_accvgpr_write_b32 a199, v202
    s_waitcnt vmcnt(11)
    v_lshlrev_b32 v16, 16, v8
    v_and_b32 v17, 0xffff0000, v8
    v_lshlrev_b32 v18, 16, v10
    v_and_b32 v19, 0xffff0000, v10
    v_lshlrev_b32 v20, 16, v11
    v_and_b32 v21, 0xffff0000, v11
    v_mul_f32 v22, 0xbfb8aa3b, v16
    v_mul_f32 v23, 0xbfb8aa3b, v17
    v_mul_f32 v24, 0xbfb8aa3b, v18
    v_mul_f32 v25, 0xbfb8aa3b, v19
    v_mul_f32 v26, 0xbfb8aa3b, v20
    v_mul_f32 v27, 0xbfb8aa3b, v21
    v_exp_f32 v22, v22
    v_exp_f32 v23, v23
    v_exp_f32 v24, v24
    v_exp_f32 v25, v25
    v_exp_f32 v26, v26
    v_exp_f32 v27, v27
    v_add_f32 v22, 1.0, v22
    v_add_f32 v23, 1.0, v23
    v_add_f32 v24, 1.0, v24
    v_add_f32 v25, 1.0, v25
    v_add_f32 v26, 1.0, v26
    v_add_f32 v27, 1.0, v27
    v_rcp_f32 v22, v22
    v_rcp_f32 v23, v23
    v_rcp_f32 v24, v24
    v_rcp_f32 v25, v25
    v_rcp_f32 v26, v26
    v_rcp_f32 v27, v27
    v_mul_f32 v22, v16, v22
    v_mul_f32 v23, v17, v23
    v_mul_f32 v24, v18, v24
    v_mul_f32 v25, v19, v25
    v_mul_f32 v26, v20, v26
    v_mul_f32 v27, v21, v27
    v_cvt_pk_bf16_f32 v8, v22, v23
    v_cvt_pk_bf16_f32 v9, v24, v25
    v_cvt_pk_bf16_f32 v10, v26, v27
    v_lshlrev_b32 v16, 16, v8
    v_and_b32 v17, 0xffff0000, v8
    v_lshlrev_b32 v18, 16, v9
    v_and_b32 v19, 0xffff0000, v9
    v_lshlrev_b32 v20, 16, v10
    v_and_b32 v21, 0xffff0000, v10
    s_cmp_ge_u32 s2, 128
    s_cselect_b64 vcc, -1, 0
    v_cndmask_b32 v228, v18, 1.0, vcc
    v_cndmask_b32 v229, v19, 1.0, vcc
    v_cndmask_b32 v230, v20, 1.0, vcc
    v_cndmask_b32 v231, v21, 1.0, vcc
    s_lshl_b32 s44, s3, 4
    v_lshl_add_u32 v1, v194, 2, s44
    v_mov_b32 v2, 0
    s_lshl_b32 s44, s42, 9
    s_lshl_b32 s45, s43, 4
    s_add_u32 s44, s44, s45
    s_add_u32 s44, s44, 344064
    s_cmp_ge_u32 s42, 4
    s_cselect_b32 s45, 1.0, 0
    s_waitcnt vmcnt(9)
    v_lshlrev_b32 v32, 16, v12
    v_and_b32 v33, 0xffff0000, v12
    v_lshlrev_b32 v34, 16, v13
    v_and_b32 v35, 0xffff0000, v13
    v_pk_mul_f32 v[28:29], v[32:33], v[16:17] op_sel_hi:[1,0]
    v_pk_mul_f32 v[30:31], v[34:35], v[16:17] op_sel_hi:[1,0]
    s_waitcnt vmcnt(8)
    v_lshlrev_b32 v36, 16, v14
    v_and_b32 v37, 0xffff0000, v14
    v_lshlrev_b32 v38, 16, v15
    v_and_b32 v39, 0xffff0000, v15
    v_fmac_f32 v28, v36, v17
    v_fmac_f32 v29, v37, v17
    v_fmac_f32 v30, v38, v17
    v_fmac_f32 v31, v39, v17
    s_nop 0
    v_permlane32_swap_b32 v28, v30
    v_permlane32_swap_b32 v29, v31
    v_add_f32 v28, v28, v30
    v_add_f32 v29, v29, v31
    s_nop 1
    v_permlane16_swap_b32 v28, v29
    v_add_f32 v28, v28, v29
    s_nop 1
    v_add_f32_dpp v28, v28, v28 row_ror:8 row_mask:0xf bank_mask:0xf
    s_nop 1
    v_add_f32_dpp v28, v28, v28 row_ror:4 row_mask:0xf bank_mask:0xf
    s_nop 1
    v_add_f32_dpp v28, v28, v28 row_ror:2 row_mask:0xf bank_mask:0xf
    s_nop 1
    v_add_f32_dpp v28, v28, v28 row_ror:1 row_mask:0xf bank_mask:0xf
    ds_write_b32 v1, v28 offset:36864
    s_waitcnt lgkmcnt(0)
    s_add_u32 s51, s14, 0x9e3779b9
    s_barrier
    s_cmp_lg_u32 s3, 0
    s_cbranch_scc1 L_kf_nw_8
    ds_read_b128 v[12:15], v2 offset:36864
    ds_read_b128 v[16:19], v2 offset:36880
    ds_read_b128 v[20:23], v2 offset:36896
    ds_read_b128 v[24:27], v2 offset:36912
    v_mov_b32 v10, s51
    s_waitcnt lgkmcnt(2)
    v_pk_add_f32 v[12:13], v[12:13], v[16:17]
    v_pk_add_f32 v[14:15], v[14:15], v[18:19]
    s_waitcnt lgkmcnt(0)
    v_pk_add_f32 v[20:21], v[20:21], v[24:25]
    v_pk_add_f32 v[22:23], v[22:23], v[26:27]
    v_pk_add_f32 v[12:13], v[12:13], v[20:21]
    v_pk_add_f32 v[14:15], v[14:15], v[22:23]
    v_cvt_pk_bf16_f32 v8, v12, v13
    v_cvt_pk_bf16_f32 v9, v14, v15
    v_lshlrev_b32 v12, 16, v8
    v_and_b32 v13, 0xffff0000, v8
    v_lshlrev_b32 v14, 16, v9
    v_and_b32 v15, 0xffff0000, v9
    v_add_f32 v12, s45, v12
    v_add_f32 v13, s45, v13
    v_add_f32 v14, s45, v14
    v_add_f32 v15, s45, v15
    v_cvt_pk_bf16_f32 v8, v12, v13
    v_cvt_pk_bf16_f32 v9, v14, v15
    s_mov_b64 exec, 1
    buffer_store_dwordx3 v[8:10], off, s[32:35], s44 sc1
    s_mov_b64 exec, -1
L_kf_nw_8:
    s_barrier
    buffer_load_dwordx4 v[160:163], v204, s[28:31], s47 offen offset:0
    buffer_load_dwordx4 v[164:167], v204, s[28:31], s47 offen offset:64
    buffer_load_dwordx4 v[168:171], v204, s[28:31], s47 offen offset:128
    buffer_load_dwordx4 v[172:175], v204, s[28:31], s47 offen offset:192
    s_add_u32 s47, s47, 0x4000
    buffer_load_dwordx4 v[176:179], v204, s[28:31], s47 offen offset:0
    buffer_load_dwordx4 v[180:183], v204, s[28:31], s47 offen offset:64
    buffer_load_dwordx4 v[184:187], v204, s[28:31], s47 offen offset:128
    buffer_load_dwordx4 v[188:191], v204, s[28:31], s47 offen offset:192
    buffer_load_dword a220, v4, s[24:27], s50 offen
    v_lshl_add_u32 v255, v194, 5, s36
    s_cmp_eq_u32 s3, 0
    s_waitcnt vmcnt(14)
    s_cbranch_scc1 L_kf_w0_9
    s_waitcnt vmcnt(13)
L_kf_w0_9:
    v_mfma_f32_16x16x32_bf16 v[208:211], a[216:219], v[128:131], 0
    v_lshlrev_b32 v0, 16, v128
    v_and_b32 v1, 0xffff0000, v128
    v_lshlrev_b32 v2, 16, v129
    v_and_b32 v3, 0xffff0000, v129
    v_lshlrev_b32 v4, 16, v130
    v_and_b32 v5, 0xffff0000, v130
    v_lshlrev_b32 v6, 16, v131
    v_and_b32 v7, 0xffff0000, v131
    v_mfma_f32_16x16x32_bf16 v[208:211], a[216:219], v[132:135], v[208:211]
    v_lshlrev_b32 v8, 16, v132
    v_and_b32 v9, 0xffff0000, v132
    v_lshlrev_b32 v10, 16, v133
    v_and_b32 v11, 0xffff0000, v133
    v_lshlrev_b32 v12, 16, v134
    v_and_b32 v13, 0xffff0000, v134
    v_lshlrev_b32 v14, 16, v135
    v_and_b32 v15, 0xffff0000, v135
    v_mfma_f32_16x16x32_bf16 v[208:211], a[216:219], v[136:139], v[208:211]
    v_lshlrev_b32 v16, 16, v136
    v_and_b32 v17, 0xffff0000, v136
    v_lshlrev_b32 v18, 16, v137
    v_and_b32 v19, 0xffff0000, v137
    v_lshlrev_b32 v20, 16, v138
    v_and_b32 v21, 0xffff0000, v138
    v_lshlrev_b32 v22, 16, v139
    v_and_b32 v23, 0xffff0000, v139
    v_mfma_f32_16x16x32_bf16 v[208:211], a[216:219], v[140:143], v[208:211]
    v_lshlrev_b32 v24, 16, v140
    v_and_b32 v25, 0xffff0000, v140
    v_lshlrev_b32 v26, 16, v141
    v_and_b32 v27, 0xffff0000, v141
    v_lshlrev_b32 v28, 16, v142
    v_and_b32 v29, 0xffff0000, v142
    v_lshlrev_b32 v30, 16, v143
    v_and_b32 v31, 0xffff0000, v143
    v_and_b32 v137, 0xf0, v250
    v_lshrrev_b32 v137, 1, v137
    v_add_u32 v137, 38912, v137
    v_add_u32 v136, s36, v137
    v_add_u32 v138, 81920, v137
    v_lshrrev_b32 v131, 9, v250
    v_mul_u32_u24 v131, 1536, v131
    v_add_u32 v131, v131, v250
    v_mul_f32 v216, 0xbc000000, v208
    v_pk_add_f32 v[0:1], v[0:1], v[216:217] op_sel_hi:[1,0]
    v_pk_add_f32 v[2:3], v[2:3], v[216:217] op_sel_hi:[1,0]
    v_pk_add_f32 v[4:5], v[4:5], v[216:217] op_sel_hi:[1,0]
    v_pk_add_f32 v[6:7], v[6:7], v[216:217] op_sel_hi:[1,0]
    v_pk_add_f32 v[8:9], v[8:9], v[216:217] op_sel_hi:[1,0]
    v_pk_add_f32 v[10:11], v[10:11], v[216:217] op_sel_hi:[1,0]
    v_pk_add_f32 v[12:13], v[12:13], v[216:217] op_sel_hi:[1,0]
    v_pk_add_f32 v[14:15], v[14:15], v[216:217] op_sel_hi:[1,0]
    v_pk_add_f32 v[16:17], v[16:17], v[216:217] op_sel_hi:[1,0]
    v_pk_add_f32 v[18:19], v[18:19], v[216:217] op_sel_hi:[1,0]
    v_pk_add_f32 v[20:21], v[20:21], v[216:217] op_sel_hi:[1,0]
    v_pk_add_f32 v[22:23], v[22:23], v[216:217] op_sel_hi:[1,0]
    v_pk_add_f32 v[24:25], v[24:25], v[216:217] op_sel_hi:[1,0]
    v_pk_add_f32 v[26:27], v[26:27], v[216:217] op_sel_hi:[1,0]
    v_pk_add_f32 v[28:29], v[28:29], v[216:217] op_sel_hi:[1,0]
    v_pk_add_f32 v[30:31], v[30:31], v[216:217] op_sel_hi:[1,0]
    v_pk_mul_f32 v[212:213], v[0:1], v[0:1]
    v_pk_mul_f32 v[214:215], v[2:3], v[2:3]
    v_pk_fma_f32 v[212:213], v[4:5], v[4:5], v[212:213]
    v_pk_fma_f32 v[214:215], v[6:7], v[6:7], v[214:215]
    v_pk_fma_f32 v[212:213], v[8:9], v[8:9], v[212:213]
    v_pk_fma_f32 v[214:215], v[10:11], v[10:11], v[214:215]
    v_pk_fma_f32 v[212:213], v[12:13], v[12:13], v[212:213]
    v_pk_fma_f32 v[214:215], v[14:15], v[14:15], v[214:215]
    v_pk_fma_f32 v[212:213], v[16:17], v[16:17], v[212:213]
    v_pk_fma_f32 v[214:215], v[18:19], v[18:19], v[214:215]
    v_pk_fma_f32 v[212:213], v[20:21], v[20:21], v[212:213]
    v_pk_fma_f32 v[214:215], v[22:23], v[22:23], v[214:215]
    v_pk_fma_f32 v[212:213], v[24:25], v[24:25], v[212:213]
    v_pk_fma_f32 v[214:215], v[26:27], v[26:27], v[214:215]
    v_pk_fma_f32 v[212:213], v[28:29], v[28:29], v[212:213]
    v_pk_fma_f32 v[214:215], v[30:31], v[30:31], v[214:215]
    v_pk_add_f32 v[212:213], v[212:213], v[214:215]
    v_add_f32 v217, v212, v213
    v_mov_b32 v212, v217
    s_nop 1
    v_permlane32_swap_b32 v217, v212
    v_add_f32 v217, v217, v212
    v_mov_b32 v212, v217
    s_nop 1
    v_permlane16_swap_b32 v217, v212
    v_add_f32 v217, v217, v212
    s_mov_b64 exec, 0xffff
    ds_write_b64 v136, v[216:217] offset:0
    s_mov_b64 exec, -1
    s_cmp_eq_u32 s3, 0
    s_waitcnt vmcnt(10)
    s_cbranch_scc1 L_kf_w0_10
    s_waitcnt vmcnt(9)
L_kf_w0_10:
    v_mfma_f32_16x16x32_bf16 v[208:211], a[216:219], v[144:147], 0
    v_lshlrev_b32 v32, 16, v144
    v_and_b32 v33, 0xffff0000, v144
    v_lshlrev_b32 v34, 16, v145
    v_and_b32 v35, 0xffff0000, v145
    v_lshlrev_b32 v36, 16, v146
    v_and_b32 v37, 0xffff0000, v146
    v_lshlrev_b32 v38, 16, v147
    v_and_b32 v39, 0xffff0000, v147
    v_mfma_f32_16x16x32_bf16 v[208:211], a[216:219], v[148:151], v[208:211]
    v_lshlrev_b32 v40, 16, v148
    v_and_b32 v41, 0xffff0000, v148
    v_lshlrev_b32 v42, 16, v149
    v_and_b32 v43, 0xffff0000, v149
    v_lshlrev_b32 v44, 16, v150
    v_and_b32 v45, 0xffff0000, v150
    v_lshlrev_b32 v46, 16, v151
    v_and_b32 v47, 0xffff0000, v151
    v_mfma_f32_16x16x32_bf16 v[208:211], a[216:219], v[152:155], v[208:211]
    v_lshlrev_b32 v48, 16, v152
    v_and_b32 v49, 0xffff0000, v152
    v_lshlrev_b32 v50, 16, v153
    v_and_b32 v51, 0xffff0000, v153
    v_lshlrev_b32 v52, 16, v154
    v_and_b32 v53, 0xffff0000, v154
    v_lshlrev_b32 v54, 16, v155
    v_and_b32 v55, 0xffff0000, v155
    v_mfma_f32_16x16x32_bf16 v[208:211], a[216:219], v[156:159], v[208:211]
    v_lshlrev_b32 v56, 16, v156
    v_and_b32 v57, 0xffff0000, v156
    v_lshlrev_b32 v58, 16, v157
    v_and_b32 v59, 0xffff0000, v157
    v_lshlrev_b32 v60, 16, v158
    v_and_b32 v61, 0xffff0000, v158
    v_lshlrev_b32 v62, 16, v159
    v_and_b32 v63, 0xffff0000, v159
    v_mul_f32 v218, 0xbc000000, v208
    v_pk_add_f32 v[32:33], v[32:33], v[218:219] op_sel_hi:[1,0]
    v_pk_add_f32 v[34:35], v[34:35], v[218:219] op_sel_hi:[1,0]
    v_pk_add_f32 v[36:37], v[36:37], v[218:219] op_sel_hi:[1,0]
    v_pk_add_f32 v[38:39], v[38:39], v[218:219] op_sel_hi:[1,0]
    v_pk_add_f32 v[40:41], v[40:41], v[218:219] op_sel_hi:[1,0]
    v_pk_add_f32 v[42:43], v[42:43], v[218:219] op_sel_hi:[1,0]
    v_pk_add_f32 v[44:45], v[44:45], v[218:219] op_sel_hi:[1,0]
    v_pk_add_f32 v[46:47], v[46:47], v[218:219] op_sel_hi:[1,0]
    v_pk_add_f32 v[48:49], v[48:49], v[218:219] op_sel_hi:[1,0]
    v_pk_add_f32 v[50:51], v[50:51], v[218:219] op_sel_hi:[1,0]
    v_pk_add_f32 v[52:53], v[52:53], v[218:219] op_sel_hi:[1,0]
    v_pk_add_f32 v[54:55], v[54:55], v[218:219] op_sel_hi:[1,0]
    v_pk_add_f32 v[56:57], v[56:57], v[218:219] op_sel_hi:[1,0]
    v_pk_add_f32 v[58:59], v[58:59], v[218:219] op_sel_hi:[1,0]
    v_pk_add_f32 v[60:61], v[60:61], v[218:219] op_sel_hi:[1,0]
    v_pk_add_f32 v[62:63], v[62:63], v[218:219] op_sel_hi:[1,0]
    v_pk_mul_f32 v[212:213], v[32:33], v[32:33]
    v_pk_mul_f32 v[214:215], v[34:35], v[34:35]
    v_pk_fma_f32 v[212:213], v[36:37], v[36:37], v[212:213]
    v_pk_fma_f32 v[214:215], v[38:39], v[38:39], v[214:215]
    v_pk_fma_f32 v[212:213], v[40:41], v[40:41], v[212:213]
    v_pk_fma_f32 v[214:215], v[42:43], v[42:43], v[214:215]
    v_pk_fma_f32 v[212:213], v[44:45], v[44:45], v[212:213]
    v_pk_fma_f32 v[214:215], v[46:47], v[46:47], v[214:215]
    v_pk_fma_f32 v[212:213], v[48:49], v[48:49], v[212:213]
    v_pk_fma_f32 v[214:215], v[50:51], v[50:51], v[214:215]
    v_pk_fma_f32 v[212:213], v[52:53], v[52:53], v[212:213]
    v_pk_fma_f32 v[214:215], v[54:55], v[54:55], v[214:215]
    v_pk_fma_f32 v[212:213], v[56:57], v[56:57], v[212:213]
    v_pk_fma_f32 v[214:215], v[58:59], v[58:59], v[214:215]
    v_pk_fma_f32 v[212:213], v[60:61], v[60:61], v[212:213]
    v_pk_fma_f32 v[214:215], v[62:63], v[62:63], v[214:215]
    v_pk_add_f32 v[212:213], v[212:213], v[214:215]
    v_add_f32 v219, v212, v213
    v_mov_b32 v212, v219
    s_nop 1
    v_permlane32_swap_b32 v219, v212
    v_add_f32 v219, v219, v212
    v_mov_b32 v212, v219
    s_nop 1
    v_permlane16_swap_b32 v219, v212
    v_add_f32 v219, v219, v212
    s_mov_b64 exec, 0xffff
    ds_write_b64 v136, v[218:219] offset:128
    s_mov_b64 exec, -1
    s_waitcnt vmcnt(5)
    v_mfma_f32_16x16x32_bf16 v[208:211], a[216:219], v[160:163], 0
    v_lshlrev_b32 v64, 16, v160
    v_and_b32 v65, 0xffff0000, v160
    v_lshlrev_b32 v66, 16, v161
    v_and_b32 v67, 0xffff0000, v161
    v_lshlrev_b32 v68, 16, v162
    v_and_b32 v69, 0xffff0000, v162
    v_lshlrev_b32 v70, 16, v163
    v_and_b32 v71, 0xffff0000, v163
    v_mfma_f32_16x16x32_bf16 v[208:211], a[216:219], v[164:167], v[208:211]
    v_lshlrev_b32 v72, 16, v164
    v_and_b32 v73, 0xffff0000, v164
    v_lshlrev_b32 v74, 16, v165
    v_and_b32 v75, 0xffff0000, v165
    v_lshlrev_b32 v76, 16, v166
    v_and_b32 v77, 0xffff0000, v166
    v_lshlrev_b32 v78, 16, v167
    v_and_b32 v79, 0xffff0000, v167
    v_mfma_f32_16x16x32_bf16 v[208:211], a[216:219], v[168:171], v[208:211]
    v_lshlrev_b32 v80, 16, v168
    v_and_b32 v81, 0xffff0000, v168
    v_lshlrev_b32 v82, 16, v169
    v_and_b32 v83, 0xffff0000, v169
    v_lshlrev_b32 v84, 16, v170
    v_and_b32 v85, 0xffff0000, v170
    v_lshlrev_b32 v86, 16, v171
    v_and_b32 v87, 0xffff0000, v171
    v_mfma_f32_16x16x32_bf16 v[208:211], a[216:219], v[172:175], v[208:211]
    v_lshlrev_b32 v88, 16, v172
    v_and_b32 v89, 0xffff0000, v172
    v_lshlrev_b32 v90, 16, v173
    v_and_b32 v91, 0xffff0000, v173
    v_lshlrev_b32 v92, 16, v174
    v_and_b32 v93, 0xffff0000, v174
    v_lshlrev_b32 v94, 16, v175
    v_and_b32 v95, 0xffff0000, v175
    v_mul_f32 v220, 0xbc000000, v208
    v_pk_add_f32 v[64:65], v[64:65], v[220:221] op_sel_hi:[1,0]
    v_pk_add_f32 v[66:67], v[66:67], v[220:221] op_sel_hi:[1,0]
    v_pk_add_f32 v[68:69], v[68:69], v[220:221] op_sel_hi:[1,0]
    v_pk_add_f32 v[70:71], v[70:71], v[220:221] op_sel_hi:[1,0]
    v_pk_add_f32 v[72:73], v[72:73], v[220:221] op_sel_hi:[1,0]
    v_pk_add_f32 v[74:75], v[74:75], v[220:221] op_sel_hi:[1,0]
    v_pk_add_f32 v[76:77], v[76:77], v[220:221] op_sel_hi:[1,0]
    v_pk_add_f32 v[78:79], v[78:79], v[220:221] op_sel_hi:[1,0]
    v_pk_add_f32 v[80:81], v[80:81], v[220:221] op_sel_hi:[1,0]
    v_pk_add_f32 v[82:83], v[82:83], v[220:221] op_sel_hi:[1,0]
    v_pk_add_f32 v[84:85], v[84:85], v[220:221] op_sel_hi:[1,0]
    v_pk_add_f32 v[86:87], v[86:87], v[220:221] op_sel_hi:[1,0]
    v_pk_add_f32 v[88:89], v[88:89], v[220:221] op_sel_hi:[1,0]
    v_pk_add_f32 v[90:91], v[90:91], v[220:221] op_sel_hi:[1,0]
    v_pk_add_f32 v[92:93], v[92:93], v[220:221] op_sel_hi:[1,0]
    v_pk_add_f32 v[94:95], v[94:95], v[220:221] op_sel_hi:[1,0]
    v_pk_mul_f32 v[212:213], v[64:65], v[64:65]
    v_pk_mul_f32 v[214:215], v[66:67], v[66:67]
    v_pk_fma_f32 v[212:213], v[68:69], v[68:69], v[212:213]
    v_pk_fma_f32 v[214:215], v[70:71], v[70:71], v[214:215]
    v_pk_fma_f32 v[212:213], v[72:73], v[72:73], v[212:213]
    v_pk_fma_f32 v[214:215], v[74:75], v[74:75], v[214:215]
    v_pk_fma_f32 v[212:213], v[76:77], v[76:77], v[212:213]
    v_pk_fma_f32 v[214:215], v[78:79], v[78:79], v[214:215]
    v_pk_fma_f32 v[212:213], v[80:81], v[80:81], v[212:213]
    v_pk_fma_f32 v[214:215], v[82:83], v[82:83], v[214:215]
    v_pk_fma_f32 v[212:213], v[84:85], v[84:85], v[212:213]
    v_pk_fma_f32 v[214:215], v[86:87], v[86:87], v[214:215]
    v_pk_fma_f32 v[212:213], v[88:89], v[88:89], v[212:213]
    v_pk_fma_f32 v[214:215], v[90:91], v[90:91], v[214:215]
    v_pk_fma_f32 v[212:213], v[92:93], v[92:93], v[212:213]
    v_pk_fma_f32 v[214:215], v[94:95], v[94:95], v[214:215]
    v_pk_add_f32 v[212:213], v[212:213], v[214:215]
    v_add_f32 v221, v212, v213
    v_mov_b32 v212, v221
    s_nop 1
    v_permlane32_swap_b32 v221, v212
    v_add_f32 v221, v221, v212
    v_mov_b32 v212, v221
    s_nop 1
    v_permlane16_swap_b32 v221, v212
    v_add_f32 v221, v221, v212
    s_mov_b64 exec, 0xffff
    ds_write_b64 v136, v[220:221] offset:256
    s_mov_b64 exec, -1
    s_waitcnt lgkmcnt(0)
    s_barrier
    ds_read_b64 v[192:193], v137 offset:0
    ds_read_b64 v[194:195], v137 offset:40960
    ds_read_b64 v[196:197], v138 offset:0
    ds_read_b64 v[198:199], v138 offset:40960
    ds_read_b64 v[200:201], v137 offset:128
    ds_read_b64 v[202:203], v137 offset:41088
    ds_read_b64 v[204:205], v138 offset:128
    ds_read_b64 v[206:207], v138 offset:41088
    ds_read_b64 v[208:209], v137 offset:256
    ds_read_b64 v[210:211], v137 offset:41216
    ds_read_b64 v[212:213], v138 offset:256
    ds_read_b64 v[214:215], v138 offset:41216
    s_lshl_b32 s50, s3, 9
    s_add_u32 s50, s50, 344064
    buffer_load_dwordx3 v[128:130], v131, s[32:35], s50 offen sc1
    s_add_u32 m0, s36, 16384
    s_mov_b32 s39, 0
    buffer_load_dwordx4 v252, s[24:27], s39 offen offset:0 lds
    s_mov_b32 s39, 130048
    buffer_load_dwordx4 v252, s[24:27], s39 offen offset:1024 lds
    s_mov_b32 s39, 30720
    buffer_load_dwordx4 v252, s[24:27], s39 offen offset:2048 lds
    s_mov_b32 s39, 160768
    buffer_load_dwordx4 v252, s[24:27], s39 offen offset:3072 lds
    s_add_u32 m0, s36, 20352
    s_mov_b32 s39, 0
    buffer_load_dwordx4 v252, s[24:27], s39 offen offset:128 lds
    s_mov_b32 s39, 130048
    buffer_load_dwordx4 v252, s[24:27], s39 offen offset:1152 lds
    s_mov_b32 s39, 30720
    buffer_load_dwordx4 v252, s[24:27], s39 offen offset:2176 lds
    s_mov_b32 s39, 160768
    buffer_load_dwordx4 v252, s[24:27], s39 offen offset:3200 lds
    s_waitcnt lgkmcnt(0)
    v_add_f32 v224, v192, v194
    v_add_f32 v232, v200, v202
    v_add_f32 v234, v208, v210
    v_add_f32 v225, v196, v198
    v_add_f32 v233, v204, v206
    v_add_f32 v235, v212, v214
    v_add_f32 v193, v193, v195
    v_add_f32 v201, v201, v203
    v_add_f32 v209, v209, v211
    v_add_f32 v224, v224, v225
    v_add_f32 v232, v232, v233
    v_add_f32 v234, v234, v235
    v_add_f32 v197, v197, v199
    v_add_f32 v205, v205, v207
    v_add_f32 v213, v213, v215
    v_mul_f32 v225, 0x3e800000, v224
    v_mul_f32 v233, 0x3e800000, v232
    v_mul_f32 v235, 0x3e800000, v234
    v_add_f32 v193, v193, v197
    v_add_f32 v201, v201, v205
    v_add_f32 v209, v209, v213
    v_sub_f32 v192, v192, v225
    v_sub_f32 v200, v200, v233
    v_sub_f32 v208, v208, v235
    v_sub_f32 v194, v194, v225
    v_sub_f32 v202, v202, v233
    v_sub_f32 v210, v210, v235
    v_sub_f32 v196, v196, v225
    v_sub_f32 v204, v204, v233
    v_sub_f32 v212, v212, v235
    v_sub_f32 v198, v198, v225
    v_sub_f32 v206, v206, v233
    v_sub_f32 v214, v214, v235
    v_mul_f32 v195, v192, v192
    v_mul_f32 v203, v200, v200
    v_mul_f32 v211, v208, v208
    v_fmac_f32 v195, v194, v194
    v_fmac_f32 v203, v202, v202
    v_fmac_f32 v211, v210, v210
    v_fmac_f32 v195, v196, v196
    v_fmac_f32 v203, v204, v204
    v_fmac_f32 v211, v212, v212
    v_fmac_f32 v195, v198, v198
    v_fmac_f32 v203, v206, v206
    v_fmac_f32 v211, v214, v214
    v_fmamk_f32 v193, v195, 0x43000000, v193
    v_fmamk_f32 v201, v203, 0x43000000, v201
    v_fmamk_f32 v209, v211, 0x43000000, v209
    v_fmamk_f32 v193, v193, 0x3b000000, v227
    v_fmamk_f32 v201, v201, 0x3b000000, v227
    v_fmamk_f32 v209, v209, 0x3b000000, v227
    v_rsq_f32 v224, v193
    v_rsq_f32 v232, v201
    v_rsq_f32 v234, v209
    v_sub_f32 v216, v225, v216
    v_sub_f32 v218, v233, v218
    v_sub_f32 v220, v235, v220
    v_mul_f32 v216, v216, v224
    v_mul_f32 v218, v218, v232
    v_mul_f32 v220, v220, v234
    v_pk_fma_f32 v[0:1], v[0:1], v[224:225], v[216:217] op_sel_hi:[1,0,0]
    v_pk_fma_f32 v[2:3], v[2:3], v[224:225], v[216:217] op_sel_hi:[1,0,0]
    v_pk_fma_f32 v[4:5], v[4:5], v[224:225], v[216:217] op_sel_hi:[1,0,0]
    v_pk_fma_f32 v[6:7], v[6:7], v[224:225], v[216:217] op_sel_hi:[1,0,0]
    v_pk_fma_f32 v[8:9], v[8:9], v[224:225], v[216:217] op_sel_hi:[1,0,0]
    v_pk_fma_f32 v[10:11], v[10:11], v[224:225], v[216:217] op_sel_hi:[1,0,0]
    v_pk_fma_f32 v[12:13], v[12:13], v[224:225], v[216:217] op_sel_hi:[1,0,0]
    v_pk_fma_f32 v[14:15], v[14:15], v[224:225], v[216:217] op_sel_hi:[1,0,0]
    v_pk_fma_f32 v[16:17], v[16:17], v[224:225], v[216:217] op_sel_hi:[1,0,0]
    v_pk_fma_f32 v[18:19], v[18:19], v[224:225], v[216:217] op_sel_hi:[1,0,0]
    v_pk_fma_f32 v[20:21], v[20:21], v[224:225], v[216:217] op_sel_hi:[1,0,0]
    v_pk_fma_f32 v[22:23], v[22:23], v[224:225], v[216:217] op_sel_hi:[1,0,0]
    v_pk_fma_f32 v[24:25], v[24:25], v[224:225], v[216:217] op_sel_hi:[1,0,0]
    v_pk_fma_f32 v[26:27], v[26:27], v[224:225], v[216:217] op_sel_hi:[1,0,0]
    v_pk_fma_f32 v[28:29], v[28:29], v[224:225], v[216:217] op_sel_hi:[1,0,0]
    v_pk_fma_f32 v[30:31], v[30:31], v[224:225], v[216:217] op_sel_hi:[1,0,0]
    v_pk_fma_f32 v[32:33], v[32:33], v[232:233], v[218:219] op_sel_hi:[1,0,0]
    v_pk_fma_f32 v[34:35], v[34:35], v[232:233], v[218:219] op_sel_hi:[1,0,0]
    v_pk_fma_f32 v[36:37], v[36:37], v[232:233], v[218:219] op_sel_hi:[1,0,0]
    v_pk_fma_f32 v[38:39], v[38:39], v[232:233], v[218:219] op_sel_hi:[1,0,0]
    v_pk_fma_f32 v[40:41], v[40:41], v[232:233], v[218:219] op_sel_hi:[1,0,0]
    v_pk_fma_f32 v[42:43], v[42:43], v[232:233], v[218:219] op_sel_hi:[1,0,0]
    v_pk_fma_f32 v[44:45], v[44:45], v[232:233], v[218:219] op_sel_hi:[1,0,0]
    v_pk_fma_f32 v[46:47], v[46:47], v[232:233], v[218:219] op_sel_hi:[1,0,0]
    v_pk_fma_f32 v[48:49], v[48:49], v[232:233], v[218:219] op_sel_hi:[1,0,0]
    v_pk_fma_f32 v[50:51], v[50:51], v[232:233], v[218:219] op_sel_hi:[1,0,0]
    v_pk_fma_f32 v[52:53], v[52:53], v[232:233], v[218:219] op_sel_hi:[1,0,0]
    v_pk_fma_f32 v[54:55], v[54:55], v[232:233], v[218:219] op_sel_hi:[1,0,0]
    v_pk_fma_f32 v[56:57], v[56:57], v[232:233], v[218:219] op_sel_hi:[1,0,0]
    v_pk_fma_f32 v[58:59], v[58:59], v[232:233], v[218:219] op_sel_hi:[1,0,0]
    v_pk_fma_f32 v[60:61], v[60:61], v[232:233], v[218:219] op_sel_hi:[1,0,0]
    v_pk_fma_f32 v[62:63], v[62:63], v[232:233], v[218:219] op_sel_hi:[1,0,0]
    v_pk_fma_f32 v[64:65], v[64:65], v[234:235], v[220:221] op_sel_hi:[1,0,0]
    v_pk_fma_f32 v[66:67], v[66:67], v[234:235], v[220:221] op_sel_hi:[1,0,0]
    v_pk_fma_f32 v[68:69], v[68:69], v[234:235], v[220:221] op_sel_hi:[1,0,0]
    v_pk_fma_f32 v[70:71], v[70:71], v[234:235], v[220:221] op_sel_hi:[1,0,0]
    v_pk_fma_f32 v[72:73], v[72:73], v[234:235], v[220:221] op_sel_hi:[1,0,0]
    v_pk_fma_f32 v[74:75], v[74:75], v[234:235], v[220:221] op_sel_hi:[1,0,0]
    v_pk_fma_f32 v[76:77], v[76:77], v[234:235], v[220:221] op_sel_hi:[1,0,0]
    v_pk_fma_f32 v[78:79], v[78:79], v[234:235], v[220:221] op_sel_hi:[1,0,0]
    v_pk_fma_f32 v[80:81], v[80:81], v[234:235], v[220:221] op_sel_hi:[1,0,0]
    v_pk_fma_f32 v[82:83], v[82:83], v[234:235], v[220:221] op_sel_hi:[1,0,0]
    v_pk_fma_f32 v[84:85], v[84:85], v[234:235], v[220:221] op_sel_hi:[1,0,0]
    v_pk_fma_f32 v[86:87], v[86:87], v[234:235], v[220:221] op_sel_hi:[1,0,0]
    v_pk_fma_f32 v[88:89], v[88:89], v[234:235], v[220:221] op_sel_hi:[1,0,0]
    v_pk_fma_f32 v[90:91], v[90:91], v[234:235], v[220:221] op_sel_hi:[1,0,0]
    v_pk_fma_f32 v[92:93], v[92:93], v[234:235], v[220:221] op_sel_hi:[1,0,0]
    v_pk_fma_f32 v[94:95], v[94:95], v[234:235], v[220:221] op_sel_hi:[1,0,0]
    s_waitcnt vmcnt(10)
    v_mfma_f32_16x16x32_bf16 v[208:211], a[216:219], v[176:179], 0
    v_lshlrev_b32 v96, 16, v176
    v_and_b32 v97, 0xffff0000, v176
    v_lshlrev_b32 v98, 16, v177
    v_and_b32 v99, 0xffff0000, v177
    v_lshlrev_b32 v100, 16, v178
    v_and_b32 v101, 0xffff0000, v178
    v_lshlrev_b32 v102, 16, v179
    v_and_b32 v103, 0xffff0000, v179
    v_mfma_f32_16x16x32_bf16 v[208:211], a[216:219], v[180:183], v[208:211]
    v_lshlrev_b32 v104, 16, v180
    v_and_b32 v105, 0xffff0000, v180
    v_lshlrev_b32 v106, 16, v181
    v_and_b32 v107, 0xffff0000, v181
    v_lshlrev_b32 v108, 16, v182
    v_and_b32 v109, 0xffff0000, v182
    v_lshlrev_b32 v110, 16, v183
    v_and_b32 v111, 0xffff0000, v183
    v_mfma_f32_16x16x32_bf16 v[208:211], a[216:219], v[184:187], v[208:211]
    v_lshlrev_b32 v112, 16, v184
    v_and_b32 v113, 0xffff0000, v184
    v_lshlrev_b32 v114, 16, v185
    v_and_b32 v115, 0xffff0000, v185
    v_lshlrev_b32 v116, 16, v186
    v_and_b32 v117, 0xffff0000, v186
    v_lshlrev_b32 v118, 16, v187
    v_and_b32 v119, 0xffff0000, v187
    v_mfma_f32_16x16x32_bf16 v[208:211], a[216:219], v[188:191], v[208:211]
    v_lshlrev_b32 v120, 16, v188
    v_and_b32 v121, 0xffff0000, v188
    v_lshlrev_b32 v122, 16, v189
    v_and_b32 v123, 0xffff0000, v189
    v_lshlrev_b32 v124, 16, v190
    v_and_b32 v125, 0xffff0000, v190
    v_lshlrev_b32 v126, 16, v191
    v_and_b32 v127, 0xffff0000, v191
    v_mul_f32 v222, 0xbc000000, v208
    v_pk_add_f32 v[96:97], v[96:97], v[222:223] op_sel_hi:[1,0]
    v_pk_add_f32 v[98:99], v[98:99], v[222:223] op_sel_hi:[1,0]
    v_pk_add_f32 v[100:101], v[100:101], v[222:223] op_sel_hi:[1,0]
    v_pk_add_f32 v[102:103], v[102:103], v[222:223] op_sel_hi:[1,0]
    v_pk_add_f32 v[104:105], v[104:105], v[222:223] op_sel_hi:[1,0]
    v_pk_add_f32 v[106:107], v[106:107], v[222:223] op_sel_hi:[1,0]
    v_pk_add_f32 v[108:109], v[108:109], v[222:223] op_sel_hi:[1,0]
    v_pk_add_f32 v[110:111], v[110:111], v[222:223] op_sel_hi:[1,0]
    v_pk_add_f32 v[112:113], v[112:113], v[222:223] op_sel_hi:[1,0]
    v_pk_add_f32 v[114:115], v[114:115], v[222:223] op_sel_hi:[1,0]
    v_pk_add_f32 v[116:117], v[116:117], v[222:223] op_sel_hi:[1,0]
    v_pk_add_f32 v[118:119], v[118:119], v[222:223] op_sel_hi:[1,0]
    v_pk_add_f32 v[120:121], v[120:121], v[222:223] op_sel_hi:[1,0]
    v_pk_add_f32 v[122:123], v[122:123], v[222:223] op_sel_hi:[1,0]
    v_pk_add_f32 v[124:125], v[124:125], v[222:223] op_sel_hi:[1,0]
    v_pk_add_f32 v[126:127], v[126:127], v[222:223] op_sel_hi:[1,0]
    v_pk_mul_f32 v[212:213], v[96:97], v[96:97]
    v_pk_mul_f32 v[214:215], v[98:99], v[98:99]
    v_pk_fma_f32 v[212:213], v[100:101], v[100:101], v[212:213]
    v_pk_fma_f32 v[214:215], v[102:103], v[102:103], v[214:215]
    v_pk_fma_f32 v[212:213], v[104:105], v[104:105], v[212:213]
    v_pk_fma_f32 v[214:215], v[106:107], v[106:107], v[214:215]
    v_pk_fma_f32 v[212:213], v[108:109], v[108:109], v[212:213]
    v_pk_fma_f32 v[214:215], v[110:111], v[110:111], v[214:215]
    v_pk_fma_f32 v[212:213], v[112:113], v[112:113], v[212:213]
    v_pk_fma_f32 v[214:215], v[114:115], v[114:115], v[214:215]
    v_pk_fma_f32 v[212:213], v[116:117], v[116:117], v[212:213]
    v_pk_fma_f32 v[214:215], v[118:119], v[118:119], v[214:215]
    v_pk_fma_f32 v[212:213], v[120:121], v[120:121], v[212:213]
    v_pk_fma_f32 v[214:215], v[122:123], v[122:123], v[214:215]
    v_pk_fma_f32 v[212:213], v[124:125], v[124:125], v[212:213]
    v_pk_fma_f32 v[214:215], v[126:127], v[126:127], v[214:215]
    v_pk_add_f32 v[212:213], v[212:213], v[214:215]
    v_add_f32 v223, v212, v213
    v_mov_b32 v212, v223
    s_nop 1
    v_permlane32_swap_b32 v223, v212
    v_add_f32 v223, v223, v212
    v_mov_b32 v212, v223
    s_nop 1
    v_permlane16_swap_b32 v223, v212
    v_add_f32 v223, v223, v212
    s_mov_b64 exec, 0xffff
    ds_write_b64 v136, v[222:223] offset:384
    s_mov_b64 exec, -1
    s_lshr_b32 s44, s2, 2
    s_min_u32 s44, s44, 59
    s_cmp_lt_u32 s44, 32
    s_cselect_b64 s[46:47], s[78:79], s[92:93]
    s_cselect_b32 s45, 1, -2
    s_cselect_b32 s48, 12, 7
    s_lshl_b32 s45, s45, 11
    s_lshl_b32 s48, s48, 9
    s_lshl_b32 s44, s44, 7
    s_add_u32 s44, s44, s45
    s_and_b32 s45, s2, 3
    s_lshl_b32 s45, s45, 2
    s_add_u32 s45, s45, s3
    s_lshl_b32 s45, s45, 5
    s_mul_i32 s45, s45, s48
    s_add_u32 s44, s44, s45
    v_lshrrev_b32 v139, 7, v250
    v_lshlrev_b32 v139, 2, v139
    v_mul_u32_u24 v139, s48, v139
    v_and_b32 v140, 0x70, v250
    v_add3_u32 v139, v139, v140, s44
    v_add_u32 v140, s48, v139
    v_add_u32 v141, s48, v140
    v_add_u32 v142, s48, v141
    s_lshl_b32 s15, s2, 11
    s_lshl_b32 s45, s3, 9
    s_add_u32 s15, s15, s45
    s_add_u32 s15, s15, 1048576
    s_waitcnt lgkmcnt(0)
    s_barrier
    ds_read_b64 v[208:209], v137 offset:384
    ds_read_b64 v[210:211], v137 offset:41344
    ds_read_b64 v[212:213], v138 offset:384
    ds_read_b64 v[214:215], v138 offset:41344
    s_waitcnt vmcnt(8)
L_kf_poll_13:
    v_cmp_ne_u32 vcc, s51, v130
    s_cbranch_vccz L_kf_seen_14
    s_sleep 1
    buffer_load_dwordx3 v[128:130], v131, s[32:35], s50 offen sc1
    s_sub_i32 s52, s52, 1
    s_cmp_gt_i32 s52, 0
    s_waitcnt vmcnt(0)
    s_cbranch_scc1 L_kf_poll_13
L_kf_seen_14:
    v_lshlrev_b32 v132, 16, v128
    v_and_b32 v133, 0xffff0000, v128
    v_lshlrev_b32 v134, 16, v129
    v_and_b32 v135, 0xffff0000, v129
    v_mul_f32 v132, 0x3e0293ee, v132
    v_mul_f32 v133, 0x3e0293ee, v133
    v_mul_f32 v134, 0x3e0293ee, v134
    v_mul_f32 v135, 0x3e0293ee, v135
    ds_write_b128 v254, v[132:135] offset:37888
    s_add_u32 m0, s36, 24576
    s_mov_b32 s39, 262144
    buffer_load_dwordx4 v252, s[24:27], s39 offen offset:0 lds
    s_mov_b32 s39, 392192
    buffer_load_dwordx4 v252, s[24:27], s39 offen offset:1024 lds
    s_mov_b32 s39, 292864
    buffer_load_dwordx4 v252, s[24:27], s39 offen offset:2048 lds
    s_mov_b32 s39, 422912
    buffer_load_dwordx4 v252, s[24:27], s39 offen offset:3072 lds
    s_add_u32 m0, s36, 28544
    s_mov_b32 s39, 262144
    buffer_load_dwordx4 v252, s[24:27], s39 offen offset:128 lds
    s_mov_b32 s39, 392192
    buffer_load_dwordx4 v252, s[24:27], s39 offen offset:1152 lds
    s_mov_b32 s39, 292864
    buffer_load_dwordx4 v252, s[24:27], s39 offen offset:2176 lds
    s_mov_b32 s39, 422912
    buffer_load_dwordx4 v252, s[24:27], s39 offen offset:3200 lds
    global_load_dwordx4 a[200:203], v139, s[46:47]
    global_load_dwordx4 a[204:207], v140, s[46:47]
    global_load_dwordx4 a[208:211], v141, s[46:47]
    global_load_dwordx4 a[212:215], v142, s[46:47]
    ds_read_b128 v[128:131], v255 offset:37888
    ds_read_b128 v[132:135], v255 offset:37904
    ds_read_b128 v[136:139], v255 offset:38400
    ds_read_b128 v[140:143], v255 offset:38416
    ds_read_b128 v[144:147], v255 offset:38016
    ds_read_b128 v[148:151], v255 offset:38032
    ds_read_b128 v[152:155], v255 offset:38528
    ds_read_b128 v[156:159], v255 offset:38544
    ds_read_b128 v[160:163], v255 offset:38144
    ds_read_b128 v[164:167], v255 offset:38160
    ds_read_b128 v[168:171], v255 offset:38656
    ds_read_b128 v[172:175], v255 offset:38672
    s_waitcnt lgkmcnt(13)
    v_add_f32 v224, v208, v210
    v_add_f32 v225, v212, v214
    v_add_f32 v209, v209, v211
    v_add_f32 v224, v224, v225
    v_add_f32 v213, v213, v215
    v_mul_f32 v225, 0x3e800000, v224
    v_add_f32 v209, v209, v213
    v_sub_f32 v208, v208, v225
    v_sub_f32 v210, v210, v225
    v_sub_f32 v212, v212, v225
    v_sub_f32 v214, v214, v225
    v_mul_f32 v211, v208, v208
    v_fmac_f32 v211, v210, v210
    v_fmac_f32 v211, v212, v212
    v_fmac_f32 v211, v214, v214
    v_fmamk_f32 v209, v211, 0x43000000, v209
    v_fmamk_f32 v209, v209, 0x3b000000, v227
    v_rsq_f32 v224, v209
    v_sub_f32 v222, v225, v222
    v_mul_f32 v222, v222, v224
    v_pk_fma_f32 v[96:97], v[96:97], v[224:225], v[222:223] op_sel_hi:[1,0,0]
    v_pk_fma_f32 v[98:99], v[98:99], v[224:225], v[222:223] op_sel_hi:[1,0,0]
    v_pk_fma_f32 v[100:101], v[100:101], v[224:225], v[222:223] op_sel_hi:[1,0,0]
    v_pk_fma_f32 v[102:103], v[102:103], v[224:225], v[222:223] op_sel_hi:[1,0,0]
    v_pk_fma_f32 v[104:105], v[104:105], v[224:225], v[222:223] op_sel_hi:[1,0,0]
    v_pk_fma_f32 v[106:107], v[106:107], v[224:225], v[222:223] op_sel_hi:[1,0,0]
    v_pk_fma_f32 v[108:109], v[108:109], v[224:225], v[222:223] op_sel_hi:[1,0,0]
    v_pk_fma_f32 v[110:111], v[110:111], v[224:225], v[222:223] op_sel_hi:[1,0,0]
    v_pk_fma_f32 v[112:113], v[112:113], v[224:225], v[222:223] op_sel_hi:[1,0,0]
    v_pk_fma_f32 v[114:115], v[114:115], v[224:225], v[222:223] op_sel_hi:[1,0,0]
    v_pk_fma_f32 v[116:117], v[116:117], v[224:225], v[222:223] op_sel_hi:[1,0,0]
    v_pk_fma_f32 v[118:119], v[118:119], v[224:225], v[222:223] op_sel_hi:[1,0,0]
    v_pk_fma_f32 v[120:121], v[120:121], v[224:225], v[222:223] op_sel_hi:[1,0,0]
    v_pk_fma_f32 v[122:123], v[122:123], v[224:225], v[222:223] op_sel_hi:[1,0,0]
    v_pk_fma_f32 v[124:125], v[124:125], v[224:225], v[222:223] op_sel_hi:[1,0,0]
    v_pk_fma_f32 v[126:127], v[126:127], v[224:225], v[222:223] op_sel_hi:[1,0,0]
    ds_read_b128 v[192:195], v255 offset:38272
    ds_read_b128 v[196:199], v255 offset:38288
    ds_read_b128 v[200:203], v255 offset:38784
    ds_read_b128 v[204:207], v255 offset:38800
    s_waitcnt lgkmcnt(12)
    v_pk_fma_f32 v[0:1], v[0:1], v[136:137], v[128:129]
    v_pk_fma_f32 v[2:3], v[2:3], v[138:139], v[130:131]
    v_pk_fma_f32 v[4:5], v[4:5], v[140:141], v[132:133]
    v_pk_fma_f32 v[6:7], v[6:7], v[142:143], v[134:135]
    v_cvt_pk_bf16_f32 v0, v0, v1
    v_cvt_pk_bf16_f32 v1, v2, v3
    v_cvt_pk_bf16_f32 v2, v4, v5
    v_cvt_pk_bf16_f32 v3, v6, v7
    ds_write_b128 v254, v[0:3] offset:0
    v_pk_fma_f32 v[32:33], v[32:33], v[136:137], v[128:129]
    v_pk_fma_f32 v[34:35], v[34:35], v[138:139], v[130:131]
    v_pk_fma_f32 v[36:37], v[36:37], v[140:141], v[132:133]
    v_pk_fma_f32 v[38:39], v[38:39], v[142:143], v[134:135]
    v_cvt_pk_bf16_f32 v32, v32, v33
    v_cvt_pk_bf16_f32 v33, v34, v35
    v_cvt_pk_bf16_f32 v34, v36, v37
    v_cvt_pk_bf16_f32 v35, v38, v39
    ds_write_b128 v254, v[32:35] offset:1024
    v_pk_fma_f32 v[64:65], v[64:65], v[136:137], v[128:129]
    v_pk_fma_f32 v[66:67], v[66:67], v[138:139], v[130:131]
    v_pk_fma_f32 v[68:69], v[68:69], v[140:141], v[132:133]
    v_pk_fma_f32 v[70:71], v[70:71], v[142:143], v[134:135]
    v_cvt_pk_bf16_f32 v64, v64, v65
    v_cvt_pk_bf16_f32 v65, v66, v67
    v_cvt_pk_bf16_f32 v66, v68, v69
    v_cvt_pk_bf16_f32 v67, v70, v71
    ds_write_b128 v254, v[64:67] offset:2048
    v_pk_fma_f32 v[96:97], v[96:97], v[136:137], v[128:129]
    v_pk_fma_f32 v[98:99], v[98:99], v[138:139], v[130:131]
    v_pk_fma_f32 v[100:101], v[100:101], v[140:141], v[132:133]
    v_pk_fma_f32 v[102:103], v[102:103], v[142:143], v[134:135]
    v_cvt_pk_bf16_f32 v96, v96, v97
    v_cvt_pk_bf16_f32 v97, v98, v99
    v_cvt_pk_bf16_f32 v98, v100, v101
    v_cvt_pk_bf16_f32 v99, v102, v103
    ds_write_b128 v254, v[96:99] offset:3072
    s_waitcnt lgkmcnt(12)
    v_pk_fma_f32 v[8:9], v[8:9], v[152:153], v[144:145]
    v_pk_fma_f32 v[10:11], v[10:11], v[154:155], v[146:147]
    v_pk_fma_f32 v[12:13], v[12:13], v[156:157], v[148:149]
    v_pk_fma_f32 v[14:15], v[14:15], v[158:159], v[150:151]
    v_cvt_pk_bf16_f32 v8, v8, v9
    v_cvt_pk_bf16_f32 v9, v10, v11
    v_cvt_pk_bf16_f32 v10, v12, v13
    v_cvt_pk_bf16_f32 v11, v14, v15
    ds_write_b128 v254, v[8:11] offset:4096
    v_pk_fma_f32 v[40:41], v[40:41], v[152:153], v[144:145]
    v_pk_fma_f32 v[42:43], v[42:43], v[154:155], v[146:147]
    v_pk_fma_f32 v[44:45], v[44:45], v[156:157], v[148:149]
    v_pk_fma_f32 v[46:47], v[46:47], v[158:159], v[150:151]
    v_cvt_pk_bf16_f32 v40, v40, v41
    v_cvt_pk_bf16_f32 v41, v42, v43
    v_cvt_pk_bf16_f32 v42, v44, v45
    v_cvt_pk_bf16_f32 v43, v46, v47
    ds_write_b128 v254, v[40:43] offset:5120
    v_pk_fma_f32 v[72:73], v[72:73], v[152:153], v[144:145]
    v_pk_fma_f32 v[74:75], v[74:75], v[154:155], v[146:147]
    v_pk_fma_f32 v[76:77], v[76:77], v[156:157], v[148:149]
    v_pk_fma_f32 v[78:79], v[78:79], v[158:159], v[150:151]
    v_cvt_pk_bf16_f32 v72, v72, v73
    v_cvt_pk_bf16_f32 v73, v74, v75
    v_cvt_pk_bf16_f32 v74, v76, v77
    v_cvt_pk_bf16_f32 v75, v78, v79
    ds_write_b128 v254, v[72:75] offset:6144
    v_pk_fma_f32 v[104:105], v[104:105], v[152:153], v[144:145]
    v_pk_fma_f32 v[106:107], v[106:107], v[154:155], v[146:147]
    v_pk_fma_f32 v[108:109], v[108:109], v[156:157], v[148:149]
    v_pk_fma_f32 v[110:111], v[110:111], v[158:159], v[150:151]
    v_cvt_pk_bf16_f32 v104, v104, v105
    v_cvt_pk_bf16_f32 v105, v106, v107
    v_cvt_pk_bf16_f32 v106, v108, v109
    v_cvt_pk_bf16_f32 v107, v110, v111
    ds_write_b128 v254, v[104:107] offset:7168
    s_waitcnt lgkmcnt(12)
    v_pk_fma_f32 v[16:17], v[16:17], v[168:169], v[160:161]
    v_pk_fma_f32 v[18:19], v[18:19], v[170:171], v[162:163]
    v_pk_fma_f32 v[20:21], v[20:21], v[172:173], v[164:165]
    v_pk_fma_f32 v[22:23], v[22:23], v[174:175], v[166:167]
    v_cvt_pk_bf16_f32 v16, v16, v17
    v_cvt_pk_bf16_f32 v17, v18, v19
    v_cvt_pk_bf16_f32 v18, v20, v21
    v_cvt_pk_bf16_f32 v19, v22, v23
    ds_write_b128 v254, v[16:19] offset:8192
    v_pk_fma_f32 v[48:49], v[48:49], v[168:169], v[160:161]
    v_pk_fma_f32 v[50:51], v[50:51], v[170:171], v[162:163]
    v_pk_fma_f32 v[52:53], v[52:53], v[172:173], v[164:165]
    v_pk_fma_f32 v[54:55], v[54:55], v[174:175], v[166:167]
    v_cvt_pk_bf16_f32 v48, v48, v49
    v_cvt_pk_bf16_f32 v49, v50, v51
    v_cvt_pk_bf16_f32 v50, v52, v53
    v_cvt_pk_bf16_f32 v51, v54, v55
    ds_write_b128 v254, v[48:51] offset:9216
    v_pk_fma_f32 v[80:81], v[80:81], v[168:169], v[160:161]
    v_pk_fma_f32 v[82:83], v[82:83], v[170:171], v[162:163]
    v_pk_fma_f32 v[84:85], v[84:85], v[172:173], v[164:165]
    v_pk_fma_f32 v[86:87], v[86:87], v[174:175], v[166:167]
    v_cvt_pk_bf16_f32 v80, v80, v81
    v_cvt_pk_bf16_f32 v81, v82, v83
    v_cvt_pk_bf16_f32 v82, v84, v85
    v_cvt_pk_bf16_f32 v83, v86, v87
    ds_write_b128 v254, v[80:83] offset:10240
    v_pk_fma_f32 v[112:113], v[112:113], v[168:169], v[160:161]
    v_pk_fma_f32 v[114:115], v[114:115], v[170:171], v[162:163]
    v_pk_fma_f32 v[116:117], v[116:117], v[172:173], v[164:165]
    v_pk_fma_f32 v[118:119], v[118:119], v[174:175], v[166:167]
    v_cvt_pk_bf16_f32 v112, v112, v113
    v_cvt_pk_bf16_f32 v113, v114, v115
    v_cvt_pk_bf16_f32 v114, v116, v117
    v_cvt_pk_bf16_f32 v115, v118, v119
    ds_write_b128 v254, v[112:115] offset:11264
    s_waitcnt lgkmcnt(12)
    v_pk_fma_f32 v[24:25], v[24:25], v[200:201], v[192:193]
    v_pk_fma_f32 v[26:27], v[26:27], v[202:203], v[194:195]
    v_pk_fma_f32 v[28:29], v[28:29], v[204:205], v[196:197]
    v_pk_fma_f32 v[30:31], v[30:31], v[206:207], v[198:199]
    v_cvt_pk_bf16_f32 v24, v24, v25
    v_cvt_pk_bf16_f32 v25, v26, v27
    v_cvt_pk_bf16_f32 v26, v28, v29
    v_cvt_pk_bf16_f32 v27, v30, v31
    ds_write_b128 v254, v[24:27] offset:12288
    v_pk_fma_f32 v[56:57], v[56:57], v[200:201], v[192:193]
    v_pk_fma_f32 v[58:59], v[58:59], v[202:203], v[194:195]
    v_pk_fma_f32 v[60:61], v[60:61], v[204:205], v[196:197]
    v_pk_fma_f32 v[62:63], v[62:63], v[206:207], v[198:199]
    v_cvt_pk_bf16_f32 v56, v56, v57
    v_cvt_pk_bf16_f32 v57, v58, v59
    v_cvt_pk_bf16_f32 v58, v60, v61
    v_cvt_pk_bf16_f32 v59, v62, v63
    ds_write_b128 v254, v[56:59] offset:13312
    v_pk_fma_f32 v[88:89], v[88:89], v[200:201], v[192:193]
    v_pk_fma_f32 v[90:91], v[90:91], v[202:203], v[194:195]
    v_pk_fma_f32 v[92:93], v[92:93], v[204:205], v[196:197]
    v_pk_fma_f32 v[94:95], v[94:95], v[206:207], v[198:199]
    v_cvt_pk_bf16_f32 v88, v88, v89
    v_cvt_pk_bf16_f32 v89, v90, v91
    v_cvt_pk_bf16_f32 v90, v92, v93
    v_cvt_pk_bf16_f32 v91, v94, v95
    ds_write_b128 v254, v[88:91] offset:14336
    v_pk_fma_f32 v[120:121], v[120:121], v[200:201], v[192:193]
    v_pk_fma_f32 v[122:123], v[122:123], v[202:203], v[194:195]
    v_pk_fma_f32 v[124:125], v[124:125], v[204:205], v[196:197]
    v_pk_fma_f32 v[126:127], v[126:127], v[206:207], v[198:199]
    v_cvt_pk_bf16_f32 v120, v120, v121
    v_cvt_pk_bf16_f32 v121, v122, v123
    v_cvt_pk_bf16_f32 v122, v124, v125
    v_cvt_pk_bf16_f32 v123, v126, v127
    ds_write_b128 v254, v[120:123] offset:15360
    s_waitcnt lgkmcnt(0)
    s_barrier
    v_xor_b32 v128, 0, v253
    v_xor_b32 v129, 32, v253
    v_xor_b32 v130, 64, v253
    v_xor_b32 v131, 96, v253
    ds_read_b128 a[164:167], v250 offset:0
    ds_read_b128 a[168:171], v250 offset:1024
    ds_read_b128 a[172:175], v250 offset:2048
    ds_read_b128 a[176:179], v250 offset:3072
    s_add_u32 m0, s36, 32768
    s_mov_b32 s39, 524288
    buffer_load_dwordx4 v252, s[24:27], s39 offen offset:0 lds
    s_mov_b32 s39, 654336
    buffer_load_dwordx4 v252, s[24:27], s39 offen offset:1024 lds
    s_mov_b32 s39, 555008
    buffer_load_dwordx4 v252, s[24:27], s39 offen offset:2048 lds
    s_mov_b32 s39, 685056
    buffer_load_dwordx4 v252, s[24:27], s39 offen offset:3072 lds
    s_add_u32 m0, s36, 36736
    s_mov_b32 s39, 524288
    buffer_load_dwordx4 v252, s[24:27], s39 offen offset:128 lds
    s_mov_b32 s39, 654336
    buffer_load_dwordx4 v252, s[24:27], s39 offen offset:1152 lds
    s_mov_b32 s39, 555008
    buffer_load_dwordx4 v252, s[24:27], s39 offen offset:2176 lds
    s_mov_b32 s39, 685056
    buffer_load_dwordx4 v252, s[24:27], s39 offen offset:3200 lds
    s_waitcnt vmcnt(20)
    ds_read_b64_tr_b16 a[132:133], v128 offset:16384
    ds_read_b64_tr_b16 a[134:135], v128 offset:18432
    ds_read_b64_tr_b16 a[136:137], v129 offset:16384
    ds_read_b64_tr_b16 a[138:139], v129 offset:18432
    ds_read_b64_tr_b16 a[140:141], v130 offset:16384
    ds_read_b64_tr_b16 a[142:143], v130 offset:18432
    ds_read_b64_tr_b16 a[144:145], v131 offset:16384
    ds_read_b64_tr_b16 a[146:147], v131 offset:18432
    ds_read_b64_tr_b16 a[148:149], v128 offset:20480
    ds_read_b64_tr_b16 a[150:151], v128 offset:22528
    ds_read_b64_tr_b16 a[152:153], v129 offset:20480
    ds_read_b64_tr_b16 a[154:155], v129 offset:22528
    ds_read_b64_tr_b16 a[156:157], v130 offset:20480
    ds_read_b64_tr_b16 a[158:159], v130 offset:22528
    ds_read_b64_tr_b16 a[160:161], v131 offset:20480
    ds_read_b64_tr_b16 a[162:163], v131 offset:22528
    s_waitcnt lgkmcnt(8)
    v_mfma_f32_16x16x32_bf16 v[0:3], a[132:135], a[164:167], 0
    ds_read_b128 a[180:183], v250 offset:4096
    v_mfma_f32_16x16x32_bf16 v[4:7], a[132:135], a[168:171], 0
    s_waitcnt vmcnt(16)
    s_add_u32 m0, s36, 16384
    s_mov_b32 s39, 786432
    v_mfma_f32_16x16x32_bf16 v[8:11], a[132:135], a[172:175], 0
    buffer_load_dwordx4 v252, s[24:27], s39 offen offset:0 lds
    v_mfma_f32_16x16x32_bf16 v[12:15], a[132:135], a[176:179], 0
    ds_read_b64_tr_b16 a[132:133], v128 offset:24576
    ds_read_b64_tr_b16 a[134:135], v128 offset:26624
    v_mfma_f32_16x16x32_bf16 v[16:19], a[136:139], a[164:167], 0
    ds_read_b128 a[184:187], v250 offset:5120
    v_mfma_f32_16x16x32_bf16 v[20:23], a[136:139], a[168:171], 0
    s_mov_b32 s39, 916480
    v_mfma_f32_16x16x32_bf16 v[24:27], a[136:139], a[172:175], 0
    buffer_load_dwordx4 v252, s[24:27], s39 offen offset:1024 lds
    v_mfma_f32_16x16x32_bf16 v[28:31], a[136:139], a[176:179], 0
    ds_read_b64_tr_b16 a[136:137], v129 offset:24576
    ds_read_b64_tr_b16 a[138:139], v129 offset:26624
    v_mfma_f32_16x16x32_bf16 v[32:35], a[140:143], a[164:167], 0
    ds_read_b128 a[188:191], v250 offset:6144
    v_mfma_f32_16x16x32_bf16 v[36:39], a[140:143], a[168:171], 0
    s_mov_b32 s39, 817152
    v_mfma_f32_16x16x32_bf16 v[40:43], a[140:143], a[172:175], 0
    buffer_load_dwordx4 v252, s[24:27], s39 offen offset:2048 lds
    v_mfma_f32_16x16x32_bf16 v[44:47], a[140:143], a[176:179], 0
    ds_read_b64_tr_b16 a[140:141], v130 offset:24576
    ds_read_b64_tr_b16 a[142:143], v130 offset:26624
    v_mfma_f32_16x16x32_bf16 v[48:51], a[144:147], a[164:167], 0
    ds_read_b128 a[192:195], v250 offset:7168
    v_mfma_f32_16x16x32_bf16 v[52:55], a[144:147], a[168:171], 0
    s_waitcnt lgkmcnt(10)
    s_mov_b32 s39, 947200
    v_mfma_f32_16x16x32_bf16 v[56:59], a[144:147], a[172:175], 0
    buffer_load_dwordx4 v252, s[24:27], s39 offen offset:3072 lds
    v_mfma_f32_16x16x32_bf16 v[60:63], a[144:147], a[176:179], 0
    ds_read_b64_tr_b16 a[144:145], v131 offset:24576
    ds_read_b64_tr_b16 a[146:147], v131 offset:26624
    v_mfma_f32_16x16x32_bf16 v[64:67], a[148:151], a[164:167], 0
    v_mfma_f32_16x16x32_bf16 v[68:71], a[148:151], a[168:171], 0
    s_waitcnt vmcnt(16)
    s_add_u32 m0, s36, 20352
    s_mov_b32 s39, 786432
    v_mfma_f32_16x16x32_bf16 v[72:75], a[148:151], a[172:175], 0
    buffer_load_dwordx4 v252, s[24:27], s39 offen offset:128 lds
    v_mfma_f32_16x16x32_bf16 v[76:79], a[148:151], a[176:179], 0
    ds_read_b64_tr_b16 a[148:149], v128 offset:28672
    ds_read_b64_tr_b16 a[150:151], v128 offset:30720
    v_mfma_f32_16x16x32_bf16 v[80:83], a[152:155], a[164:167], 0
    v_mfma_f32_16x16x32_bf16 v[84:87], a[152:155], a[168:171], 0
    s_mov_b32 s39, 916480
    v_mfma_f32_16x16x32_bf16 v[88:91], a[152:155], a[172:175], 0
    buffer_load_dwordx4 v252, s[24:27], s39 offen offset:1152 lds
    v_mfma_f32_16x16x32_bf16 v[92:95], a[152:155], a[176:179], 0
    ds_read_b64_tr_b16 a[152:153], v129 offset:28672
    ds_read_b64_tr_b16 a[154:155], v129 offset:30720
    v_mfma_f32_16x16x32_bf16 v[96:99], a[156:159], a[164:167], 0
    v_mfma_f32_16x16x32_bf16 v[100:103], a[156:159], a[168:171], 0
    s_mov_b32 s39, 817152
    v_mfma_f32_16x16x32_bf16 v[104:107], a[156:159], a[172:175], 0
    buffer_load_dwordx4 v252, s[24:27], s39 offen offset:2176 lds
    v_mfma_f32_16x16x32_bf16 v[108:111], a[156:159], a[176:179], 0
    ds_read_b64_tr_b16 a[156:157], v130 offset:28672
    ds_read_b64_tr_b16 a[158:159], v130 offset:30720
    v_mfma_f32_16x16x32_bf16 v[112:115], a[160:163], a[164:167], 0
    v_mfma_f32_16x16x32_bf16 v[116:119], a[160:163], a[168:171], 0
    s_waitcnt lgkmcnt(6)
    s_mov_b32 s39, 947200
    v_mfma_f32_16x16x32_bf16 v[120:123], a[160:163], a[172:175], 0
    buffer_load_dwordx4 v252, s[24:27], s39 offen offset:3200 lds
    v_mfma_f32_16x16x32_bf16 v[124:127], a[160:163], a[176:179], 0
    ds_read_b64_tr_b16 a[160:161], v131 offset:28672
    ds_read_b64_tr_b16 a[162:163], v131 offset:30720
    v_mfma_f32_16x16x32_bf16 v[0:3], a[132:135], a[180:183], v[0:3]
    ds_read_b128 a[164:167], v250 offset:8192
    v_mfma_f32_16x16x32_bf16 v[4:7], a[132:135], a[184:187], v[4:7]
    s_waitcnt vmcnt(12)
    s_add_u32 m0, s36, 24576
    s_mov_b32 s39, 1048576
    v_mfma_f32_16x16x32_bf16 v[8:11], a[132:135], a[188:191], v[8:11]
    buffer_load_dwordx4 v252, s[24:27], s39 offen offset:0 lds
    v_mfma_f32_16x16x32_bf16 v[12:15], a[132:135], a[192:195], v[12:15]
    ds_read_b64_tr_b16 a[132:133], v128 offset:32768
    ds_read_b64_tr_b16 a[134:135], v128 offset:34816
    v_mfma_f32_16x16x32_bf16 v[16:19], a[136:139], a[180:183], v[16:19]
    ds_read_b128 a[168:171], v250 offset:9216
    v_mfma_f32_16x16x32_bf16 v[20:23], a[136:139], a[184:187], v[20:23]
    s_mov_b32 s39, 1178624
    v_mfma_f32_16x16x32_bf16 v[24:27], a[136:139], a[188:191], v[24:27]
    buffer_load_dwordx4 v252, s[24:27], s39 offen offset:1024 lds
    v_mfma_f32_16x16x32_bf16 v[28:31], a[136:139], a[192:195], v[28:31]
    ds_read_b64_tr_b16 a[136:137], v129 offset:32768
    ds_read_b64_tr_b16 a[138:139], v129 offset:34816
    v_mfma_f32_16x16x32_bf16 v[32:35], a[140:143], a[180:183], v[32:35]
    ds_read_b128 a[172:175], v250 offset:10240
    v_mfma_f32_16x16x32_bf16 v[36:39], a[140:143], a[184:187], v[36:39]
    s_mov_b32 s39, 1079296
    v_mfma_f32_16x16x32_bf16 v[40:43], a[140:143], a[188:191], v[40:43]
    buffer_load_dwordx4 v252, s[24:27], s39 offen offset:2048 lds
    v_mfma_f32_16x16x32_bf16 v[44:47], a[140:143], a[192:195], v[44:47]
    ds_read_b64_tr_b16 a[140:141], v130 offset:32768
    ds_read_b64_tr_b16 a[142:143], v130 offset:34816
    v_mfma_f32_16x16x32_bf16 v[48:51], a[144:147], a[180:183], v[48:51]
    ds_read_b128 a[176:179], v250 offset:11264
    v_mfma_f32_16x16x32_bf16 v[52:55], a[144:147], a[184:187], v[52:55]
    s_waitcnt lgkmcnt(10)
    s_mov_b32 s39, 1209344
    v_mfma_f32_16x16x32_bf16 v[56:59], a[144:147], a[188:191], v[56:59]
    buffer_load_dwordx4 v252, s[24:27], s39 offen offset:3072 lds
    v_mfma_f32_16x16x32_bf16 v[60:63], a[144:147], a[192:195], v[60:63]
    ds_read_b64_tr_b16 a[144:145], v131 offset:32768
    ds_read_b64_tr_b16 a[146:147], v131 offset:34816
    v_mfma_f32_16x16x32_bf16 v[64:67], a[148:151], a[180:183], v[64:67]
    v_mfma_f32_16x16x32_bf16 v[68:71], a[148:151], a[184:187], v[68:71]
    s_waitcnt vmcnt(12)
    s_add_u32 m0, s36, 28544
    s_mov_b32 s39, 1048576
    v_mfma_f32_16x16x32_bf16 v[72:75], a[148:151], a[188:191], v[72:75]
    buffer_load_dwordx4 v252, s[24:27], s39 offen offset:128 lds
    v_mfma_f32_16x16x32_bf16 v[76:79], a[148:151], a[192:195], v[76:79]
    ds_read_b64_tr_b16 a[148:149], v128 offset:36864
    ds_read_b64_tr_b16 a[150:151], v128 offset:38912
    v_mfma_f32_16x16x32_bf16 v[80:83], a[152:155], a[180:183], v[80:83]
    v_mfma_f32_16x16x32_bf16 v[84:87], a[152:155], a[184:187], v[84:87]
    s_mov_b32 s39, 1178624
    v_mfma_f32_16x16x32_bf16 v[88:91], a[152:155], a[188:191], v[88:91]
    buffer_load_dwordx4 v252, s[24:27], s39 offen offset:1152 lds
    v_mfma_f32_16x16x32_bf16 v[92:95], a[152:155], a[192:195], v[92:95]
    ds_read_b64_tr_b16 a[152:153], v129 offset:36864
    ds_read_b64_tr_b16 a[154:155], v129 offset:38912
    v_mfma_f32_16x16x32_bf16 v[96:99], a[156:159], a[180:183], v[96:99]
    v_mfma_f32_16x16x32_bf16 v[100:103], a[156:159], a[184:187], v[100:103]
    s_mov_b32 s39, 1079296
    v_mfma_f32_16x16x32_bf16 v[104:107], a[156:159], a[188:191], v[104:107]
    buffer_load_dwordx4 v252, s[24:27], s39 offen offset:2176 lds
    v_mfma_f32_16x16x32_bf16 v[108:111], a[156:159], a[192:195], v[108:111]
    ds_read_b64_tr_b16 a[156:157], v130 offset:36864
    ds_read_b64_tr_b16 a[158:159], v130 offset:38912
    v_mfma_f32_16x16x32_bf16 v[112:115], a[160:163], a[180:183], v[112:115]
    v_mfma_f32_16x16x32_bf16 v[116:119], a[160:163], a[184:187], v[116:119]
    s_waitcnt lgkmcnt(6)
    s_mov_b32 s39, 1209344
    v_mfma_f32_16x16x32_bf16 v[120:123], a[160:163], a[188:191], v[120:123]
    buffer_load_dwordx4 v252, s[24:27], s39 offen offset:3200 lds
    v_mfma_f32_16x16x32_bf16 v[124:127], a[160:163], a[192:195], v[124:127]
    ds_read_b64_tr_b16 a[160:161], v131 offset:36864
    ds_read_b64_tr_b16 a[162:163], v131 offset:38912
    v_mfma_f32_16x16x32_bf16 v[0:3], a[132:135], a[164:167], v[0:3]
    ds_read_b128 a[180:183], v250 offset:12288
    v_mfma_f32_16x16x32_bf16 v[4:7], a[132:135], a[168:171], v[4:7]
    s_waitcnt vmcnt(12)
    s_add_u32 m0, s36, 32768
    s_mov_b32 s39, 1310720
    v_mfma_f32_16x16x32_bf16 v[8:11], a[132:135], a[172:175], v[8:11]
    buffer_load_dwordx4 v252, s[24:27], s39 offen offset:0 lds
    v_mfma_f32_16x16x32_bf16 v[12:15], a[132:135], a[176:179], v[12:15]
    ds_read_b64_tr_b16 a[132:133], v128 offset:16384
    ds_read_b64_tr_b16 a[134:135], v128 offset:18432
    v_mfma_f32_16x16x32_bf16 v[16:19], a[136:139], a[164:167], v[16:19]
    ds_read_b128 a[184:187], v250 offset:13312
    v_mfma_f32_16x16x32_bf16 v[20:23], a[136:139], a[168:171], v[20:23]
    s_mov_b32 s39, 1440768
    v_mfma_f32_16x16x32_bf16 v[24:27], a[136:139], a[172:175], v[24:27]
    buffer_load_dwordx4 v252, s[24:27], s39 offen offset:1024 lds
    v_mfma_f32_16x16x32_bf16 v[28:31], a[136:139], a[176:179], v[28:31]
    ds_read_b64_tr_b16 a[136:137], v129 offset:16384
    ds_read_b64_tr_b16 a[138:139], v129 offset:18432
    v_mfma_f32_16x16x32_bf16 v[32:35], a[140:143], a[164:167], v[32:35]
    ds_read_b128 a[188:191], v250 offset:14336
    v_mfma_f32_16x16x32_bf16 v[36:39], a[140:143], a[168:171], v[36:39]
    s_mov_b32 s39, 1341440
    v_mfma_f32_16x16x32_bf16 v[40:43], a[140:143], a[172:175], v[40:43]
    buffer_load_dwordx4 v252, s[24:27], s39 offen offset:2048 lds
    v_mfma_f32_16x16x32_bf16 v[44:47], a[140:143], a[176:179], v[44:47]
    ds_read_b64_tr_b16 a[140:141], v130 offset:16384
    ds_read_b64_tr_b16 a[142:143], v130 offset:18432
    v_mfma_f32_16x16x32_bf16 v[48:51], a[144:147], a[164:167], v[48:51]
    ds_read_b128 a[192:195], v250 offset:15360
    v_mfma_f32_16x16x32_bf16 v[52:55], a[144:147], a[168:171], v[52:55]
    s_waitcnt lgkmcnt(10)
    s_mov_b32 s39, 1471488
    v_mfma_f32_16x16x32_bf16 v[56:59], a[144:147], a[172:175], v[56:59]
    buffer_load_dwordx4 v252, s[24:27], s39 offen offset:3072 lds
    v_mfma_f32_16x16x32_bf16 v[60:63], a[144:147], a[176:179], v[60:63]
    ds_read_b64_tr_b16 a[144:145], v131 offset:16384
    ds_read_b64_tr_b16 a[146:147], v131 offset:18432
    v_mfma_f32_16x16x32_bf16 v[64:67], a[148:151], a[164:167], v[64:67]
    v_mfma_f32_16x16x32_bf16 v[68:71], a[148:151], a[168:171], v[68:71]
    s_waitcnt vmcnt(12)
    s_add_u32 m0, s36, 36736
    s_mov_b32 s39, 1310720
    v_mfma_f32_16x16x32_bf16 v[72:75], a[148:151], a[172:175], v[72:75]
    buffer_load_dwordx4 v252, s[24:27], s39 offen offset:128 lds
    v_mfma_f32_16x16x32_bf16 v[76:79], a[148:151], a[176:179], v[76:79]
    ds_read_b64_tr_b16 a[148:149], v128 offset:20480
    ds_read_b64_tr_b16 a[150:151], v128 offset:22528
    v_mfma_f32_16x16x32_bf16 v[80:83], a[152:155], a[164:167], v[80:83]
    v_mfma_f32_16x16x32_bf16 v[84:87], a[152:155], a[168:171], v[84:87]
    s_mov_b32 s39, 1440768
    v_mfma_f32_16x16x32_bf16 v[88:91], a[152:155], a[172:175], v[88:91]
    buffer_load_dwordx4 v252, s[24:27], s39 offen offset:1152 lds
    v_mfma_f32_16x16x32_bf16 v[92:95], a[152:155], a[176:179], v[92:95]
    ds_read_b64_tr_b16 a[152:153], v129 offset:20480
    ds_read_b64_tr_b16 a[154:155], v129 offset:22528
    v_mfma_f32_16x16x32_bf16 v[96:99], a[156:159], a[164:167], v[96:99]
    v_mfma_f32_16x16x32_bf16 v[100:103], a[156:159], a[168:171], v[100:103]
    s_mov_b32 s39, 1341440
    v_mfma_f32_16x16x32_bf16 v[104:107], a[156:159], a[172:175], v[104:107]
    buffer_load_dwordx4 v252, s[24:27], s39 offen offset:2176 lds
    v_mfma_f32_16x16x32_bf16 v[108:111], a[156:159], a[176:179], v[108:111]
    ds_read_b64_tr_b16 a[156:157], v130 offset:20480
    ds_read_b64_tr_b16 a[158:159], v130 offset:22528
    v_mfma_f32_16x16x32_bf16 v[112:115], a[160:163], a[164:167], v[112:115]
    v_mfma_f32_16x16x32_bf16 v[116:119], a[160:163], a[168:171], v[116:119]
    s_waitcnt lgkmcnt(6)
    s_mov_b32 s39, 1471488
    v_mfma_f32_16x16x32_bf16 v[120:123], a[160:163], a[172:175], v[120:123]
    buffer_load_dwordx4 v252, s[24:27], s39 offen offset:3200 lds
    v_mfma_f32_16x16x32_bf16 v[124:127], a[160:163], a[176:179], v[124:127]
    ds_read_b64_tr_b16 a[160:161], v131 offset:20480
    ds_read_b64_tr_b16 a[162:163], v131 offset:22528
    v_mfma_f32_16x16x32_bf16 v[0:3], a[132:135], a[180:183], v[0:3]
    ds_read_b128 a[164:167], v250 offset:40960
    v_accvgpr_read_b32 v144, a200
    v_mfma_f32_16x16x32_bf16 v[4:7], a[132:135], a[184:187], v[4:7]
    s_waitcnt vmcnt(12)
    s_add_u32 m0, s36, 16384
    s_mov_b32 s39, 1572864
    v_and_b32 v147, 0xffff0000, v144
    v_mfma_f32_16x16x32_bf16 v[8:11], a[132:135], a[188:191], v[8:11]
    buffer_load_dwordx4 v252, s[24:27], s39 offen offset:0 lds
    v_mfma_f32_16x16x32_bf16 v[12:15], a[132:135], a[192:195], v[12:15]
    ds_read_b64_tr_b16 a[132:133], v128 offset:24576
    ds_read_b64_tr_b16 a[134:135], v128 offset:26624
    v_mfma_f32_16x16x32_bf16 v[16:19], a[136:139], a[180:183], v[16:19]
    ds_read_b128 a[168:171], v250 offset:41984
    v_lshlrev_b32 v146, 16, v144
    v_mfma_f32_16x16x32_bf16 v[20:23], a[136:139], a[184:187], v[20:23]
    s_mov_b32 s39, 1702912
    v_pk_mul_f32 v[136:137], v[146:147], v[228:229] op_sel_hi:[1,0]
    v_mfma_f32_16x16x32_bf16 v[24:27], a[136:139], a[188:191], v[24:27]
    buffer_load_dwordx4 v252, s[24:27], s39 offen offset:1024 lds
    v_mfma_f32_16x16x32_bf16 v[28:31], a[136:139], a[192:195], v[28:31]
    ds_read_b64_tr_b16 a[136:137], v129 offset:24576
    ds_read_b64_tr_b16 a[138:139], v129 offset:26624
    v_mfma_f32_16x16x32_bf16 v[32:35], a[140:143], a[180:183], v[32:35]
    ds_read_b128 a[172:175], v250 offset:43008
    v_accvgpr_read_b32 v148, a201
    v_mfma_f32_16x16x32_bf16 v[36:39], a[140:143], a[184:187], v[36:39]
    s_mov_b32 s39, 1603584
    v_and_b32 v151, 0xffff0000, v148
    v_mfma_f32_16x16x32_bf16 v[40:43], a[140:143], a[188:191], v[40:43]
    buffer_load_dwordx4 v252, s[24:27], s39 offen offset:2048 lds
    v_mfma_f32_16x16x32_bf16 v[44:47], a[140:143], a[192:195], v[44:47]
    ds_read_b64_tr_b16 a[140:141], v130 offset:24576
    ds_read_b64_tr_b16 a[142:143], v130 offset:26624
    v_mfma_f32_16x16x32_bf16 v[48:51], a[144:147], a[180:183], v[48:51]
    ds_read_b128 a[176:179], v250 offset:44032
    v_lshlrev_b32 v150, 16, v148
    v_mfma_f32_16x16x32_bf16 v[52:55], a[144:147], a[184:187], v[52:55]
    s_waitcnt lgkmcnt(10)
    s_mov_b32 s39, 1733632
    v_pk_mul_f32 v[138:139], v[150:151], v[228:229] op_sel_hi:[1,0]
    v_mfma_f32_16x16x32_bf16 v[56:59], a[144:147], a[188:191], v[56:59]
    buffer_load_dwordx4 v252, s[24:27], s39 offen offset:3072 lds
    v_mfma_f32_16x16x32_bf16 v[60:63], a[144:147], a[192:195], v[60:63]
    ds_read_b64_tr_b16 a[144:145], v131 offset:24576
    ds_read_b64_tr_b16 a[146:147], v131 offset:26624
    v_mfma_f32_16x16x32_bf16 v[64:67], a[148:151], a[180:183], v[64:67]
    v_accvgpr_read_b32 v144, a202
    v_mfma_f32_16x16x32_bf16 v[68:71], a[148:151], a[184:187], v[68:71]
    s_waitcnt vmcnt(12)
    s_add_u32 m0, s36, 20352
    s_mov_b32 s39, 1572864
    v_and_b32 v147, 0xffff0000, v144
    v_mfma_f32_16x16x32_bf16 v[72:75], a[148:151], a[188:191], v[72:75]
    buffer_load_dwordx4 v252, s[24:27], s39 offen offset:128 lds
    v_mfma_f32_16x16x32_bf16 v[76:79], a[148:151], a[192:195], v[76:79]
    ds_read_b64_tr_b16 a[148:149], v128 offset:28672
    ds_read_b64_tr_b16 a[150:151], v128 offset:30720
    v_mfma_f32_16x16x32_bf16 v[80:83], a[152:155], a[180:183], v[80:83]
    v_lshlrev_b32 v146, 16, v144
    v_mfma_f32_16x16x32_bf16 v[84:87], a[152:155], a[184:187], v[84:87]
    s_mov_b32 s39, 1702912
    v_pk_mul_f32 v[140:141], v[146:147], v[228:229] op_sel_hi:[1,0]
    v_mfma_f32_16x16x32_bf16 v[88:91], a[152:155], a[188:191], v[88:91]
    buffer_load_dwordx4 v252, s[24:27], s39 offen offset:1152 lds
    v_mfma_f32_16x16x32_bf16 v[92:95], a[152:155], a[192:195], v[92:95]
    ds_read_b64_tr_b16 a[152:153], v129 offset:28672
    ds_read_b64_tr_b16 a[154:155], v129 offset:30720
    v_mfma_f32_16x16x32_bf16 v[96:99], a[156:159], a[180:183], v[96:99]
    v_accvgpr_read_b32 v148, a203
    v_mfma_f32_16x16x32_bf16 v[100:103], a[156:159], a[184:187], v[100:103]
    s_mov_b32 s39, 1603584
    v_and_b32 v151, 0xffff0000, v148
    v_mfma_f32_16x16x32_bf16 v[104:107], a[156:159], a[188:191], v[104:107]
    buffer_load_dwordx4 v252, s[24:27], s39 offen offset:2176 lds
    v_mfma_f32_16x16x32_bf16 v[108:111], a[156:159], a[192:195], v[108:111]
    ds_read_b64_tr_b16 a[156:157], v130 offset:28672
    ds_read_b64_tr_b16 a[158:159], v130 offset:30720
    v_mfma_f32_16x16x32_bf16 v[112:115], a[160:163], a[180:183], v[112:115]
    v_lshlrev_b32 v150, 16, v148
    v_mfma_f32_16x16x32_bf16 v[116:119], a[160:163], a[184:187], v[116:119]
    s_waitcnt lgkmcnt(6)
    s_mov_b32 s39, 1733632
    v_pk_mul_f32 v[142:143], v[150:151], v[228:229] op_sel_hi:[1,0]
    v_mfma_f32_16x16x32_bf16 v[120:123], a[160:163], a[188:191], v[120:123]
    buffer_load_dwordx4 v252, s[24:27], s39 offen offset:3200 lds
    v_mfma_f32_16x16x32_bf16 v[124:127], a[160:163], a[192:195], v[124:127]
    ds_read_b64_tr_b16 a[160:161], v131 offset:28672
    ds_read_b64_tr_b16 a[162:163], v131 offset:30720
    v_mfma_f32_16x16x32_bf16 v[0:3], a[132:135], a[164:167], v[0:3]
    ds_read_b128 a[180:183], v250 offset:45056
    v_accvgpr_read_b32 v144, a204
    v_mfma_f32_16x16x32_bf16 v[4:7], a[132:135], a[168:171], v[4:7]
    s_waitcnt vmcnt(12)
    s_add_u32 m0, s36, 24576
    s_mov_b32 s39, 1835008
    v_and_b32 v147, 0xffff0000, v144
    v_mfma_f32_16x16x32_bf16 v[8:11], a[132:135], a[172:175], v[8:11]
    buffer_load_dwordx4 v252, s[24:27], s39 offen offset:0 lds
    v_mfma_f32_16x16x32_bf16 v[12:15], a[132:135], a[176:179], v[12:15]
    ds_read_b64_tr_b16 a[132:133], v128 offset:32768
    ds_read_b64_tr_b16 a[134:135], v128 offset:34816
    v_mfma_f32_16x16x32_bf16 v[16:19], a[136:139], a[164:167], v[16:19]
    ds_read_b128 a[184:187], v250 offset:46080
    v_lshlrev_b32 v146, 16, v144
    v_mfma_f32_16x16x32_bf16 v[20:23], a[136:139], a[168:171], v[20:23]
    s_mov_b32 s39, 1965056
    v_fmac_f32 v136, v146, v229
    v_mfma_f32_16x16x32_bf16 v[24:27], a[136:139], a[172:175], v[24:27]
    buffer_load_dwordx4 v252, s[24:27], s39 offen offset:1024 lds
    v_mfma_f32_16x16x32_bf16 v[28:31], a[136:139], a[176:179], v[28:31]
    ds_read_b64_tr_b16 a[136:137], v129 offset:32768
    ds_read_b64_tr_b16 a[138:139], v129 offset:34816
    v_mfma_f32_16x16x32_bf16 v[32:35], a[140:143], a[164:167], v[32:35]
    ds_read_b128 a[188:191], v250 offset:47104
    v_fmac_f32 v137, v147, v229
    v_mfma_f32_16x16x32_bf16 v[36:39], a[140:143], a[168:171], v[36:39]
    s_mov_b32 s39, 1865728
    v_accvgpr_read_b32 v148, a205
    v_mfma_f32_16x16x32_bf16 v[40:43], a[140:143], a[172:175], v[40:43]
    buffer_load_dwordx4 v252, s[24:27], s39 offen offset:2048 lds
    v_mfma_f32_16x16x32_bf16 v[44:47], a[140:143], a[176:179], v[44:47]
    ds_read_b64_tr_b16 a[140:141], v130 offset:32768
    ds_read_b64_tr_b16 a[142:143], v130 offset:34816
    v_mfma_f32_16x16x32_bf16 v[48:51], a[144:147], a[164:167], v[48:51]
    ds_read_b128 a[192:195], v250 offset:48128
    v_and_b32 v151, 0xffff0000, v148
    v_mfma_f32_16x16x32_bf16 v[52:55], a[144:147], a[168:171], v[52:55]
    s_waitcnt lgkmcnt(10)
    s_mov_b32 s39, 1995776
    v_lshlrev_b32 v150, 16, v148
    v_mfma_f32_16x16x32_bf16 v[56:59], a[144:147], a[172:175], v[56:59]
    buffer_load_dwordx4 v252, s[24:27], s39 offen offset:3072 lds
    v_mfma_f32_16x16x32_bf16 v[60:63], a[144:147], a[176:179], v[60:63]
    ds_read_b64_tr_b16 a[144:145], v131 offset:32768
    ds_read_b64_tr_b16 a[146:147], v131 offset:34816
    v_mfma_f32_16x16x32_bf16 v[64:67], a[148:151], a[164:167], v[64:67]
    v_fmac_f32 v138, v150, v229
    v_mfma_f32_16x16x32_bf16 v[68:71], a[148:151], a[168:171], v[68:71]
    s_waitcnt vmcnt(12)
    s_add_u32 m0, s36, 28544
    s_mov_b32 s39, 1835008
    v_fmac_f32 v139, v151, v229
    v_mfma_f32_16x16x32_bf16 v[72:75], a[148:151], a[172:175], v[72:75]
    buffer_load_dwordx4 v252, s[24:27], s39 offen offset:128 lds
    v_mfma_f32_16x16x32_bf16 v[76:79], a[148:151], a[176:179], v[76:79]
    ds_read_b64_tr_b16 a[148:149], v128 offset:36864
    ds_read_b64_tr_b16 a[150:151], v128 offset:38912
    v_mfma_f32_16x16x32_bf16 v[80:83], a[152:155], a[164:167], v[80:83]
    v_accvgpr_read_b32 v144, a206
    v_mfma_f32_16x16x32_bf16 v[84:87], a[152:155], a[168:171], v[84:87]
    s_mov_b32 s39, 1965056
    v_and_b32 v147, 0xffff0000, v144
    v_mfma_f32_16x16x32_bf16 v[88:91], a[152:155], a[172:175], v[88:91]
    buffer_load_dwordx4 v252, s[24:27], s39 offen offset:1152 lds
    v_mfma_f32_16x16x32_bf16 v[92:95], a[152:155], a[176:179], v[92:95]
    ds_read_b64_tr_b16 a[152:153], v129 offset:36864
    ds_read_b64_tr_b16 a[154:155], v129 offset:38912
    v_mfma_f32_16x16x32_bf16 v[96:99], a[156:159], a[164:167], v[96:99]
    v_lshlrev_b32 v146, 16, v144
    v_mfma_f32_16x16x32_bf16 v[100:103], a[156:159], a[168:171], v[100:103]
    s_mov_b32 s39, 1865728
    v_fmac_f32 v140, v146, v229
    v_mfma_f32_16x16x32_bf16 v[104:107], a[156:159], a[172:175], v[104:107]
    buffer_load_dwordx4 v252, s[24:27], s39 offen offset:2176 lds
    v_mfma_f32_16x16x32_bf16 v[108:111], a[156:159], a[176:179], v[108:111]
    ds_read_b64_tr_b16 a[156:157], v130 offset:36864
    ds_read_b64_tr_b16 a[158:159], v130 offset:38912
    v_mfma_f32_16x16x32_bf16 v[112:115], a[160:163], a[164:167], v[112:115]
    v_fmac_f32 v141, v147, v229
    v_mfma_f32_16x16x32_bf16 v[116:119], a[160:163], a[168:171], v[116:119]
    s_waitcnt lgkmcnt(6)
    s_mov_b32 s39, 1995776
    v_accvgpr_read_b32 v148, a207
    v_mfma_f32_16x16x32_bf16 v[120:123], a[160:163], a[172:175], v[120:123]
    buffer_load_dwordx4 v252, s[24:27], s39 offen offset:3200 lds
    v_mfma_f32_16x16x32_bf16 v[124:127], a[160:163], a[176:179], v[124:127]
    ds_read_b64_tr_b16 a[160:161], v131 offset:36864
    ds_read_b64_tr_b16 a[162:163], v131 offset:38912
    v_mfma_f32_16x16x32_bf16 v[0:3], a[132:135], a[180:183], v[0:3]
    ds_read_b128 a[164:167], v250 offset:49152
    v_and_b32 v151, 0xffff0000, v148
    v_mfma_f32_16x16x32_bf16 v[4:7], a[132:135], a[184:187], v[4:7]
    s_waitcnt vmcnt(12)
    s_add_u32 m0, s36, 32768
    s_mov_b32 s39, 2097152
    v_lshlrev_b32 v150, 16, v148
    v_mfma_f32_16x16x32_bf16 v[8:11], a[132:135], a[188:191], v[8:11]
    buffer_load_dwordx4 v252, s[24:27], s39 offen offset:0 lds
    v_mfma_f32_16x16x32_bf16 v[12:15], a[132:135], a[192:195], v[12:15]
    ds_read_b64_tr_b16 a[132:133], v128 offset:16384
    ds_read_b64_tr_b16 a[134:135], v128 offset:18432
    v_mfma_f32_16x16x32_bf16 v[16:19], a[136:139], a[180:183], v[16:19]
    ds_read_b128 a[168:171], v250 offset:50176
    v_fmac_f32 v142, v150, v229
    v_mfma_f32_16x16x32_bf16 v[20:23], a[136:139], a[184:187], v[20:23]
    s_mov_b32 s39, 2227200
    v_fmac_f32 v143, v151, v229
    v_mfma_f32_16x16x32_bf16 v[24:27], a[136:139], a[188:191], v[24:27]
    buffer_load_dwordx4 v252, s[24:27], s39 offen offset:1024 lds
    v_mfma_f32_16x16x32_bf16 v[28:31], a[136:139], a[192:195], v[28:31]
    ds_read_b64_tr_b16 a[136:137], v129 offset:16384
    ds_read_b64_tr_b16 a[138:139], v129 offset:18432
    v_mfma_f32_16x16x32_bf16 v[32:35], a[140:143], a[180:183], v[32:35]
    ds_read_b128 a[172:175], v250 offset:51200
    v_accvgpr_read_b32 v144, a208
    v_mfma_f32_16x16x32_bf16 v[36:39], a[140:143], a[184:187], v[36:39]
    s_mov_b32 s39, 2127872
    v_and_b32 v147, 0xffff0000, v144
    v_mfma_f32_16x16x32_bf16 v[40:43], a[140:143], a[188:191], v[40:43]
    buffer_load_dwordx4 v252, s[24:27], s39 offen offset:2048 lds
    v_mfma_f32_16x16x32_bf16 v[44:47], a[140:143], a[192:195], v[44:47]
    ds_read_b64_tr_b16 a[140:141], v130 offset:16384
    ds_read_b64_tr_b16 a[142:143], v130 offset:18432
    v_mfma_f32_16x16x32_bf16 v[48:51], a[144:147], a[180:183], v[48:51]
    ds_read_b128 a[176:179], v250 offset:52224
    v_lshlrev_b32 v146, 16, v144
    v_mfma_f32_16x16x32_bf16 v[52:55], a[144:147], a[184:187], v[52:55]
    s_waitcnt lgkmcnt(10)
    s_mov_b32 s39, 2257920
    v_pk_fma_f32 v[136:137], v[146:147], v[230:231], v[136:137] op_sel_hi:[1,0,1]
    v_mfma_f32_16x16x32_bf16 v[56:59], a[144:147], a[188:191], v[56:59]
    buffer_load_dwordx4 v252, s[24:27], s39 offen offset:3072 lds
    v_mfma_f32_16x16x32_bf16 v[60:63], a[144:147], a[192:195], v[60:63]
    ds_read_b64_tr_b16 a[144:145], v131 offset:16384
    ds_read_b64_tr_b16 a[146:147], v131 offset:18432
    v_mfma_f32_16x16x32_bf16 v[64:67], a[148:151], a[180:183], v[64:67]
    v_accvgpr_read_b32 v148, a209
    v_mfma_f32_16x16x32_bf16 v[68:71], a[148:151], a[184:187], v[68:71]
    s_waitcnt vmcnt(12)
    s_add_u32 m0, s36, 36736
    s_mov_b32 s39, 2097152
    v_and_b32 v151, 0xffff0000, v148
    v_mfma_f32_16x16x32_bf16 v[72:75], a[148:151], a[188:191], v[72:75]
    buffer_load_dwordx4 v252, s[24:27], s39 offen offset:128 lds
    v_mfma_f32_16x16x32_bf16 v[76:79], a[148:151], a[192:195], v[76:79]
    ds_read_b64_tr_b16 a[148:149], v128 offset:20480
    ds_read_b64_tr_b16 a[150:151], v128 offset:22528
    v_mfma_f32_16x16x32_bf16 v[80:83], a[152:155], a[180:183], v[80:83]
    v_lshlrev_b32 v150, 16, v148
    v_mfma_f32_16x16x32_bf16 v[84:87], a[152:155], a[184:187], v[84:87]
    s_mov_b32 s39, 2227200
    v_pk_fma_f32 v[138:139], v[150:151], v[230:231], v[138:139] op_sel_hi:[1,0,1]
    v_mfma_f32_16x16x32_bf16 v[88:91], a[152:155], a[188:191], v[88:91]
    buffer_load_dwordx4 v252, s[24:27], s39 offen offset:1152 lds
    v_mfma_f32_16x16x32_bf16 v[92:95], a[152:155], a[192:195], v[92:95]
    ds_read_b64_tr_b16 a[152:153], v129 offset:20480
    ds_read_b64_tr_b16 a[154:155], v129 offset:22528
    v_mfma_f32_16x16x32_bf16 v[96:99], a[156:159], a[180:183], v[96:99]
    v_accvgpr_read_b32 v144, a210
    v_mfma_f32_16x16x32_bf16 v[100:103], a[156:159], a[184:187], v[100:103]
    s_mov_b32 s39, 2127872
    v_and_b32 v147, 0xffff0000, v144
    v_mfma_f32_16x16x32_bf16 v[104:107], a[156:159], a[188:191], v[104:107]
    buffer_load_dwordx4 v252, s[24:27], s39 offen offset:2176 lds
    v_mfma_f32_16x16x32_bf16 v[108:111], a[156:159], a[192:195], v[108:111]
    ds_read_b64_tr_b16 a[156:157], v130 offset:20480
    ds_read_b64_tr_b16 a[158:159], v130 offset:22528
    v_mfma_f32_16x16x32_bf16 v[112:115], a[160:163], a[180:183], v[112:115]
    v_lshlrev_b32 v146, 16, v144
    v_mfma_f32_16x16x32_bf16 v[116:119], a[160:163], a[184:187], v[116:119]
    s_waitcnt lgkmcnt(6)
    s_mov_b32 s39, 2257920
    v_pk_fma_f32 v[140:141], v[146:147], v[230:231], v[140:141] op_sel_hi:[1,0,1]
    v_mfma_f32_16x16x32_bf16 v[120:123], a[160:163], a[188:191], v[120:123]
    buffer_load_dwordx4 v252, s[24:27], s39 offen offset:3200 lds
    v_mfma_f32_16x16x32_bf16 v[124:127], a[160:163], a[192:195], v[124:127]
    ds_read_b64_tr_b16 a[160:161], v131 offset:20480
    ds_read_b64_tr_b16 a[162:163], v131 offset:22528
    v_mfma_f32_16x16x32_bf16 v[0:3], a[132:135], a[164:167], v[0:3]
    ds_read_b128 a[180:183], v250 offset:53248
    v_accvgpr_read_b32 v148, a211
    v_mfma_f32_16x16x32_bf16 v[4:7], a[132:135], a[168:171], v[4:7]
    s_waitcnt vmcnt(12)
    s_add_u32 m0, s36, 16384
    s_mov_b32 s39, 2359296
    v_and_b32 v151, 0xffff0000, v148
    v_mfma_f32_16x16x32_bf16 v[8:11], a[132:135], a[172:175], v[8:11]
    buffer_load_dwordx4 v252, s[24:27], s39 offen offset:0 lds
    v_mfma_f32_16x16x32_bf16 v[12:15], a[132:135], a[176:179], v[12:15]
    ds_read_b64_tr_b16 a[132:133], v128 offset:24576
    ds_read_b64_tr_b16 a[134:135], v128 offset:26624
    v_mfma_f32_16x16x32_bf16 v[16:19], a[136:139], a[164:167], v[16:19]
    ds_read_b128 a[184:187], v250 offset:54272
    v_lshlrev_b32 v150, 16, v148
    v_mfma_f32_16x16x32_bf16 v[20:23], a[136:139], a[168:171], v[20:23]
    s_mov_b32 s39, 2489344
    v_pk_fma_f32 v[142:143], v[150:151], v[230:231], v[142:143] op_sel_hi:[1,0,1]
    v_mfma_f32_16x16x32_bf16 v[24:27], a[136:139], a[172:175], v[24:27]
    buffer_load_dwordx4 v252, s[24:27], s39 offen offset:1024 lds
    v_mfma_f32_16x16x32_bf16 v[28:31], a[136:139], a[176:179], v[28:31]
    ds_read_b64_tr_b16 a[136:137], v129 offset:24576
    ds_read_b64_tr_b16 a[138:139], v129 offset:26624
    v_mfma_f32_16x16x32_bf16 v[32:35], a[140:143], a[164:167], v[32:35]
    ds_read_b128 a[188:191], v250 offset:55296
    v_accvgpr_read_b32 v144, a212
    v_mfma_f32_16x16x32_bf16 v[36:39], a[140:143], a[168:171], v[36:39]
    s_mov_b32 s39, 2390016
    v_and_b32 v147, 0xffff0000, v144
    v_mfma_f32_16x16x32_bf16 v[40:43], a[140:143], a[172:175], v[40:43]
    buffer_load_dwordx4 v252, s[24:27], s39 offen offset:2048 lds
    v_mfma_f32_16x16x32_bf16 v[44:47], a[140:143], a[176:179], v[44:47]
    ds_read_b64_tr_b16 a[140:141], v130 offset:24576
    ds_read_b64_tr_b16 a[142:143], v130 offset:26624
    v_mfma_f32_16x16x32_bf16 v[48:51], a[144:147], a[164:167], v[48:51]
    ds_read_b128 a[192:195], v250 offset:56320
    v_lshlrev_b32 v146, 16, v144
    v_mfma_f32_16x16x32_bf16 v[52:55], a[144:147], a[168:171], v[52:55]
    s_waitcnt lgkmcnt(10)
    s_mov_b32 s39, 2520064
    v_fmac_f32 v136, v146, v231
    v_mfma_f32_16x16x32_bf16 v[56:59], a[144:147], a[172:175], v[56:59]
    buffer_load_dwordx4 v252, s[24:27], s39 offen offset:3072 lds
    v_mfma_f32_16x16x32_bf16 v[60:63], a[144:147], a[176:179], v[60:63]
    ds_read_b64_tr_b16 a[144:145], v131 offset:24576
    ds_read_b64_tr_b16 a[146:147], v131 offset:26624
    v_mfma_f32_16x16x32_bf16 v[64:67], a[148:151], a[164:167], v[64:67]
    v_fmac_f32 v137, v147, v231
    v_mfma_f32_16x16x32_bf16 v[68:71], a[148:151], a[168:171], v[68:71]
    s_waitcnt vmcnt(12)
    s_add_u32 m0, s36, 20352
    s_mov_b32 s39, 2359296
    v_accvgpr_read_b32 v148, a213
    v_mfma_f32_16x16x32_bf16 v[72:75], a[148:151], a[172:175], v[72:75]
    buffer_load_dwordx4 v252, s[24:27], s39 offen offset:128 lds
    v_mfma_f32_16x16x32_bf16 v[76:79], a[148:151], a[176:179], v[76:79]
    ds_read_b64_tr_b16 a[148:149], v128 offset:28672
    ds_read_b64_tr_b16 a[150:151], v128 offset:30720
    v_mfma_f32_16x16x32_bf16 v[80:83], a[152:155], a[164:167], v[80:83]
    v_and_b32 v151, 0xffff0000, v148
    v_mfma_f32_16x16x32_bf16 v[84:87], a[152:155], a[168:171], v[84:87]
    s_mov_b32 s39, 2489344
    v_lshlrev_b32 v150, 16, v148
    v_mfma_f32_16x16x32_bf16 v[88:91], a[152:155], a[172:175], v[88:91]
    buffer_load_dwordx4 v252, s[24:27], s39 offen offset:1152 lds
    v_mfma_f32_16x16x32_bf16 v[92:95], a[152:155], a[176:179], v[92:95]
    ds_read_b64_tr_b16 a[152:153], v129 offset:28672
    ds_read_b64_tr_b16 a[154:155], v129 offset:30720
    v_mfma_f32_16x16x32_bf16 v[96:99], a[156:159], a[164:167], v[96:99]
    v_fmac_f32 v138, v150, v231
    v_mfma_f32_16x16x32_bf16 v[100:103], a[156:159], a[168:171], v[100:103]
    s_mov_b32 s39, 2390016
    v_fmac_f32 v139, v151, v231
    v_mfma_f32_16x16x32_bf16 v[104:107], a[156:159], a[172:175], v[104:107]
    buffer_load_dwordx4 v252, s[24:27], s39 offen offset:2176 lds
    v_mfma_f32_16x16x32_bf16 v[108:111], a[156:159], a[176:179], v[108:111]
    ds_read_b64_tr_b16 a[156:157], v130 offset:28672
    ds_read_b64_tr_b16 a[158:159], v130 offset:30720
    v_mfma_f32_16x16x32_bf16 v[112:115], a[160:163], a[164:167], v[112:115]
    v_accvgpr_read_b32 v144, a214
    v_mfma_f32_16x16x32_bf16 v[116:119], a[160:163], a[168:171], v[116:119]
    s_waitcnt lgkmcnt(6)
    s_mov_b32 s39, 2520064
    v_and_b32 v147, 0xffff0000, v144
    v_mfma_f32_16x16x32_bf16 v[120:123], a[160:163], a[172:175], v[120:123]
    buffer_load_dwordx4 v252, s[24:27], s39 offen offset:3200 lds
    v_mfma_f32_16x16x32_bf16 v[124:127], a[160:163], a[176:179], v[124:127]
    ds_read_b64_tr_b16 a[160:161], v131 offset:28672
    ds_read_b64_tr_b16 a[162:163], v131 offset:30720
    v_mfma_f32_16x16x32_bf16 v[0:3], a[132:135], a[180:183], v[0:3]
    ds_read_b128 a[164:167], v251 offset:0
    v_lshlrev_b32 v146, 16, v144
    v_mfma_f32_16x16x32_bf16 v[4:7], a[132:135], a[184:187], v[4:7]
    s_waitcnt vmcnt(12)
    s_add_u32 m0, s36, 24576
    s_mov_b32 s39, 2621440
    v_fmac_f32 v140, v146, v231
    v_mfma_f32_16x16x32_bf16 v[8:11], a[132:135], a[188:191], v[8:11]
    buffer_load_dwordx4 v252, s[24:27], s39 offen offset:0 lds
    v_mfma_f32_16x16x32_bf16 v[12:15], a[132:135], a[192:195], v[12:15]
    ds_read_b64_tr_b16 a[132:133], v128 offset:32768
    ds_read_b64_tr_b16 a[134:135], v128 offset:34816
    v_mfma_f32_16x16x32_bf16 v[16:19], a[136:139], a[180:183], v[16:19]
    ds_read_b128 a[168:171], v251 offset:1024
    v_fmac_f32 v141, v147, v231
    v_mfma_f32_16x16x32_bf16 v[20:23], a[136:139], a[184:187], v[20:23]
    s_mov_b32 s39, 2751488
    v_accvgpr_read_b32 v148, a215
    v_mfma_f32_16x16x32_bf16 v[24:27], a[136:139], a[188:191], v[24:27]
    buffer_load_dwordx4 v252, s[24:27], s39 offen offset:1024 lds
    v_mfma_f32_16x16x32_bf16 v[28:31], a[136:139], a[192:195], v[28:31]
    ds_read_b64_tr_b16 a[136:137], v129 offset:32768
    ds_read_b64_tr_b16 a[138:139], v129 offset:34816
    v_mfma_f32_16x16x32_bf16 v[32:35], a[140:143], a[180:183], v[32:35]
    ds_read_b128 a[172:175], v251 offset:2048
    v_and_b32 v151, 0xffff0000, v148
    v_mfma_f32_16x16x32_bf16 v[36:39], a[140:143], a[184:187], v[36:39]
    s_mov_b32 s39, 2652160
    v_lshlrev_b32 v150, 16, v148
    v_mfma_f32_16x16x32_bf16 v[40:43], a[140:143], a[188:191], v[40:43]
    buffer_load_dwordx4 v252, s[24:27], s39 offen offset:2048 lds
    v_mfma_f32_16x16x32_bf16 v[44:47], a[140:143], a[192:195], v[44:47]
    ds_read_b64_tr_b16 a[140:141], v130 offset:32768
    ds_read_b64_tr_b16 a[142:143], v130 offset:34816
    v_mfma_f32_16x16x32_bf16 v[48:51], a[144:147], a[180:183], v[48:51]
    ds_read_b128 a[176:179], v251 offset:3072
    v_fmac_f32 v142, v150, v231
    v_mfma_f32_16x16x32_bf16 v[52:55], a[144:147], a[184:187], v[52:55]
    s_waitcnt lgkmcnt(10)
    s_mov_b32 s39, 2782208
    v_fmac_f32 v143, v151, v231
    v_mfma_f32_16x16x32_bf16 v[56:59], a[144:147], a[188:191], v[56:59]
    buffer_load_dwordx4 v252, s[24:27], s39 offen offset:3072 lds
    v_mfma_f32_16x16x32_bf16 v[60:63], a[144:147], a[192:195], v[60:63]
    ds_read_b64_tr_b16 a[144:145], v131 offset:32768
    ds_read_b64_tr_b16 a[146:147], v131 offset:34816
    v_mfma_f32_16x16x32_bf16 v[64:67], a[148:151], a[180:183], v[64:67]
    v_permlane32_swap_b32 v136, v140
    v_mfma_f32_16x16x32_bf16 v[68:71], a[148:151], a[184:187], v[68:71]
    s_waitcnt vmcnt(12)
    s_add_u32 m0, s36, 28544
    s_mov_b32 s39, 2621440
    v_permlane32_swap_b32 v137, v141
    v_mfma_f32_16x16x32_bf16 v[72:75], a[148:151], a[188:191], v[72:75]
    buffer_load_dwordx4 v252, s[24:27], s39 offen offset:128 lds
    v_mfma_f32_16x16x32_bf16 v[76:79], a[148:151], a[192:195], v[76:79]
    ds_read_b64_tr_b16 a[148:149], v128 offset:36864
    ds_read_b64_tr_b16 a[150:151], v128 offset:38912
    v_mfma_f32_16x16x32_bf16 v[80:83], a[152:155], a[180:183], v[80:83]
    v_permlane32_swap_b32 v138, v142
    v_mfma_f32_16x16x32_bf16 v[84:87], a[152:155], a[184:187], v[84:87]
    s_mov_b32 s39, 2751488
    v_permlane32_swap_b32 v139, v143
    v_mfma_f32_16x16x32_bf16 v[88:91], a[152:155], a[188:191], v[88:91]
    buffer_load_dwordx4 v252, s[24:27], s39 offen offset:1152 lds
    v_mfma_f32_16x16x32_bf16 v[92:95], a[152:155], a[192:195], v[92:95]
    ds_read_b64_tr_b16 a[152:153], v129 offset:36864
    ds_read_b64_tr_b16 a[154:155], v129 offset:38912
    v_mfma_f32_16x16x32_bf16 v[96:99], a[156:159], a[180:183], v[96:99]
    v_add_f32 v136, v136, v140
    v_mfma_f32_16x16x32_bf16 v[100:103], a[156:159], a[184:187], v[100:103]
    s_mov_b32 s39, 2652160
    v_add_f32 v137, v137, v141
    v_mfma_f32_16x16x32_bf16 v[104:107], a[156:159], a[188:191], v[104:107]
    buffer_load_dwordx4 v252, s[24:27], s39 offen offset:2176 lds
    v_mfma_f32_16x16x32_bf16 v[108:111], a[156:159], a[192:195], v[108:111]
    ds_read_b64_tr_b16 a[156:157], v130 offset:36864
    ds_read_b64_tr_b16 a[158:159], v130 offset:38912
    v_mfma_f32_16x16x32_bf16 v[112:115], a[160:163], a[180:183], v[112:115]
    v_add_f32 v138, v138, v142
    v_mfma_f32_16x16x32_bf16 v[116:119], a[160:163], a[184:187], v[116:119]
    s_waitcnt lgkmcnt(6)
    s_mov_b32 s39, 2782208
    v_add_f32 v139, v139, v143
    v_mfma_f32_16x16x32_bf16 v[120:123], a[160:163], a[188:191], v[120:123]
    buffer_load_dwordx4 v252, s[24:27], s39 offen offset:3200 lds
    v_mfma_f32_16x16x32_bf16 v[124:127], a[160:163], a[192:195], v[124:127]
    ds_read_b64_tr_b16 a[160:161], v131 offset:36864
    ds_read_b64_tr_b16 a[162:163], v131 offset:38912
    v_mfma_f32_16x16x32_bf16 v[0:3], a[132:135], a[164:167], v[0:3]
    ds_read_b128 a[180:183], v251 offset:4096
    v_permlane16_swap_b32 v136, v138
    v_mfma_f32_16x16x32_bf16 v[4:7], a[132:135], a[168:171], v[4:7]
    s_waitcnt vmcnt(12)
    s_add_u32 m0, s36, 32768
    s_mov_b32 s39, 2883584
    v_permlane16_swap_b32 v137, v139
    v_mfma_f32_16x16x32_bf16 v[8:11], a[132:135], a[172:175], v[8:11]
    buffer_load_dwordx4 v252, s[24:27], s39 offen offset:0 lds
    v_mfma_f32_16x16x32_bf16 v[12:15], a[132:135], a[176:179], v[12:15]
    ds_read_b64_tr_b16 a[132:133], v128 offset:16384
    ds_read_b64_tr_b16 a[134:135], v128 offset:18432
    v_mfma_f32_16x16x32_bf16 v[16:19], a[136:139], a[164:167], v[16:19]
    ds_read_b128 a[184:187], v251 offset:5120
    v_add_f32 v136, v136, v138
    v_mfma_f32_16x16x32_bf16 v[20:23], a[136:139], a[168:171], v[20:23]
    s_mov_b32 s39, 3013632
    v_add_f32 v137, v137, v139
    v_mfma_f32_16x16x32_bf16 v[24:27], a[136:139], a[172:175], v[24:27]
    buffer_load_dwordx4 v252, s[24:27], s39 offen offset:1024 lds
    v_mfma_f32_16x16x32_bf16 v[28:31], a[136:139], a[176:179], v[28:31]
    ds_read_b64_tr_b16 a[136:137], v129 offset:16384
    ds_read_b64_tr_b16 a[138:139], v129 offset:18432
    v_mfma_f32_16x16x32_bf16 v[32:35], a[140:143], a[164:167], v[32:35]
    ds_read_b128 a[188:191], v251 offset:6144
    v_and_b32 v144, 0x70, v250
    v_mfma_f32_16x16x32_bf16 v[36:39], a[140:143], a[168:171], v[36:39]
    s_mov_b32 s39, 2914304
    v_lshrrev_b32 v145, 8, v250
    v_mfma_f32_16x16x32_bf16 v[40:43], a[140:143], a[172:175], v[40:43]
    buffer_load_dwordx4 v252, s[24:27], s39 offen offset:2048 lds
    v_mfma_f32_16x16x32_bf16 v[44:47], a[140:143], a[176:179], v[44:47]
    ds_read_b64_tr_b16 a[140:141], v130 offset:16384
    ds_read_b64_tr_b16 a[142:143], v130 offset:18432
    v_mfma_f32_16x16x32_bf16 v[48:51], a[144:147], a[164:167], v[48:51]
    ds_read_b128 a[192:195], v251 offset:7168
    v_add_f32_dpp v136, v136, v136 row_ror:8 row_mask:0xf bank_mask:0xf
    v_mfma_f32_16x16x32_bf16 v[52:55], a[144:147], a[168:171], v[52:55]
    s_waitcnt lgkmcnt(10)
    s_mov_b32 s39, 3044352
    v_add_f32_dpp v137, v137, v137 row_ror:8 row_mask:0xf bank_mask:0xf
    v_mfma_f32_16x16x32_bf16 v[56:59], a[144:147], a[172:175], v[56:59]
    buffer_load_dwordx4 v252, s[24:27], s39 offen offset:3072 lds
    v_mfma_f32_16x16x32_bf16 v[60:63], a[144:147], a[176:179], v[60:63]
    ds_read_b64_tr_b16 a[144:145], v131 offset:16384
    ds_read_b64_tr_b16 a[146:147], v131 offset:18432
    v_mfma_f32_16x16x32_bf16 v[64:67], a[148:151], a[164:167], v[64:67]
    v_lshlrev_b32 v144, 2, v144
    v_mfma_f32_16x16x32_bf16 v[68:71], a[148:151], a[168:171], v[68:71]
    s_waitcnt vmcnt(12)
    s_add_u32 m0, s36, 36736
    s_mov_b32 s39, 2883584
    v_lshl_add_u32 v144, v145, 4, v144
    v_mfma_f32_16x16x32_bf16 v[72:75], a[148:151], a[172:175], v[72:75]
    buffer_load_dwordx4 v252, s[24:27], s39 offen offset:128 lds
    v_mfma_f32_16x16x32_bf16 v[76:79], a[148:151], a[176:179], v[76:79]
    ds_read_b64_tr_b16 a[148:149], v128 offset:20480
    ds_read_b64_tr_b16 a[150:151], v128 offset:22528
    v_mfma_f32_16x16x32_bf16 v[80:83], a[152:155], a[164:167], v[80:83]
    v_mov_b32 v138, s51
    v_mfma_f32_16x16x32_bf16 v[84:87], a[152:155], a[168:171], v[84:87]
    s_mov_b32 s39, 3013632
    buffer_store_dwordx3 v[136:138], v144, s[32:35], s15 offen sc1
    v_mfma_f32_16x16x32_bf16 v[88:91], a[152:155], a[172:175], v[88:91]
    buffer_load_dwordx4 v252, s[24:27], s39 offen offset:1152 lds
    v_mfma_f32_16x16x32_bf16 v[92:95], a[152:155], a[176:179], v[92:95]
    ds_read_b64_tr_b16 a[152:153], v129 offset:20480
    ds_read_b64_tr_b16 a[154:155], v129 offset:22528
    v_mfma_f32_16x16x32_bf16 v[96:99], a[156:159], a[164:167], v[96:99]
    v_mfma_f32_16x16x32_bf16 v[100:103], a[156:159], a[168:171], v[100:103]
    s_mov_b32 s39, 2914304
    v_mfma_f32_16x16x32_bf16 v[104:107], a[156:159], a[172:175], v[104:107]
    buffer_load_dwordx4 v252, s[24:27], s39 offen offset:2176 lds
    v_mfma_f32_16x16x32_bf16 v[108:111], a[156:159], a[176:179], v[108:111]
    ds_read_b64_tr_b16 a[156:157], v130 offset:20480
    ds_read_b64_tr_b16 a[158:159], v130 offset:22528
    v_mfma_f32_16x16x32_bf16 v[112:115], a[160:163], a[164:167], v[112:115]
    v_mfma_f32_16x16x32_bf16 v[116:119], a[160:163], a[168:171], v[116:119]
    s_waitcnt lgkmcnt(6)
    s_mov_b32 s39, 3044352
    v_mfma_f32_16x16x32_bf16 v[120:123], a[160:163], a[172:175], v[120:123]
    buffer_load_dwordx4 v252, s[24:27], s39 offen offset:3200 lds
    v_mfma_f32_16x16x32_bf16 v[124:127], a[160:163], a[176:179], v[124:127]
    ds_read_b64_tr_b16 a[160:161], v131 offset:20480
    ds_read_b64_tr_b16 a[162:163], v131 offset:22528
    v_mfma_f32_16x16x32_bf16 v[0:3], a[132:135], a[180:183], v[0:3]
    ds_read_b128 a[164:167], v251 offset:8192
    v_mfma_f32_16x16x32_bf16 v[4:7], a[132:135], a[184:187], v[4:7]
    s_waitcnt vmcnt(13)
    s_add_u32 m0, s36, 16384
    s_mov_b32 s39, 3145728
    v_mfma_f32_16x16x32_bf16 v[8:11], a[132:135], a[188:191], v[8:11]
    buffer_load_dwordx4 v252, s[24:27], s39 offen offset:0 lds
    v_mfma_f32_16x16x32_bf16 v[12:15], a[132:135], a[192:195], v[12:15]
    ds_read_b64_tr_b16 a[132:133], v128 offset:24576
    ds_read_b64_tr_b16 a[134:135], v128 offset:26624
    v_mfma_f32_16x16x32_bf16 v[16:19], a[136:139], a[180:183], v[16:19]
    ds_read_b128 a[168:171], v251 offset:9216
    v_mfma_f32_16x16x32_bf16 v[20:23], a[136:139], a[184:187], v[20:23]
    s_mov_b32 s39, 3275776
    v_mfma_f32_16x16x32_bf16 v[24:27], a[136:139], a[188:191], v[24:27]
    buffer_load_dwordx4 v252, s[24:27], s39 offen offset:1024 lds
    v_mfma_f32_16x16x32_bf16 v[28:31], a[136:139], a[192:195], v[28:31]
    ds_read_b64_tr_b16 a[136:137], v129 offset:24576
    ds_read_b64_tr_b16 a[138:139], v129 offset:26624
    v_mfma_f32_16x16x32_bf16 v[32:35], a[140:143], a[180:183], v[32:35]
    ds_read_b128 a[172:175], v251 offset:10240
    v_mfma_f32_16x16x32_bf16 v[36:39], a[140:143], a[184:187], v[36:39]
    s_mov_b32 s39, 3176448
    v_mfma_f32_16x16x32_bf16 v[40:43], a[140:143], a[188:191], v[40:43]
    buffer_load_dwordx4 v252, s[24:27], s39 offen offset:2048 lds
    v_mfma_f32_16x16x32_bf16 v[44:47], a[140:143], a[192:195], v[44:47]
    ds_read_b64_tr_b16 a[140:141], v130 offset:24576
    ds_read_b64_tr_b16 a[142:143], v130 offset:26624
    v_mfma_f32_16x16x32_bf16 v[48:51], a[144:147], a[180:183], v[48:51]
    ds_read_b128 a[176:179], v251 offset:11264
    v_mfma_f32_16x16x32_bf16 v[52:55], a[144:147], a[184:187], v[52:55]
    s_waitcnt lgkmcnt(10)
    s_mov_b32 s39, 3306496
    v_mfma_f32_16x16x32_bf16 v[56:59], a[144:147], a[188:191], v[56:59]
    buffer_load_dwordx4 v252, s[24:27], s39 offen offset:3072 lds
    v_mfma_f32_16x16x32_bf16 v[60:63], a[144:147], a[192:195], v[60:63]
    ds_read_b64_tr_b16 a[144:145], v131 offset:24576
    ds_read_b64_tr_b16 a[146:147], v131 offset:26624
    v_mfma_f32_16x16x32_bf16 v[64:67], a[148:151], a[180:183], v[64:67]
    v_mfma_f32_16x16x32_bf16 v[68:71], a[148:151], a[184:187], v[68:71]
    s_waitcnt vmcnt(13)
    s_add_u32 m0, s36, 20352
    s_mov_b32 s39, 3145728
    v_mfma_f32_16x16x32_bf16 v[72:75], a[148:151], a[188:191], v[72:75]
    buffer_load_dwordx4 v252, s[24:27], s39 offen offset:128 lds
    v_mfma_f32_16x16x32_bf16 v[76:79], a[148:151], a[192:195], v[76:79]
    ds_read_b64_tr_b16 a[148:149], v128 offset:28672
    ds_read_b64_tr_b16 a[150:151], v128 offset:30720
    v_mfma_f32_16x16x32_bf16 v[80:83], a[152:155], a[180:183], v[80:83]
    v_mfma_f32_16x16x32_bf16 v[84:87], a[152:155], a[184:187], v[84:87]
    s_mov_b32 s39, 3275776
    v_mfma_f32_16x16x32_bf16 v[88:91], a[152:155], a[188:191], v[88:91]
    buffer_load_dwordx4 v252, s[24:27], s39 offen offset:1152 lds
    v_mfma_f32_16x16x32_bf16 v[92:95], a[152:155], a[192:195], v[92:95]
    ds_read_b64_tr_b16 a[152:153], v129 offset:28672
    ds_read_b64_tr_b16 a[154:155], v129 offset:30720
    v_mfma_f32_16x16x32_bf16 v[96:99], a[156:159], a[180:183], v[96:99]
    v_mfma_f32_16x16x32_bf16 v[100:103], a[156:159], a[184:187], v[100:103]
    s_mov_b32 s39, 3176448
    v_mfma_f32_16x16x32_bf16 v[104:107], a[156:159], a[188:191], v[104:107]
    buffer_load_dwordx4 v252, s[24:27], s39 offen offset:2176 lds
    v_mfma_f32_16x16x32_bf16 v[108:111], a[156:159], a[192:195], v[108:111]
    ds_read_b64_tr_b16 a[156:157], v130 offset:28672
    ds_read_b64_tr_b16 a[158:159], v130 offset:30720
    v_mfma_f32_16x16x32_bf16 v[112:115], a[160:163], a[180:183], v[112:115]
    v_mfma_f32_16x16x32_bf16 v[116:119], a[160:163], a[184:187], v[116:119]
    s_waitcnt lgkmcnt(6)
    s_mov_b32 s39, 3306496
    v_mfma_f32_16x16x32_bf16 v[120:123], a[160:163], a[188:191], v[120:123]
    buffer_load_dwordx4 v252, s[24:27], s39 offen offset:3200 lds
    v_mfma_f32_16x16x32_bf16 v[124:127], a[160:163], a[192:195], v[124:127]
    ds_read_b64_tr_b16 a[160:161], v131 offset:28672
    ds_read_b64_tr_b16 a[162:163], v131 offset:30720
    v_mfma_f32_16x16x32_bf16 v[0:3], a[132:135], a[164:167], v[0:3]
    ds_read_b128 a[180:183], v251 offset:12288
    v_mfma_f32_16x16x32_bf16 v[4:7], a[132:135], a[168:171], v[4:7]
    s_waitcnt vmcnt(13)
    s_add_u32 m0, s36, 24576
    s_mov_b32 s39, 3407872
    v_mfma_f32_16x16x32_bf16 v[8:11], a[132:135], a[172:175], v[8:11]
    buffer_load_dwordx4 v252, s[24:27], s39 offen offset:0 lds
    v_mfma_f32_16x16x32_bf16 v[12:15], a[132:135], a[176:179], v[12:15]
    ds_read_b64_tr_b16 a[132:133], v128 offset:32768
    ds_read_b64_tr_b16 a[134:135], v128 offset:34816
    v_mfma_f32_16x16x32_bf16 v[16:19], a[136:139], a[164:167], v[16:19]
    ds_read_b128 a[184:187], v251 offset:13312
    v_mfma_f32_16x16x32_bf16 v[20:23], a[136:139], a[168:171], v[20:23]
    s_mov_b32 s39, 3537920
    v_mfma_f32_16x16x32_bf16 v[24:27], a[136:139], a[172:175], v[24:27]
    buffer_load_dwordx4 v252, s[24:27], s39 offen offset:1024 lds
    v_mfma_f32_16x16x32_bf16 v[28:31], a[136:139], a[176:179], v[28:31]
    ds_read_b64_tr_b16 a[136:137], v129 offset:32768
    ds_read_b64_tr_b16 a[138:139], v129 offset:34816
    v_mfma_f32_16x16x32_bf16 v[32:35], a[140:143], a[164:167], v[32:35]
    ds_read_b128 a[188:191], v251 offset:14336
    v_mfma_f32_16x16x32_bf16 v[36:39], a[140:143], a[168:171], v[36:39]
    s_mov_b32 s39, 3438592
    v_mfma_f32_16x16x32_bf16 v[40:43], a[140:143], a[172:175], v[40:43]
    buffer_load_dwordx4 v252, s[24:27], s39 offen offset:2048 lds
    v_mfma_f32_16x16x32_bf16 v[44:47], a[140:143], a[176:179], v[44:47]
    ds_read_b64_tr_b16 a[140:141], v130 offset:32768
    ds_read_b64_tr_b16 a[142:143], v130 offset:34816
    v_mfma_f32_16x16x32_bf16 v[48:51], a[144:147], a[164:167], v[48:51]
    ds_read_b128 a[192:195], v251 offset:15360
    v_mfma_f32_16x16x32_bf16 v[52:55], a[144:147], a[168:171], v[52:55]
    s_waitcnt lgkmcnt(10)
    s_mov_b32 s39, 3568640
    v_mfma_f32_16x16x32_bf16 v[56:59], a[144:147], a[172:175], v[56:59]
    buffer_load_dwordx4 v252, s[24:27], s39 offen offset:3072 lds
    v_mfma_f32_16x16x32_bf16 v[60:63], a[144:147], a[176:179], v[60:63]
    ds_read_b64_tr_b16 a[144:145], v131 offset:32768
    ds_read_b64_tr_b16 a[146:147], v131 offset:34816
    v_mfma_f32_16x16x32_bf16 v[64:67], a[148:151], a[164:167], v[64:67]
    v_mfma_f32_16x16x32_bf16 v[68:71], a[148:151], a[168:171], v[68:71]
    s_waitcnt vmcnt(12)
    s_add_u32 m0, s36, 28544
    s_mov_b32 s39, 3407872
    v_mfma_f32_16x16x32_bf16 v[72:75], a[148:151], a[172:175], v[72:75]
    buffer_load_dwordx4 v252, s[24:27], s39 offen offset:128 lds
    v_mfma_f32_16x16x32_bf16 v[76:79], a[148:151], a[176:179], v[76:79]
    ds_read_b64_tr_b16 a[148:149], v128 offset:36864
    ds_read_b64_tr_b16 a[150:151], v128 offset:38912
    v_mfma_f32_16x16x32_bf16 v[80:83], a[152:155], a[164:167], v[80:83]
    v_mfma_f32_16x16x32_bf16 v[84:87], a[152:155], a[168:171], v[84:87]
    s_mov_b32 s39, 3537920
    v_mfma_f32_16x16x32_bf16 v[88:91], a[152:155], a[172:175], v[88:91]
    buffer_load_dwordx4 v252, s[24:27], s39 offen offset:1152 lds
    v_mfma_f32_16x16x32_bf16 v[92:95], a[152:155], a[176:179], v[92:95]
    ds_read_b64_tr_b16 a[152:153], v129 offset:36864
    ds_read_b64_tr_b16 a[154:155], v129 offset:38912
    v_mfma_f32_16x16x32_bf16 v[96:99], a[156:159], a[164:167], v[96:99]
    v_mfma_f32_16x16x32_bf16 v[100:103], a[156:159], a[168:171], v[100:103]
    s_mov_b32 s39, 3438592
    v_mfma_f32_16x16x32_bf16 v[104:107], a[156:159], a[172:175], v[104:107]
    buffer_load_dwordx4 v252, s[24:27], s39 offen offset:2176 lds
    v_mfma_f32_16x16x32_bf16 v[108:111], a[156:159], a[176:179], v[108:111]
    ds_read_b64_tr_b16 a[156:157], v130 offset:36864
    ds_read_b64_tr_b16 a[158:159], v130 offset:38912
    v_mfma_f32_16x16x32_bf16 v[112:115], a[160:163], a[164:167], v[112:115]
    v_mfma_f32_16x16x32_bf16 v[116:119], a[160:163], a[168:171], v[116:119]
    s_waitcnt lgkmcnt(6)
    s_mov_b32 s39, 3568640
    v_mfma_f32_16x16x32_bf16 v[120:123], a[160:163], a[172:175], v[120:123]
    buffer_load_dwordx4 v252, s[24:27], s39 offen offset:3200 lds
    v_mfma_f32_16x16x32_bf16 v[124:127], a[160:163], a[176:179], v[124:127]
    ds_read_b64_tr_b16 a[160:161], v131 offset:36864
    ds_read_b64_tr_b16 a[162:163], v131 offset:38912
    v_mfma_f32_16x16x32_bf16 v[0:3], a[132:135], a[180:183], v[0:3]
    ds_read_b128 a[164:167], v251 offset:40960
    v_mfma_f32_16x16x32_bf16 v[4:7], a[132:135], a[184:187], v[4:7]
    s_waitcnt vmcnt(12)
    s_add_u32 m0, s36, 32768
    s_mov_b32 s39, 3670016
    v_mfma_f32_16x16x32_bf16 v[8:11], a[132:135], a[188:191], v[8:11]
    buffer_load_dwordx4 v252, s[24:27], s39 offen offset:0 lds
    v_mfma_f32_16x16x32_bf16 v[12:15], a[132:135], a[192:195], v[12:15]
    ds_read_b64_tr_b16 a[132:133], v128 offset:16384
    ds_read_b64_tr_b16 a[134:135], v128 offset:18432
    v_mfma_f32_16x16x32_bf16 v[16:19], a[136:139], a[180:183], v[16:19]
    ds_read_b128 a[168:171], v251 offset:41984
    v_mfma_f32_16x16x32_bf16 v[20:23], a[136:139], a[184:187], v[20:23]
    s_mov_b32 s39, 3800064
    v_mfma_f32_16x16x32_bf16 v[24:27], a[136:139], a[188:191], v[24:27]
    buffer_load_dwordx4 v252, s[24:27], s39 offen offset:1024 lds
    v_mfma_f32_16x16x32_bf16 v[28:31], a[136:139], a[192:195], v[28:31]
    ds_read_b64_tr_b16 a[136:137], v129 offset:16384
    ds_read_b64_tr_b16 a[138:139], v129 offset:18432
    v_mfma_f32_16x16x32_bf16 v[32:35], a[140:143], a[180:183], v[32:35]
    ds_read_b128 a[172:175], v251 offset:43008
    v_mfma_f32_16x16x32_bf16 v[36:39], a[140:143], a[184:187], v[36:39]
    s_mov_b32 s39, 3700736
    v_mfma_f32_16x16x32_bf16 v[40:43], a[140:143], a[188:191], v[40:43]
    buffer_load_dwordx4 v252, s[24:27], s39 offen offset:2048 lds
    v_mfma_f32_16x16x32_bf16 v[44:47], a[140:143], a[192:195], v[44:47]
    ds_read_b64_tr_b16 a[140:141], v130 offset:16384
    ds_read_b64_tr_b16 a[142:143], v130 offset:18432
    v_mfma_f32_16x16x32_bf16 v[48:51], a[144:147], a[180:183], v[48:51]
    ds_read_b128 a[176:179], v251 offset:44032
    v_mfma_f32_16x16x32_bf16 v[52:55], a[144:147], a[184:187], v[52:55]
    s_waitcnt lgkmcnt(10)
    s_mov_b32 s39, 3830784
    v_mfma_f32_16x16x32_bf16 v[56:59], a[144:147], a[188:191], v[56:59]
    buffer_load_dwordx4 v252, s[24:27], s39 offen offset:3072 lds
    v_mfma_f32_16x16x32_bf16 v[60:63], a[144:147], a[192:195], v[60:63]
    ds_read_b64_tr_b16 a[144:145], v131 offset:16384
    ds_read_b64_tr_b16 a[146:147], v131 offset:18432
    v_mfma_f32_16x16x32_bf16 v[64:67], a[148:151], a[180:183], v[64:67]
    v_mfma_f32_16x16x32_bf16 v[68:71], a[148:151], a[184:187], v[68:71]
    s_waitcnt vmcnt(12)
    s_add_u32 m0, s36, 36736
    s_mov_b32 s39, 3670016
    v_mfma_f32_16x16x32_bf16 v[72:75], a[148:151], a[188:191], v[72:75]
    buffer_load_dwordx4 v252, s[24:27], s39 offen offset:128 lds
    v_mfma_f32_16x16x32_bf16 v[76:79], a[148:151], a[192:195], v[76:79]
    ds_read_b64_tr_b16 a[148:149], v128 offset:20480
    ds_read_b64_tr_b16 a[150:151], v128 offset:22528
    v_mfma_f32_16x16x32_bf16 v[80:83], a[152:155], a[180:183], v[80:83]
    v_mfma_f32_16x16x32_bf16 v[84:87], a[152:155], a[184:187], v[84:87]
    s_mov_b32 s39, 3800064
    v_mfma_f32_16x16x32_bf16 v[88:91], a[152:155], a[188:191], v[88:91]
    buffer_load_dwordx4 v252, s[24:27], s39 offen offset:1152 lds
    v_mfma_f32_16x16x32_bf16 v[92:95], a[152:155], a[192:195], v[92:95]
    ds_read_b64_tr_b16 a[152:153], v129 offset:20480
    ds_read_b64_tr_b16 a[154:155], v129 offset:22528
    v_mfma_f32_16x16x32_bf16 v[96:99], a[156:159], a[180:183], v[96:99]
    v_mfma_f32_16x16x32_bf16 v[100:103], a[156:159], a[184:187], v[100:103]
    s_mov_b32 s39, 3700736
    v_mfma_f32_16x16x32_bf16 v[104:107], a[156:159], a[188:191], v[104:107]
    buffer_load_dwordx4 v252, s[24:27], s39 offen offset:2176 lds
    v_mfma_f32_16x16x32_bf16 v[108:111], a[156:159], a[192:195], v[108:111]
    ds_read_b64_tr_b16 a[156:157], v130 offset:20480
    ds_read_b64_tr_b16 a[158:159], v130 offset:22528
    v_mfma_f32_16x16x32_bf16 v[112:115], a[160:163], a[180:183], v[112:115]
    v_mfma_f32_16x16x32_bf16 v[116:119], a[160:163], a[184:187], v[116:119]
    s_waitcnt lgkmcnt(6)
    s_mov_b32 s39, 3830784
    v_mfma_f32_16x16x32_bf16 v[120:123], a[160:163], a[188:191], v[120:123]
    buffer_load_dwordx4 v252, s[24:27], s39 offen offset:3200 lds
    v_mfma_f32_16x16x32_bf16 v[124:127], a[160:163], a[192:195], v[124:127]
    ds_read_b64_tr_b16 a[160:161], v131 offset:20480
    ds_read_b64_tr_b16 a[162:163], v131 offset:22528
    v_mfma_f32_16x16x32_bf16 v[0:3], a[132:135], a[164:167], v[0:3]
    ds_read_b128 a[180:183], v251 offset:45056
    v_mfma_f32_16x16x32_bf16 v[4:7], a[132:135], a[168:171], v[4:7]
    s_waitcnt vmcnt(12)
    s_add_u32 m0, s36, 16384
    s_mov_b32 s39, 3932160
    v_mfma_f32_16x16x32_bf16 v[8:11], a[132:135], a[172:175], v[8:11]
    buffer_load_dwordx4 v252, s[24:27], s39 offen offset:0 lds
    v_mfma_f32_16x16x32_bf16 v[12:15], a[132:135], a[176:179], v[12:15]
    ds_read_b64_tr_b16 a[132:133], v128 offset:24576
    ds_read_b64_tr_b16 a[134:135], v128 offset:26624
    v_mfma_f32_16x16x32_bf16 v[16:19], a[136:139], a[164:167], v[16:19]
    ds_read_b128 a[184:187], v251 offset:46080
    v_mfma_f32_16x16x32_bf16 v[20:23], a[136:139], a[168:171], v[20:23]
    s_mov_b32 s39, 4062208
    v_mfma_f32_16x16x32_bf16 v[24:27], a[136:139], a[172:175], v[24:27]
    buffer_load_dwordx4 v252, s[24:27], s39 offen offset:1024 lds
    v_mfma_f32_16x16x32_bf16 v[28:31], a[136:139], a[176:179], v[28:31]
    ds_read_b64_tr_b16 a[136:137], v129 offset:24576
    ds_read_b64_tr_b16 a[138:139], v129 offset:26624
    v_mfma_f32_16x16x32_bf16 v[32:35], a[140:143], a[164:167], v[32:35]
    ds_read_b128 a[188:191], v251 offset:47104
    v_mfma_f32_16x16x32_bf16 v[36:39], a[140:143], a[168:171], v[36:39]
    s_mov_b32 s39, 3962880
    v_mfma_f32_16x16x32_bf16 v[40:43], a[140:143], a[172:175], v[40:43]
    buffer_load_dwordx4 v252, s[24:27], s39 offen offset:2048 lds
    v_mfma_f32_16x16x32_bf16 v[44:47], a[140:143], a[176:179], v[44:47]
    ds_read_b64_tr_b16 a[140:141], v130 offset:24576
    ds_read_b64_tr_b16 a[142:143], v130 offset:26624
    v_mfma_f32_16x16x32_bf16 v[48:51], a[144:147], a[164:167], v[48:51]
    ds_read_b128 a[192:195], v251 offset:48128
    v_mfma_f32_16x16x32_bf16 v[52:55], a[144:147], a[168:171], v[52:55]
    s_waitcnt lgkmcnt(10)
    s_mov_b32 s39, 4092928
    v_mfma_f32_16x16x32_bf16 v[56:59], a[144:147], a[172:175], v[56:59]
    buffer_load_dwordx4 v252, s[24:27], s39 offen offset:3072 lds
    v_mfma_f32_16x16x32_bf16 v[60:63], a[144:147], a[176:179], v[60:63]
    ds_read_b64_tr_b16 a[144:145], v131 offset:24576
    ds_read_b64_tr_b16 a[146:147], v131 offset:26624
    v_mfma_f32_16x16x32_bf16 v[64:67], a[148:151], a[164:167], v[64:67]
    v_mfma_f32_16x16x32_bf16 v[68:71], a[148:151], a[168:171], v[68:71]
    s_waitcnt vmcnt(12)
    s_add_u32 m0, s36, 20352
    s_mov_b32 s39, 3932160
    v_mfma_f32_16x16x32_bf16 v[72:75], a[148:151], a[172:175], v[72:75]
    buffer_load_dwordx4 v252, s[24:27], s39 offen offset:128 lds
    v_mfma_f32_16x16x32_bf16 v[76:79], a[148:151], a[176:179], v[76:79]
    ds_read_b64_tr_b16 a[148:149], v128 offset:28672
    ds_read_b64_tr_b16 a[150:151], v128 offset:30720
    v_mfma_f32_16x16x32_bf16 v[80:83], a[152:155], a[164:167], v[80:83]
    v_mfma_f32_16x16x32_bf16 v[84:87], a[152:155], a[168:171], v[84:87]
    s_mov_b32 s39, 4062208
    v_mfma_f32_16x16x32_bf16 v[88:91], a[152:155], a[172:175], v[88:91]
    buffer_load_dwordx4 v252, s[24:27], s39 offen offset:1152 lds
    v_mfma_f32_16x16x32_bf16 v[92:95], a[152:155], a[176:179], v[92:95]
    ds_read_b64_tr_b16 a[152:153], v129 offset:28672
    ds_read_b64_tr_b16 a[154:155], v129 offset:30720
    v_mfma_f32_16x16x32_bf16 v[96:99], a[156:159], a[164:167], v[96:99]
    v_mfma_f32_16x16x32_bf16 v[100:103], a[156:159], a[168:171], v[100:103]
    s_mov_b32 s39, 3962880
    v_mfma_f32_16x16x32_bf16 v[104:107], a[156:159], a[172:175], v[104:107]
    buffer_load_dwordx4 v252, s[24:27], s39 offen offset:2176 lds
    v_mfma_f32_16x16x32_bf16 v[108:111], a[156:159], a[176:179], v[108:111]
    ds_read_b64_tr_b16 a[156:157], v130 offset:28672
    ds_read_b64_tr_b16 a[158:159], v130 offset:30720
    v_mfma_f32_16x16x32_bf16 v[112:115], a[160:163], a[164:167], v[112:115]
    v_mfma_f32_16x16x32_bf16 v[116:119], a[160:163], a[168:171], v[116:119]
    s_waitcnt lgkmcnt(6)
    s_mov_b32 s39, 4092928
    v_mfma_f32_16x16x32_bf16 v[120:123], a[160:163], a[172:175], v[120:123]
    buffer_load_dwordx4 v252, s[24:27], s39 offen offset:3200 lds
    v_mfma_f32_16x16x32_bf16 v[124:127], a[160:163], a[176:179], v[124:127]
    ds_read_b64_tr_b16 a[160:161], v131 offset:28672
    ds_read_b64_tr_b16 a[162:163], v131 offset:30720
    v_mfma_f32_16x16x32_bf16 v[0:3], a[132:135], a[180:183], v[0:3]
    ds_read_b128 a[164:167], v251 offset:49152
    v_mfma_f32_16x16x32_bf16 v[4:7], a[132:135], a[184:187], v[4:7]
    s_waitcnt vmcnt(12)
    s_add_u32 m0, s36, 24576
    v_mfma_f32_16x16x32_bf16 v[8:11], a[132:135], a[188:191], v[8:11]
    buffer_load_dwordx4 v248, s[16:19], s37 offen offset:0 lds
    v_mfma_f32_16x16x32_bf16 v[12:15], a[132:135], a[192:195], v[12:15]
    ds_read_b64_tr_b16 a[132:133], v128 offset:32768
    ds_read_b64_tr_b16 a[134:135], v128 offset:34816
    v_mfma_f32_16x16x32_bf16 v[16:19], a[136:139], a[180:183], v[16:19]
    ds_read_b128 a[168:171], v251 offset:50176
    v_mfma_f32_16x16x32_bf16 v[20:23], a[136:139], a[184:187], v[20:23]
    v_mfma_f32_16x16x32_bf16 v[24:27], a[136:139], a[188:191], v[24:27]
    buffer_load_dwordx4 v248, s[16:19], s37 offen offset:1024 lds
    v_mfma_f32_16x16x32_bf16 v[28:31], a[136:139], a[192:195], v[28:31]
    ds_read_b64_tr_b16 a[136:137], v129 offset:32768
    ds_read_b64_tr_b16 a[138:139], v129 offset:34816
    v_mfma_f32_16x16x32_bf16 v[32:35], a[140:143], a[180:183], v[32:35]
    ds_read_b128 a[172:175], v251 offset:51200
    v_mfma_f32_16x16x32_bf16 v[36:39], a[140:143], a[184:187], v[36:39]
    v_mfma_f32_16x16x32_bf16 v[40:43], a[140:143], a[188:191], v[40:43]
    buffer_load_dwordx4 v248, s[16:19], s37 offen offset:2048 lds
    v_mfma_f32_16x16x32_bf16 v[44:47], a[140:143], a[192:195], v[44:47]
    ds_read_b64_tr_b16 a[140:141], v130 offset:32768
    ds_read_b64_tr_b16 a[142:143], v130 offset:34816
    v_mfma_f32_16x16x32_bf16 v[48:51], a[144:147], a[180:183], v[48:51]
    ds_read_b128 a[176:179], v251 offset:52224
    v_mfma_f32_16x16x32_bf16 v[52:55], a[144:147], a[184:187], v[52:55]
    s_waitcnt lgkmcnt(10)
    v_mfma_f32_16x16x32_bf16 v[56:59], a[144:147], a[188:191], v[56:59]
    buffer_load_dwordx4 v248, s[16:19], s37 offen offset:3072 lds
    v_mfma_f32_16x16x32_bf16 v[60:63], a[144:147], a[192:195], v[60:63]
    s_add_u32 s37, s37, 0x4000
    ds_read_b64_tr_b16 a[144:145], v131 offset:32768
    ds_read_b64_tr_b16 a[146:147], v131 offset:34816
    v_mfma_f32_16x16x32_bf16 v[64:67], a[148:151], a[180:183], v[64:67]
    v_mfma_f32_16x16x32_bf16 v[68:71], a[148:151], a[184:187], v[68:71]
    s_waitcnt vmcnt(12)
    s_add_u32 m0, s36, 28672
    v_mfma_f32_16x16x32_bf16 v[72:75], a[148:151], a[188:191], v[72:75]
    buffer_load_dwordx4 v248, s[16:19], s37 offen offset:0 lds
    v_mfma_f32_16x16x32_bf16 v[76:79], a[148:151], a[192:195], v[76:79]
    ds_read_b64_tr_b16 a[148:149], v128 offset:36864
    ds_read_b64_tr_b16 a[150:151], v128 offset:38912
    v_mfma_f32_16x16x32_bf16 v[80:83], a[152:155], a[180:183], v[80:83]
    v_mfma_f32_16x16x32_bf16 v[84:87], a[152:155], a[184:187], v[84:87]
    v_mfma_f32_16x16x32_bf16 v[88:91], a[152:155], a[188:191], v[88:91]
    buffer_load_dwordx4 v248, s[16:19], s37 offen offset:1024 lds
    v_mfma_f32_16x16x32_bf16 v[92:95], a[152:155], a[192:195], v[92:95]
    ds_read_b64_tr_b16 a[152:153], v129 offset:36864
    ds_read_b64_tr_b16 a[154:155], v129 offset:38912
    v_mfma_f32_16x16x32_bf16 v[96:99], a[156:159], a[180:183], v[96:99]
    v_mfma_f32_16x16x32_bf16 v[100:103], a[156:159], a[184:187], v[100:103]
    v_mfma_f32_16x16x32_bf16 v[104:107], a[156:159], a[188:191], v[104:107]
    buffer_load_dwordx4 v248, s[16:19], s37 offen offset:2048 lds
    v_mfma_f32_16x16x32_bf16 v[108:111], a[156:159], a[192:195], v[108:111]
    ds_read_b64_tr_b16 a[156:157], v130 offset:36864
    ds_read_b64_tr_b16 a[158:159], v130 offset:38912
    v_mfma_f32_16x16x32_bf16 v[112:115], a[160:163], a[180:183], v[112:115]
    v_mfma_f32_16x16x32_bf16 v[116:119], a[160:163], a[184:187], v[116:119]
    s_waitcnt lgkmcnt(6)
    v_mfma_f32_16x16x32_bf16 v[120:123], a[160:163], a[188:191], v[120:123]
    buffer_load_dwordx4 v248, s[16:19], s37 offen offset:3072 lds
    v_mfma_f32_16x16x32_bf16 v[124:127], a[160:163], a[192:195], v[124:127]
    s_add_u32 s37, s37, 0x4000
    ds_read_b64_tr_b16 a[160:161], v131 offset:36864
    ds_read_b64_tr_b16 a[162:163], v131 offset:38912
    v_mfma_f32_16x16x32_bf16 v[0:3], a[132:135], a[164:167], v[0:3]
    ds_read_b128 a[180:183], v251 offset:53248
    v_mfma_f32_16x16x32_bf16 v[4:7], a[132:135], a[168:171], v[4:7]
    s_waitcnt vmcnt(12)
    s_add_u32 m0, s36, 32768
    v_mfma_f32_16x16x32_bf16 v[8:11], a[132:135], a[172:175], v[8:11]
    buffer_load_dwordx4 v249, s[20:23], s38 offen offset:0 lds
    v_mfma_f32_16x16x32_bf16 v[12:15], a[132:135], a[176:179], v[12:15]
    ds_read_b64_tr_b16 a[132:133], v128 offset:16384
    ds_read_b64_tr_b16 a[134:135], v128 offset:18432
    v_mfma_f32_16x16x32_bf16 v[16:19], a[136:139], a[164:167], v[16:19]
    ds_read_b128 a[184:187], v251 offset:54272
    v_mfma_f32_16x16x32_bf16 v[20:23], a[136:139], a[168:171], v[20:23]
    v_mfma_f32_16x16x32_bf16 v[24:27], a[136:139], a[172:175], v[24:27]
    buffer_load_dwordx4 v249, s[20:23], s38 offen offset:1024 lds
    v_mfma_f32_16x16x32_bf16 v[28:31], a[136:139], a[176:179], v[28:31]
    ds_read_b64_tr_b16 a[136:137], v129 offset:16384
    ds_read_b64_tr_b16 a[138:139], v129 offset:18432
    v_mfma_f32_16x16x32_bf16 v[32:35], a[140:143], a[164:167], v[32:35]
    ds_read_b128 a[188:191], v251 offset:55296
    v_mfma_f32_16x16x32_bf16 v[36:39], a[140:143], a[168:171], v[36:39]
    v_mfma_f32_16x16x32_bf16 v[40:43], a[140:143], a[172:175], v[40:43]
    buffer_load_dwordx4 v249, s[20:23], s38 offen offset:2048 lds
    v_mfma_f32_16x16x32_bf16 v[44:47], a[140:143], a[176:179], v[44:47]
    ds_read_b64_tr_b16 a[140:141], v130 offset:16384
    ds_read_b64_tr_b16 a[142:143], v130 offset:18432
    v_mfma_f32_16x16x32_bf16 v[48:51], a[144:147], a[164:167], v[48:51]
    ds_read_b128 a[192:195], v251 offset:56320
    v_mfma_f32_16x16x32_bf16 v[52:55], a[144:147], a[168:171], v[52:55]
    s_waitcnt lgkmcnt(10)
    v_mfma_f32_16x16x32_bf16 v[56:59], a[144:147], a[172:175], v[56:59]
    buffer_load_dwordx4 v249, s[20:23], s38 offen offset:3072 lds
    v_mfma_f32_16x16x32_bf16 v[60:63], a[144:147], a[176:179], v[60:63]
    s_add_u32 s38, s38, 0x4000
    ds_read_b64_tr_b16 a[144:145], v131 offset:16384
    ds_read_b64_tr_b16 a[146:147], v131 offset:18432
    v_mfma_f32_16x16x32_bf16 v[64:67], a[148:151], a[164:167], v[64:67]
    v_mfma_f32_16x16x32_bf16 v[68:71], a[148:151], a[168:171], v[68:71]
    s_waitcnt vmcnt(12)
    s_add_u32 m0, s36, 36864
    v_mfma_f32_16x16x32_bf16 v[72:75], a[148:151], a[172:175], v[72:75]
    buffer_load_dwordx4 v248, s[16:19], s37 offen offset:0 lds
    v_mfma_f32_16x16x32_bf16 v[76:79], a[148:151], a[176:179], v[76:79]
    ds_read_b64_tr_b16 a[148:149], v128 offset:20480
    ds_read_b64_tr_b16 a[150:151], v128 offset:22528
    v_mfma_f32_16x16x32_bf16 v[80:83], a[152:155], a[164:167], v[80:83]
    v_mfma_f32_16x16x32_bf16 v[84:87], a[152:155], a[168:171], v[84:87]
    v_mfma_f32_16x16x32_bf16 v[88:91], a[152:155], a[172:175], v[88:91]
    buffer_load_dwordx4 v248, s[16:19], s37 offen offset:1024 lds
    v_mfma_f32_16x16x32_bf16 v[92:95], a[152:155], a[176:179], v[92:95]
    ds_read_b64_tr_b16 a[152:153], v129 offset:20480
    ds_read_b64_tr_b16 a[154:155], v129 offset:22528
    v_mfma_f32_16x16x32_bf16 v[96:99], a[156:159], a[164:167], v[96:99]
    v_mfma_f32_16x16x32_bf16 v[100:103], a[156:159], a[168:171], v[100:103]
    v_mfma_f32_16x16x32_bf16 v[104:107], a[156:159], a[172:175], v[104:107]
    buffer_load_dwordx4 v248, s[16:19], s37 offen offset:2048 lds
    v_mfma_f32_16x16x32_bf16 v[108:111], a[156:159], a[176:179], v[108:111]
    ds_read_b64_tr_b16 a[156:157], v130 offset:20480
    ds_read_b64_tr_b16 a[158:159], v130 offset:22528
    v_mfma_f32_16x16x32_bf16 v[112:115], a[160:163], a[164:167], v[112:115]
    v_mfma_f32_16x16x32_bf16 v[116:119], a[160:163], a[168:171], v[116:119]
    s_waitcnt lgkmcnt(6)
    v_mfma_f32_16x16x32_bf16 v[120:123], a[160:163], a[172:175], v[120:123]
    buffer_load_dwordx4 v248, s[16:19], s37 offen offset:3072 lds
    v_mfma_f32_16x16x32_bf16 v[124:127], a[160:163], a[176:179], v[124:127]
    s_add_u32 s37, s37, 0x4000
    ds_read_b64_tr_b16 a[160:161], v131 offset:20480
    ds_read_b64_tr_b16 a[162:163], v131 offset:22528
    v_mfma_f32_16x16x32_bf16 v[0:3], a[132:135], a[180:183], v[0:3]
    v_mfma_f32_16x16x32_bf16 v[4:7], a[132:135], a[184:187], v[4:7]
    s_add_u32 m0, s36, 16384
    v_mfma_f32_16x16x32_bf16 v[8:11], a[132:135], a[188:191], v[8:11]
    buffer_load_dwordx4 v249, s[20:23], s38 offen offset:0 lds
    v_mfma_f32_16x16x32_bf16 v[12:15], a[132:135], a[192:195], v[12:15]
    v_mfma_f32_16x16x32_bf16 v[16:19], a[136:139], a[180:183], v[16:19]
    v_mfma_f32_16x16x32_bf16 v[20:23], a[136:139], a[184:187], v[20:23]
    v_mfma_f32_16x16x32_bf16 v[24:27], a[136:139], a[188:191], v[24:27]
    buffer_load_dwordx4 v249, s[20:23], s38 offen offset:1024 lds
    v_mfma_f32_16x16x32_bf16 v[28:31], a[136:139], a[192:195], v[28:31]
    v_mfma_f32_16x16x32_bf16 v[32:35], a[140:143], a[180:183], v[32:35]
    v_mfma_f32_16x16x32_bf16 v[36:39], a[140:143], a[184:187], v[36:39]
    v_mfma_f32_16x16x32_bf16 v[40:43], a[140:143], a[188:191], v[40:43]
    buffer_load_dwordx4 v249, s[20:23], s38 offen offset:2048 lds
    v_mfma_f32_16x16x32_bf16 v[44:47], a[140:143], a[192:195], v[44:47]
    v_mfma_f32_16x16x32_bf16 v[48:51], a[144:147], a[180:183], v[48:51]
    v_mfma_f32_16x16x32_bf16 v[52:55], a[144:147], a[184:187], v[52:55]
    s_waitcnt lgkmcnt(0)
    v_mfma_f32_16x16x32_bf16 v[56:59], a[144:147], a[188:191], v[56:59]
    buffer_load_dwordx4 v249, s[20:23], s38 offen offset:3072 lds
    v_mfma_f32_16x16x32_bf16 v[60:63], a[144:147], a[192:195], v[60:63]
    s_add_u32 s38, s38, 0x4000
    v_mfma_f32_16x16x32_bf16 v[64:67], a[148:151], a[180:183], v[64:67]
    v_mfma_f32_16x16x32_bf16 v[68:71], a[148:151], a[184:187], v[68:71]
    v_mfma_f32_16x16x32_bf16 v[72:75], a[148:151], a[188:191], v[72:75]
    v_mfma_f32_16x16x32_bf16 v[76:79], a[148:151], a[192:195], v[76:79]
    v_mfma_f32_16x16x32_bf16 v[80:83], a[152:155], a[180:183], v[80:83]
    v_mfma_f32_16x16x32_bf16 v[84:87], a[152:155], a[184:187], v[84:87]
    v_mfma_f32_16x16x32_bf16 v[88:91], a[152:155], a[188:191], v[88:91]
    v_mfma_f32_16x16x32_bf16 v[92:95], a[152:155], a[192:195], v[92:95]
    v_mfma_f32_16x16x32_bf16 v[96:99], a[156:159], a[180:183], v[96:99]
    v_mfma_f32_16x16x32_bf16 v[100:103], a[156:159], a[184:187], v[100:103]
    v_mfma_f32_16x16x32_bf16 v[104:107], a[156:159], a[188:191], v[104:107]
    v_mfma_f32_16x16x32_bf16 v[108:111], a[156:159], a[192:195], v[108:111]
    v_mfma_f32_16x16x32_bf16 v[112:115], a[160:163], a[180:183], v[112:115]
    v_mfma_f32_16x16x32_bf16 v[116:119], a[160:163], a[184:187], v[116:119]
    v_mfma_f32_16x16x32_bf16 v[120:123], a[160:163], a[188:191], v[120:123]
    v_mfma_f32_16x16x32_bf16 v[124:127], a[160:163], a[192:195], v[124:127]
    s_cmp_ge_u32 s2, 120
    s_cselect_b32 s44, 1, s3
    s_cmp_lg_u32 s44, 0
    s_cbranch_scc1 L_kf_nw_15
    v_lshrrev_b32 v176, 6, v250
    v_and_b32 v177, 0x30, v250
    v_lshl_add_u32 v176, v176, 9, v177
    s_lshr_b32 s44, s2, 1
    s_lshl_b32 s44, s44, 13
    s_and_b32 s45, s2, 1
    s_lshl_b32 s45, s45, 8
    s_add_u32 s44, s44, s45
    s_add_u32 s15, s44, 1048576
    buffer_load_dwordx3 v[160:162], v176, s[32:35], s15 offen offset:0 sc1
    buffer_load_dwordx3 v[164:166], v176, s[32:35], s15 offen offset:64 sc1
    buffer_load_dwordx3 v[168:170], v176, s[32:35], s15 offen offset:128 sc1
    buffer_load_dwordx3 v[172:174], v176, s[32:35], s15 offen offset:192 sc1
L_kf_nw_15:
    s_mov_b32 s24, s10
    s_mov_b32 s25, s11
    s_mov_b32 s26, 0x400000
    s_mov_b32 s27, 0x20000
    v_mov_b32 v252, v226
    v_cvt_pk_bf16_f32 v128, v0, v1
    v_cvt_pk_bf16_f32 v129, v2, v3
    v_cvt_pk_bf16_f32 v130, v16, v17
    v_cvt_pk_bf16_f32 v131, v18, v19
    v_cvt_pk_bf16_f32 v132, v4, v5
    v_cvt_pk_bf16_f32 v133, v6, v7
    v_cvt_pk_bf16_f32 v134, v20, v21
    v_cvt_pk_bf16_f32 v135, v22, v23
    v_cvt_pk_bf16_f32 v136, v8, v9
    v_cvt_pk_bf16_f32 v137, v10, v11
    v_cvt_pk_bf16_f32 v138, v24, v25
    v_cvt_pk_bf16_f32 v139, v26, v27
    v_cvt_pk_bf16_f32 v140, v12, v13
    v_cvt_pk_bf16_f32 v141, v14, v15
    v_cvt_pk_bf16_f32 v142, v28, v29
    v_cvt_pk_bf16_f32 v143, v30, v31
    v_permlane32_swap_b32 v128, v130
    v_permlane32_swap_b32 v129, v131
    v_permlane32_swap_b32 v132, v134
    v_permlane32_swap_b32 v133, v135
    v_permlane32_swap_b32 v136, v138
    v_permlane32_swap_b32 v137, v139
    v_permlane32_swap_b32 v140, v142
    v_permlane32_swap_b32 v141, v143
    v_permlane16_swap_b32 v128, v130
    v_permlane16_swap_b32 v129, v131
    v_permlane16_swap_b32 v132, v134
    v_permlane16_swap_b32 v133, v135
    v_permlane16_swap_b32 v136, v138
    v_permlane16_swap_b32 v137, v139
    v_permlane16_swap_b32 v140, v142
    v_permlane16_swap_b32 v141, v143
    v_accvgpr_write_b32 a0, v128
    v_accvgpr_write_b32 a1, v129
    v_accvgpr_write_b32 a2, v130
    v_accvgpr_write_b32 a3, v131
    v_accvgpr_write_b32 a16, v132
    v_accvgpr_write_b32 a17, v133
    v_accvgpr_write_b32 a18, v134
    v_accvgpr_write_b32 a19, v135
    v_accvgpr_write_b32 a32, v136
    v_accvgpr_write_b32 a33, v137
    v_accvgpr_write_b32 a34, v138
    v_accvgpr_write_b32 a35, v139
    v_accvgpr_write_b32 a48, v140
    v_accvgpr_write_b32 a49, v141
    v_accvgpr_write_b32 a50, v142
    v_accvgpr_write_b32 a51, v143
    v_cvt_pk_bf16_f32 v144, v32, v33
    v_cvt_pk_bf16_f32 v145, v34, v35
    v_cvt_pk_bf16_f32 v146, v48, v49
    v_cvt_pk_bf16_f32 v147, v50, v51
    v_cvt_pk_bf16_f32 v148, v36, v37
    v_cvt_pk_bf16_f32 v149, v38, v39
    v_cvt_pk_bf16_f32 v150, v52, v53
    v_cvt_pk_bf16_f32 v151, v54, v55
    v_cvt_pk_bf16_f32 v152, v40, v41
    v_cvt_pk_bf16_f32 v153, v42, v43
    v_cvt_pk_bf16_f32 v154, v56, v57
    v_cvt_pk_bf16_f32 v155, v58, v59
    v_cvt_pk_bf16_f32 v156, v44, v45
    v_cvt_pk_bf16_f32 v157, v46, v47
    v_cvt_pk_bf16_f32 v158, v60, v61
    v_cvt_pk_bf16_f32 v159, v62, v63
    v_permlane32_swap_b32 v144, v146
    v_permlane32_swap_b32 v145, v147
    v_permlane32_swap_b32 v148, v150
    v_permlane32_swap_b32 v149, v151
    v_permlane32_swap_b32 v152, v154
    v_permlane32_swap_b32 v153, v155
    v_permlane32_swap_b32 v156, v158
    v_permlane32_swap_b32 v157, v159
    v_permlane16_swap_b32 v144, v146
    v_permlane16_swap_b32 v145, v147
    v_permlane16_swap_b32 v148, v150
    v_permlane16_swap_b32 v149, v151
    v_permlane16_swap_b32 v152, v154
    v_permlane16_swap_b32 v153, v155
    v_permlane16_swap_b32 v156, v158
    v_permlane16_swap_b32 v157, v159
    v_accvgpr_write_b32 a4, v144
    v_accvgpr_write_b32 a5, v145
    v_accvgpr_write_b32 a6, v146
    v_accvgpr_write_b32 a7, v147
    v_accvgpr_write_b32 a20, v148
    v_accvgpr_write_b32 a21, v149
    v_accvgpr_write_b32 a22, v150
    v_accvgpr_write_b32 a23, v151
    v_accvgpr_write_b32 a36, v152
    v_accvgpr_write_b32 a37, v153
    v_accvgpr_write_b32 a38, v154
    v_accvgpr_write_b32 a39, v155
    v_accvgpr_write_b32 a52, v156
    v_accvgpr_write_b32 a53, v157
    v_accvgpr_write_b32 a54, v158
    v_accvgpr_write_b32 a55, v159
    v_cvt_pk_bf16_f32 v128, v64, v65
    v_cvt_pk_bf16_f32 v129, v66, v67
    v_cvt_pk_bf16_f32 v130, v80, v81
    v_cvt_pk_bf16_f32 v131, v82, v83
    v_cvt_pk_bf16_f32 v132, v68, v69
    v_cvt_pk_bf16_f32 v133, v70, v71
    v_cvt_pk_bf16_f32 v134, v84, v85
    v_cvt_pk_bf16_f32 v135, v86, v87
    v_cvt_pk_bf16_f32 v136, v72, v73
    v_cvt_pk_bf16_f32 v137, v74, v75
    v_cvt_pk_bf16_f32 v138, v88, v89
    v_cvt_pk_bf16_f32 v139, v90, v91
    v_cvt_pk_bf16_f32 v140, v76, v77
    v_cvt_pk_bf16_f32 v141, v78, v79
    v_cvt_pk_bf16_f32 v142, v92, v93
    v_cvt_pk_bf16_f32 v143, v94, v95
    v_permlane32_swap_b32 v128, v130
    v_permlane32_swap_b32 v129, v131
    v_permlane32_swap_b32 v132, v134
    v_permlane32_swap_b32 v133, v135
    v_permlane32_swap_b32 v136, v138
    v_permlane32_swap_b32 v137, v139
    v_permlane32_swap_b32 v140, v142
    v_permlane32_swap_b32 v141, v143
    v_permlane16_swap_b32 v128, v130
    v_permlane16_swap_b32 v129, v131
    v_permlane16_swap_b32 v132, v134
    v_permlane16_swap_b32 v133, v135
    v_permlane16_swap_b32 v136, v138
    v_permlane16_swap_b32 v137, v139
    v_permlane16_swap_b32 v140, v142
    v_permlane16_swap_b32 v141, v143
    v_accvgpr_write_b32 a8, v128
    v_accvgpr_write_b32 a9, v129
    v_accvgpr_write_b32 a10, v130
    v_accvgpr_write_b32 a11, v131
    v_accvgpr_write_b32 a24, v132
    v_accvgpr_write_b32 a25, v133
    v_accvgpr_write_b32 a26, v134
    v_accvgpr_write_b32 a27, v135
    v_accvgpr_write_b32 a40, v136
    v_accvgpr_write_b32 a41, v137
    v_accvgpr_write_b32 a42, v138
    v_accvgpr_write_b32 a43, v139
    v_accvgpr_write_b32 a56, v140
    v_accvgpr_write_b32 a57, v141
    v_accvgpr_write_b32 a58, v142
    v_accvgpr_write_b32 a59, v143
    v_cvt_pk_bf16_f32 v144, v96, v97
    v_cvt_pk_bf16_f32 v145, v98, v99
    v_cvt_pk_bf16_f32 v146, v112, v113
    v_cvt_pk_bf16_f32 v147, v114, v115
    v_cvt_pk_bf16_f32 v148, v100, v101
    v_cvt_pk_bf16_f32 v149, v102, v103
    v_cvt_pk_bf16_f32 v150, v116, v117
    v_cvt_pk_bf16_f32 v151, v118, v119
    v_cvt_pk_bf16_f32 v152, v104, v105
    v_cvt_pk_bf16_f32 v153, v106, v107
    v_cvt_pk_bf16_f32 v154, v120, v121
    v_cvt_pk_bf16_f32 v155, v122, v123
    v_cvt_pk_bf16_f32 v156, v108, v109
    v_cvt_pk_bf16_f32 v157, v110, v111
    v_cvt_pk_bf16_f32 v158, v124, v125
    v_cvt_pk_bf16_f32 v159, v126, v127
    v_permlane32_swap_b32 v144, v146
    v_permlane32_swap_b32 v145, v147
    v_permlane32_swap_b32 v148, v150
    v_permlane32_swap_b32 v149, v151
    v_permlane32_swap_b32 v152, v154
    v_permlane32_swap_b32 v153, v155
    v_permlane32_swap_b32 v156, v158
    v_permlane32_swap_b32 v157, v159
    v_permlane16_swap_b32 v144, v146
    v_permlane16_swap_b32 v145, v147
    v_permlane16_swap_b32 v148, v150
    v_permlane16_swap_b32 v149, v151
    v_permlane16_swap_b32 v152, v154
    v_permlane16_swap_b32 v153, v155
    v_permlane16_swap_b32 v156, v158
    v_permlane16_swap_b32 v157, v159
    v_accvgpr_write_b32 a12, v144
    v_accvgpr_write_b32 a13, v145
    v_accvgpr_write_b32 a14, v146
    v_accvgpr_write_b32 a15, v147
    v_accvgpr_write_b32 a28, v148
    v_accvgpr_write_b32 a29, v149
    v_accvgpr_write_b32 a30, v150
    v_accvgpr_write_b32 a31, v151
    v_accvgpr_write_b32 a44, v152
    v_accvgpr_write_b32 a45, v153
    v_accvgpr_write_b32 a46, v154
    v_accvgpr_write_b32 a47, v155
    v_accvgpr_write_b32 a60, v156
    v_accvgpr_write_b32 a61, v157
    v_accvgpr_write_b32 a62, v158
    v_accvgpr_write_b32 a63, v159
L_kf_att_3:
    s_waitcnt vmcnt(0)
    s_barrier
    s_cmp_ge_u32 s2, 120
    s_cselect_b32 s44, 1, s3
    s_or_b32 s44, s44, s41
    s_cmp_lg_u32 s44, 0
    s_cbranch_scc1 L_kf_nw_16
L_kf_poll_17:
    v_cmp_ne_u32 vcc, s51, v162
    v_cmp_ne_u32 s[46:47], s51, v166
    s_or_b64 vcc, vcc, s[46:47]
    v_cmp_ne_u32 s[46:47], s51, v170
    s_or_b64 vcc, vcc, s[46:47]
    v_cmp_ne_u32 s[46:47], s51, v174
    s_or_b64 vcc, vcc, s[46:47]
    s_cbranch_vccz L_kf_seen_18
    s_sleep 1
    buffer_load_dwordx3 v[160:162], v176, s[32:35], s15 offen offset:0 sc1
    buffer_load_dwordx3 v[164:166], v176, s[32:35], s15 offen offset:64 sc1
    buffer_load_dwordx3 v[168:170], v176, s[32:35], s15 offen offset:128 sc1
    buffer_load_dwordx3 v[172:174], v176, s[32:35], s15 offen offset:192 sc1
    s_sub_i32 s52, s52, 1
    s_cmp_gt_i32 s52, 0
    s_waitcnt vmcnt(0)
    s_cbranch_scc1 L_kf_poll_17
L_kf_seen_18:
    v_permlane32_swap_b32 v160, v168
    v_permlane32_swap_b32 v161, v169
    v_permlane32_swap_b32 v164, v172
    v_permlane32_swap_b32 v165, v173
    v_add_f32 v160, v160, v168
    v_add_f32 v161, v161, v169
    v_add_f32 v164, v164, v172
    v_add_f32 v165, v165, v173
    s_nop 0
    v_permlane16_swap_b32 v160, v164
    v_permlane16_swap_b32 v161, v165
    v_add_f32 v160, v160, v164
    v_add_f32 v161, v161, v165
    s_nop 0
    v_add_f32_dpp v160, v160, v160 row_ror:8 row_mask:0xf bank_mask:0xf
    v_add_f32_dpp v161, v161, v161 row_ror:8 row_mask:0xf bank_mask:0xf
    s_nop 0
    v_add_f32_dpp v160, v160, v160 row_ror:4 row_mask:0xf bank_mask:0xf
    v_add_f32_dpp v161, v161, v161 row_ror:4 row_mask:0xf bank_mask:0xf
    s_lshr_b32 s44, s2, 4
    s_cmp_eq_u32 s44, 2
    s_cselect_b32 s45, 1.0, 0
    v_cvt_pk_bf16_f32 v164, v160, v161
    v_lshlrev_b32 v162, 16, v164
    v_and_b32 v163, 0xffff0000, v164
    v_add_f32 v162, s45, v162
    v_add_f32 v163, s45, v163
    v_cvt_pk_bf16_f32 v164, v162, v163
    v_lshlrev_b32 v162, 16, v164
    v_and_b32 v163, 0xffff0000, v164
    s_cmp_ge_u32 s2, 64
    s_cselect_b64 vcc, -1, 0
    s_cselect_b32 s44, 2, 1
    s_lshl_b32 s44, s44, 12
    v_cndmask_b32 v162, v162, v160, vcc
    v_cndmask_b32 v163, v163, v161, vcc
    s_lshl_b32 s45, s2, 7
    s_add_u32 s44, s44, s45
    v_lshrrev_b32 v164, 8, v250
    v_lshlrev_b32 v164, 5, v164
    v_lshrrev_b32 v177, 1, v177
    v_add_u32 v164, v164, v177
    buffer_store_dwordx2 v[162:163], v164, s[32:35], s44 offen sc1
L_kf_nw_16:
    s_mov_b32 s28, s12
    s_mov_b32 s29, s13
    s_mov_b32 s30, 0x2e00000
    s_mov_b32 s31, 0x20000
    s_lshr_b32 s44, s43, 3
    s_lshl_b32 s45, s42, 2
    s_add_u32 s44, s44, s45
    s_lshl_b32 s44, s44, 2
    s_and_b32 s45, s43, 7
    s_lshr_b32 s46, s45, 1
    s_add_u32 s46, s46, s44
    s_lshl_b32 s46, s46, 14
    s_and_b32 s47, s45, 1
    s_lshl_b32 s47, s47, 7
    s_add_u32 s46, s46, s47
    s_min_u32 s47, s3, 2
    s_lshl_b32 s47, s47, 21
    s_add_u32 s46, s46, s47
    s_add_u32 s46, s46, 20971520
    v_lshlrev_b32 v227, 4, v250
    buffer_load_dword v255, v227, s[28:31], s46 offen
    s_add_u32 s44, s44, s3
    s_lshl_b32 s46, s44, 14
    s_lshl_b32 s47, s45, 11
    s_add_u32 s46, s46, s47
    s_add_u32 s46, s46, 27262976
    v_and_b32 v227, 0xf0, v250
    v_lshlrev_b32 v227, 3, v227
    v_and_b32 v226, 0x100, v250
    v_lshl_add_u32 v227, v226, 13, v227
    buffer_load_dword v255, v227, s[28:31], s46 offen
    s_lshl_b32 s44, s44, 10
    s_lshl_b32 s45, s45, 7
    s_add_u32 s44, s44, s45
    s_add_u32 s44, s44, 32768
    buffer_load_dword v255, off, s[28:31], s44
    v_lshlrev_b32 v227, 3, v250
    s_lshl_b32 s44, s74, 19
    s_and_b32 s45, s43, 30
    s_lshl_b32 s45, s45, 14
    s_add_u32 s44, s44, s45
    s_lshl_b32 s45, s3, 13
    s_add_u32 s44, s44, s45
    buffer_load_dword v255, v227, s[24:27], s44 offen
    ds_read_b128 a[64:67], v236 offset:24576
    ds_read_b128 a[68:71], v236 offset:25600
    ds_read_b128 a[72:75], v237 offset:24576
    ds_read_b128 a[76:79], v237 offset:25600
    ds_read_b128 a[80:83], v238 offset:24576
    ds_read_b128 a[84:87], v238 offset:25600
    ds_read_b128 a[88:91], v239 offset:24576
    ds_read_b128 a[92:95], v239 offset:25600
    v_accvgpr_read_b32 v208, a196
    v_accvgpr_read_b32 v212, a197
    v_accvgpr_read_b32 v216, a198
    v_accvgpr_read_b32 v220, a199
    v_mov_b32 v224, 0
    v_mov_b32 v225, 0
    s_mov_b32 s40, 7
    s_waitcnt lgkmcnt(7)
    v_mfma_f32_16x16x32_bf16 v[128:131], a[64:67], a[0:3], 0
    v_mfma_f32_16x16x32_bf16 v[136:139], a[64:67], a[16:19], 0
    v_mfma_f32_16x16x32_bf16 v[144:147], a[64:67], a[32:35], 0
    v_mfma_f32_16x16x32_bf16 v[152:155], a[64:67], a[48:51], 0
    ds_read_b128 a[64:67], v236 offset:26624
    s_waitcnt lgkmcnt(7)
    v_mfma_f32_16x16x32_bf16 v[132:135], a[68:71], a[0:3], 0
    v_mfma_f32_16x16x32_bf16 v[140:143], a[68:71], a[16:19], 0
    v_mfma_f32_16x16x32_bf16 v[148:151], a[68:71], a[32:35], 0
    v_mfma_f32_16x16x32_bf16 v[156:159], a[68:71], a[48:51], 0
    ds_read_b128 a[68:71], v236 offset:27648
    s_waitcnt lgkmcnt(7)
    v_mfma_f32_16x16x32_bf16 v[128:131], a[72:75], a[4:7], v[128:131]
    v_mfma_f32_16x16x32_bf16 v[136:139], a[72:75], a[20:23], v[136:139]
    v_mfma_f32_16x16x32_bf16 v[144:147], a[72:75], a[36:39], v[144:147]
    v_mfma_f32_16x16x32_bf16 v[152:155], a[72:75], a[52:55], v[152:155]
    ds_read_b128 a[72:75], v237 offset:26624
    s_waitcnt lgkmcnt(7)
    v_mfma_f32_16x16x32_bf16 v[132:135], a[76:79], a[4:7], v[132:135]
    v_mfma_f32_16x16x32_bf16 v[140:143], a[76:79], a[20:23], v[140:143]
    v_mfma_f32_16x16x32_bf16 v[148:151], a[76:79], a[36:39], v[148:151]
    v_mfma_f32_16x16x32_bf16 v[156:159], a[76:79], a[52:55], v[156:159]
    ds_read_b128 a[76:79], v237 offset:27648
    s_waitcnt lgkmcnt(7)
    v_mfma_f32_16x16x32_bf16 v[128:131], a[80:83], a[8:11], v[128:131]
    v_mfma_f32_16x16x32_bf16 v[136:139], a[80:83], a[24:27], v[136:139]
    v_mfma_f32_16x16x32_bf16 v[144:147], a[80:83], a[40:43], v[144:147]
    v_mfma_f32_16x16x32_bf16 v[152:155], a[80:83], a[56:59], v[152:155]
    ds_read_b128 a[80:83], v238 offset:26624
    s_waitcnt lgkmcnt(7)
    v_mfma_f32_16x16x32_bf16 v[132:135], a[84:87], a[8:11], v[132:135]
    v_mfma_f32_16x16x32_bf16 v[140:143], a[84:87], a[24:27], v[140:143]
    v_mfma_f32_16x16x32_bf16 v[148:151], a[84:87], a[40:43], v[148:151]
    v_mfma_f32_16x16x32_bf16 v[156:159], a[84:87], a[56:59], v[156:159]
    ds_read_b128 a[84:87], v238 offset:27648
    s_waitcnt lgkmcnt(7)
    v_mfma_f32_16x16x32_bf16 v[128:131], a[88:91], a[12:15], v[128:131]
    v_mfma_f32_16x16x32_bf16 v[136:139], a[88:91], a[28:31], v[136:139]
    v_mfma_f32_16x16x32_bf16 v[144:147], a[88:91], a[44:47], v[144:147]
    v_mfma_f32_16x16x32_bf16 v[152:155], a[88:91], a[60:63], v[152:155]
    ds_read_b128 a[88:91], v239 offset:26624
    s_waitcnt lgkmcnt(7)
    v_mfma_f32_16x16x32_bf16 v[132:135], a[92:95], a[12:15], v[132:135]
    v_mfma_f32_16x16x32_bf16 v[140:143], a[92:95], a[28:31], v[140:143]
    v_mfma_f32_16x16x32_bf16 v[148:151], a[92:95], a[44:47], v[148:151]
    v_mfma_f32_16x16x32_bf16 v[156:159], a[92:95], a[60:63], v[156:159]
    ds_read_b128 a[92:95], v239 offset:27648
    v_mov_b32 v192, v208
    v_mov_b32 v193, v212
    v_mov_b32 v194, v216
    v_mov_b32 v195, v220
    v_max3_f32 v192, v192, v128, v129
    v_max3_f32 v193, v193, v136, v137
    v_max3_f32 v194, v194, v144, v145
    v_max3_f32 v195, v195, v152, v153
    v_max3_f32 v192, v192, v130, v131
    v_max3_f32 v193, v193, v138, v139
    v_max3_f32 v194, v194, v146, v147
    v_max3_f32 v195, v195, v154, v155
    v_max3_f32 v192, v192, v132, v133
    v_max3_f32 v193, v193, v140, v141
    v_max3_f32 v194, v194, v148, v149
    v_max3_f32 v195, v195, v156, v157
    v_max3_f32 v192, v192, v134, v135
    v_max3_f32 v193, v193, v142, v143
    v_max3_f32 v194, v194, v150, v151
    v_max3_f32 v195, v195, v158, v159
    v_mov_b32 v196, v192
    v_mov_b32 v197, v193
    v_mov_b32 v198, v194
    v_mov_b32 v199, v195
    v_permlane32_swap_b32 v192, v196
    v_permlane32_swap_b32 v193, v197
    v_permlane32_swap_b32 v194, v198
    v_permlane32_swap_b32 v195, v199
    v_max_f32 v192, v192, v196
    v_max_f32 v193, v193, v197
    v_max_f32 v194, v194, v198
    v_max_f32 v195, v195, v199
    v_mov_b32 v196, v192
    v_mov_b32 v197, v193
    v_mov_b32 v198, v194
    v_mov_b32 v199, v195
    v_permlane16_swap_b32 v192, v196
    v_permlane16_swap_b32 v193, v197
    v_permlane16_swap_b32 v194, v198
    v_permlane16_swap_b32 v195, v199
    v_max_f32 v192, v192, v196
    v_max_f32 v193, v193, v197
    v_max_f32 v194, v194, v198
    v_max_f32 v195, v195, v199
    v_sub_f32 v208, 0, v192
    v_sub_f32 v209, 0, v192
    v_sub_f32 v210, 0, v192
    v_sub_f32 v211, 0, v192
    v_sub_f32 v212, 0, v193
    v_sub_f32 v213, 0, v193
    v_sub_f32 v214, 0, v193
    v_sub_f32 v215, 0, v193
    v_sub_f32 v216, 0, v194
    v_sub_f32 v217, 0, v194
    v_sub_f32 v218, 0, v194
    v_sub_f32 v219, 0, v194
    v_sub_f32 v220, 0, v195
    v_sub_f32 v221, 0, v195
    v_sub_f32 v222, 0, v195
    v_sub_f32 v223, 0, v195
    v_add_f32 v128, v128, v208
    v_add_f32 v129, v129, v208
    v_add_f32 v130, v130, v208
    v_add_f32 v131, v131, v208
    v_add_f32 v132, v132, v208
    v_add_f32 v133, v133, v208
    v_add_f32 v134, v134, v208
    v_add_f32 v135, v135, v208
    v_add_f32 v136, v136, v212
    v_add_f32 v137, v137, v212
    v_add_f32 v138, v138, v212
    v_add_f32 v139, v139, v212
    v_add_f32 v140, v140, v212
    v_add_f32 v141, v141, v212
    v_add_f32 v142, v142, v212
    v_add_f32 v143, v143, v212
    v_add_f32 v144, v144, v216
    v_add_f32 v145, v145, v216
    v_add_f32 v146, v146, v216
    v_add_f32 v147, v147, v216
    v_add_f32 v148, v148, v216
    v_add_f32 v149, v149, v216
    v_add_f32 v150, v150, v216
    v_add_f32 v151, v151, v216
    v_add_f32 v152, v152, v220
    v_add_f32 v153, v153, v220
    v_add_f32 v154, v154, v220
    v_add_f32 v155, v155, v220
    v_add_f32 v156, v156, v220
    v_add_f32 v157, v157, v220
    v_add_f32 v158, v158, v220
    v_add_f32 v159, v159, v220
    v_exp_f32 v128, v128
    v_exp_f32 v129, v129
    v_exp_f32 v130, v130
    v_exp_f32 v131, v131
    v_exp_f32 v132, v132
    v_exp_f32 v133, v133
    v_exp_f32 v134, v134
    v_exp_f32 v135, v135
    v_exp_f32 v136, v136
    v_cvt_pk_bf16_f32 v192, v128, v129
    v_cvt_pk_bf16_f32 v193, v130, v131
    v_cvt_pk_bf16_f32 v194, v132, v133
    v_cvt_pk_bf16_f32 v195, v134, v135
    s_waitcnt lgkmcnt(0)
    v_mfma_f32_16x16x32_bf16 v[160:163], a[64:67], a[0:3], v[208:211]
    v_exp_f32 v137, v137
    v_mfma_f32_16x16x32_bf16 v[168:171], a[64:67], a[16:19], v[212:215]
    ds_read_b64_tr_b16 a[96:97], v240 offset:32768
    v_cvt_pk_bf16_f32 v196, v136, v137
    v_mfma_f32_16x16x32_bf16 v[176:179], a[64:67], a[32:35], v[216:219]
    v_exp_f32 v138, v138
    v_mfma_f32_16x16x32_bf16 v[184:187], a[64:67], a[48:51], v[220:223]
    s_add_u32 m0, s36, 0
    v_mfma_f32_16x16x32_bf16 v[164:167], a[68:71], a[0:3], v[208:211]
    buffer_load_dwordx4 v249, s[20:23], s38 offen offset:0 lds
    v_mfma_f32_16x16x32_bf16 v[172:175], a[68:71], a[16:19], v[212:215]
    v_exp_f32 v139, v139
    v_mfma_f32_16x16x32_bf16 v[180:183], a[68:71], a[32:35], v[216:219]
    ds_read_b64_tr_b16 a[98:99], v240 offset:33792
    v_cvt_pk_bf16_f32 v197, v138, v139
    v_mfma_f32_16x16x32_bf16 v[188:191], a[68:71], a[48:51], v[220:223]
    v_exp_f32 v140, v140
    v_mfma_f32_16x16x32_bf16 v[160:163], a[72:75], a[4:7], v[160:163]
    buffer_load_dwordx4 v249, s[20:23], s38 offen offset:1024 lds
    v_mfma_f32_16x16x32_bf16 v[168:171], a[72:75], a[20:23], v[168:171]
    v_exp_f32 v141, v141
    v_mfma_f32_16x16x32_bf16 v[176:179], a[72:75], a[36:39], v[176:179]
    ds_read_b64_tr_b16 a[100:101], v241 offset:32768
    v_cvt_pk_bf16_f32 v198, v140, v141
    v_mfma_f32_16x16x32_bf16 v[184:187], a[72:75], a[52:55], v[184:187]
    v_exp_f32 v142, v142
    v_mfma_f32_16x16x32_bf16 v[164:167], a[76:79], a[4:7], v[164:167]
    v_mfma_f32_16x16x32_bf16 v[172:175], a[76:79], a[20:23], v[172:175]
    buffer_load_dwordx4 v249, s[20:23], s38 offen offset:2048 lds
    v_mfma_f32_16x16x32_bf16 v[180:183], a[76:79], a[36:39], v[180:183]
    v_exp_f32 v143, v143
    v_mfma_f32_16x16x32_bf16 v[188:191], a[76:79], a[52:55], v[188:191]
    ds_read_b64_tr_b16 a[102:103], v241 offset:33792
    v_cvt_pk_bf16_f32 v199, v142, v143
    v_mfma_f32_16x16x32_bf16 v[160:163], a[80:83], a[8:11], v[160:163]
    v_exp_f32 v144, v144
    v_mfma_f32_16x16x32_bf16 v[168:171], a[80:83], a[24:27], v[168:171]
    buffer_load_dwordx4 v249, s[20:23], s38 offen offset:3072 lds
    v_mfma_f32_16x16x32_bf16 v[176:179], a[80:83], a[40:43], v[176:179]
    s_add_u32 s38, s38, 0x4000
    v_exp_f32 v145, v145
    v_mfma_f32_16x16x32_bf16 v[184:187], a[80:83], a[56:59], v[184:187]
    ds_read_b64_tr_b16 a[104:105], v242 offset:32768
    v_cvt_pk_bf16_f32 v200, v144, v145
    v_mfma_f32_16x16x32_bf16 v[164:167], a[84:87], a[8:11], v[164:167]
    v_exp_f32 v146, v146
    v_mfma_f32_16x16x32_bf16 v[172:175], a[84:87], a[24:27], v[172:175]
    ds_read_b64_tr_b16 a[106:107], v242 offset:33792
    ds_read_b64_tr_b16 a[108:109], v243 offset:32768
    v_mfma_f32_16x16x32_bf16 v[180:183], a[84:87], a[40:43], v[180:183]
    v_exp_f32 v147, v147
    v_mfma_f32_16x16x32_bf16 v[188:191], a[84:87], a[56:59], v[188:191]
    ds_read_b64_tr_b16 a[110:111], v243 offset:33792
    v_cvt_pk_bf16_f32 v201, v146, v147
    v_mfma_f32_16x16x32_bf16 v[160:163], a[88:91], a[12:15], v[160:163]
    v_exp_f32 v148, v148
    v_mfma_f32_16x16x32_bf16 v[168:171], a[88:91], a[28:31], v[168:171]
    ds_read_b64_tr_b16 a[112:113], v244 offset:32768
    ds_read_b64_tr_b16 a[114:115], v244 offset:33792
    v_mfma_f32_16x16x32_bf16 v[176:179], a[88:91], a[44:47], v[176:179]
    v_exp_f32 v149, v149
    v_mfma_f32_16x16x32_bf16 v[184:187], a[88:91], a[60:63], v[184:187]
    ds_read_b64_tr_b16 a[116:117], v245 offset:32768
    v_cvt_pk_bf16_f32 v202, v148, v149
    v_mfma_f32_16x16x32_bf16 v[164:167], a[92:95], a[12:15], v[164:167]
    v_exp_f32 v150, v150
    v_mfma_f32_16x16x32_bf16 v[172:175], a[92:95], a[28:31], v[172:175]
    ds_read_b64_tr_b16 a[118:119], v245 offset:33792
    ds_read_b64_tr_b16 a[120:121], v246 offset:32768
    v_mfma_f32_16x16x32_bf16 v[180:183], a[92:95], a[44:47], v[180:183]
    s_waitcnt lgkmcnt(5)
    v_exp_f32 v151, v151
    v_mfma_f32_16x16x32_bf16 v[188:191], a[92:95], a[60:63], v[188:191]
    ds_read_b64_tr_b16 a[122:123], v246 offset:33792
    v_cvt_pk_bf16_f32 v203, v150, v151
    v_mfma_f32_16x16x32_bf16 v[0:3], a[96:99], v[192:195], 0
    v_exp_f32 v152, v152
    v_mfma_f32_16x16x32_bf16 v[4:7], a[96:99], v[196:199], 0
    ds_read_b64_tr_b16 a[124:125], v247 offset:32768
    v_add_f32 v224, v224, v128
    v_mfma_f32_16x16x32_bf16 v[16:19], a[100:103], v[192:195], 0
    v_exp_f32 v153, v153
    v_mfma_f32_16x16x32_bf16 v[20:23], a[100:103], v[196:199], 0
    ds_read_b64_tr_b16 a[126:127], v247 offset:33792
    v_cvt_pk_bf16_f32 v204, v152, v153
    v_mfma_f32_16x16x32_bf16 v[32:35], a[104:107], v[192:195], 0
    v_exp_f32 v154, v154
    v_mfma_f32_16x16x32_bf16 v[36:39], a[104:107], v[196:199], 0
    ds_read_b128 a[64:67], v236 offset:28672
    v_add_f32 v225, v225, v136
    v_mfma_f32_16x16x32_bf16 v[48:51], a[108:111], v[192:195], 0
    s_waitcnt lgkmcnt(3)
    v_exp_f32 v155, v155
    v_mfma_f32_16x16x32_bf16 v[52:55], a[108:111], v[196:199], 0
    ds_read_b128 a[68:71], v236 offset:29696
    v_cvt_pk_bf16_f32 v205, v154, v155
    v_mfma_f32_16x16x32_bf16 v[64:67], a[112:115], v[192:195], 0
    v_exp_f32 v156, v156
    v_mfma_f32_16x16x32_bf16 v[68:71], a[112:115], v[196:199], 0
    ds_read_b128 a[72:75], v237 offset:28672
    v_add_f32 v224, v224, v129
    v_mfma_f32_16x16x32_bf16 v[80:83], a[116:119], v[192:195], 0
    v_exp_f32 v157, v157
    v_mfma_f32_16x16x32_bf16 v[84:87], a[116:119], v[196:199], 0
    ds_read_b128 a[76:79], v237 offset:29696
    v_cvt_pk_bf16_f32 v206, v156, v157
    v_mfma_f32_16x16x32_bf16 v[96:99], a[120:123], v[192:195], 0
    s_waitcnt lgkmcnt(4)
    v_exp_f32 v158, v158
    v_mfma_f32_16x16x32_bf16 v[100:103], a[120:123], v[196:199], 0
    ds_read_b128 a[80:83], v238 offset:28672
    v_add_f32 v225, v225, v137
    v_mfma_f32_16x16x32_bf16 v[112:115], a[124:127], v[192:195], 0
    v_exp_f32 v159, v159
    v_mfma_f32_16x16x32_bf16 v[116:119], a[124:127], v[196:199], 0
    ds_read_b128 a[84:87], v238 offset:29696
    v_cvt_pk_bf16_f32 v207, v158, v159
    v_mfma_f32_16x16x32_bf16 v[8:11], a[96:99], v[200:203], 0
    v_exp_f32 v160, v160
    v_mfma_f32_16x16x32_bf16 v[12:15], a[96:99], v[204:207], 0
    ds_read_b128 a[88:91], v239 offset:28672
    v_add_f32 v224, v224, v130
    v_mfma_f32_16x16x32_bf16 v[24:27], a[100:103], v[200:203], 0
    v_exp_f32 v161, v161
    v_mfma_f32_16x16x32_bf16 v[28:31], a[100:103], v[204:207], 0
    ds_read_b128 a[92:95], v239 offset:29696
    v_cvt_pk_bf16_f32 v192, v160, v161
    v_mfma_f32_16x16x32_bf16 v[228:231], a[128:131], v[200:203], 0
    v_exp_f32 v162, v162
    v_mfma_f32_16x16x32_bf16 v[40:43], a[104:107], v[200:203], 0
    v_add_f32 v225, v225, v138
    v_add_f32 v224, v224, v131
    v_mfma_f32_16x16x32_bf16 v[44:47], a[104:107], v[204:207], 0
    v_exp_f32 v163, v163
    v_mfma_f32_16x16x32_bf16 v[56:59], a[108:111], v[200:203], 0
    v_cvt_pk_bf16_f32 v193, v162, v163
    v_add_f32 v225, v225, v139
    v_mfma_f32_16x16x32_bf16 v[60:63], a[108:111], v[204:207], 0
    v_exp_f32 v164, v164
    v_mfma_f32_16x16x32_bf16 v[72:75], a[112:115], v[200:203], 0
    v_add_f32 v224, v224, v132
    v_add_f32 v225, v225, v140
    v_mfma_f32_16x16x32_bf16 v[76:79], a[112:115], v[204:207], 0
    v_exp_f32 v165, v165
    v_mfma_f32_16x16x32_bf16 v[232:235], a[128:131], v[204:207], 0
    v_cvt_pk_bf16_f32 v194, v164, v165
    v_add_f32 v224, v224, v133
    v_mfma_f32_16x16x32_bf16 v[88:91], a[116:119], v[200:203], 0
    v_exp_f32 v166, v166
    v_mfma_f32_16x16x32_bf16 v[92:95], a[116:119], v[204:207], 0
    v_add_f32 v225, v225, v141
    v_add_f32 v224, v224, v134
    v_mfma_f32_16x16x32_bf16 v[104:107], a[120:123], v[200:203], 0
    s_waitcnt lgkmcnt(0)
    v_exp_f32 v167, v167
    v_mfma_f32_16x16x32_bf16 v[108:111], a[120:123], v[204:207], 0
    v_cvt_pk_bf16_f32 v195, v166, v167
    v_add_f32 v225, v225, v142
    v_mfma_f32_16x16x32_bf16 v[120:123], a[124:127], v[200:203], 0
    v_exp_f32 v168, v168
    v_mfma_f32_16x16x32_bf16 v[124:127], a[124:127], v[204:207], 0
    v_add_f32 v224, v224, v135
    v_add_f32 v225, v225, v143
    v_mfma_f32_16x16x32_bf16 v[128:131], a[64:67], a[0:3], v[208:211]
    v_exp_f32 v169, v169
    v_mfma_f32_16x16x32_bf16 v[136:139], a[64:67], a[16:19], v[212:215]
    ds_read_b64_tr_b16 a[96:97], v240 offset:34816
    v_cvt_pk_bf16_f32 v196, v168, v169
    v_mfma_f32_16x16x32_bf16 v[144:147], a[64:67], a[32:35], v[216:219]
    v_exp_f32 v170, v170
    v_mfma_f32_16x16x32_bf16 v[152:155], a[64:67], a[48:51], v[220:223]
    s_add_u32 m0, s36, 4096
    v_mfma_f32_16x16x32_bf16 v[132:135], a[68:71], a[0:3], v[208:211]
    buffer_load_dwordx4 v248, s[16:19], s37 offen offset:0 lds
    v_mfma_f32_16x16x32_bf16 v[140:143], a[68:71], a[16:19], v[212:215]
    v_exp_f32 v171, v171
    v_mfma_f32_16x16x32_bf16 v[148:151], a[68:71], a[32:35], v[216:219]
    ds_read_b64_tr_b16 a[98:99], v240 offset:35840
    v_cvt_pk_bf16_f32 v197, v170, v171
    v_mfma_f32_16x16x32_bf16 v[156:159], a[68:71], a[48:51], v[220:223]
    v_exp_f32 v172, v172
    v_mfma_f32_16x16x32_bf16 v[128:131], a[72:75], a[4:7], v[128:131]
    buffer_load_dwordx4 v248, s[16:19], s37 offen offset:1024 lds
    v_mfma_f32_16x16x32_bf16 v[136:139], a[72:75], a[20:23], v[136:139]
    v_exp_f32 v173, v173
    v_mfma_f32_16x16x32_bf16 v[144:147], a[72:75], a[36:39], v[144:147]
    ds_read_b64_tr_b16 a[100:101], v241 offset:34816
    v_cvt_pk_bf16_f32 v198, v172, v173
    v_mfma_f32_16x16x32_bf16 v[152:155], a[72:75], a[52:55], v[152:155]
    v_exp_f32 v174, v174
    v_mfma_f32_16x16x32_bf16 v[132:135], a[76:79], a[4:7], v[132:135]
    v_mfma_f32_16x16x32_bf16 v[140:143], a[76:79], a[20:23], v[140:143]
    buffer_load_dwordx4 v248, s[16:19], s37 offen offset:2048 lds
    v_mfma_f32_16x16x32_bf16 v[148:151], a[76:79], a[36:39], v[148:151]
    v_exp_f32 v175, v175
    v_mfma_f32_16x16x32_bf16 v[156:159], a[76:79], a[52:55], v[156:159]
    ds_read_b64_tr_b16 a[102:103], v241 offset:35840
    v_cvt_pk_bf16_f32 v199, v174, v175
    v_mfma_f32_16x16x32_bf16 v[128:131], a[80:83], a[8:11], v[128:131]
    v_exp_f32 v176, v176
    v_mfma_f32_16x16x32_bf16 v[136:139], a[80:83], a[24:27], v[136:139]
    buffer_load_dwordx4 v248, s[16:19], s37 offen offset:3072 lds
    v_mfma_f32_16x16x32_bf16 v[144:147], a[80:83], a[40:43], v[144:147]
    s_add_u32 s37, s37, 0x4000
    v_exp_f32 v177, v177
    v_mfma_f32_16x16x32_bf16 v[152:155], a[80:83], a[56:59], v[152:155]
    ds_read_b64_tr_b16 a[104:105], v242 offset:34816
    v_cvt_pk_bf16_f32 v200, v176, v177
    v_mfma_f32_16x16x32_bf16 v[132:135], a[84:87], a[8:11], v[132:135]
    v_exp_f32 v178, v178
    v_mfma_f32_16x16x32_bf16 v[140:143], a[84:87], a[24:27], v[140:143]
    ds_read_b64_tr_b16 a[106:107], v242 offset:35840
    ds_read_b64_tr_b16 a[108:109], v243 offset:34816
    v_mfma_f32_16x16x32_bf16 v[148:151], a[84:87], a[40:43], v[148:151]
    v_exp_f32 v179, v179
    v_mfma_f32_16x16x32_bf16 v[156:159], a[84:87], a[56:59], v[156:159]
    ds_read_b64_tr_b16 a[110:111], v243 offset:35840
    v_cvt_pk_bf16_f32 v201, v178, v179
    v_mfma_f32_16x16x32_bf16 v[128:131], a[88:91], a[12:15], v[128:131]
    v_exp_f32 v180, v180
    v_mfma_f32_16x16x32_bf16 v[136:139], a[88:91], a[28:31], v[136:139]
    ds_read_b64_tr_b16 a[112:113], v244 offset:34816
    ds_read_b64_tr_b16 a[114:115], v244 offset:35840
    v_mfma_f32_16x16x32_bf16 v[144:147], a[88:91], a[44:47], v[144:147]
    v_exp_f32 v181, v181
    v_mfma_f32_16x16x32_bf16 v[152:155], a[88:91], a[60:63], v[152:155]
    ds_read_b64_tr_b16 a[116:117], v245 offset:34816
    v_cvt_pk_bf16_f32 v202, v180, v181
    v_mfma_f32_16x16x32_bf16 v[132:135], a[92:95], a[12:15], v[132:135]
    v_exp_f32 v182, v182
    v_mfma_f32_16x16x32_bf16 v[140:143], a[92:95], a[28:31], v[140:143]
    ds_read_b64_tr_b16 a[118:119], v245 offset:35840
    ds_read_b64_tr_b16 a[120:121], v246 offset:34816
    v_mfma_f32_16x16x32_bf16 v[148:151], a[92:95], a[44:47], v[148:151]
    s_waitcnt lgkmcnt(5)
    v_exp_f32 v183, v183
    v_mfma_f32_16x16x32_bf16 v[156:159], a[92:95], a[60:63], v[156:159]
    ds_read_b64_tr_b16 a[122:123], v246 offset:35840
    v_cvt_pk_bf16_f32 v203, v182, v183
    v_mfma_f32_16x16x32_bf16 v[0:3], a[96:99], v[192:195], v[0:3]
    v_exp_f32 v184, v184
    v_mfma_f32_16x16x32_bf16 v[4:7], a[96:99], v[196:199], v[4:7]
    ds_read_b64_tr_b16 a[124:125], v247 offset:34816
    v_add_f32 v224, v224, v160
    v_mfma_f32_16x16x32_bf16 v[16:19], a[100:103], v[192:195], v[16:19]
    v_exp_f32 v185, v185
    v_mfma_f32_16x16x32_bf16 v[20:23], a[100:103], v[196:199], v[20:23]
    ds_read_b64_tr_b16 a[126:127], v247 offset:35840
    v_cvt_pk_bf16_f32 v204, v184, v185
    v_mfma_f32_16x16x32_bf16 v[32:35], a[104:107], v[192:195], v[32:35]
    v_exp_f32 v186, v186
    v_mfma_f32_16x16x32_bf16 v[36:39], a[104:107], v[196:199], v[36:39]
    ds_read_b128 a[64:67], v236 offset:30720
    v_add_f32 v225, v225, v168
    v_mfma_f32_16x16x32_bf16 v[48:51], a[108:111], v[192:195], v[48:51]
    s_waitcnt lgkmcnt(3)
    v_exp_f32 v187, v187
    v_mfma_f32_16x16x32_bf16 v[52:55], a[108:111], v[196:199], v[52:55]
    ds_read_b128 a[68:71], v236 offset:31744
    v_cvt_pk_bf16_f32 v205, v186, v187
    v_mfma_f32_16x16x32_bf16 v[64:67], a[112:115], v[192:195], v[64:67]
    v_exp_f32 v188, v188
    v_mfma_f32_16x16x32_bf16 v[68:71], a[112:115], v[196:199], v[68:71]
    ds_read_b128 a[72:75], v237 offset:30720
    v_add_f32 v224, v224, v161
    v_mfma_f32_16x16x32_bf16 v[80:83], a[116:119], v[192:195], v[80:83]
    v_exp_f32 v189, v189
    v_mfma_f32_16x16x32_bf16 v[84:87], a[116:119], v[196:199], v[84:87]
    ds_read_b128 a[76:79], v237 offset:31744
    v_cvt_pk_bf16_f32 v206, v188, v189
    v_mfma_f32_16x16x32_bf16 v[96:99], a[120:123], v[192:195], v[96:99]
    s_waitcnt lgkmcnt(4)
    v_exp_f32 v190, v190
    v_mfma_f32_16x16x32_bf16 v[100:103], a[120:123], v[196:199], v[100:103]
    ds_read_b128 a[80:83], v238 offset:30720
    v_add_f32 v225, v225, v169
    v_mfma_f32_16x16x32_bf16 v[112:115], a[124:127], v[192:195], v[112:115]
    v_exp_f32 v191, v191
    v_mfma_f32_16x16x32_bf16 v[116:119], a[124:127], v[196:199], v[116:119]
    ds_read_b128 a[84:87], v238 offset:31744
    v_cvt_pk_bf16_f32 v207, v190, v191
    v_mfma_f32_16x16x32_bf16 v[8:11], a[96:99], v[200:203], v[8:11]
    v_exp_f32 v128, v128
    v_mfma_f32_16x16x32_bf16 v[12:15], a[96:99], v[204:207], v[12:15]
    ds_read_b128 a[88:91], v239 offset:30720
    v_add_f32 v224, v224, v162
    v_mfma_f32_16x16x32_bf16 v[24:27], a[100:103], v[200:203], v[24:27]
    v_exp_f32 v129, v129
    v_mfma_f32_16x16x32_bf16 v[28:31], a[100:103], v[204:207], v[28:31]
    ds_read_b128 a[92:95], v239 offset:31744
    v_cvt_pk_bf16_f32 v192, v128, v129
    v_mfma_f32_16x16x32_bf16 v[228:231], a[128:131], v[200:203], v[228:231]
    v_exp_f32 v130, v130
    v_mfma_f32_16x16x32_bf16 v[40:43], a[104:107], v[200:203], v[40:43]
    v_add_f32 v225, v225, v170
    v_add_f32 v224, v224, v163
    v_mfma_f32_16x16x32_bf16 v[44:47], a[104:107], v[204:207], v[44:47]
    v_exp_f32 v131, v131
    v_mfma_f32_16x16x32_bf16 v[56:59], a[108:111], v[200:203], v[56:59]
    v_cvt_pk_bf16_f32 v193, v130, v131
    v_add_f32 v225, v225, v171
    v_mfma_f32_16x16x32_bf16 v[60:63], a[108:111], v[204:207], v[60:63]
    v_exp_f32 v132, v132
    v_mfma_f32_16x16x32_bf16 v[72:75], a[112:115], v[200:203], v[72:75]
    v_add_f32 v224, v224, v164
    v_add_f32 v225, v225, v172
    v_mfma_f32_16x16x32_bf16 v[76:79], a[112:115], v[204:207], v[76:79]
    v_exp_f32 v133, v133
    v_mfma_f32_16x16x32_bf16 v[232:235], a[128:131], v[204:207], v[232:235]
    v_cvt_pk_bf16_f32 v194, v132, v133
    v_add_f32 v224, v224, v165
    v_mfma_f32_16x16x32_bf16 v[88:91], a[116:119], v[200:203], v[88:91]
    v_exp_f32 v134, v134
    v_mfma_f32_16x16x32_bf16 v[92:95], a[116:119], v[204:207], v[92:95]
    v_add_f32 v225, v225, v173
    v_add_f32 v224, v224, v166
    v_mfma_f32_16x16x32_bf16 v[104:107], a[120:123], v[200:203], v[104:107]
    s_waitcnt lgkmcnt(0)
    v_exp_f32 v135, v135
    v_mfma_f32_16x16x32_bf16 v[108:111], a[120:123], v[204:207], v[108:111]
    v_cvt_pk_bf16_f32 v195, v134, v135
    v_add_f32 v225, v225, v174
    v_mfma_f32_16x16x32_bf16 v[120:123], a[124:127], v[200:203], v[120:123]
    v_exp_f32 v136, v136
    v_mfma_f32_16x16x32_bf16 v[124:127], a[124:127], v[204:207], v[124:127]
    v_add_f32 v224, v224, v167
    v_add_f32 v225, v225, v175
    v_mfma_f32_16x16x32_bf16 v[160:163], a[64:67], a[0:3], v[208:211]
    v_exp_f32 v137, v137
    v_mfma_f32_16x16x32_bf16 v[168:171], a[64:67], a[16:19], v[212:215]
    ds_read_b64_tr_b16 a[96:97], v240 offset:16384
    v_cvt_pk_bf16_f32 v196, v136, v137
    v_mfma_f32_16x16x32_bf16 v[176:179], a[64:67], a[32:35], v[216:219]
    v_exp_f32 v138, v138
    v_mfma_f32_16x16x32_bf16 v[184:187], a[64:67], a[48:51], v[220:223]
    s_add_u32 m0, s36, 20480
    v_mfma_f32_16x16x32_bf16 v[164:167], a[68:71], a[0:3], v[208:211]
    buffer_load_dwordx4 v249, s[20:23], s38 offen offset:0 lds
    v_mfma_f32_16x16x32_bf16 v[172:175], a[68:71], a[16:19], v[212:215]
    v_exp_f32 v139, v139
    v_mfma_f32_16x16x32_bf16 v[180:183], a[68:71], a[32:35], v[216:219]
    ds_read_b64_tr_b16 a[98:99], v240 offset:17408
    v_cvt_pk_bf16_f32 v197, v138, v139
    v_mfma_f32_16x16x32_bf16 v[188:191], a[68:71], a[48:51], v[220:223]
    v_exp_f32 v140, v140
    v_mfma_f32_16x16x32_bf16 v[160:163], a[72:75], a[4:7], v[160:163]
    buffer_load_dwordx4 v249, s[20:23], s38 offen offset:1024 lds
    v_mfma_f32_16x16x32_bf16 v[168:171], a[72:75], a[20:23], v[168:171]
    v_exp_f32 v141, v141
    v_mfma_f32_16x16x32_bf16 v[176:179], a[72:75], a[36:39], v[176:179]
    ds_read_b64_tr_b16 a[100:101], v241 offset:16384
    v_cvt_pk_bf16_f32 v198, v140, v141
    v_mfma_f32_16x16x32_bf16 v[184:187], a[72:75], a[52:55], v[184:187]
    v_exp_f32 v142, v142
    v_mfma_f32_16x16x32_bf16 v[164:167], a[76:79], a[4:7], v[164:167]
    v_mfma_f32_16x16x32_bf16 v[172:175], a[76:79], a[20:23], v[172:175]
    buffer_load_dwordx4 v249, s[20:23], s38 offen offset:2048 lds
    v_mfma_f32_16x16x32_bf16 v[180:183], a[76:79], a[36:39], v[180:183]
    v_exp_f32 v143, v143
    v_mfma_f32_16x16x32_bf16 v[188:191], a[76:79], a[52:55], v[188:191]
    ds_read_b64_tr_b16 a[102:103], v241 offset:17408
    v_cvt_pk_bf16_f32 v199, v142, v143
    v_mfma_f32_16x16x32_bf16 v[160:163], a[80:83], a[8:11], v[160:163]
    v_exp_f32 v144, v144
    v_mfma_f32_16x16x32_bf16 v[168:171], a[80:83], a[24:27], v[168:171]
    buffer_load_dwordx4 v249, s[20:23], s38 offen offset:3072 lds
    v_mfma_f32_16x16x32_bf16 v[176:179], a[80:83], a[40:43], v[176:179]
    s_add_u32 s38, s38, 0x4000
    v_exp_f32 v145, v145
    v_mfma_f32_16x16x32_bf16 v[184:187], a[80:83], a[56:59], v[184:187]
    ds_read_b64_tr_b16 a[104:105], v242 offset:16384
    v_cvt_pk_bf16_f32 v200, v144, v145
    v_mfma_f32_16x16x32_bf16 v[164:167], a[84:87], a[8:11], v[164:167]
    v_exp_f32 v146, v146
    v_mfma_f32_16x16x32_bf16 v[172:175], a[84:87], a[24:27], v[172:175]
    ds_read_b64_tr_b16 a[106:107], v242 offset:17408
    ds_read_b64_tr_b16 a[108:109], v243 offset:16384
    v_mfma_f32_16x16x32_bf16 v[180:183], a[84:87], a[40:43], v[180:183]
    v_exp_f32 v147, v147
    v_mfma_f32_16x16x32_bf16 v[188:191], a[84:87], a[56:59], v[188:191]
    ds_read_b64_tr_b16 a[110:111], v243 offset:17408
    v_cvt_pk_bf16_f32 v201, v146, v147
    v_mfma_f32_16x16x32_bf16 v[160:163], a[88:91], a[12:15], v[160:163]
    v_exp_f32 v148, v148
    v_mfma_f32_16x16x32_bf16 v[168:171], a[88:91], a[28:31], v[168:171]
    ds_read_b64_tr_b16 a[112:113], v244 offset:16384
    ds_read_b64_tr_b16 a[114:115], v244 offset:17408
    v_mfma_f32_16x16x32_bf16 v[176:179], a[88:91], a[44:47], v[176:179]
    v_exp_f32 v149, v149
    v_mfma_f32_16x16x32_bf16 v[184:187], a[88:91], a[60:63], v[184:187]
    ds_read_b64_tr_b16 a[116:117], v245 offset:16384
    v_cvt_pk_bf16_f32 v202, v148, v149
    v_mfma_f32_16x16x32_bf16 v[164:167], a[92:95], a[12:15], v[164:167]
    v_exp_f32 v150, v150
    v_mfma_f32_16x16x32_bf16 v[172:175], a[92:95], a[28:31], v[172:175]
    ds_read_b64_tr_b16 a[118:119], v245 offset:17408
    ds_read_b64_tr_b16 a[120:121], v246 offset:16384
    v_mfma_f32_16x16x32_bf16 v[180:183], a[92:95], a[44:47], v[180:183]
    s_waitcnt lgkmcnt(5)
    v_exp_f32 v151, v151
    v_mfma_f32_16x16x32_bf16 v[188:191], a[92:95], a[60:63], v[188:191]
    ds_read_b64_tr_b16 a[122:123], v246 offset:17408
    v_cvt_pk_bf16_f32 v203, v150, v151
    v_mfma_f32_16x16x32_bf16 v[0:3], a[96:99], v[192:195], v[0:3]
    v_exp_f32 v152, v152
    v_mfma_f32_16x16x32_bf16 v[4:7], a[96:99], v[196:199], v[4:7]
    ds_read_b64_tr_b16 a[124:125], v247 offset:16384
    v_add_f32 v224, v224, v128
    v_mfma_f32_16x16x32_bf16 v[16:19], a[100:103], v[192:195], v[16:19]
    v_exp_f32 v153, v153
    v_mfma_f32_16x16x32_bf16 v[20:23], a[100:103], v[196:199], v[20:23]
    ds_read_b64_tr_b16 a[126:127], v247 offset:17408
    v_cvt_pk_bf16_f32 v204, v152, v153
    v_mfma_f32_16x16x32_bf16 v[32:35], a[104:107], v[192:195], v[32:35]
    v_exp_f32 v154, v154
    v_mfma_f32_16x16x32_bf16 v[36:39], a[104:107], v[196:199], v[36:39]
    ds_read_b128 a[64:67], v236 offset:36864
    v_add_f32 v225, v225, v136
    v_mfma_f32_16x16x32_bf16 v[48:51], a[108:111], v[192:195], v[48:51]
    s_waitcnt lgkmcnt(3)
    v_exp_f32 v155, v155
    v_mfma_f32_16x16x32_bf16 v[52:55], a[108:111], v[196:199], v[52:55]
    ds_read_b128 a[68:71], v236 offset:37888
    v_cvt_pk_bf16_f32 v205, v154, v155
    v_mfma_f32_16x16x32_bf16 v[64:67], a[112:115], v[192:195], v[64:67]
    v_exp_f32 v156, v156
    v_mfma_f32_16x16x32_bf16 v[68:71], a[112:115], v[196:199], v[68:71]
    ds_read_b128 a[72:75], v237 offset:36864
    v_add_f32 v224, v224, v129
    v_mfma_f32_16x16x32_bf16 v[80:83], a[116:119], v[192:195], v[80:83]
    v_exp_f32 v157, v157
    v_mfma_f32_16x16x32_bf16 v[84:87], a[116:119], v[196:199], v[84:87]
    ds_read_b128 a[76:79], v237 offset:37888
    v_cvt_pk_bf16_f32 v206, v156, v157
    v_mfma_f32_16x16x32_bf16 v[96:99], a[120:123], v[192:195], v[96:99]
    s_waitcnt lgkmcnt(4)
    v_exp_f32 v158, v158
    v_mfma_f32_16x16x32_bf16 v[100:103], a[120:123], v[196:199], v[100:103]
    ds_read_b128 a[80:83], v238 offset:36864
    v_add_f32 v225, v225, v137
    v_mfma_f32_16x16x32_bf16 v[112:115], a[124:127], v[192:195], v[112:115]
    v_exp_f32 v159, v159
    v_mfma_f32_16x16x32_bf16 v[116:119], a[124:127], v[196:199], v[116:119]
    ds_read_b128 a[84:87], v238 offset:37888
    v_cvt_pk_bf16_f32 v207, v158, v159
    v_mfma_f32_16x16x32_bf16 v[8:11], a[96:99], v[200:203], v[8:11]
    v_exp_f32 v160, v160
    v_mfma_f32_16x16x32_bf16 v[12:15], a[96:99], v[204:207], v[12:15]
    ds_read_b128 a[88:91], v239 offset:36864
    v_add_f32 v224, v224, v130
    v_mfma_f32_16x16x32_bf16 v[24:27], a[100:103], v[200:203], v[24:27]
    v_exp_f32 v161, v161
    v_mfma_f32_16x16x32_bf16 v[28:31], a[100:103], v[204:207], v[28:31]
    ds_read_b128 a[92:95], v239 offset:37888
    v_cvt_pk_bf16_f32 v192, v160, v161
    v_mfma_f32_16x16x32_bf16 v[228:231], a[128:131], v[200:203], v[228:231]
    v_exp_f32 v162, v162
    v_mfma_f32_16x16x32_bf16 v[40:43], a[104:107], v[200:203], v[40:43]
    v_add_f32 v225, v225, v138
    v_add_f32 v224, v224, v131
    v_mfma_f32_16x16x32_bf16 v[44:47], a[104:107], v[204:207], v[44:47]
    v_exp_f32 v163, v163
    v_mfma_f32_16x16x32_bf16 v[56:59], a[108:111], v[200:203], v[56:59]
    v_cvt_pk_bf16_f32 v193, v162, v163
    v_add_f32 v225, v225, v139
    v_mfma_f32_16x16x32_bf16 v[60:63], a[108:111], v[204:207], v[60:63]
    v_exp_f32 v164, v164
    v_mfma_f32_16x16x32_bf16 v[72:75], a[112:115], v[200:203], v[72:75]
    v_add_f32 v224, v224, v132
    v_add_f32 v225, v225, v140
    v_mfma_f32_16x16x32_bf16 v[76:79], a[112:115], v[204:207], v[76:79]
    v_exp_f32 v165, v165
    v_mfma_f32_16x16x32_bf16 v[232:235], a[128:131], v[204:207], v[232:235]
    v_cvt_pk_bf16_f32 v194, v164, v165
    v_add_f32 v224, v224, v133
    v_mfma_f32_16x16x32_bf16 v[88:91], a[116:119], v[200:203], v[88:91]
    v_exp_f32 v166, v166
    v_mfma_f32_16x16x32_bf16 v[92:95], a[116:119], v[204:207], v[92:95]
    v_add_f32 v225, v225, v141
    v_add_f32 v224, v224, v134
    v_mfma_f32_16x16x32_bf16 v[104:107], a[120:123], v[200:203], v[104:107]
    s_waitcnt lgkmcnt(0)
    v_exp_f32 v167, v167
    v_mfma_f32_16x16x32_bf16 v[108:111], a[120:123], v[204:207], v[108:111]
    v_cvt_pk_bf16_f32 v195, v166, v167
    v_add_f32 v225, v225, v142
    v_mfma_f32_16x16x32_bf16 v[120:123], a[124:127], v[200:203], v[120:123]
    v_exp_f32 v168, v168
    v_mfma_f32_16x16x32_bf16 v[124:127], a[124:127], v[204:207], v[124:127]
    v_add_f32 v224, v224, v135
    v_add_f32 v225, v225, v143
    v_mfma_f32_16x16x32_bf16 v[128:131], a[64:67], a[0:3], v[208:211]
    v_exp_f32 v169, v169
    v_mfma_f32_16x16x32_bf16 v[136:139], a[64:67], a[16:19], v[212:215]
    ds_read_b64_tr_b16 a[96:97], v240 offset:18432
    v_cvt_pk_bf16_f32 v196, v168, v169
    v_mfma_f32_16x16x32_bf16 v[144:147], a[64:67], a[32:35], v[216:219]
    v_exp_f32 v170, v170
    v_mfma_f32_16x16x32_bf16 v[152:155], a[64:67], a[48:51], v[220:223]
    s_add_u32 m0, s36, 8192
    v_mfma_f32_16x16x32_bf16 v[132:135], a[68:71], a[0:3], v[208:211]
    buffer_load_dwordx4 v248, s[16:19], s37 offen offset:0 lds
    v_mfma_f32_16x16x32_bf16 v[140:143], a[68:71], a[16:19], v[212:215]
    v_exp_f32 v171, v171
    v_mfma_f32_16x16x32_bf16 v[148:151], a[68:71], a[32:35], v[216:219]
    ds_read_b64_tr_b16 a[98:99], v240 offset:19456
    v_cvt_pk_bf16_f32 v197, v170, v171
    v_mfma_f32_16x16x32_bf16 v[156:159], a[68:71], a[48:51], v[220:223]
    v_exp_f32 v172, v172
    v_mfma_f32_16x16x32_bf16 v[128:131], a[72:75], a[4:7], v[128:131]
    buffer_load_dwordx4 v248, s[16:19], s37 offen offset:1024 lds
    v_mfma_f32_16x16x32_bf16 v[136:139], a[72:75], a[20:23], v[136:139]
    v_exp_f32 v173, v173
    v_mfma_f32_16x16x32_bf16 v[144:147], a[72:75], a[36:39], v[144:147]
    ds_read_b64_tr_b16 a[100:101], v241 offset:18432
    v_cvt_pk_bf16_f32 v198, v172, v173
    v_mfma_f32_16x16x32_bf16 v[152:155], a[72:75], a[52:55], v[152:155]
    v_exp_f32 v174, v174
    v_mfma_f32_16x16x32_bf16 v[132:135], a[76:79], a[4:7], v[132:135]
    v_mfma_f32_16x16x32_bf16 v[140:143], a[76:79], a[20:23], v[140:143]
    buffer_load_dwordx4 v248, s[16:19], s37 offen offset:2048 lds
    v_mfma_f32_16x16x32_bf16 v[148:151], a[76:79], a[36:39], v[148:151]
    v_exp_f32 v175, v175
    v_mfma_f32_16x16x32_bf16 v[156:159], a[76:79], a[52:55], v[156:159]
    ds_read_b64_tr_b16 a[102:103], v241 offset:19456
    v_cvt_pk_bf16_f32 v199, v174, v175
    v_mfma_f32_16x16x32_bf16 v[128:131], a[80:83], a[8:11], v[128:131]
    v_exp_f32 v176, v176
    v_mfma_f32_16x16x32_bf16 v[136:139], a[80:83], a[24:27], v[136:139]
    buffer_load_dwordx4 v248, s[16:19], s37 offen offset:3072 lds
    v_mfma_f32_16x16x32_bf16 v[144:147], a[80:83], a[40:43], v[144:147]
    s_add_u32 s37, s37, 0x4000
    v_exp_f32 v177, v177
    v_mfma_f32_16x16x32_bf16 v[152:155], a[80:83], a[56:59], v[152:155]
    ds_read_b64_tr_b16 a[104:105], v242 offset:18432
    v_cvt_pk_bf16_f32 v200, v176, v177
    v_mfma_f32_16x16x32_bf16 v[132:135], a[84:87], a[8:11], v[132:135]
    v_exp_f32 v178, v178
    v_mfma_f32_16x16x32_bf16 v[140:143], a[84:87], a[24:27], v[140:143]
    ds_read_b64_tr_b16 a[106:107], v242 offset:19456
    ds_read_b64_tr_b16 a[108:109], v243 offset:18432
    v_mfma_f32_16x16x32_bf16 v[148:151], a[84:87], a[40:43], v[148:151]
    v_exp_f32 v179, v179
    v_mfma_f32_16x16x32_bf16 v[156:159], a[84:87], a[56:59], v[156:159]
    ds_read_b64_tr_b16 a[110:111], v243 offset:19456
    v_cvt_pk_bf16_f32 v201, v178, v179
    v_mfma_f32_16x16x32_bf16 v[128:131], a[88:91], a[12:15], v[128:131]
    v_exp_f32 v180, v180
    v_mfma_f32_16x16x32_bf16 v[136:139], a[88:91], a[28:31], v[136:139]
    ds_read_b64_tr_b16 a[112:113], v244 offset:18432
    ds_read_b64_tr_b16 a[114:115], v244 offset:19456
    v_mfma_f32_16x16x32_bf16 v[144:147], a[88:91], a[44:47], v[144:147]
    v_exp_f32 v181, v181
    v_mfma_f32_16x16x32_bf16 v[152:155], a[88:91], a[60:63], v[152:155]
    ds_read_b64_tr_b16 a[116:117], v245 offset:18432
    v_cvt_pk_bf16_f32 v202, v180, v181
    v_mfma_f32_16x16x32_bf16 v[132:135], a[92:95], a[12:15], v[132:135]
    v_exp_f32 v182, v182
    v_mfma_f32_16x16x32_bf16 v[140:143], a[92:95], a[28:31], v[140:143]
    ds_read_b64_tr_b16 a[118:119], v245 offset:19456
    ds_read_b64_tr_b16 a[120:121], v246 offset:18432
    v_mfma_f32_16x16x32_bf16 v[148:151], a[92:95], a[44:47], v[148:151]
    s_waitcnt lgkmcnt(5)
    v_exp_f32 v183, v183
    v_mfma_f32_16x16x32_bf16 v[156:159], a[92:95], a[60:63], v[156:159]
    ds_read_b64_tr_b16 a[122:123], v246 offset:19456
    v_cvt_pk_bf16_f32 v203, v182, v183
    v_mfma_f32_16x16x32_bf16 v[0:3], a[96:99], v[192:195], v[0:3]
    v_exp_f32 v184, v184
    v_mfma_f32_16x16x32_bf16 v[4:7], a[96:99], v[196:199], v[4:7]
    ds_read_b64_tr_b16 a[124:125], v247 offset:18432
    v_add_f32 v224, v224, v160
    v_mfma_f32_16x16x32_bf16 v[16:19], a[100:103], v[192:195], v[16:19]
    v_exp_f32 v185, v185
    v_mfma_f32_16x16x32_bf16 v[20:23], a[100:103], v[196:199], v[20:23]
    ds_read_b64_tr_b16 a[126:127], v247 offset:19456
    v_cvt_pk_bf16_f32 v204, v184, v185
    v_mfma_f32_16x16x32_bf16 v[32:35], a[104:107], v[192:195], v[32:35]
    v_exp_f32 v186, v186
    v_mfma_f32_16x16x32_bf16 v[36:39], a[104:107], v[196:199], v[36:39]
    ds_read_b128 a[64:67], v236 offset:38912
    v_add_f32 v225, v225, v168
    v_mfma_f32_16x16x32_bf16 v[48:51], a[108:111], v[192:195], v[48:51]
    s_waitcnt lgkmcnt(3)
    v_exp_f32 v187, v187
    v_mfma_f32_16x16x32_bf16 v[52:55], a[108:111], v[196:199], v[52:55]
    ds_read_b128 a[68:71], v236 offset:39936
    v_cvt_pk_bf16_f32 v205, v186, v187
    v_mfma_f32_16x16x32_bf16 v[64:67], a[112:115], v[192:195], v[64:67]
    v_exp_f32 v188, v188
    v_mfma_f32_16x16x32_bf16 v[68:71], a[112:115], v[196:199], v[68:71]
    ds_read_b128 a[72:75], v237 offset:38912
    v_add_f32 v224, v224, v161
    v_mfma_f32_16x16x32_bf16 v[80:83], a[116:119], v[192:195], v[80:83]
    v_exp_f32 v189, v189
    v_mfma_f32_16x16x32_bf16 v[84:87], a[116:119], v[196:199], v[84:87]
    ds_read_b128 a[76:79], v237 offset:39936
    v_cvt_pk_bf16_f32 v206, v188, v189
    v_mfma_f32_16x16x32_bf16 v[96:99], a[120:123], v[192:195], v[96:99]
    s_waitcnt lgkmcnt(4)
    v_exp_f32 v190, v190
    v_mfma_f32_16x16x32_bf16 v[100:103], a[120:123], v[196:199], v[100:103]
    ds_read_b128 a[80:83], v238 offset:38912
    v_add_f32 v225, v225, v169
    v_mfma_f32_16x16x32_bf16 v[112:115], a[124:127], v[192:195], v[112:115]
    v_exp_f32 v191, v191
    v_mfma_f32_16x16x32_bf16 v[116:119], a[124:127], v[196:199], v[116:119]
    ds_read_b128 a[84:87], v238 offset:39936
    v_cvt_pk_bf16_f32 v207, v190, v191
    v_mfma_f32_16x16x32_bf16 v[8:11], a[96:99], v[200:203], v[8:11]
    v_exp_f32 v128, v128
    v_mfma_f32_16x16x32_bf16 v[12:15], a[96:99], v[204:207], v[12:15]
    ds_read_b128 a[88:91], v239 offset:38912
    v_add_f32 v224, v224, v162
    v_mfma_f32_16x16x32_bf16 v[24:27], a[100:103], v[200:203], v[24:27]
    v_exp_f32 v129, v129
    v_mfma_f32_16x16x32_bf16 v[28:31], a[100:103], v[204:207], v[28:31]
    ds_read_b128 a[92:95], v239 offset:39936
    v_cvt_pk_bf16_f32 v192, v128, v129
    v_mfma_f32_16x16x32_bf16 v[228:231], a[128:131], v[200:203], v[228:231]
    v_exp_f32 v130, v130
    v_mfma_f32_16x16x32_bf16 v[40:43], a[104:107], v[200:203], v[40:43]
    v_add_f32 v225, v225, v170
    v_add_f32 v224, v224, v163
    v_mfma_f32_16x16x32_bf16 v[44:47], a[104:107], v[204:207], v[44:47]
    v_exp_f32 v131, v131
    v_mfma_f32_16x16x32_bf16 v[56:59], a[108:111], v[200:203], v[56:59]
    v_cvt_pk_bf16_f32 v193, v130, v131
    v_add_f32 v225, v225, v171
    v_mfma_f32_16x16x32_bf16 v[60:63], a[108:111], v[204:207], v[60:63]
    v_exp_f32 v132, v132
    v_mfma_f32_16x16x32_bf16 v[72:75], a[112:115], v[200:203], v[72:75]
    v_add_f32 v224, v224, v164
    v_add_f32 v225, v225, v172
    v_mfma_f32_16x16x32_bf16 v[76:79], a[112:115], v[204:207], v[76:79]
    v_exp_f32 v133, v133
    v_mfma_f32_16x16x32_bf16 v[232:235], a[128:131], v[204:207], v[232:235]
    v_cvt_pk_bf16_f32 v194, v132, v133
    v_add_f32 v224, v224, v165
    v_mfma_f32_16x16x32_bf16 v[88:91], a[116:119], v[200:203], v[88:91]
    v_exp_f32 v134, v134
    v_mfma_f32_16x16x32_bf16 v[92:95], a[116:119], v[204:207], v[92:95]
    v_add_f32 v225, v225, v173
    v_add_f32 v224, v224, v166
    v_mfma_f32_16x16x32_bf16 v[104:107], a[120:123], v[200:203], v[104:107]
    s_waitcnt lgkmcnt(0)
    v_exp_f32 v135, v135
    v_mfma_f32_16x16x32_bf16 v[108:111], a[120:123], v[204:207], v[108:111]
    v_cvt_pk_bf16_f32 v195, v134, v135
    v_add_f32 v225, v225, v174
    v_mfma_f32_16x16x32_bf16 v[120:123], a[124:127], v[200:203], v[120:123]
    s_waitcnt vmcnt(0)
    v_exp_f32 v136, v136
    v_mfma_f32_16x16x32_bf16 v[124:127], a[124:127], v[204:207], v[124:127]
    v_add_f32 v224, v224, v167
    v_add_f32 v225, v225, v175
    s_or_b32 s44, s3, s41
    s_cmp_lg_u32 s44, 0
    s_cbranch_scc1 L_kf_na_19
    s_mul_i32 s44, s85, 6
    s_lshl_b64 s[46:47], 1, s44
    s_or_b32 s47, s47, 0x10000
    s_lshl_b32 s44, s42, 3
    v_mov_b32 v226, s46
    v_mov_b32 v227, s47
    v_mov_b32 v254, s44
    s_mov_b64 exec, 1
    global_atomic_add_x2 v254, v[226:227], s[98:99] sc1
    s_mov_b64 exec, -1
L_kf_na_19:
L_kf_loop_4:
    v_mfma_f32_16x16x32_bf16 v[160:163], a[64:67], a[0:3], v[208:211]
    s_barrier
    v_exp_f32 v137, v137
    v_mfma_f32_16x16x32_bf16 v[168:171], a[64:67], a[16:19], v[212:215]
    ds_read_b64_tr_b16 a[96:97], v240 offset:0
    v_cvt_pk_bf16_f32 v196, v136, v137
    v_mfma_f32_16x16x32_bf16 v[176:179], a[64:67], a[32:35], v[216:219]
    v_exp_f32 v138, v138
    v_mfma_f32_16x16x32_bf16 v[184:187], a[64:67], a[48:51], v[220:223]
    s_add_u32 m0, s36, 32768
    v_mfma_f32_16x16x32_bf16 v[164:167], a[68:71], a[0:3], v[208:211]
    buffer_load_dwordx4 v249, s[20:23], s38 offen offset:0 lds
    v_mfma_f32_16x16x32_bf16 v[172:175], a[68:71], a[16:19], v[212:215]
    v_exp_f32 v139, v139
    v_mfma_f32_16x16x32_bf16 v[180:183], a[68:71], a[32:35], v[216:219]
    ds_read_b64_tr_b16 a[98:99], v240 offset:1024
    v_cvt_pk_bf16_f32 v197, v138, v139
    v_mfma_f32_16x16x32_bf16 v[188:191], a[68:71], a[48:51], v[220:223]
    v_exp_f32 v140, v140
    v_mfma_f32_16x16x32_bf16 v[160:163], a[72:75], a[4:7], v[160:163]
    buffer_load_dwordx4 v249, s[20:23], s38 offen offset:1024 lds
    v_mfma_f32_16x16x32_bf16 v[168:171], a[72:75], a[20:23], v[168:171]
    v_exp_f32 v141, v141
    v_mfma_f32_16x16x32_bf16 v[176:179], a[72:75], a[36:39], v[176:179]
    ds_read_b64_tr_b16 a[100:101], v241 offset:0
    v_cvt_pk_bf16_f32 v198, v140, v141
    v_mfma_f32_16x16x32_bf16 v[184:187], a[72:75], a[52:55], v[184:187]
    v_exp_f32 v142, v142
    v_mfma_f32_16x16x32_bf16 v[164:167], a[76:79], a[4:7], v[164:167]
    v_mfma_f32_16x16x32_bf16 v[172:175], a[76:79], a[20:23], v[172:175]
    buffer_load_dwordx4 v249, s[20:23], s38 offen offset:2048 lds
    v_mfma_f32_16x16x32_bf16 v[180:183], a[76:79], a[36:39], v[180:183]
    v_exp_f32 v143, v143
    v_mfma_f32_16x16x32_bf16 v[188:191], a[76:79], a[52:55], v[188:191]
    ds_read_b64_tr_b16 a[102:103], v241 offset:1024
    v_cvt_pk_bf16_f32 v199, v142, v143
    v_mfma_f32_16x16x32_bf16 v[160:163], a[80:83], a[8:11], v[160:163]
    v_exp_f32 v144, v144
    v_mfma_f32_16x16x32_bf16 v[168:171], a[80:83], a[24:27], v[168:171]
    buffer_load_dwordx4 v249, s[20:23], s38 offen offset:3072 lds
    v_mfma_f32_16x16x32_bf16 v[176:179], a[80:83], a[40:43], v[176:179]
    s_add_u32 s38, s38, 0x4000
    v_exp_f32 v145, v145
    v_mfma_f32_16x16x32_bf16 v[184:187], a[80:83], a[56:59], v[184:187]
    ds_read_b64_tr_b16 a[104:105], v242 offset:0
    v_cvt_pk_bf16_f32 v200, v144, v145
    v_mfma_f32_16x16x32_bf16 v[164:167], a[84:87], a[8:11], v[164:167]
    v_exp_f32 v146, v146
    v_mfma_f32_16x16x32_bf16 v[172:175], a[84:87], a[24:27], v[172:175]
    ds_read_b64_tr_b16 a[106:107], v242 offset:1024
    ds_read_b64_tr_b16 a[108:109], v243 offset:0
    v_mfma_f32_16x16x32_bf16 v[180:183], a[84:87], a[40:43], v[180:183]
    v_exp_f32 v147, v147
    v_mfma_f32_16x16x32_bf16 v[188:191], a[84:87], a[56:59], v[188:191]
    ds_read_b64_tr_b16 a[110:111], v243 offset:1024
    v_cvt_pk_bf16_f32 v201, v146, v147
    v_mfma_f32_16x16x32_bf16 v[160:163], a[88:91], a[12:15], v[160:163]
    v_exp_f32 v148, v148
    v_mfma_f32_16x16x32_bf16 v[168:171], a[88:91], a[28:31], v[168:171]
    ds_read_b64_tr_b16 a[112:113], v244 offset:0
    ds_read_b64_tr_b16 a[114:115], v244 offset:1024
    v_mfma_f32_16x16x32_bf16 v[176:179], a[88:91], a[44:47], v[176:179]
    v_exp_f32 v149, v149
    v_mfma_f32_16x16x32_bf16 v[184:187], a[88:91], a[60:63], v[184:187]
    ds_read_b64_tr_b16 a[116:117], v245 offset:0
    v_cvt_pk_bf16_f32 v202, v148, v149
    v_mfma_f32_16x16x32_bf16 v[164:167], a[92:95], a[12:15], v[164:167]
    v_exp_f32 v150, v150
    v_mfma_f32_16x16x32_bf16 v[172:175], a[92:95], a[28:31], v[172:175]
    ds_read_b64_tr_b16 a[118:119], v245 offset:1024
    ds_read_b64_tr_b16 a[120:121], v246 offset:0
    v_mfma_f32_16x16x32_bf16 v[180:183], a[92:95], a[44:47], v[180:183]
    s_waitcnt lgkmcnt(5)
    v_exp_f32 v151, v151
    v_mfma_f32_16x16x32_bf16 v[188:191], a[92:95], a[60:63], v[188:191]
    ds_read_b64_tr_b16 a[122:123], v246 offset:1024
    v_cvt_pk_bf16_f32 v203, v150, v151
    v_mfma_f32_16x16x32_bf16 v[0:3], a[96:99], v[192:195], v[0:3]
    v_exp_f32 v152, v152
    v_mfma_f32_16x16x32_bf16 v[4:7], a[96:99], v[196:199], v[4:7]
    ds_read_b64_tr_b16 a[124:125], v247 offset:0
    v_add_f32 v224, v224, v128
    v_mfma_f32_16x16x32_bf16 v[16:19], a[100:103], v[192:195], v[16:19]
    v_exp_f32 v153, v153
    v_mfma_f32_16x16x32_bf16 v[20:23], a[100:103], v[196:199], v[20:23]
    ds_read_b64_tr_b16 a[126:127], v247 offset:1024
    v_cvt_pk_bf16_f32 v204, v152, v153
    v_mfma_f32_16x16x32_bf16 v[32:35], a[104:107], v[192:195], v[32:35]
    v_exp_f32 v154, v154
    v_mfma_f32_16x16x32_bf16 v[36:39], a[104:107], v[196:199], v[36:39]
    ds_read_b128 a[64:67], v236 offset:4096
    v_add_f32 v225, v225, v136
    v_mfma_f32_16x16x32_bf16 v[48:51], a[108:111], v[192:195], v[48:51]
    s_waitcnt lgkmcnt(3)
    v_exp_f32 v155, v155
    v_mfma_f32_16x16x32_bf16 v[52:55], a[108:111], v[196:199], v[52:55]
    ds_read_b128 a[68:71], v236 offset:5120
    v_cvt_pk_bf16_f32 v205, v154, v155
    v_mfma_f32_16x16x32_bf16 v[64:67], a[112:115], v[192:195], v[64:67]
    v_exp_f32 v156, v156
    v_mfma_f32_16x16x32_bf16 v[68:71], a[112:115], v[196:199], v[68:71]
    ds_read_b128 a[72:75], v237 offset:4096
    v_add_f32 v224, v224, v129
    v_mfma_f32_16x16x32_bf16 v[80:83], a[116:119], v[192:195], v[80:83]
    v_exp_f32 v157, v157
    v_mfma_f32_16x16x32_bf16 v[84:87], a[116:119], v[196:199], v[84:87]
    ds_read_b128 a[76:79], v237 offset:5120
    v_cvt_pk_bf16_f32 v206, v156, v157
    v_mfma_f32_16x16x32_bf16 v[96:99], a[120:123], v[192:195], v[96:99]
    s_waitcnt lgkmcnt(4)
    v_exp_f32 v158, v158
    v_mfma_f32_16x16x32_bf16 v[100:103], a[120:123], v[196:199], v[100:103]
    ds_read_b128 a[80:83], v238 offset:4096
    v_add_f32 v225, v225, v137
    v_mfma_f32_16x16x32_bf16 v[112:115], a[124:127], v[192:195], v[112:115]
    v_exp_f32 v159, v159
    v_mfma_f32_16x16x32_bf16 v[116:119], a[124:127], v[196:199], v[116:119]
    ds_read_b128 a[84:87], v238 offset:5120
    v_cvt_pk_bf16_f32 v207, v158, v159
    v_mfma_f32_16x16x32_bf16 v[8:11], a[96:99], v[200:203], v[8:11]
    v_exp_f32 v160, v160
    v_mfma_f32_16x16x32_bf16 v[12:15], a[96:99], v[204:207], v[12:15]
    ds_read_b128 a[88:91], v239 offset:4096
    v_add_f32 v224, v224, v130
    v_mfma_f32_16x16x32_bf16 v[24:27], a[100:103], v[200:203], v[24:27]
    v_exp_f32 v161, v161
    v_mfma_f32_16x16x32_bf16 v[28:31], a[100:103], v[204:207], v[28:31]
    ds_read_b128 a[92:95], v239 offset:5120
    v_cvt_pk_bf16_f32 v192, v160, v161
    v_mfma_f32_16x16x32_bf16 v[228:231], a[128:131], v[200:203], v[228:231]
    v_exp_f32 v162, v162
    v_mfma_f32_16x16x32_bf16 v[40:43], a[104:107], v[200:203], v[40:43]
    v_add_f32 v225, v225, v138
    v_add_f32 v224, v224, v131
    v_mfma_f32_16x16x32_bf16 v[44:47], a[104:107], v[204:207], v[44:47]
    v_exp_f32 v163, v163
    v_mfma_f32_16x16x32_bf16 v[56:59], a[108:111], v[200:203], v[56:59]
    v_cvt_pk_bf16_f32 v193, v162, v163
    v_add_f32 v225, v225, v139
    v_mfma_f32_16x16x32_bf16 v[60:63], a[108:111], v[204:207], v[60:63]
    v_exp_f32 v164, v164
    v_mfma_f32_16x16x32_bf16 v[72:75], a[112:115], v[200:203], v[72:75]
    v_add_f32 v224, v224, v132
    v_add_f32 v225, v225, v140
    v_mfma_f32_16x16x32_bf16 v[76:79], a[112:115], v[204:207], v[76:79]
    v_exp_f32 v165, v165
    v_mfma_f32_16x16x32_bf16 v[232:235], a[128:131], v[204:207], v[232:235]
    v_cvt_pk_bf16_f32 v194, v164, v165
    v_add_f32 v224, v224, v133
    v_mfma_f32_16x16x32_bf16 v[88:91], a[116:119], v[200:203], v[88:91]
    v_exp_f32 v166, v166
    v_mfma_f32_16x16x32_bf16 v[92:95], a[116:119], v[204:207], v[92:95]
    v_add_f32 v225, v225, v141
    v_add_f32 v224, v224, v134
    v_mfma_f32_16x16x32_bf16 v[104:107], a[120:123], v[200:203], v[104:107]
    s_waitcnt lgkmcnt(0)
    v_exp_f32 v167, v167
    v_mfma_f32_16x16x32_bf16 v[108:111], a[120:123], v[204:207], v[108:111]
    v_cvt_pk_bf16_f32 v195, v166, v167
    v_add_f32 v225, v225, v142
    v_mfma_f32_16x16x32_bf16 v[120:123], a[124:127], v[200:203], v[120:123]
    v_exp_f32 v168, v168
    v_mfma_f32_16x16x32_bf16 v[124:127], a[124:127], v[204:207], v[124:127]
    v_add_f32 v224, v224, v135
    v_add_f32 v225, v225, v143
    v_mfma_f32_16x16x32_bf16 v[128:131], a[64:67], a[0:3], v[208:211]
    v_exp_f32 v169, v169
    v_mfma_f32_16x16x32_bf16 v[136:139], a[64:67], a[16:19], v[212:215]
    ds_read_b64_tr_b16 a[96:97], v240 offset:2048
    v_cvt_pk_bf16_f32 v196, v168, v169
    v_mfma_f32_16x16x32_bf16 v[144:147], a[64:67], a[32:35], v[216:219]
    v_exp_f32 v170, v170
    v_mfma_f32_16x16x32_bf16 v[152:155], a[64:67], a[48:51], v[220:223]
    s_add_u32 m0, s36, 28672
    v_mfma_f32_16x16x32_bf16 v[132:135], a[68:71], a[0:3], v[208:211]
    buffer_load_dwordx4 v248, s[16:19], s37 offen offset:0 lds
    v_mfma_f32_16x16x32_bf16 v[140:143], a[68:71], a[16:19], v[212:215]
    v_exp_f32 v171, v171
    v_mfma_f32_16x16x32_bf16 v[148:151], a[68:71], a[32:35], v[216:219]
    ds_read_b64_tr_b16 a[98:99], v240 offset:3072
    v_cvt_pk_bf16_f32 v197, v170, v171
    v_mfma_f32_16x16x32_bf16 v[156:159], a[68:71], a[48:51], v[220:223]
    v_exp_f32 v172, v172
    v_mfma_f32_16x16x32_bf16 v[128:131], a[72:75], a[4:7], v[128:131]
    buffer_load_dwordx4 v248, s[16:19], s37 offen offset:1024 lds
    v_mfma_f32_16x16x32_bf16 v[136:139], a[72:75], a[20:23], v[136:139]
    v_exp_f32 v173, v173
    v_mfma_f32_16x16x32_bf16 v[144:147], a[72:75], a[36:39], v[144:147]
    ds_read_b64_tr_b16 a[100:101], v241 offset:2048
    v_cvt_pk_bf16_f32 v198, v172, v173
    v_mfma_f32_16x16x32_bf16 v[152:155], a[72:75], a[52:55], v[152:155]
    v_exp_f32 v174, v174
    v_mfma_f32_16x16x32_bf16 v[132:135], a[76:79], a[4:7], v[132:135]
    v_mfma_f32_16x16x32_bf16 v[140:143], a[76:79], a[20:23], v[140:143]
    buffer_load_dwordx4 v248, s[16:19], s37 offen offset:2048 lds
    v_mfma_f32_16x16x32_bf16 v[148:151], a[76:79], a[36:39], v[148:151]
    v_exp_f32 v175, v175
    v_mfma_f32_16x16x32_bf16 v[156:159], a[76:79], a[52:55], v[156:159]
    ds_read_b64_tr_b16 a[102:103], v241 offset:3072
    v_cvt_pk_bf16_f32 v199, v174, v175
    v_mfma_f32_16x16x32_bf16 v[128:131], a[80:83], a[8:11], v[128:131]
    v_exp_f32 v176, v176
    v_mfma_f32_16x16x32_bf16 v[136:139], a[80:83], a[24:27], v[136:139]
    buffer_load_dwordx4 v248, s[16:19], s37 offen offset:3072 lds
    v_mfma_f32_16x16x32_bf16 v[144:147], a[80:83], a[40:43], v[144:147]
    s_add_u32 s37, s37, 0x4000
    v_exp_f32 v177, v177
    v_mfma_f32_16x16x32_bf16 v[152:155], a[80:83], a[56:59], v[152:155]
    ds_read_b64_tr_b16 a[104:105], v242 offset:2048
    v_cvt_pk_bf16_f32 v200, v176, v177
    v_mfma_f32_16x16x32_bf16 v[132:135], a[84:87], a[8:11], v[132:135]
    v_exp_f32 v178, v178
    v_mfma_f32_16x16x32_bf16 v[140:143], a[84:87], a[24:27], v[140:143]
    ds_read_b64_tr_b16 a[106:107], v242 offset:3072
    ds_read_b64_tr_b16 a[108:109], v243 offset:2048
    v_mfma_f32_16x16x32_bf16 v[148:151], a[84:87], a[40:43], v[148:151]
    v_exp_f32 v179, v179
    v_mfma_f32_16x16x32_bf16 v[156:159], a[84:87], a[56:59], v[156:159]
    ds_read_b64_tr_b16 a[110:111], v243 offset:3072
    v_cvt_pk_bf16_f32 v201, v178, v179
    v_mfma_f32_16x16x32_bf16 v[128:131], a[88:91], a[12:15], v[128:131]
    v_exp_f32 v180, v180
    v_mfma_f32_16x16x32_bf16 v[136:139], a[88:91], a[28:31], v[136:139]
    ds_read_b64_tr_b16 a[112:113], v244 offset:2048
    ds_read_b64_tr_b16 a[114:115], v244 offset:3072
    v_mfma_f32_16x16x32_bf16 v[144:147], a[88:91], a[44:47], v[144:147]
    v_exp_f32 v181, v181
    v_mfma_f32_16x16x32_bf16 v[152:155], a[88:91], a[60:63], v[152:155]
    ds_read_b64_tr_b16 a[116:117], v245 offset:2048
    v_cvt_pk_bf16_f32 v202, v180, v181
    v_mfma_f32_16x16x32_bf16 v[132:135], a[92:95], a[12:15], v[132:135]
    v_exp_f32 v182, v182
    v_mfma_f32_16x16x32_bf16 v[140:143], a[92:95], a[28:31], v[140:143]
    ds_read_b64_tr_b16 a[118:119], v245 offset:3072
    ds_read_b64_tr_b16 a[120:121], v246 offset:2048
    v_mfma_f32_16x16x32_bf16 v[148:151], a[92:95], a[44:47], v[148:151]
    s_waitcnt lgkmcnt(5)
    v_exp_f32 v183, v183
    v_mfma_f32_16x16x32_bf16 v[156:159], a[92:95], a[60:63], v[156:159]
    ds_read_b64_tr_b16 a[122:123], v246 offset:3072
    v_cvt_pk_bf16_f32 v203, v182, v183
    v_mfma_f32_16x16x32_bf16 v[0:3], a[96:99], v[192:195], v[0:3]
    v_exp_f32 v184, v184
    v_mfma_f32_16x16x32_bf16 v[4:7], a[96:99], v[196:199], v[4:7]
    ds_read_b64_tr_b16 a[124:125], v247 offset:2048
    v_add_f32 v224, v224, v160
    v_mfma_f32_16x16x32_bf16 v[16:19], a[100:103], v[192:195], v[16:19]
    v_exp_f32 v185, v185
    v_mfma_f32_16x16x32_bf16 v[20:23], a[100:103], v[196:199], v[20:23]
    ds_read_b64_tr_b16 a[126:127], v247 offset:3072
    v_cvt_pk_bf16_f32 v204, v184, v185
    v_mfma_f32_16x16x32_bf16 v[32:35], a[104:107], v[192:195], v[32:35]
    v_exp_f32 v186, v186
    v_mfma_f32_16x16x32_bf16 v[36:39], a[104:107], v[196:199], v[36:39]
    ds_read_b128 a[64:67], v236 offset:6144
    v_add_f32 v225, v225, v168
    v_mfma_f32_16x16x32_bf16 v[48:51], a[108:111], v[192:195], v[48:51]
    s_waitcnt lgkmcnt(3)
    v_exp_f32 v187, v187
    v_mfma_f32_16x16x32_bf16 v[52:55], a[108:111], v[196:199], v[52:55]
    ds_read_b128 a[68:71], v236 offset:7168
    v_cvt_pk_bf16_f32 v205, v186, v187
    v_mfma_f32_16x16x32_bf16 v[64:67], a[112:115], v[192:195], v[64:67]
    v_exp_f32 v188, v188
    v_mfma_f32_16x16x32_bf16 v[68:71], a[112:115], v[196:199], v[68:71]
    ds_read_b128 a[72:75], v237 offset:6144
    v_add_f32 v224, v224, v161
    v_mfma_f32_16x16x32_bf16 v[80:83], a[116:119], v[192:195], v[80:83]
    v_exp_f32 v189, v189
    v_mfma_f32_16x16x32_bf16 v[84:87], a[116:119], v[196:199], v[84:87]
    ds_read_b128 a[76:79], v237 offset:7168
    v_cvt_pk_bf16_f32 v206, v188, v189
    v_mfma_f32_16x16x32_bf16 v[96:99], a[120:123], v[192:195], v[96:99]
    s_waitcnt lgkmcnt(4)
    v_exp_f32 v190, v190
    v_mfma_f32_16x16x32_bf16 v[100:103], a[120:123], v[196:199], v[100:103]
    ds_read_b128 a[80:83], v238 offset:6144
    v_add_f32 v225, v225, v169
    v_mfma_f32_16x16x32_bf16 v[112:115], a[124:127], v[192:195], v[112:115]
    v_exp_f32 v191, v191
    v_mfma_f32_16x16x32_bf16 v[116:119], a[124:127], v[196:199], v[116:119]
    ds_read_b128 a[84:87], v238 offset:7168
    v_cvt_pk_bf16_f32 v207, v190, v191
    v_mfma_f32_16x16x32_bf16 v[8:11], a[96:99], v[200:203], v[8:11]
    v_exp_f32 v128, v128
    v_mfma_f32_16x16x32_bf16 v[12:15], a[96:99], v[204:207], v[12:15]
    ds_read_b128 a[88:91], v239 offset:6144
    v_add_f32 v224, v224, v162
    v_mfma_f32_16x16x32_bf16 v[24:27], a[100:103], v[200:203], v[24:27]
    v_exp_f32 v129, v129
    v_mfma_f32_16x16x32_bf16 v[28:31], a[100:103], v[204:207], v[28:31]
    ds_read_b128 a[92:95], v239 offset:7168
    v_cvt_pk_bf16_f32 v192, v128, v129
    v_mfma_f32_16x16x32_bf16 v[228:231], a[128:131], v[200:203], v[228:231]
    v_exp_f32 v130, v130
    v_mfma_f32_16x16x32_bf16 v[40:43], a[104:107], v[200:203], v[40:43]
    v_add_f32 v225, v225, v170
    v_add_f32 v224, v224, v163
    v_mfma_f32_16x16x32_bf16 v[44:47], a[104:107], v[204:207], v[44:47]
    v_exp_f32 v131, v131
    v_mfma_f32_16x16x32_bf16 v[56:59], a[108:111], v[200:203], v[56:59]
    v_cvt_pk_bf16_f32 v193, v130, v131
    v_add_f32 v225, v225, v171
    v_mfma_f32_16x16x32_bf16 v[60:63], a[108:111], v[204:207], v[60:63]
    v_exp_f32 v132, v132
    v_mfma_f32_16x16x32_bf16 v[72:75], a[112:115], v[200:203], v[72:75]
    v_add_f32 v224, v224, v164
    v_add_f32 v225, v225, v172
    v_mfma_f32_16x16x32_bf16 v[76:79], a[112:115], v[204:207], v[76:79]
    v_exp_f32 v133, v133
    v_mfma_f32_16x16x32_bf16 v[232:235], a[128:131], v[204:207], v[232:235]
    v_cvt_pk_bf16_f32 v194, v132, v133
    v_add_f32 v224, v224, v165
    v_mfma_f32_16x16x32_bf16 v[88:91], a[116:119], v[200:203], v[88:91]
    v_exp_f32 v134, v134
    v_mfma_f32_16x16x32_bf16 v[92:95], a[116:119], v[204:207], v[92:95]
    v_add_f32 v225, v225, v173
    v_add_f32 v224, v224, v166
    v_mfma_f32_16x16x32_bf16 v[104:107], a[120:123], v[200:203], v[104:107]
    s_waitcnt lgkmcnt(0)
    v_exp_f32 v135, v135
    v_mfma_f32_16x16x32_bf16 v[108:111], a[120:123], v[204:207], v[108:111]
    v_cvt_pk_bf16_f32 v195, v134, v135
    v_add_f32 v225, v225, v174
    v_mfma_f32_16x16x32_bf16 v[120:123], a[124:127], v[200:203], v[120:123]
    v_exp_f32 v136, v136
    v_mfma_f32_16x16x32_bf16 v[124:127], a[124:127], v[204:207], v[124:127]
    v_add_f32 v224, v224, v167
    v_add_f32 v225, v225, v175
    v_mfma_f32_16x16x32_bf16 v[160:163], a[64:67], a[0:3], v[208:211]
    v_exp_f32 v137, v137
    v_mfma_f32_16x16x32_bf16 v[168:171], a[64:67], a[16:19], v[212:215]
    ds_read_b64_tr_b16 a[96:97], v240 offset:20480
    v_cvt_pk_bf16_f32 v196, v136, v137
    v_mfma_f32_16x16x32_bf16 v[176:179], a[64:67], a[32:35], v[216:219]
    v_exp_f32 v138, v138
    v_mfma_f32_16x16x32_bf16 v[184:187], a[64:67], a[48:51], v[220:223]
    s_add_u32 m0, s36, 16384
    v_mfma_f32_16x16x32_bf16 v[164:167], a[68:71], a[0:3], v[208:211]
    buffer_load_dwordx4 v249, s[20:23], s38 offen offset:0 lds
    v_mfma_f32_16x16x32_bf16 v[172:175], a[68:71], a[16:19], v[212:215]
    v_exp_f32 v139, v139
    v_mfma_f32_16x16x32_bf16 v[180:183], a[68:71], a[32:35], v[216:219]
    ds_read_b64_tr_b16 a[98:99], v240 offset:21504
    v_cvt_pk_bf16_f32 v197, v138, v139
    v_mfma_f32_16x16x32_bf16 v[188:191], a[68:71], a[48:51], v[220:223]
    v_exp_f32 v140, v140
    v_mfma_f32_16x16x32_bf16 v[160:163], a[72:75], a[4:7], v[160:163]
    buffer_load_dwordx4 v249, s[20:23], s38 offen offset:1024 lds
    v_mfma_f32_16x16x32_bf16 v[168:171], a[72:75], a[20:23], v[168:171]
    v_exp_f32 v141, v141
    v_mfma_f32_16x16x32_bf16 v[176:179], a[72:75], a[36:39], v[176:179]
    ds_read_b64_tr_b16 a[100:101], v241 offset:20480
    v_cvt_pk_bf16_f32 v198, v140, v141
    v_mfma_f32_16x16x32_bf16 v[184:187], a[72:75], a[52:55], v[184:187]
    v_exp_f32 v142, v142
    v_mfma_f32_16x16x32_bf16 v[164:167], a[76:79], a[4:7], v[164:167]
    v_mfma_f32_16x16x32_bf16 v[172:175], a[76:79], a[20:23], v[172:175]
    buffer_load_dwordx4 v249, s[20:23], s38 offen offset:2048 lds
    v_mfma_f32_16x16x32_bf16 v[180:183], a[76:79], a[36:39], v[180:183]
    v_exp_f32 v143, v143
    v_mfma_f32_16x16x32_bf16 v[188:191], a[76:79], a[52:55], v[188:191]
    ds_read_b64_tr_b16 a[102:103], v241 offset:21504
    v_cvt_pk_bf16_f32 v199, v142, v143
    v_mfma_f32_16x16x32_bf16 v[160:163], a[80:83], a[8:11], v[160:163]
    v_exp_f32 v144, v144
    v_mfma_f32_16x16x32_bf16 v[168:171], a[80:83], a[24:27], v[168:171]
    buffer_load_dwordx4 v249, s[20:23], s38 offen offset:3072 lds
    v_mfma_f32_16x16x32_bf16 v[176:179], a[80:83], a[40:43], v[176:179]
    s_add_u32 s38, s38, 0x4000
    v_exp_f32 v145, v145
    v_mfma_f32_16x16x32_bf16 v[184:187], a[80:83], a[56:59], v[184:187]
    ds_read_b64_tr_b16 a[104:105], v242 offset:20480
    v_cvt_pk_bf16_f32 v200, v144, v145
    v_mfma_f32_16x16x32_bf16 v[164:167], a[84:87], a[8:11], v[164:167]
    v_exp_f32 v146, v146
    v_mfma_f32_16x16x32_bf16 v[172:175], a[84:87], a[24:27], v[172:175]
    ds_read_b64_tr_b16 a[106:107], v242 offset:21504
    ds_read_b64_tr_b16 a[108:109], v243 offset:20480
    v_mfma_f32_16x16x32_bf16 v[180:183], a[84:87], a[40:43], v[180:183]
    v_exp_f32 v147, v147
    v_mfma_f32_16x16x32_bf16 v[188:191], a[84:87], a[56:59], v[188:191]
    ds_read_b64_tr_b16 a[110:111], v243 offset:21504
    v_cvt_pk_bf16_f32 v201, v146, v147
    v_mfma_f32_16x16x32_bf16 v[160:163], a[88:91], a[12:15], v[160:163]
    v_exp_f32 v148, v148
    v_mfma_f32_16x16x32_bf16 v[168:171], a[88:91], a[28:31], v[168:171]
    ds_read_b64_tr_b16 a[112:113], v244 offset:20480
    ds_read_b64_tr_b16 a[114:115], v244 offset:21504
    v_mfma_f32_16x16x32_bf16 v[176:179], a[88:91], a[44:47], v[176:179]
    v_exp_f32 v149, v149
    v_mfma_f32_16x16x32_bf16 v[184:187], a[88:91], a[60:63], v[184:187]
    ds_read_b64_tr_b16 a[116:117], v245 offset:20480
    v_cvt_pk_bf16_f32 v202, v148, v149
    v_mfma_f32_16x16x32_bf16 v[164:167], a[92:95], a[12:15], v[164:167]
    v_exp_f32 v150, v150
    v_mfma_f32_16x16x32_bf16 v[172:175], a[92:95], a[28:31], v[172:175]
    ds_read_b64_tr_b16 a[118:119], v245 offset:21504
    ds_read_b64_tr_b16 a[120:121], v246 offset:20480
    v_mfma_f32_16x16x32_bf16 v[180:183], a[92:95], a[44:47], v[180:183]
    s_waitcnt lgkmcnt(5)
    v_exp_f32 v151, v151
    v_mfma_f32_16x16x32_bf16 v[188:191], a[92:95], a[60:63], v[188:191]
    ds_read_b64_tr_b16 a[122:123], v246 offset:21504
    v_cvt_pk_bf16_f32 v203, v150, v151
    v_mfma_f32_16x16x32_bf16 v[0:3], a[96:99], v[192:195], v[0:3]
    v_exp_f32 v152, v152
    v_mfma_f32_16x16x32_bf16 v[4:7], a[96:99], v[196:199], v[4:7]
    ds_read_b64_tr_b16 a[124:125], v247 offset:20480
    v_add_f32 v224, v224, v128
    v_mfma_f32_16x16x32_bf16 v[16:19], a[100:103], v[192:195], v[16:19]
    v_exp_f32 v153, v153
    v_mfma_f32_16x16x32_bf16 v[20:23], a[100:103], v[196:199], v[20:23]
    ds_read_b64_tr_b16 a[126:127], v247 offset:21504
    v_cvt_pk_bf16_f32 v204, v152, v153
    v_mfma_f32_16x16x32_bf16 v[32:35], a[104:107], v[192:195], v[32:35]
    v_exp_f32 v154, v154
    v_mfma_f32_16x16x32_bf16 v[36:39], a[104:107], v[196:199], v[36:39]
    ds_read_b128 a[64:67], v236 offset:8192
    v_add_f32 v225, v225, v136
    v_mfma_f32_16x16x32_bf16 v[48:51], a[108:111], v[192:195], v[48:51]
    s_waitcnt lgkmcnt(3)
    v_exp_f32 v155, v155
    v_mfma_f32_16x16x32_bf16 v[52:55], a[108:111], v[196:199], v[52:55]
    ds_read_b128 a[68:71], v236 offset:9216
    v_cvt_pk_bf16_f32 v205, v154, v155
    v_mfma_f32_16x16x32_bf16 v[64:67], a[112:115], v[192:195], v[64:67]
    v_exp_f32 v156, v156
    v_mfma_f32_16x16x32_bf16 v[68:71], a[112:115], v[196:199], v[68:71]
    ds_read_b128 a[72:75], v237 offset:8192
    v_add_f32 v224, v224, v129
    v_mfma_f32_16x16x32_bf16 v[80:83], a[116:119], v[192:195], v[80:83]
    v_exp_f32 v157, v157
    v_mfma_f32_16x16x32_bf16 v[84:87], a[116:119], v[196:199], v[84:87]
    ds_read_b128 a[76:79], v237 offset:9216
    v_cvt_pk_bf16_f32 v206, v156, v157
    v_mfma_f32_16x16x32_bf16 v[96:99], a[120:123], v[192:195], v[96:99]
    s_waitcnt lgkmcnt(4)
    v_exp_f32 v158, v158
    v_mfma_f32_16x16x32_bf16 v[100:103], a[120:123], v[196:199], v[100:103]
    ds_read_b128 a[80:83], v238 offset:8192
    v_add_f32 v225, v225, v137
    v_mfma_f32_16x16x32_bf16 v[112:115], a[124:127], v[192:195], v[112:115]
    v_exp_f32 v159, v159
    v_mfma_f32_16x16x32_bf16 v[116:119], a[124:127], v[196:199], v[116:119]
    ds_read_b128 a[84:87], v238 offset:9216
    v_cvt_pk_bf16_f32 v207, v158, v159
    v_mfma_f32_16x16x32_bf16 v[8:11], a[96:99], v[200:203], v[8:11]
    v_exp_f32 v160, v160
    v_mfma_f32_16x16x32_bf16 v[12:15], a[96:99], v[204:207], v[12:15]
    ds_read_b128 a[88:91], v239 offset:8192
    v_add_f32 v224, v224, v130
    v_mfma_f32_16x16x32_bf16 v[24:27], a[100:103], v[200:203], v[24:27]
    v_exp_f32 v161, v161
    v_mfma_f32_16x16x32_bf16 v[28:31], a[100:103], v[204:207], v[28:31]
    ds_read_b128 a[92:95], v239 offset:9216
    v_cvt_pk_bf16_f32 v192, v160, v161
    v_mfma_f32_16x16x32_bf16 v[228:231], a[128:131], v[200:203], v[228:231]
    v_exp_f32 v162, v162
    v_mfma_f32_16x16x32_bf16 v[40:43], a[104:107], v[200:203], v[40:43]
    v_add_f32 v225, v225, v138
    v_add_f32 v224, v224, v131
    v_mfma_f32_16x16x32_bf16 v[44:47], a[104:107], v[204:207], v[44:47]
    v_exp_f32 v163, v163
    v_mfma_f32_16x16x32_bf16 v[56:59], a[108:111], v[200:203], v[56:59]
    v_cvt_pk_bf16_f32 v193, v162, v163
    v_add_f32 v225, v225, v139
    v_mfma_f32_16x16x32_bf16 v[60:63], a[108:111], v[204:207], v[60:63]
    v_exp_f32 v164, v164
    v_mfma_f32_16x16x32_bf16 v[72:75], a[112:115], v[200:203], v[72:75]
    v_add_f32 v224, v224, v132
    v_add_f32 v225, v225, v140
    v_mfma_f32_16x16x32_bf16 v[76:79], a[112:115], v[204:207], v[76:79]
    v_exp_f32 v165, v165
    v_mfma_f32_16x16x32_bf16 v[232:235], a[128:131], v[204:207], v[232:235]
    v_cvt_pk_bf16_f32 v194, v164, v165
    v_add_f32 v224, v224, v133
    v_mfma_f32_16x16x32_bf16 v[88:91], a[116:119], v[200:203], v[88:91]
    v_exp_f32 v166, v166
    v_mfma_f32_16x16x32_bf16 v[92:95], a[116:119], v[204:207], v[92:95]
    v_add_f32 v225, v225, v141
    v_add_f32 v224, v224, v134
    v_mfma_f32_16x16x32_bf16 v[104:107], a[120:123], v[200:203], v[104:107]
    s_waitcnt lgkmcnt(0)
    v_exp_f32 v167, v167
    v_mfma_f32_16x16x32_bf16 v[108:111], a[120:123], v[204:207], v[108:111]
    v_cvt_pk_bf16_f32 v195, v166, v167
    v_add_f32 v225, v225, v142
    v_mfma_f32_16x16x32_bf16 v[120:123], a[124:127], v[200:203], v[120:123]
    v_exp_f32 v168, v168
    v_mfma_f32_16x16x32_bf16 v[124:127], a[124:127], v[204:207], v[124:127]
    v_add_f32 v224, v224, v135
    v_add_f32 v225, v225, v143
    v_mfma_f32_16x16x32_bf16 v[128:131], a[64:67], a[0:3], v[208:211]
    v_exp_f32 v169, v169
    v_mfma_f32_16x16x32_bf16 v[136:139], a[64:67], a[16:19], v[212:215]
    ds_read_b64_tr_b16 a[96:97], v240 offset:22528
    v_cvt_pk_bf16_f32 v196, v168, v169
    v_mfma_f32_16x16x32_bf16 v[144:147], a[64:67], a[32:35], v[216:219]
    v_exp_f32 v170, v170
    v_mfma_f32_16x16x32_bf16 v[152:155], a[64:67], a[48:51], v[220:223]
    s_add_u32 m0, s36, 36864
    v_mfma_f32_16x16x32_bf16 v[132:135], a[68:71], a[0:3], v[208:211]
    buffer_load_dwordx4 v248, s[16:19], s37 offen offset:0 lds
    v_mfma_f32_16x16x32_bf16 v[140:143], a[68:71], a[16:19], v[212:215]
    v_exp_f32 v171, v171
    v_mfma_f32_16x16x32_bf16 v[148:151], a[68:71], a[32:35], v[216:219]
    ds_read_b64_tr_b16 a[98:99], v240 offset:23552
    v_cvt_pk_bf16_f32 v197, v170, v171
    v_mfma_f32_16x16x32_bf16 v[156:159], a[68:71], a[48:51], v[220:223]
    v_exp_f32 v172, v172
    v_mfma_f32_16x16x32_bf16 v[128:131], a[72:75], a[4:7], v[128:131]
    buffer_load_dwordx4 v248, s[16:19], s37 offen offset:1024 lds
    v_mfma_f32_16x16x32_bf16 v[136:139], a[72:75], a[20:23], v[136:139]
    v_exp_f32 v173, v173
    v_mfma_f32_16x16x32_bf16 v[144:147], a[72:75], a[36:39], v[144:147]
    ds_read_b64_tr_b16 a[100:101], v241 offset:22528
    v_cvt_pk_bf16_f32 v198, v172, v173
    v_mfma_f32_16x16x32_bf16 v[152:155], a[72:75], a[52:55], v[152:155]
    v_exp_f32 v174, v174
    v_mfma_f32_16x16x32_bf16 v[132:135], a[76:79], a[4:7], v[132:135]
    v_mfma_f32_16x16x32_bf16 v[140:143], a[76:79], a[20:23], v[140:143]
    buffer_load_dwordx4 v248, s[16:19], s37 offen offset:2048 lds
    v_mfma_f32_16x16x32_bf16 v[148:151], a[76:79], a[36:39], v[148:151]
    v_exp_f32 v175, v175
    v_mfma_f32_16x16x32_bf16 v[156:159], a[76:79], a[52:55], v[156:159]
    ds_read_b64_tr_b16 a[102:103], v241 offset:23552
    v_cvt_pk_bf16_f32 v199, v174, v175
    v_mfma_f32_16x16x32_bf16 v[128:131], a[80:83], a[8:11], v[128:131]
    v_exp_f32 v176, v176
    v_mfma_f32_16x16x32_bf16 v[136:139], a[80:83], a[24:27], v[136:139]
    buffer_load_dwordx4 v248, s[16:19], s37 offen offset:3072 lds
    v_mfma_f32_16x16x32_bf16 v[144:147], a[80:83], a[40:43], v[144:147]
    s_add_u32 s37, s37, 0x4000
    v_exp_f32 v177, v177
    v_mfma_f32_16x16x32_bf16 v[152:155], a[80:83], a[56:59], v[152:155]
    ds_read_b64_tr_b16 a[104:105], v242 offset:22528
    v_cvt_pk_bf16_f32 v200, v176, v177
    v_mfma_f32_16x16x32_bf16 v[132:135], a[84:87], a[8:11], v[132:135]
    v_exp_f32 v178, v178
    v_mfma_f32_16x16x32_bf16 v[140:143], a[84:87], a[24:27], v[140:143]
    ds_read_b64_tr_b16 a[106:107], v242 offset:23552
    ds_read_b64_tr_b16 a[108:109], v243 offset:22528
    v_mfma_f32_16x16x32_bf16 v[148:151], a[84:87], a[40:43], v[148:151]
    v_exp_f32 v179, v179
    v_mfma_f32_16x16x32_bf16 v[156:159], a[84:87], a[56:59], v[156:159]
    ds_read_b64_tr_b16 a[110:111], v243 offset:23552
    v_cvt_pk_bf16_f32 v201, v178, v179
    v_mfma_f32_16x16x32_bf16 v[128:131], a[88:91], a[12:15], v[128:131]
    v_exp_f32 v180, v180
    v_mfma_f32_16x16x32_bf16 v[136:139], a[88:91], a[28:31], v[136:139]
    ds_read_b64_tr_b16 a[112:113], v244 offset:22528
    ds_read_b64_tr_b16 a[114:115], v244 offset:23552
    v_mfma_f32_16x16x32_bf16 v[144:147], a[88:91], a[44:47], v[144:147]
    v_exp_f32 v181, v181
    v_mfma_f32_16x16x32_bf16 v[152:155], a[88:91], a[60:63], v[152:155]
    ds_read_b64_tr_b16 a[116:117], v245 offset:22528
    v_cvt_pk_bf16_f32 v202, v180, v181
    v_mfma_f32_16x16x32_bf16 v[132:135], a[92:95], a[12:15], v[132:135]
    v_exp_f32 v182, v182
    v_mfma_f32_16x16x32_bf16 v[140:143], a[92:95], a[28:31], v[140:143]
    ds_read_b64_tr_b16 a[118:119], v245 offset:23552
    ds_read_b64_tr_b16 a[120:121], v246 offset:22528
    v_mfma_f32_16x16x32_bf16 v[148:151], a[92:95], a[44:47], v[148:151]
    s_waitcnt lgkmcnt(5)
    v_exp_f32 v183, v183
    v_mfma_f32_16x16x32_bf16 v[156:159], a[92:95], a[60:63], v[156:159]
    ds_read_b64_tr_b16 a[122:123], v246 offset:23552
    v_cvt_pk_bf16_f32 v203, v182, v183
    v_mfma_f32_16x16x32_bf16 v[0:3], a[96:99], v[192:195], v[0:3]
    v_exp_f32 v184, v184
    v_mfma_f32_16x16x32_bf16 v[4:7], a[96:99], v[196:199], v[4:7]
    ds_read_b64_tr_b16 a[124:125], v247 offset:22528
    v_add_f32 v224, v224, v160
    v_mfma_f32_16x16x32_bf16 v[16:19], a[100:103], v[192:195], v[16:19]
    v_exp_f32 v185, v185
    v_mfma_f32_16x16x32_bf16 v[20:23], a[100:103], v[196:199], v[20:23]
    ds_read_b64_tr_b16 a[126:127], v247 offset:23552
    v_cvt_pk_bf16_f32 v204, v184, v185
    v_mfma_f32_16x16x32_bf16 v[32:35], a[104:107], v[192:195], v[32:35]
    v_exp_f32 v186, v186
    v_mfma_f32_16x16x32_bf16 v[36:39], a[104:107], v[196:199], v[36:39]
    ds_read_b128 a[64:67], v236 offset:10240
    v_add_f32 v225, v225, v168
    v_mfma_f32_16x16x32_bf16 v[48:51], a[108:111], v[192:195], v[48:51]
    s_waitcnt lgkmcnt(3)
    v_exp_f32 v187, v187
    v_mfma_f32_16x16x32_bf16 v[52:55], a[108:111], v[196:199], v[52:55]
    ds_read_b128 a[68:71], v236 offset:11264
    v_cvt_pk_bf16_f32 v205, v186, v187
    v_mfma_f32_16x16x32_bf16 v[64:67], a[112:115], v[192:195], v[64:67]
    v_exp_f32 v188, v188
    v_mfma_f32_16x16x32_bf16 v[68:71], a[112:115], v[196:199], v[68:71]
    ds_read_b128 a[72:75], v237 offset:10240
    v_add_f32 v224, v224, v161
    v_mfma_f32_16x16x32_bf16 v[80:83], a[116:119], v[192:195], v[80:83]
    v_exp_f32 v189, v189
    v_mfma_f32_16x16x32_bf16 v[84:87], a[116:119], v[196:199], v[84:87]
    ds_read_b128 a[76:79], v237 offset:11264
    v_cvt_pk_bf16_f32 v206, v188, v189
    v_mfma_f32_16x16x32_bf16 v[96:99], a[120:123], v[192:195], v[96:99]
    s_waitcnt lgkmcnt(4)
    v_exp_f32 v190, v190
    v_mfma_f32_16x16x32_bf16 v[100:103], a[120:123], v[196:199], v[100:103]
    ds_read_b128 a[80:83], v238 offset:10240
    v_add_f32 v225, v225, v169
    v_mfma_f32_16x16x32_bf16 v[112:115], a[124:127], v[192:195], v[112:115]
    v_exp_f32 v191, v191
    v_mfma_f32_16x16x32_bf16 v[116:119], a[124:127], v[196:199], v[116:119]
    ds_read_b128 a[84:87], v238 offset:11264
    v_cvt_pk_bf16_f32 v207, v190, v191
    v_mfma_f32_16x16x32_bf16 v[8:11], a[96:99], v[200:203], v[8:11]
    v_exp_f32 v128, v128
    v_mfma_f32_16x16x32_bf16 v[12:15], a[96:99], v[204:207], v[12:15]
    ds_read_b128 a[88:91], v239 offset:10240
    v_add_f32 v224, v224, v162
    v_mfma_f32_16x16x32_bf16 v[24:27], a[100:103], v[200:203], v[24:27]
    v_exp_f32 v129, v129
    v_mfma_f32_16x16x32_bf16 v[28:31], a[100:103], v[204:207], v[28:31]
    ds_read_b128 a[92:95], v239 offset:11264
    v_cvt_pk_bf16_f32 v192, v128, v129
    v_mfma_f32_16x16x32_bf16 v[228:231], a[128:131], v[200:203], v[228:231]
    v_exp_f32 v130, v130
    v_mfma_f32_16x16x32_bf16 v[40:43], a[104:107], v[200:203], v[40:43]
    v_add_f32 v225, v225, v170
    v_add_f32 v224, v224, v163
    v_mfma_f32_16x16x32_bf16 v[44:47], a[104:107], v[204:207], v[44:47]
    v_exp_f32 v131, v131
    v_mfma_f32_16x16x32_bf16 v[56:59], a[108:111], v[200:203], v[56:59]
    v_cvt_pk_bf16_f32 v193, v130, v131
    v_add_f32 v225, v225, v171
    v_mfma_f32_16x16x32_bf16 v[60:63], a[108:111], v[204:207], v[60:63]
    v_exp_f32 v132, v132
    v_mfma_f32_16x16x32_bf16 v[72:75], a[112:115], v[200:203], v[72:75]
    v_add_f32 v224, v224, v164
    v_add_f32 v225, v225, v172
    v_mfma_f32_16x16x32_bf16 v[76:79], a[112:115], v[204:207], v[76:79]
    v_exp_f32 v133, v133
    v_mfma_f32_16x16x32_bf16 v[232:235], a[128:131], v[204:207], v[232:235]
    v_cvt_pk_bf16_f32 v194, v132, v133
    v_add_f32 v224, v224, v165
    v_mfma_f32_16x16x32_bf16 v[88:91], a[116:119], v[200:203], v[88:91]
    v_exp_f32 v134, v134
    v_mfma_f32_16x16x32_bf16 v[92:95], a[116:119], v[204:207], v[92:95]
    v_add_f32 v225, v225, v173
    v_add_f32 v224, v224, v166
    v_mfma_f32_16x16x32_bf16 v[104:107], a[120:123], v[200:203], v[104:107]
    s_waitcnt lgkmcnt(0)
    v_exp_f32 v135, v135
    v_mfma_f32_16x16x32_bf16 v[108:111], a[120:123], v[204:207], v[108:111]
    v_cvt_pk_bf16_f32 v195, v134, v135
    v_add_f32 v225, v225, v174
    v_mfma_f32_16x16x32_bf16 v[120:123], a[124:127], v[200:203], v[120:123]
    s_waitcnt vmcnt(0)
    v_exp_f32 v136, v136
    v_mfma_f32_16x16x32_bf16 v[124:127], a[124:127], v[204:207], v[124:127]
    v_add_f32 v224, v224, v167
    v_add_f32 v225, v225, v175
    v_mfma_f32_16x16x32_bf16 v[160:163], a[64:67], a[0:3], v[208:211]
    s_barrier
    v_exp_f32 v137, v137
    v_mfma_f32_16x16x32_bf16 v[168:171], a[64:67], a[16:19], v[212:215]
    ds_read_b64_tr_b16 a[96:97], v240 offset:32768
    v_cvt_pk_bf16_f32 v196, v136, v137
    v_mfma_f32_16x16x32_bf16 v[176:179], a[64:67], a[32:35], v[216:219]
    v_exp_f32 v138, v138
    v_mfma_f32_16x16x32_bf16 v[184:187], a[64:67], a[48:51], v[220:223]
    s_add_u32 m0, s36, 0
    v_mfma_f32_16x16x32_bf16 v[164:167], a[68:71], a[0:3], v[208:211]
    buffer_load_dwordx4 v249, s[20:23], s38 offen offset:0 lds
    v_mfma_f32_16x16x32_bf16 v[172:175], a[68:71], a[16:19], v[212:215]
    v_exp_f32 v139, v139
    v_mfma_f32_16x16x32_bf16 v[180:183], a[68:71], a[32:35], v[216:219]
    ds_read_b64_tr_b16 a[98:99], v240 offset:33792
    v_cvt_pk_bf16_f32 v197, v138, v139
    v_mfma_f32_16x16x32_bf16 v[188:191], a[68:71], a[48:51], v[220:223]
    v_exp_f32 v140, v140
    v_mfma_f32_16x16x32_bf16 v[160:163], a[72:75], a[4:7], v[160:163]
    buffer_load_dwordx4 v249, s[20:23], s38 offen offset:1024 lds
    v_mfma_f32_16x16x32_bf16 v[168:171], a[72:75], a[20:23], v[168:171]
    v_exp_f32 v141, v141
    v_mfma_f32_16x16x32_bf16 v[176:179], a[72:75], a[36:39], v[176:179]
    ds_read_b64_tr_b16 a[100:101], v241 offset:32768
    v_cvt_pk_bf16_f32 v198, v140, v141
    v_mfma_f32_16x16x32_bf16 v[184:187], a[72:75], a[52:55], v[184:187]
    v_exp_f32 v142, v142
    v_mfma_f32_16x16x32_bf16 v[164:167], a[76:79], a[4:7], v[164:167]
    v_mfma_f32_16x16x32_bf16 v[172:175], a[76:79], a[20:23], v[172:175]
    buffer_load_dwordx4 v249, s[20:23], s38 offen offset:2048 lds
    v_mfma_f32_16x16x32_bf16 v[180:183], a[76:79], a[36:39], v[180:183]
    v_exp_f32 v143, v143
    v_mfma_f32_16x16x32_bf16 v[188:191], a[76:79], a[52:55], v[188:191]
    ds_read_b64_tr_b16 a[102:103], v241 offset:33792
    v_cvt_pk_bf16_f32 v199, v142, v143
    v_mfma_f32_16x16x32_bf16 v[160:163], a[80:83], a[8:11], v[160:163]
    v_exp_f32 v144, v144
    v_mfma_f32_16x16x32_bf16 v[168:171], a[80:83], a[24:27], v[168:171]
    buffer_load_dwordx4 v249, s[20:23], s38 offen offset:3072 lds
    v_mfma_f32_16x16x32_bf16 v[176:179], a[80:83], a[40:43], v[176:179]
    s_add_u32 s38, s38, 0x4000
    v_exp_f32 v145, v145
    v_mfma_f32_16x16x32_bf16 v[184:187], a[80:83], a[56:59], v[184:187]
    ds_read_b64_tr_b16 a[104:105], v242 offset:32768
    v_cvt_pk_bf16_f32 v200, v144, v145
    v_mfma_f32_16x16x32_bf16 v[164:167], a[84:87], a[8:11], v[164:167]
    v_exp_f32 v146, v146
    v_mfma_f32_16x16x32_bf16 v[172:175], a[84:87], a[24:27], v[172:175]
    ds_read_b64_tr_b16 a[106:107], v242 offset:33792
    ds_read_b64_tr_b16 a[108:109], v243 offset:32768
    v_mfma_f32_16x16x32_bf16 v[180:183], a[84:87], a[40:43], v[180:183]
    v_exp_f32 v147, v147
    v_mfma_f32_16x16x32_bf16 v[188:191], a[84:87], a[56:59], v[188:191]
    ds_read_b64_tr_b16 a[110:111], v243 offset:33792
    v_cvt_pk_bf16_f32 v201, v146, v147
    v_mfma_f32_16x16x32_bf16 v[160:163], a[88:91], a[12:15], v[160:163]
    v_exp_f32 v148, v148
    v_mfma_f32_16x16x32_bf16 v[168:171], a[88:91], a[28:31], v[168:171]
    ds_read_b64_tr_b16 a[112:113], v244 offset:32768
    ds_read_b64_tr_b16 a[114:115], v244 offset:33792
    v_mfma_f32_16x16x32_bf16 v[176:179], a[88:91], a[44:47], v[176:179]
    v_exp_f32 v149, v149
    v_mfma_f32_16x16x32_bf16 v[184:187], a[88:91], a[60:63], v[184:187]
    ds_read_b64_tr_b16 a[116:117], v245 offset:32768
    v_cvt_pk_bf16_f32 v202, v148, v149
    v_mfma_f32_16x16x32_bf16 v[164:167], a[92:95], a[12:15], v[164:167]
    v_exp_f32 v150, v150
    v_mfma_f32_16x16x32_bf16 v[172:175], a[92:95], a[28:31], v[172:175]
    ds_read_b64_tr_b16 a[118:119], v245 offset:33792
    ds_read_b64_tr_b16 a[120:121], v246 offset:32768
    v_mfma_f32_16x16x32_bf16 v[180:183], a[92:95], a[44:47], v[180:183]
    s_waitcnt lgkmcnt(5)
    v_exp_f32 v151, v151
    v_mfma_f32_16x16x32_bf16 v[188:191], a[92:95], a[60:63], v[188:191]
    ds_read_b64_tr_b16 a[122:123], v246 offset:33792
    v_cvt_pk_bf16_f32 v203, v150, v151
    v_mfma_f32_16x16x32_bf16 v[0:3], a[96:99], v[192:195], v[0:3]
    v_exp_f32 v152, v152
    v_mfma_f32_16x16x32_bf16 v[4:7], a[96:99], v[196:199], v[4:7]
    ds_read_b64_tr_b16 a[124:125], v247 offset:32768
    v_add_f32 v224, v224, v128
    v_mfma_f32_16x16x32_bf16 v[16:19], a[100:103], v[192:195], v[16:19]
    v_exp_f32 v153, v153
    v_mfma_f32_16x16x32_bf16 v[20:23], a[100:103], v[196:199], v[20:23]
    ds_read_b64_tr_b16 a[126:127], v247 offset:33792
    v_cvt_pk_bf16_f32 v204, v152, v153
    v_mfma_f32_16x16x32_bf16 v[32:35], a[104:107], v[192:195], v[32:35]
    v_exp_f32 v154, v154
    v_mfma_f32_16x16x32_bf16 v[36:39], a[104:107], v[196:199], v[36:39]
    ds_read_b128 a[64:67], v236 offset:28672
    v_add_f32 v225, v225, v136
    v_mfma_f32_16x16x32_bf16 v[48:51], a[108:111], v[192:195], v[48:51]
    s_waitcnt lgkmcnt(3)
    v_exp_f32 v155, v155
    v_mfma_f32_16x16x32_bf16 v[52:55], a[108:111], v[196:199], v[52:55]
    ds_read_b128 a[68:71], v236 offset:29696
    v_cvt_pk_bf16_f32 v205, v154, v155
    v_mfma_f32_16x16x32_bf16 v[64:67], a[112:115], v[192:195], v[64:67]
    v_exp_f32 v156, v156
    v_mfma_f32_16x16x32_bf16 v[68:71], a[112:115], v[196:199], v[68:71]
    ds_read_b128 a[72:75], v237 offset:28672
    v_add_f32 v224, v224, v129
    v_mfma_f32_16x16x32_bf16 v[80:83], a[116:119], v[192:195], v[80:83]
    v_exp_f32 v157, v157
    v_mfma_f32_16x16x32_bf16 v[84:87], a[116:119], v[196:199], v[84:87]
    ds_read_b128 a[76:79], v237 offset:29696
    v_cvt_pk_bf16_f32 v206, v156, v157
    v_mfma_f32_16x16x32_bf16 v[96:99], a[120:123], v[192:195], v[96:99]
    s_waitcnt lgkmcnt(4)
    v_exp_f32 v158, v158
    v_mfma_f32_16x16x32_bf16 v[100:103], a[120:123], v[196:199], v[100:103]
    ds_read_b128 a[80:83], v238 offset:28672
    v_add_f32 v225, v225, v137
    v_mfma_f32_16x16x32_bf16 v[112:115], a[124:127], v[192:195], v[112:115]
    v_exp_f32 v159, v159
    v_mfma_f32_16x16x32_bf16 v[116:119], a[124:127], v[196:199], v[116:119]
    ds_read_b128 a[84:87], v238 offset:29696
    v_cvt_pk_bf16_f32 v207, v158, v159
    v_mfma_f32_16x16x32_bf16 v[8:11], a[96:99], v[200:203], v[8:11]
    v_exp_f32 v160, v160
    v_mfma_f32_16x16x32_bf16 v[12:15], a[96:99], v[204:207], v[12:15]
    ds_read_b128 a[88:91], v239 offset:28672
    v_add_f32 v224, v224, v130
    v_mfma_f32_16x16x32_bf16 v[24:27], a[100:103], v[200:203], v[24:27]
    v_exp_f32 v161, v161
    v_mfma_f32_16x16x32_bf16 v[28:31], a[100:103], v[204:207], v[28:31]
    ds_read_b128 a[92:95], v239 offset:29696
    v_cvt_pk_bf16_f32 v192, v160, v161
    v_mfma_f32_16x16x32_bf16 v[228:231], a[128:131], v[200:203], v[228:231]
    v_exp_f32 v162, v162
    v_mfma_f32_16x16x32_bf16 v[40:43], a[104:107], v[200:203], v[40:43]
    v_add_f32 v225, v225, v138
    v_add_f32 v224, v224, v131
    v_mfma_f32_16x16x32_bf16 v[44:47], a[104:107], v[204:207], v[44:47]
    v_exp_f32 v163, v163
    v_mfma_f32_16x16x32_bf16 v[56:59], a[108:111], v[200:203], v[56:59]
    v_cvt_pk_bf16_f32 v193, v162, v163
    v_add_f32 v225, v225, v139
    v_mfma_f32_16x16x32_bf16 v[60:63], a[108:111], v[204:207], v[60:63]
    v_exp_f32 v164, v164
    v_mfma_f32_16x16x32_bf16 v[72:75], a[112:115], v[200:203], v[72:75]
    v_add_f32 v224, v224, v132
    v_add_f32 v225, v225, v140
    v_mfma_f32_16x16x32_bf16 v[76:79], a[112:115], v[204:207], v[76:79]
    v_exp_f32 v165, v165
    v_mfma_f32_16x16x32_bf16 v[232:235], a[128:131], v[204:207], v[232:235]
    v_cvt_pk_bf16_f32 v194, v164, v165
    v_add_f32 v224, v224, v133
    v_mfma_f32_16x16x32_bf16 v[88:91], a[116:119], v[200:203], v[88:91]
    v_exp_f32 v166, v166
    v_mfma_f32_16x16x32_bf16 v[92:95], a[116:119], v[204:207], v[92:95]
    v_add_f32 v225, v225, v141
    v_add_f32 v224, v224, v134
    v_mfma_f32_16x16x32_bf16 v[104:107], a[120:123], v[200:203], v[104:107]
    s_waitcnt lgkmcnt(0)
    v_exp_f32 v167, v167
    v_mfma_f32_16x16x32_bf16 v[108:111], a[120:123], v[204:207], v[108:111]
    v_cvt_pk_bf16_f32 v195, v166, v167
    v_add_f32 v225, v225, v142
    v_mfma_f32_16x16x32_bf16 v[120:123], a[124:127], v[200:203], v[120:123]
    v_exp_f32 v168, v168
    v_mfma_f32_16x16x32_bf16 v[124:127], a[124:127], v[204:207], v[124:127]
    v_add_f32 v224, v224, v135
    v_add_f32 v225, v225, v143
    v_mfma_f32_16x16x32_bf16 v[128:131], a[64:67], a[0:3], v[208:211]
    v_exp_f32 v169, v169
    v_mfma_f32_16x16x32_bf16 v[136:139], a[64:67], a[16:19], v[212:215]
    ds_read_b64_tr_b16 a[96:97], v240 offset:34816
    v_cvt_pk_bf16_f32 v196, v168, v169
    v_mfma_f32_16x16x32_bf16 v[144:147], a[64:67], a[32:35], v[216:219]
    v_exp_f32 v170, v170
    v_mfma_f32_16x16x32_bf16 v[152:155], a[64:67], a[48:51], v[220:223]
    s_add_u32 m0, s36, 4096
    v_mfma_f32_16x16x32_bf16 v[132:135], a[68:71], a[0:3], v[208:211]
    buffer_load_dwordx4 v248, s[16:19], s37 offen offset:0 lds
    v_mfma_f32_16x16x32_bf16 v[140:143], a[68:71], a[16:19], v[212:215]
    v_exp_f32 v171, v171
    v_mfma_f32_16x16x32_bf16 v[148:151], a[68:71], a[32:35], v[216:219]
    ds_read_b64_tr_b16 a[98:99], v240 offset:35840
    v_cvt_pk_bf16_f32 v197, v170, v171
    v_mfma_f32_16x16x32_bf16 v[156:159], a[68:71], a[48:51], v[220:223]
    v_exp_f32 v172, v172
    v_mfma_f32_16x16x32_bf16 v[128:131], a[72:75], a[4:7], v[128:131]
    buffer_load_dwordx4 v248, s[16:19], s37 offen offset:1024 lds
    v_mfma_f32_16x16x32_bf16 v[136:139], a[72:75], a[20:23], v[136:139]
    v_exp_f32 v173, v173
    v_mfma_f32_16x16x32_bf16 v[144:147], a[72:75], a[36:39], v[144:147]
    ds_read_b64_tr_b16 a[100:101], v241 offset:34816
    v_cvt_pk_bf16_f32 v198, v172, v173
    v_mfma_f32_16x16x32_bf16 v[152:155], a[72:75], a[52:55], v[152:155]
    v_exp_f32 v174, v174
    v_mfma_f32_16x16x32_bf16 v[132:135], a[76:79], a[4:7], v[132:135]
    v_mfma_f32_16x16x32_bf16 v[140:143], a[76:79], a[20:23], v[140:143]
    buffer_load_dwordx4 v248, s[16:19], s37 offen offset:2048 lds
    v_mfma_f32_16x16x32_bf16 v[148:151], a[76:79], a[36:39], v[148:151]
    v_exp_f32 v175, v175
    v_mfma_f32_16x16x32_bf16 v[156:159], a[76:79], a[52:55], v[156:159]
    ds_read_b64_tr_b16 a[102:103], v241 offset:35840
    v_cvt_pk_bf16_f32 v199, v174, v175
    v_mfma_f32_16x16x32_bf16 v[128:131], a[80:83], a[8:11], v[128:131]
    v_exp_f32 v176, v176
    v_mfma_f32_16x16x32_bf16 v[136:139], a[80:83], a[24:27], v[136:139]
    buffer_load_dwordx4 v248, s[16:19], s37 offen offset:3072 lds
    v_mfma_f32_16x16x32_bf16 v[144:147], a[80:83], a[40:43], v[144:147]
    s_add_u32 s37, s37, 0x4000
    v_exp_f32 v177, v177
    v_mfma_f32_16x16x32_bf16 v[152:155], a[80:83], a[56:59], v[152:155]
    ds_read_b64_tr_b16 a[104:105], v242 offset:34816
    v_cvt_pk_bf16_f32 v200, v176, v177
    v_mfma_f32_16x16x32_bf16 v[132:135], a[84:87], a[8:11], v[132:135]
    v_exp_f32 v178, v178
    v_mfma_f32_16x16x32_bf16 v[140:143], a[84:87], a[24:27], v[140:143]
    ds_read_b64_tr_b16 a[106:107], v242 offset:35840
    ds_read_b64_tr_b16 a[108:109], v243 offset:34816
    v_mfma_f32_16x16x32_bf16 v[148:151], a[84:87], a[40:43], v[148:151]
    v_exp_f32 v179, v179
    v_mfma_f32_16x16x32_bf16 v[156:159], a[84:87], a[56:59], v[156:159]
    ds_read_b64_tr_b16 a[110:111], v243 offset:35840
    v_cvt_pk_bf16_f32 v201, v178, v179
    v_mfma_f32_16x16x32_bf16 v[128:131], a[88:91], a[12:15], v[128:131]
    v_exp_f32 v180, v180
    v_mfma_f32_16x16x32_bf16 v[136:139], a[88:91], a[28:31], v[136:139]
    ds_read_b64_tr_b16 a[112:113], v244 offset:34816
    ds_read_b64_tr_b16 a[114:115], v244 offset:35840
    v_mfma_f32_16x16x32_bf16 v[144:147], a[88:91], a[44:47], v[144:147]
    v_exp_f32 v181, v181
    v_mfma_f32_16x16x32_bf16 v[152:155], a[88:91], a[60:63], v[152:155]
    ds_read_b64_tr_b16 a[116:117], v245 offset:34816
    v_cvt_pk_bf16_f32 v202, v180, v181
    v_mfma_f32_16x16x32_bf16 v[132:135], a[92:95], a[12:15], v[132:135]
    v_exp_f32 v182, v182
    v_mfma_f32_16x16x32_bf16 v[140:143], a[92:95], a[28:31], v[140:143]
    ds_read_b64_tr_b16 a[118:119], v245 offset:35840
    ds_read_b64_tr_b16 a[120:121], v246 offset:34816
    v_mfma_f32_16x16x32_bf16 v[148:151], a[92:95], a[44:47], v[148:151]
    s_waitcnt lgkmcnt(5)
    v_exp_f32 v183, v183
    v_mfma_f32_16x16x32_bf16 v[156:159], a[92:95], a[60:63], v[156:159]
    ds_read_b64_tr_b16 a[122:123], v246 offset:35840
    v_cvt_pk_bf16_f32 v203, v182, v183
    v_mfma_f32_16x16x32_bf16 v[0:3], a[96:99], v[192:195], v[0:3]
    v_exp_f32 v184, v184
    v_mfma_f32_16x16x32_bf16 v[4:7], a[96:99], v[196:199], v[4:7]
    ds_read_b64_tr_b16 a[124:125], v247 offset:34816
    v_add_f32 v224, v224, v160
    v_mfma_f32_16x16x32_bf16 v[16:19], a[100:103], v[192:195], v[16:19]
    v_exp_f32 v185, v185
    v_mfma_f32_16x16x32_bf16 v[20:23], a[100:103], v[196:199], v[20:23]
    ds_read_b64_tr_b16 a[126:127], v247 offset:35840
    v_cvt_pk_bf16_f32 v204, v184, v185
    v_mfma_f32_16x16x32_bf16 v[32:35], a[104:107], v[192:195], v[32:35]
    v_exp_f32 v186, v186
    v_mfma_f32_16x16x32_bf16 v[36:39], a[104:107], v[196:199], v[36:39]
    ds_read_b128 a[64:67], v236 offset:30720
    v_add_f32 v225, v225, v168
    v_mfma_f32_16x16x32_bf16 v[48:51], a[108:111], v[192:195], v[48:51]
    s_waitcnt lgkmcnt(3)
    v_exp_f32 v187, v187
    v_mfma_f32_16x16x32_bf16 v[52:55], a[108:111], v[196:199], v[52:55]
    ds_read_b128 a[68:71], v236 offset:31744
    v_cvt_pk_bf16_f32 v205, v186, v187
    v_mfma_f32_16x16x32_bf16 v[64:67], a[112:115], v[192:195], v[64:67]
    v_exp_f32 v188, v188
    v_mfma_f32_16x16x32_bf16 v[68:71], a[112:115], v[196:199], v[68:71]
    ds_read_b128 a[72:75], v237 offset:30720
    v_add_f32 v224, v224, v161
    v_mfma_f32_16x16x32_bf16 v[80:83], a[116:119], v[192:195], v[80:83]
    v_exp_f32 v189, v189
    v_mfma_f32_16x16x32_bf16 v[84:87], a[116:119], v[196:199], v[84:87]
    ds_read_b128 a[76:79], v237 offset:31744
    v_cvt_pk_bf16_f32 v206, v188, v189
    v_mfma_f32_16x16x32_bf16 v[96:99], a[120:123], v[192:195], v[96:99]
    s_waitcnt lgkmcnt(4)
    v_exp_f32 v190, v190
    v_mfma_f32_16x16x32_bf16 v[100:103], a[120:123], v[196:199], v[100:103]
    ds_read_b128 a[80:83], v238 offset:30720
    v_add_f32 v225, v225, v169
    v_mfma_f32_16x16x32_bf16 v[112:115], a[124:127], v[192:195], v[112:115]
    v_exp_f32 v191, v191
    v_mfma_f32_16x16x32_bf16 v[116:119], a[124:127], v[196:199], v[116:119]
    ds_read_b128 a[84:87], v238 offset:31744
    v_cvt_pk_bf16_f32 v207, v190, v191
    v_mfma_f32_16x16x32_bf16 v[8:11], a[96:99], v[200:203], v[8:11]
    v_exp_f32 v128, v128
    v_mfma_f32_16x16x32_bf16 v[12:15], a[96:99], v[204:207], v[12:15]
    ds_read_b128 a[88:91], v239 offset:30720
    v_add_f32 v224, v224, v162
    v_mfma_f32_16x16x32_bf16 v[24:27], a[100:103], v[200:203], v[24:27]
    v_exp_f32 v129, v129
    v_mfma_f32_16x16x32_bf16 v[28:31], a[100:103], v[204:207], v[28:31]
    ds_read_b128 a[92:95], v239 offset:31744
    v_cvt_pk_bf16_f32 v192, v128, v129
    v_mfma_f32_16x16x32_bf16 v[228:231], a[128:131], v[200:203], v[228:231]
    v_exp_f32 v130, v130
    v_mfma_f32_16x16x32_bf16 v[40:43], a[104:107], v[200:203], v[40:43]
    v_add_f32 v225, v225, v170
    v_add_f32 v224, v224, v163
    v_mfma_f32_16x16x32_bf16 v[44:47], a[104:107], v[204:207], v[44:47]
    v_exp_f32 v131, v131
    v_mfma_f32_16x16x32_bf16 v[56:59], a[108:111], v[200:203], v[56:59]
    v_cvt_pk_bf16_f32 v193, v130, v131
    v_add_f32 v225, v225, v171
    v_mfma_f32_16x16x32_bf16 v[60:63], a[108:111], v[204:207], v[60:63]
    v_exp_f32 v132, v132
    v_mfma_f32_16x16x32_bf16 v[72:75], a[112:115], v[200:203], v[72:75]
    v_add_f32 v224, v224, v164
    v_add_f32 v225, v225, v172
    v_mfma_f32_16x16x32_bf16 v[76:79], a[112:115], v[204:207], v[76:79]
    v_exp_f32 v133, v133
    v_mfma_f32_16x16x32_bf16 v[232:235], a[128:131], v[204:207], v[232:235]
    v_cvt_pk_bf16_f32 v194, v132, v133
    v_add_f32 v224, v224, v165
    v_mfma_f32_16x16x32_bf16 v[88:91], a[116:119], v[200:203], v[88:91]
    v_exp_f32 v134, v134
    v_mfma_f32_16x16x32_bf16 v[92:95], a[116:119], v[204:207], v[92:95]
    v_add_f32 v225, v225, v173
    v_add_f32 v224, v224, v166
    v_mfma_f32_16x16x32_bf16 v[104:107], a[120:123], v[200:203], v[104:107]
    s_waitcnt lgkmcnt(0)
    v_exp_f32 v135, v135
    v_mfma_f32_16x16x32_bf16 v[108:111], a[120:123], v[204:207], v[108:111]
    v_cvt_pk_bf16_f32 v195, v134, v135
    v_add_f32 v225, v225, v174
    v_mfma_f32_16x16x32_bf16 v[120:123], a[124:127], v[200:203], v[120:123]
    v_exp_f32 v136, v136
    v_mfma_f32_16x16x32_bf16 v[124:127], a[124:127], v[204:207], v[124:127]
    v_add_f32 v224, v224, v167
    v_add_f32 v225, v225, v175
    v_mfma_f32_16x16x32_bf16 v[160:163], a[64:67], a[0:3], v[208:211]
    v_exp_f32 v137, v137
    v_mfma_f32_16x16x32_bf16 v[168:171], a[64:67], a[16:19], v[212:215]
    ds_read_b64_tr_b16 a[96:97], v240 offset:16384
    v_cvt_pk_bf16_f32 v196, v136, v137
    v_mfma_f32_16x16x32_bf16 v[176:179], a[64:67], a[32:35], v[216:219]
    v_exp_f32 v138, v138
    v_mfma_f32_16x16x32_bf16 v[184:187], a[64:67], a[48:51], v[220:223]
    s_add_u32 m0, s36, 20480
    v_mfma_f32_16x16x32_bf16 v[164:167], a[68:71], a[0:3], v[208:211]
    buffer_load_dwordx4 v249, s[20:23], s38 offen offset:0 lds
    v_mfma_f32_16x16x32_bf16 v[172:175], a[68:71], a[16:19], v[212:215]
    v_exp_f32 v139, v139
    v_mfma_f32_16x16x32_bf16 v[180:183], a[68:71], a[32:35], v[216:219]
    ds_read_b64_tr_b16 a[98:99], v240 offset:17408
    v_cvt_pk_bf16_f32 v197, v138, v139
    v_mfma_f32_16x16x32_bf16 v[188:191], a[68:71], a[48:51], v[220:223]
    v_exp_f32 v140, v140
    v_mfma_f32_16x16x32_bf16 v[160:163], a[72:75], a[4:7], v[160:163]
    buffer_load_dwordx4 v249, s[20:23], s38 offen offset:1024 lds
    v_mfma_f32_16x16x32_bf16 v[168:171], a[72:75], a[20:23], v[168:171]
    v_exp_f32 v141, v141
    v_mfma_f32_16x16x32_bf16 v[176:179], a[72:75], a[36:39], v[176:179]
    ds_read_b64_tr_b16 a[100:101], v241 offset:16384
    v_cvt_pk_bf16_f32 v198, v140, v141
    v_mfma_f32_16x16x32_bf16 v[184:187], a[72:75], a[52:55], v[184:187]
    v_exp_f32 v142, v142
    v_mfma_f32_16x16x32_bf16 v[164:167], a[76:79], a[4:7], v[164:167]
    v_mfma_f32_16x16x32_bf16 v[172:175], a[76:79], a[20:23], v[172:175]
    buffer_load_dwordx4 v249, s[20:23], s38 offen offset:2048 lds
    v_mfma_f32_16x16x32_bf16 v[180:183], a[76:79], a[36:39], v[180:183]
    v_exp_f32 v143, v143
    v_mfma_f32_16x16x32_bf16 v[188:191], a[76:79], a[52:55], v[188:191]
    ds_read_b64_tr_b16 a[102:103], v241 offset:17408
    v_cvt_pk_bf16_f32 v199, v142, v143
    v_mfma_f32_16x16x32_bf16 v[160:163], a[80:83], a[8:11], v[160:163]
    v_exp_f32 v144, v144
    v_mfma_f32_16x16x32_bf16 v[168:171], a[80:83], a[24:27], v[168:171]
    buffer_load_dwordx4 v249, s[20:23], s38 offen offset:3072 lds
    v_mfma_f32_16x16x32_bf16 v[176:179], a[80:83], a[40:43], v[176:179]
    s_add_u32 s38, s38, 0x4000
    v_exp_f32 v145, v145
    v_mfma_f32_16x16x32_bf16 v[184:187], a[80:83], a[56:59], v[184:187]
    ds_read_b64_tr_b16 a[104:105], v242 offset:16384
    v_cvt_pk_bf16_f32 v200, v144, v145
    v_mfma_f32_16x16x32_bf16 v[164:167], a[84:87], a[8:11], v[164:167]
    v_exp_f32 v146, v146
    v_mfma_f32_16x16x32_bf16 v[172:175], a[84:87], a[24:27], v[172:175]
    ds_read_b64_tr_b16 a[106:107], v242 offset:17408
    ds_read_b64_tr_b16 a[108:109], v243 offset:16384
    v_mfma_f32_16x16x32_bf16 v[180:183], a[84:87], a[40:43], v[180:183]
    v_exp_f32 v147, v147
    v_mfma_f32_16x16x32_bf16 v[188:191], a[84:87], a[56:59], v[188:191]
    ds_read_b64_tr_b16 a[110:111], v243 offset:17408
    v_cvt_pk_bf16_f32 v201, v146, v147
    v_mfma_f32_16x16x32_bf16 v[160:163], a[88:91], a[12:15], v[160:163]
    v_exp_f32 v148, v148
    v_mfma_f32_16x16x32_bf16 v[168:171], a[88:91], a[28:31], v[168:171]
    ds_read_b64_tr_b16 a[112:113], v244 offset:16384
    ds_read_b64_tr_b16 a[114:115], v244 offset:17408
    v_mfma_f32_16x16x32_bf16 v[176:179], a[88:91], a[44:47], v[176:179]
    v_exp_f32 v149, v149
    v_mfma_f32_16x16x32_bf16 v[184:187], a[88:91], a[60:63], v[184:187]
    ds_read_b64_tr_b16 a[116:117], v245 offset:16384
    v_cvt_pk_bf16_f32 v202, v148, v149
    v_mfma_f32_16x16x32_bf16 v[164:167], a[92:95], a[12:15], v[164:167]
    v_exp_f32 v150, v150
    v_mfma_f32_16x16x32_bf16 v[172:175], a[92:95], a[28:31], v[172:175]
    ds_read_b64_tr_b16 a[118:119], v245 offset:17408
    ds_read_b64_tr_b16 a[120:121], v246 offset:16384
    v_mfma_f32_16x16x32_bf16 v[180:183], a[92:95], a[44:47], v[180:183]
    s_waitcnt lgkmcnt(5)
    v_exp_f32 v151, v151
    v_mfma_f32_16x16x32_bf16 v[188:191], a[92:95], a[60:63], v[188:191]
    ds_read_b64_tr_b16 a[122:123], v246 offset:17408
    v_cvt_pk_bf16_f32 v203, v150, v151
    v_mfma_f32_16x16x32_bf16 v[0:3], a[96:99], v[192:195], v[0:3]
    v_exp_f32 v152, v152
    v_mfma_f32_16x16x32_bf16 v[4:7], a[96:99], v[196:199], v[4:7]
    ds_read_b64_tr_b16 a[124:125], v247 offset:16384
    v_add_f32 v224, v224, v128
    v_mfma_f32_16x16x32_bf16 v[16:19], a[100:103], v[192:195], v[16:19]
    v_exp_f32 v153, v153
    v_mfma_f32_16x16x32_bf16 v[20:23], a[100:103], v[196:199], v[20:23]
    ds_read_b64_tr_b16 a[126:127], v247 offset:17408
    v_cvt_pk_bf16_f32 v204, v152, v153
    v_mfma_f32_16x16x32_bf16 v[32:35], a[104:107], v[192:195], v[32:35]
    v_exp_f32 v154, v154
    v_mfma_f32_16x16x32_bf16 v[36:39], a[104:107], v[196:199], v[36:39]
    ds_read_b128 a[64:67], v236 offset:36864
    v_add_f32 v225, v225, v136
    v_mfma_f32_16x16x32_bf16 v[48:51], a[108:111], v[192:195], v[48:51]
    s_waitcnt lgkmcnt(3)
    v_exp_f32 v155, v155
    v_mfma_f32_16x16x32_bf16 v[52:55], a[108:111], v[196:199], v[52:55]
    ds_read_b128 a[68:71], v236 offset:37888
    v_cvt_pk_bf16_f32 v205, v154, v155
    v_mfma_f32_16x16x32_bf16 v[64:67], a[112:115], v[192:195], v[64:67]
    v_exp_f32 v156, v156
    v_mfma_f32_16x16x32_bf16 v[68:71], a[112:115], v[196:199], v[68:71]
    ds_read_b128 a[72:75], v237 offset:36864
    v_add_f32 v224, v224, v129
    v_mfma_f32_16x16x32_bf16 v[80:83], a[116:119], v[192:195], v[80:83]
    v_exp_f32 v157, v157
    v_mfma_f32_16x16x32_bf16 v[84:87], a[116:119], v[196:199], v[84:87]
    ds_read_b128 a[76:79], v237 offset:37888
    v_cvt_pk_bf16_f32 v206, v156, v157
    v_mfma_f32_16x16x32_bf16 v[96:99], a[120:123], v[192:195], v[96:99]
    s_waitcnt lgkmcnt(4)
    v_exp_f32 v158, v158
    v_mfma_f32_16x16x32_bf16 v[100:103], a[120:123], v[196:199], v[100:103]
    ds_read_b128 a[80:83], v238 offset:36864
    v_add_f32 v225, v225, v137
    v_mfma_f32_16x16x32_bf16 v[112:115], a[124:127], v[192:195], v[112:115]
    v_exp_f32 v159, v159
    v_mfma_f32_16x16x32_bf16 v[116:119], a[124:127], v[196:199], v[116:119]
    ds_read_b128 a[84:87], v238 offset:37888
    v_cvt_pk_bf16_f32 v207, v158, v159
    v_mfma_f32_16x16x32_bf16 v[8:11], a[96:99], v[200:203], v[8:11]
    v_exp_f32 v160, v160
    v_mfma_f32_16x16x32_bf16 v[12:15], a[96:99], v[204:207], v[12:15]
    ds_read_b128 a[88:91], v239 offset:36864
    v_add_f32 v224, v224, v130
    v_mfma_f32_16x16x32_bf16 v[24:27], a[100:103], v[200:203], v[24:27]
    v_exp_f32 v161, v161
    v_mfma_f32_16x16x32_bf16 v[28:31], a[100:103], v[204:207], v[28:31]
    ds_read_b128 a[92:95], v239 offset:37888
    v_cvt_pk_bf16_f32 v192, v160, v161
    v_mfma_f32_16x16x32_bf16 v[228:231], a[128:131], v[200:203], v[228:231]
    v_exp_f32 v162, v162
    v_mfma_f32_16x16x32_bf16 v[40:43], a[104:107], v[200:203], v[40:43]
    v_add_f32 v225, v225, v138
    v_add_f32 v224, v224, v131
    v_mfma_f32_16x16x32_bf16 v[44:47], a[104:107], v[204:207], v[44:47]
    v_exp_f32 v163, v163
    v_mfma_f32_16x16x32_bf16 v[56:59], a[108:111], v[200:203], v[56:59]
    v_cvt_pk_bf16_f32 v193, v162, v163
    v_add_f32 v225, v225, v139
    v_mfma_f32_16x16x32_bf16 v[60:63], a[108:111], v[204:207], v[60:63]
    v_exp_f32 v164, v164
    v_mfma_f32_16x16x32_bf16 v[72:75], a[112:115], v[200:203], v[72:75]
    v_add_f32 v224, v224, v132
    v_add_f32 v225, v225, v140
    v_mfma_f32_16x16x32_bf16 v[76:79], a[112:115], v[204:207], v[76:79]
    v_exp_f32 v165, v165
    v_mfma_f32_16x16x32_bf16 v[232:235], a[128:131], v[204:207], v[232:235]
    v_cvt_pk_bf16_f32 v194, v164, v165
    v_add_f32 v224, v224, v133
    v_mfma_f32_16x16x32_bf16 v[88:91], a[116:119], v[200:203], v[88:91]
    v_exp_f32 v166, v166
    v_mfma_f32_16x16x32_bf16 v[92:95], a[116:119], v[204:207], v[92:95]
    v_add_f32 v225, v225, v141
    v_add_f32 v224, v224, v134
    v_mfma_f32_16x16x32_bf16 v[104:107], a[120:123], v[200:203], v[104:107]
    s_waitcnt lgkmcnt(0)
    v_exp_f32 v167, v167
    v_mfma_f32_16x16x32_bf16 v[108:111], a[120:123], v[204:207], v[108:111]
    v_cvt_pk_bf16_f32 v195, v166, v167
    v_add_f32 v225, v225, v142
    v_mfma_f32_16x16x32_bf16 v[120:123], a[124:127], v[200:203], v[120:123]
    v_exp_f32 v168, v168
    v_mfma_f32_16x16x32_bf16 v[124:127], a[124:127], v[204:207], v[124:127]
    v_add_f32 v224, v224, v135
    v_add_f32 v225, v225, v143
    v_mfma_f32_16x16x32_bf16 v[128:131], a[64:67], a[0:3], v[208:211]
    v_exp_f32 v169, v169
    v_mfma_f32_16x16x32_bf16 v[136:139], a[64:67], a[16:19], v[212:215]
    ds_read_b64_tr_b16 a[96:97], v240 offset:18432
    v_cvt_pk_bf16_f32 v196, v168, v169
    v_mfma_f32_16x16x32_bf16 v[144:147], a[64:67], a[32:35], v[216:219]
    v_exp_f32 v170, v170
    v_mfma_f32_16x16x32_bf16 v[152:155], a[64:67], a[48:51], v[220:223]
    s_add_u32 m0, s36, 8192
    v_mfma_f32_16x16x32_bf16 v[132:135], a[68:71], a[0:3], v[208:211]
    buffer_load_dwordx4 v248, s[16:19], s37 offen offset:0 lds
    v_mfma_f32_16x16x32_bf16 v[140:143], a[68:71], a[16:19], v[212:215]
    v_exp_f32 v171, v171
    v_mfma_f32_16x16x32_bf16 v[148:151], a[68:71], a[32:35], v[216:219]
    ds_read_b64_tr_b16 a[98:99], v240 offset:19456
    v_cvt_pk_bf16_f32 v197, v170, v171
    v_mfma_f32_16x16x32_bf16 v[156:159], a[68:71], a[48:51], v[220:223]
    v_exp_f32 v172, v172
    v_mfma_f32_16x16x32_bf16 v[128:131], a[72:75], a[4:7], v[128:131]
    buffer_load_dwordx4 v248, s[16:19], s37 offen offset:1024 lds
    v_mfma_f32_16x16x32_bf16 v[136:139], a[72:75], a[20:23], v[136:139]
    v_exp_f32 v173, v173
    v_mfma_f32_16x16x32_bf16 v[144:147], a[72:75], a[36:39], v[144:147]
    ds_read_b64_tr_b16 a[100:101], v241 offset:18432
    v_cvt_pk_bf16_f32 v198, v172, v173
    v_mfma_f32_16x16x32_bf16 v[152:155], a[72:75], a[52:55], v[152:155]
    v_exp_f32 v174, v174
    v_mfma_f32_16x16x32_bf16 v[132:135], a[76:79], a[4:7], v[132:135]
    v_mfma_f32_16x16x32_bf16 v[140:143], a[76:79], a[20:23], v[140:143]
    buffer_load_dwordx4 v248, s[16:19], s37 offen offset:2048 lds
    v_mfma_f32_16x16x32_bf16 v[148:151], a[76:79], a[36:39], v[148:151]
    v_exp_f32 v175, v175
    v_mfma_f32_16x16x32_bf16 v[156:159], a[76:79], a[52:55], v[156:159]
    ds_read_b64_tr_b16 a[102:103], v241 offset:19456
    v_cvt_pk_bf16_f32 v199, v174, v175
    v_mfma_f32_16x16x32_bf16 v[128:131], a[80:83], a[8:11], v[128:131]
    v_exp_f32 v176, v176
    v_mfma_f32_16x16x32_bf16 v[136:139], a[80:83], a[24:27], v[136:139]
    buffer_load_dwordx4 v248, s[16:19], s37 offen offset:3072 lds
    v_mfma_f32_16x16x32_bf16 v[144:147], a[80:83], a[40:43], v[144:147]
    s_add_u32 s37, s37, 0x4000
    v_exp_f32 v177, v177
    v_mfma_f32_16x16x32_bf16 v[152:155], a[80:83], a[56:59], v[152:155]
    ds_read_b64_tr_b16 a[104:105], v242 offset:18432
    v_cvt_pk_bf16_f32 v200, v176, v177
    v_mfma_f32_16x16x32_bf16 v[132:135], a[84:87], a[8:11], v[132:135]
    v_exp_f32 v178, v178
    v_mfma_f32_16x16x32_bf16 v[140:143], a[84:87], a[24:27], v[140:143]
    ds_read_b64_tr_b16 a[106:107], v242 offset:19456
    ds_read_b64_tr_b16 a[108:109], v243 offset:18432
    v_mfma_f32_16x16x32_bf16 v[148:151], a[84:87], a[40:43], v[148:151]
    v_exp_f32 v179, v179
    v_mfma_f32_16x16x32_bf16 v[156:159], a[84:87], a[56:59], v[156:159]
    ds_read_b64_tr_b16 a[110:111], v243 offset:19456
    v_cvt_pk_bf16_f32 v201, v178, v179
    v_mfma_f32_16x16x32_bf16 v[128:131], a[88:91], a[12:15], v[128:131]
    v_exp_f32 v180, v180
    v_mfma_f32_16x16x32_bf16 v[136:139], a[88:91], a[28:31], v[136:139]
    ds_read_b64_tr_b16 a[112:113], v244 offset:18432
    ds_read_b64_tr_b16 a[114:115], v244 offset:19456
    v_mfma_f32_16x16x32_bf16 v[144:147], a[88:91], a[44:47], v[144:147]
    v_exp_f32 v181, v181
    v_mfma_f32_16x16x32_bf16 v[152:155], a[88:91], a[60:63], v[152:155]
    ds_read_b64_tr_b16 a[116:117], v245 offset:18432
    v_cvt_pk_bf16_f32 v202, v180, v181
    v_mfma_f32_16x16x32_bf16 v[132:135], a[92:95], a[12:15], v[132:135]
    v_exp_f32 v182, v182
    v_mfma_f32_16x16x32_bf16 v[140:143], a[92:95], a[28:31], v[140:143]
    ds_read_b64_tr_b16 a[118:119], v245 offset:19456
    ds_read_b64_tr_b16 a[120:121], v246 offset:18432
    v_mfma_f32_16x16x32_bf16 v[148:151], a[92:95], a[44:47], v[148:151]
    s_waitcnt lgkmcnt(5)
    v_exp_f32 v183, v183
    v_mfma_f32_16x16x32_bf16 v[156:159], a[92:95], a[60:63], v[156:159]
    ds_read_b64_tr_b16 a[122:123], v246 offset:19456
    v_cvt_pk_bf16_f32 v203, v182, v183
    v_mfma_f32_16x16x32_bf16 v[0:3], a[96:99], v[192:195], v[0:3]
    v_exp_f32 v184, v184
    v_mfma_f32_16x16x32_bf16 v[4:7], a[96:99], v[196:199], v[4:7]
    ds_read_b64_tr_b16 a[124:125], v247 offset:18432
    v_add_f32 v224, v224, v160
    v_mfma_f32_16x16x32_bf16 v[16:19], a[100:103], v[192:195], v[16:19]
    v_exp_f32 v185, v185
    v_mfma_f32_16x16x32_bf16 v[20:23], a[100:103], v[196:199], v[20:23]
    ds_read_b64_tr_b16 a[126:127], v247 offset:19456
    v_cvt_pk_bf16_f32 v204, v184, v185
    v_mfma_f32_16x16x32_bf16 v[32:35], a[104:107], v[192:195], v[32:35]
    v_exp_f32 v186, v186
    v_mfma_f32_16x16x32_bf16 v[36:39], a[104:107], v[196:199], v[36:39]
    ds_read_b128 a[64:67], v236 offset:38912
    v_add_f32 v225, v225, v168
    v_mfma_f32_16x16x32_bf16 v[48:51], a[108:111], v[192:195], v[48:51]
    s_waitcnt lgkmcnt(3)
    v_exp_f32 v187, v187
    v_mfma_f32_16x16x32_bf16 v[52:55], a[108:111], v[196:199], v[52:55]
    ds_read_b128 a[68:71], v236 offset:39936
    v_cvt_pk_bf16_f32 v205, v186, v187
    v_mfma_f32_16x16x32_bf16 v[64:67], a[112:115], v[192:195], v[64:67]
    v_exp_f32 v188, v188
    v_mfma_f32_16x16x32_bf16 v[68:71], a[112:115], v[196:199], v[68:71]
    ds_read_b128 a[72:75], v237 offset:38912
    v_add_f32 v224, v224, v161
    v_mfma_f32_16x16x32_bf16 v[80:83], a[116:119], v[192:195], v[80:83]
    v_exp_f32 v189, v189
    v_mfma_f32_16x16x32_bf16 v[84:87], a[116:119], v[196:199], v[84:87]
    ds_read_b128 a[76:79], v237 offset:39936
    v_cvt_pk_bf16_f32 v206, v188, v189
    v_mfma_f32_16x16x32_bf16 v[96:99], a[120:123], v[192:195], v[96:99]
    s_waitcnt lgkmcnt(4)
    v_exp_f32 v190, v190
    v_mfma_f32_16x16x32_bf16 v[100:103], a[120:123], v[196:199], v[100:103]
    ds_read_b128 a[80:83], v238 offset:38912
    v_add_f32 v225, v225, v169
    v_mfma_f32_16x16x32_bf16 v[112:115], a[124:127], v[192:195], v[112:115]
    v_exp_f32 v191, v191
    v_mfma_f32_16x16x32_bf16 v[116:119], a[124:127], v[196:199], v[116:119]
    ds_read_b128 a[84:87], v238 offset:39936
    v_cvt_pk_bf16_f32 v207, v190, v191
    v_mfma_f32_16x16x32_bf16 v[8:11], a[96:99], v[200:203], v[8:11]
    v_exp_f32 v128, v128
    v_mfma_f32_16x16x32_bf16 v[12:15], a[96:99], v[204:207], v[12:15]
    ds_read_b128 a[88:91], v239 offset:38912
    v_add_f32 v224, v224, v162
    v_mfma_f32_16x16x32_bf16 v[24:27], a[100:103], v[200:203], v[24:27]
    v_exp_f32 v129, v129
    v_mfma_f32_16x16x32_bf16 v[28:31], a[100:103], v[204:207], v[28:31]
    ds_read_b128 a[92:95], v239 offset:39936
    v_cvt_pk_bf16_f32 v192, v128, v129
    v_mfma_f32_16x16x32_bf16 v[228:231], a[128:131], v[200:203], v[228:231]
    v_exp_f32 v130, v130
    v_mfma_f32_16x16x32_bf16 v[40:43], a[104:107], v[200:203], v[40:43]
    v_add_f32 v225, v225, v170
    v_add_f32 v224, v224, v163
    v_mfma_f32_16x16x32_bf16 v[44:47], a[104:107], v[204:207], v[44:47]
    v_exp_f32 v131, v131
    v_mfma_f32_16x16x32_bf16 v[56:59], a[108:111], v[200:203], v[56:59]
    v_cvt_pk_bf16_f32 v193, v130, v131
    v_add_f32 v225, v225, v171
    v_mfma_f32_16x16x32_bf16 v[60:63], a[108:111], v[204:207], v[60:63]
    s_sub_u32 s40, s40, 1
    v_exp_f32 v132, v132
    v_mfma_f32_16x16x32_bf16 v[72:75], a[112:115], v[200:203], v[72:75]
    v_add_f32 v224, v224, v164
    v_add_f32 v225, v225, v172
    v_mfma_f32_16x16x32_bf16 v[76:79], a[112:115], v[204:207], v[76:79]
    s_cmp_lg_u32 s40, 0
    v_exp_f32 v133, v133
    v_mfma_f32_16x16x32_bf16 v[232:235], a[128:131], v[204:207], v[232:235]
    v_cvt_pk_bf16_f32 v194, v132, v133
    v_add_f32 v224, v224, v165
    v_mfma_f32_16x16x32_bf16 v[88:91], a[116:119], v[200:203], v[88:91]
    v_exp_f32 v134, v134
    v_mfma_f32_16x16x32_bf16 v[92:95], a[116:119], v[204:207], v[92:95]
    v_add_f32 v225, v225, v173
    v_add_f32 v224, v224, v166
    v_mfma_f32_16x16x32_bf16 v[104:107], a[120:123], v[200:203], v[104:107]
    s_waitcnt lgkmcnt(0)
    v_exp_f32 v135, v135
    v_mfma_f32_16x16x32_bf16 v[108:111], a[120:123], v[204:207], v[108:111]
    v_cvt_pk_bf16_f32 v195, v134, v135
    v_add_f32 v225, v225, v174
    v_mfma_f32_16x16x32_bf16 v[120:123], a[124:127], v[200:203], v[120:123]
    s_waitcnt vmcnt(0)
    v_exp_f32 v136, v136
    v_mfma_f32_16x16x32_bf16 v[124:127], a[124:127], v[204:207], v[124:127]
    v_add_f32 v224, v224, v167
    v_add_f32 v225, v225, v175
    s_cbranch_scc1 L_kf_loop_4
    v_lshrrev_b32 v226, 1, v250
    v_and_b32 v226, 0x38, v226
    global_load_dwordx2 v[226:227], v226, s[98:99] sc1
    v_mfma_f32_16x16x32_bf16 v[160:163], a[64:67], a[0:3], v[208:211]
    s_barrier
    v_exp_f32 v137, v137
    v_mfma_f32_16x16x32_bf16 v[168:171], a[64:67], a[16:19], v[212:215]
    ds_read_b64_tr_b16 a[96:97], v240 offset:0
    v_cvt_pk_bf16_f32 v196, v136, v137
    v_mfma_f32_16x16x32_bf16 v[176:179], a[64:67], a[32:35], v[216:219]
    s_add_u32 m0, s36, 24576
    v_exp_f32 v138, v138
    v_mfma_f32_16x16x32_bf16 v[184:187], a[64:67], a[48:51], v[220:223]
    s_mov_b32 s39, 0
    v_mfma_f32_16x16x32_bf16 v[164:167], a[68:71], a[0:3], v[208:211]
    buffer_load_dwordx4 v252, s[24:27], s39 offen offset:0 lds
    v_mfma_f32_16x16x32_bf16 v[172:175], a[68:71], a[16:19], v[212:215]
    v_exp_f32 v139, v139
    v_mfma_f32_16x16x32_bf16 v[180:183], a[68:71], a[32:35], v[216:219]
    ds_read_b64_tr_b16 a[98:99], v240 offset:1024
    v_cvt_pk_bf16_f32 v197, v138, v139
    v_mfma_f32_16x16x32_bf16 v[188:191], a[68:71], a[48:51], v[220:223]
    s_mov_b32 s39, 7168
    v_exp_f32 v140, v140
    v_mfma_f32_16x16x32_bf16 v[160:163], a[72:75], a[4:7], v[160:163]
    buffer_load_dwordx4 v252, s[24:27], s39 offen offset:1024 lds
    v_mfma_f32_16x16x32_bf16 v[168:171], a[72:75], a[20:23], v[168:171]
    v_exp_f32 v141, v141
    v_mfma_f32_16x16x32_bf16 v[176:179], a[72:75], a[36:39], v[176:179]
    ds_read_b64_tr_b16 a[100:101], v241 offset:0
    v_cvt_pk_bf16_f32 v198, v140, v141
    v_mfma_f32_16x16x32_bf16 v[184:187], a[72:75], a[52:55], v[184:187]
    v_exp_f32 v142, v142
    v_mfma_f32_16x16x32_bf16 v[164:167], a[76:79], a[4:7], v[164:167]
    s_mov_b32 s39, 14336
    v_mfma_f32_16x16x32_bf16 v[172:175], a[76:79], a[20:23], v[172:175]
    buffer_load_dwordx4 v252, s[24:27], s39 offen offset:2048 lds
    v_mfma_f32_16x16x32_bf16 v[180:183], a[76:79], a[36:39], v[180:183]
    v_exp_f32 v143, v143
    v_mfma_f32_16x16x32_bf16 v[188:191], a[76:79], a[52:55], v[188:191]
    ds_read_b64_tr_b16 a[102:103], v241 offset:1024
    v_cvt_pk_bf16_f32 v199, v142, v143
    v_mfma_f32_16x16x32_bf16 v[160:163], a[80:83], a[8:11], v[160:163]
    s_mov_b32 s39, 21504
    v_exp_f32 v144, v144
    v_mfma_f32_16x16x32_bf16 v[168:171], a[80:83], a[24:27], v[168:171]
    buffer_load_dwordx4 v252, s[24:27], s39 offen offset:3072 lds
    v_mfma_f32_16x16x32_bf16 v[176:179], a[80:83], a[40:43], v[176:179]
    v_exp_f32 v145, v145
    v_mfma_f32_16x16x32_bf16 v[184:187], a[80:83], a[56:59], v[184:187]
    ds_read_b64_tr_b16 a[104:105], v242 offset:0
    v_cvt_pk_bf16_f32 v200, v144, v145
    v_mfma_f32_16x16x32_bf16 v[164:167], a[84:87], a[8:11], v[164:167]
    v_exp_f32 v146, v146
    v_mfma_f32_16x16x32_bf16 v[172:175], a[84:87], a[24:27], v[172:175]
    ds_read_b64_tr_b16 a[106:107], v242 offset:1024
    ds_read_b64_tr_b16 a[108:109], v243 offset:0
    v_mfma_f32_16x16x32_bf16 v[180:183], a[84:87], a[40:43], v[180:183]
    v_exp_f32 v147, v147
    v_mfma_f32_16x16x32_bf16 v[188:191], a[84:87], a[56:59], v[188:191]
    ds_read_b64_tr_b16 a[110:111], v243 offset:1024
    v_cvt_pk_bf16_f32 v201, v146, v147
    v_mfma_f32_16x16x32_bf16 v[160:163], a[88:91], a[12:15], v[160:163]
    v_exp_f32 v148, v148
    v_mfma_f32_16x16x32_bf16 v[168:171], a[88:91], a[28:31], v[168:171]
    ds_read_b64_tr_b16 a[112:113], v244 offset:0
    ds_read_b64_tr_b16 a[114:115], v244 offset:1024
    v_mfma_f32_16x16x32_bf16 v[176:179], a[88:91], a[44:47], v[176:179]
    v_exp_f32 v149, v149
    v_mfma_f32_16x16x32_bf16 v[184:187], a[88:91], a[60:63], v[184:187]
    ds_read_b64_tr_b16 a[116:117], v245 offset:0
    v_cvt_pk_bf16_f32 v202, v148, v149
    v_mfma_f32_16x16x32_bf16 v[164:167], a[92:95], a[12:15], v[164:167]
    v_exp_f32 v150, v150
    v_mfma_f32_16x16x32_bf16 v[172:175], a[92:95], a[28:31], v[172:175]
    ds_read_b64_tr_b16 a[118:119], v245 offset:1024
    ds_read_b64_tr_b16 a[120:121], v246 offset:0
    v_mfma_f32_16x16x32_bf16 v[180:183], a[92:95], a[44:47], v[180:183]
    s_waitcnt lgkmcnt(5)
    v_exp_f32 v151, v151
    v_mfma_f32_16x16x32_bf16 v[188:191], a[92:95], a[60:63], v[188:191]
    ds_read_b64_tr_b16 a[122:123], v246 offset:1024
    v_cvt_pk_bf16_f32 v203, v150, v151
    v_mfma_f32_16x16x32_bf16 v[0:3], a[96:99], v[192:195], v[0:3]
    v_exp_f32 v152, v152
    v_mfma_f32_16x16x32_bf16 v[4:7], a[96:99], v[196:199], v[4:7]
    ds_read_b64_tr_b16 a[124:125], v247 offset:0
    v_add_f32 v224, v224, v128
    v_mfma_f32_16x16x32_bf16 v[16:19], a[100:103], v[192:195], v[16:19]
    v_exp_f32 v153, v153
    v_mfma_f32_16x16x32_bf16 v[20:23], a[100:103], v[196:199], v[20:23]
    ds_read_b64_tr_b16 a[126:127], v247 offset:1024
    v_cvt_pk_bf16_f32 v204, v152, v153
    v_mfma_f32_16x16x32_bf16 v[32:35], a[104:107], v[192:195], v[32:35]
    v_exp_f32 v154, v154
    v_mfma_f32_16x16x32_bf16 v[36:39], a[104:107], v[196:199], v[36:39]
    ds_read_b128 a[64:67], v236 offset:4096
    v_add_f32 v225, v225, v136
    v_mfma_f32_16x16x32_bf16 v[48:51], a[108:111], v[192:195], v[48:51]
    s_waitcnt lgkmcnt(3)
    v_exp_f32 v155, v155
    v_mfma_f32_16x16x32_bf16 v[52:55], a[108:111], v[196:199], v[52:55]
    ds_read_b128 a[68:71], v236 offset:5120
    v_cvt_pk_bf16_f32 v205, v154, v155
    v_mfma_f32_16x16x32_bf16 v[64:67], a[112:115], v[192:195], v[64:67]
    v_exp_f32 v156, v156
    v_mfma_f32_16x16x32_bf16 v[68:71], a[112:115], v[196:199], v[68:71]
    ds_read_b128 a[72:75], v237 offset:4096
    v_add_f32 v224, v224, v129
    v_mfma_f32_16x16x32_bf16 v[80:83], a[116:119], v[192:195], v[80:83]
    v_exp_f32 v157, v157
    v_mfma_f32_16x16x32_bf16 v[84:87], a[116:119], v[196:199], v[84:87]
    ds_read_b128 a[76:79], v237 offset:5120
    v_cvt_pk_bf16_f32 v206, v156, v157
    v_mfma_f32_16x16x32_bf16 v[96:99], a[120:123], v[192:195], v[96:99]
    s_waitcnt lgkmcnt(4)
    v_exp_f32 v158, v158
    v_mfma_f32_16x16x32_bf16 v[100:103], a[120:123], v[196:199], v[100:103]
    ds_read_b128 a[80:83], v238 offset:4096
    v_add_f32 v225, v225, v137
    v_mfma_f32_16x16x32_bf16 v[112:115], a[124:127], v[192:195], v[112:115]
    v_exp_f32 v159, v159
    v_mfma_f32_16x16x32_bf16 v[116:119], a[124:127], v[196:199], v[116:119]
    ds_read_b128 a[84:87], v238 offset:5120
    v_cvt_pk_bf16_f32 v207, v158, v159
    v_mfma_f32_16x16x32_bf16 v[8:11], a[96:99], v[200:203], v[8:11]
    v_exp_f32 v160, v160
    v_mfma_f32_16x16x32_bf16 v[12:15], a[96:99], v[204:207], v[12:15]
    ds_read_b128 a[88:91], v239 offset:4096
    v_add_f32 v224, v224, v130
    v_mfma_f32_16x16x32_bf16 v[24:27], a[100:103], v[200:203], v[24:27]
    v_exp_f32 v161, v161
    v_mfma_f32_16x16x32_bf16 v[28:31], a[100:103], v[204:207], v[28:31]
    ds_read_b128 a[92:95], v239 offset:5120
    v_cvt_pk_bf16_f32 v192, v160, v161
    v_mfma_f32_16x16x32_bf16 v[228:231], a[128:131], v[200:203], v[228:231]
    v_exp_f32 v162, v162
    v_mfma_f32_16x16x32_bf16 v[40:43], a[104:107], v[200:203], v[40:43]
    v_add_f32 v225, v225, v138
    v_add_f32 v224, v224, v131
    v_mfma_f32_16x16x32_bf16 v[44:47], a[104:107], v[204:207], v[44:47]
    v_exp_f32 v163, v163
    v_mfma_f32_16x16x32_bf16 v[56:59], a[108:111], v[200:203], v[56:59]
    v_cvt_pk_bf16_f32 v193, v162, v163
    v_add_f32 v225, v225, v139
    v_mfma_f32_16x16x32_bf16 v[60:63], a[108:111], v[204:207], v[60:63]
    v_exp_f32 v164, v164
    v_mfma_f32_16x16x32_bf16 v[72:75], a[112:115], v[200:203], v[72:75]
    v_add_f32 v224, v224, v132
    v_add_f32 v225, v225, v140
    v_mfma_f32_16x16x32_bf16 v[76:79], a[112:115], v[204:207], v[76:79]
    v_exp_f32 v165, v165
    v_mfma_f32_16x16x32_bf16 v[232:235], a[128:131], v[204:207], v[232:235]
    v_cvt_pk_bf16_f32 v194, v164, v165
    v_add_f32 v224, v224, v133
    v_mfma_f32_16x16x32_bf16 v[88:91], a[116:119], v[200:203], v[88:91]
    v_exp_f32 v166, v166
    v_mfma_f32_16x16x32_bf16 v[92:95], a[116:119], v[204:207], v[92:95]
    v_add_f32 v225, v225, v141
    v_add_f32 v224, v224, v134
    v_mfma_f32_16x16x32_bf16 v[104:107], a[120:123], v[200:203], v[104:107]
    s_waitcnt lgkmcnt(0)
    v_exp_f32 v167, v167
    v_mfma_f32_16x16x32_bf16 v[108:111], a[120:123], v[204:207], v[108:111]
    v_cvt_pk_bf16_f32 v195, v166, v167
    v_add_f32 v225, v225, v142
    v_mfma_f32_16x16x32_bf16 v[120:123], a[124:127], v[200:203], v[120:123]
    v_exp_f32 v168, v168
    v_mfma_f32_16x16x32_bf16 v[124:127], a[124:127], v[204:207], v[124:127]
    v_add_f32 v224, v224, v135
    v_add_f32 v225, v225, v143
    v_mfma_f32_16x16x32_bf16 v[128:131], a[64:67], a[0:3], v[208:211]
    v_exp_f32 v169, v169
    v_mfma_f32_16x16x32_bf16 v[136:139], a[64:67], a[16:19], v[212:215]
    ds_read_b64_tr_b16 a[96:97], v240 offset:2048
    v_cvt_pk_bf16_f32 v196, v168, v169
    v_mfma_f32_16x16x32_bf16 v[144:147], a[64:67], a[32:35], v[216:219]
    s_add_u32 m0, s36, 28544
    v_exp_f32 v170, v170
    v_mfma_f32_16x16x32_bf16 v[152:155], a[64:67], a[48:51], v[220:223]
    s_mov_b32 s39, 0
    v_mfma_f32_16x16x32_bf16 v[132:135], a[68:71], a[0:3], v[208:211]
    buffer_load_dwordx4 v252, s[24:27], s39 offen offset:128 lds
    v_mfma_f32_16x16x32_bf16 v[140:143], a[68:71], a[16:19], v[212:215]
    v_exp_f32 v171, v171
    v_mfma_f32_16x16x32_bf16 v[148:151], a[68:71], a[32:35], v[216:219]
    ds_read_b64_tr_b16 a[98:99], v240 offset:3072
    v_cvt_pk_bf16_f32 v197, v170, v171
    v_mfma_f32_16x16x32_bf16 v[156:159], a[68:71], a[48:51], v[220:223]
    s_mov_b32 s39, 7168
    v_exp_f32 v172, v172
    v_mfma_f32_16x16x32_bf16 v[128:131], a[72:75], a[4:7], v[128:131]
    buffer_load_dwordx4 v252, s[24:27], s39 offen offset:1152 lds
    v_mfma_f32_16x16x32_bf16 v[136:139], a[72:75], a[20:23], v[136:139]
    v_exp_f32 v173, v173
    v_mfma_f32_16x16x32_bf16 v[144:147], a[72:75], a[36:39], v[144:147]
    ds_read_b64_tr_b16 a[100:101], v241 offset:2048
    v_cvt_pk_bf16_f32 v198, v172, v173
    v_mfma_f32_16x16x32_bf16 v[152:155], a[72:75], a[52:55], v[152:155]
    v_exp_f32 v174, v174
    v_mfma_f32_16x16x32_bf16 v[132:135], a[76:79], a[4:7], v[132:135]
    s_mov_b32 s39, 14336
    v_mfma_f32_16x16x32_bf16 v[140:143], a[76:79], a[20:23], v[140:143]
    buffer_load_dwordx4 v252, s[24:27], s39 offen offset:2176 lds
    v_mfma_f32_16x16x32_bf16 v[148:151], a[76:79], a[36:39], v[148:151]
    v_exp_f32 v175, v175
    v_mfma_f32_16x16x32_bf16 v[156:159], a[76:79], a[52:55], v[156:159]
    ds_read_b64_tr_b16 a[102:103], v241 offset:3072
    v_cvt_pk_bf16_f32 v199, v174, v175
    v_mfma_f32_16x16x32_bf16 v[128:131], a[80:83], a[8:11], v[128:131]
    s_mov_b32 s39, 21504
    v_exp_f32 v176, v176
    v_mfma_f32_16x16x32_bf16 v[136:139], a[80:83], a[24:27], v[136:139]
    buffer_load_dwordx4 v252, s[24:27], s39 offen offset:3200 lds
    v_mfma_f32_16x16x32_bf16 v[144:147], a[80:83], a[40:43], v[144:147]
    v_exp_f32 v177, v177
    v_mfma_f32_16x16x32_bf16 v[152:155], a[80:83], a[56:59], v[152:155]
    ds_read_b64_tr_b16 a[104:105], v242 offset:2048
    v_cvt_pk_bf16_f32 v200, v176, v177
    v_mfma_f32_16x16x32_bf16 v[132:135], a[84:87], a[8:11], v[132:135]
    v_exp_f32 v178, v178
    v_mfma_f32_16x16x32_bf16 v[140:143], a[84:87], a[24:27], v[140:143]
    ds_read_b64_tr_b16 a[106:107], v242 offset:3072
    ds_read_b64_tr_b16 a[108:109], v243 offset:2048
    v_mfma_f32_16x16x32_bf16 v[148:151], a[84:87], a[40:43], v[148:151]
    v_exp_f32 v179, v179
    v_mfma_f32_16x16x32_bf16 v[156:159], a[84:87], a[56:59], v[156:159]
    ds_read_b64_tr_b16 a[110:111], v243 offset:3072
    v_cvt_pk_bf16_f32 v201, v178, v179
    v_mfma_f32_16x16x32_bf16 v[128:131], a[88:91], a[12:15], v[128:131]
    v_exp_f32 v180, v180
    v_mfma_f32_16x16x32_bf16 v[136:139], a[88:91], a[28:31], v[136:139]
    ds_read_b64_tr_b16 a[112:113], v244 offset:2048
    ds_read_b64_tr_b16 a[114:115], v244 offset:3072
    v_mfma_f32_16x16x32_bf16 v[144:147], a[88:91], a[44:47], v[144:147]
    v_exp_f32 v181, v181
    v_mfma_f32_16x16x32_bf16 v[152:155], a[88:91], a[60:63], v[152:155]
    ds_read_b64_tr_b16 a[116:117], v245 offset:2048
    v_cvt_pk_bf16_f32 v202, v180, v181
    v_mfma_f32_16x16x32_bf16 v[132:135], a[92:95], a[12:15], v[132:135]
    v_exp_f32 v182, v182
    v_mfma_f32_16x16x32_bf16 v[140:143], a[92:95], a[28:31], v[140:143]
    ds_read_b64_tr_b16 a[118:119], v245 offset:3072
    ds_read_b64_tr_b16 a[120:121], v246 offset:2048
    v_mfma_f32_16x16x32_bf16 v[148:151], a[92:95], a[44:47], v[148:151]
    s_waitcnt lgkmcnt(5)
    v_exp_f32 v183, v183
    v_mfma_f32_16x16x32_bf16 v[156:159], a[92:95], a[60:63], v[156:159]
    ds_read_b64_tr_b16 a[122:123], v246 offset:3072
    v_cvt_pk_bf16_f32 v203, v182, v183
    v_mfma_f32_16x16x32_bf16 v[0:3], a[96:99], v[192:195], v[0:3]
    v_exp_f32 v184, v184
    v_mfma_f32_16x16x32_bf16 v[4:7], a[96:99], v[196:199], v[4:7]
    ds_read_b64_tr_b16 a[124:125], v247 offset:2048
    v_add_f32 v224, v224, v160
    v_mfma_f32_16x16x32_bf16 v[16:19], a[100:103], v[192:195], v[16:19]
    v_exp_f32 v185, v185
    v_mfma_f32_16x16x32_bf16 v[20:23], a[100:103], v[196:199], v[20:23]
    ds_read_b64_tr_b16 a[126:127], v247 offset:3072
    v_cvt_pk_bf16_f32 v204, v184, v185
    v_mfma_f32_16x16x32_bf16 v[32:35], a[104:107], v[192:195], v[32:35]
    v_exp_f32 v186, v186
    v_mfma_f32_16x16x32_bf16 v[36:39], a[104:107], v[196:199], v[36:39]
    ds_read_b128 a[64:67], v236 offset:6144
    v_add_f32 v225, v225, v168
    v_mfma_f32_16x16x32_bf16 v[48:51], a[108:111], v[192:195], v[48:51]
    s_waitcnt lgkmcnt(3)
    v_exp_f32 v187, v187
    v_mfma_f32_16x16x32_bf16 v[52:55], a[108:111], v[196:199], v[52:55]
    ds_read_b128 a[68:71], v236 offset:7168
    v_cvt_pk_bf16_f32 v205, v186, v187
    v_mfma_f32_16x16x32_bf16 v[64:67], a[112:115], v[192:195], v[64:67]
    v_exp_f32 v188, v188
    v_mfma_f32_16x16x32_bf16 v[68:71], a[112:115], v[196:199], v[68:71]
    ds_read_b128 a[72:75], v237 offset:6144
    v_add_f32 v224, v224, v161
    v_mfma_f32_16x16x32_bf16 v[80:83], a[116:119], v[192:195], v[80:83]
    v_exp_f32 v189, v189
    v_mfma_f32_16x16x32_bf16 v[84:87], a[116:119], v[196:199], v[84:87]
    ds_read_b128 a[76:79], v237 offset:7168
    v_cvt_pk_bf16_f32 v206, v188, v189
    v_mfma_f32_16x16x32_bf16 v[96:99], a[120:123], v[192:195], v[96:99]
    s_waitcnt lgkmcnt(4)
    v_exp_f32 v190, v190
    v_mfma_f32_16x16x32_bf16 v[100:103], a[120:123], v[196:199], v[100:103]
    ds_read_b128 a[80:83], v238 offset:6144
    v_add_f32 v225, v225, v169
    v_mfma_f32_16x16x32_bf16 v[112:115], a[124:127], v[192:195], v[112:115]
    v_exp_f32 v191, v191
    v_mfma_f32_16x16x32_bf16 v[116:119], a[124:127], v[196:199], v[116:119]
    ds_read_b128 a[84:87], v238 offset:7168
    v_cvt_pk_bf16_f32 v207, v190, v191
    v_mfma_f32_16x16x32_bf16 v[8:11], a[96:99], v[200:203], v[8:11]
    v_exp_f32 v128, v128
    v_mfma_f32_16x16x32_bf16 v[12:15], a[96:99], v[204:207], v[12:15]
    ds_read_b128 a[88:91], v239 offset:6144
    v_add_f32 v224, v224, v162
    v_mfma_f32_16x16x32_bf16 v[24:27], a[100:103], v[200:203], v[24:27]
    v_exp_f32 v129, v129
    v_mfma_f32_16x16x32_bf16 v[28:31], a[100:103], v[204:207], v[28:31]
    ds_read_b128 a[92:95], v239 offset:7168
    v_cvt_pk_bf16_f32 v192, v128, v129
    v_mfma_f32_16x16x32_bf16 v[228:231], a[128:131], v[200:203], v[228:231]
    v_exp_f32 v130, v130
    v_mfma_f32_16x16x32_bf16 v[40:43], a[104:107], v[200:203], v[40:43]
    v_add_f32 v225, v225, v170
    v_add_f32 v224, v224, v163
    v_mfma_f32_16x16x32_bf16 v[44:47], a[104:107], v[204:207], v[44:47]
    v_exp_f32 v131, v131
    v_mfma_f32_16x16x32_bf16 v[56:59], a[108:111], v[200:203], v[56:59]
    v_cvt_pk_bf16_f32 v193, v130, v131
    v_add_f32 v225, v225, v171
    v_mfma_f32_16x16x32_bf16 v[60:63], a[108:111], v[204:207], v[60:63]
    v_exp_f32 v132, v132
    v_mfma_f32_16x16x32_bf16 v[72:75], a[112:115], v[200:203], v[72:75]
    v_add_f32 v224, v224, v164
    v_add_f32 v225, v225, v172
    v_mfma_f32_16x16x32_bf16 v[76:79], a[112:115], v[204:207], v[76:79]
    v_exp_f32 v133, v133
    v_mfma_f32_16x16x32_bf16 v[232:235], a[128:131], v[204:207], v[232:235]
    v_cvt_pk_bf16_f32 v194, v132, v133
    v_add_f32 v224, v224, v165
    v_mfma_f32_16x16x32_bf16 v[88:91], a[116:119], v[200:203], v[88:91]
    v_exp_f32 v134, v134
    v_mfma_f32_16x16x32_bf16 v[92:95], a[116:119], v[204:207], v[92:95]
    v_add_f32 v225, v225, v173
    v_add_f32 v224, v224, v166
    v_mfma_f32_16x16x32_bf16 v[104:107], a[120:123], v[200:203], v[104:107]
    s_waitcnt lgkmcnt(0)
    v_exp_f32 v135, v135
    v_mfma_f32_16x16x32_bf16 v[108:111], a[120:123], v[204:207], v[108:111]
    v_cvt_pk_bf16_f32 v195, v134, v135
    v_add_f32 v225, v225, v174
    v_mfma_f32_16x16x32_bf16 v[120:123], a[124:127], v[200:203], v[120:123]
    v_exp_f32 v136, v136
    v_mfma_f32_16x16x32_bf16 v[124:127], a[124:127], v[204:207], v[124:127]
    v_add_f32 v224, v224, v167
    v_add_f32 v225, v225, v175
    v_mfma_f32_16x16x32_bf16 v[160:163], a[64:67], a[0:3], v[208:211]
    s_barrier
    v_exp_f32 v137, v137
    v_mfma_f32_16x16x32_bf16 v[168:171], a[64:67], a[16:19], v[212:215]
    ds_read_b64_tr_b16 a[96:97], v240 offset:20480
    v_cvt_pk_bf16_f32 v196, v136, v137
    v_mfma_f32_16x16x32_bf16 v[176:179], a[64:67], a[32:35], v[216:219]
    s_add_u32 m0, s36, 32768
    v_exp_f32 v138, v138
    v_mfma_f32_16x16x32_bf16 v[184:187], a[64:67], a[48:51], v[220:223]
    s_mov_b32 s39, 32768
    v_mfma_f32_16x16x32_bf16 v[164:167], a[68:71], a[0:3], v[208:211]
    buffer_load_dwordx4 v252, s[24:27], s39 offen offset:0 lds
    v_mfma_f32_16x16x32_bf16 v[172:175], a[68:71], a[16:19], v[212:215]
    v_exp_f32 v139, v139
    v_mfma_f32_16x16x32_bf16 v[180:183], a[68:71], a[32:35], v[216:219]
    ds_read_b64_tr_b16 a[98:99], v240 offset:21504
    v_cvt_pk_bf16_f32 v197, v138, v139
    v_mfma_f32_16x16x32_bf16 v[188:191], a[68:71], a[48:51], v[220:223]
    s_mov_b32 s39, 39936
    v_exp_f32 v140, v140
    v_mfma_f32_16x16x32_bf16 v[160:163], a[72:75], a[4:7], v[160:163]
    buffer_load_dwordx4 v252, s[24:27], s39 offen offset:1024 lds
    v_mfma_f32_16x16x32_bf16 v[168:171], a[72:75], a[20:23], v[168:171]
    v_exp_f32 v141, v141
    v_mfma_f32_16x16x32_bf16 v[176:179], a[72:75], a[36:39], v[176:179]
    ds_read_b64_tr_b16 a[100:101], v241 offset:20480
    v_cvt_pk_bf16_f32 v198, v140, v141
    v_mfma_f32_16x16x32_bf16 v[184:187], a[72:75], a[52:55], v[184:187]
    v_exp_f32 v142, v142
    v_mfma_f32_16x16x32_bf16 v[164:167], a[76:79], a[4:7], v[164:167]
    s_mov_b32 s39, 47104
    v_mfma_f32_16x16x32_bf16 v[172:175], a[76:79], a[20:23], v[172:175]
    buffer_load_dwordx4 v252, s[24:27], s39 offen offset:2048 lds
    v_mfma_f32_16x16x32_bf16 v[180:183], a[76:79], a[36:39], v[180:183]
    v_exp_f32 v143, v143
    v_mfma_f32_16x16x32_bf16 v[188:191], a[76:79], a[52:55], v[188:191]
    ds_read_b64_tr_b16 a[102:103], v241 offset:21504
    v_cvt_pk_bf16_f32 v199, v142, v143
    v_mfma_f32_16x16x32_bf16 v[160:163], a[80:83], a[8:11], v[160:163]
    s_mov_b32 s39, 54272
    v_exp_f32 v144, v144
    v_mfma_f32_16x16x32_bf16 v[168:171], a[80:83], a[24:27], v[168:171]
    buffer_load_dwordx4 v252, s[24:27], s39 offen offset:3072 lds
    v_mfma_f32_16x16x32_bf16 v[176:179], a[80:83], a[40:43], v[176:179]
    v_exp_f32 v145, v145
    v_mfma_f32_16x16x32_bf16 v[184:187], a[80:83], a[56:59], v[184:187]
    ds_read_b64_tr_b16 a[104:105], v242 offset:20480
    v_cvt_pk_bf16_f32 v200, v144, v145
    v_mfma_f32_16x16x32_bf16 v[164:167], a[84:87], a[8:11], v[164:167]
    v_exp_f32 v146, v146
    v_mfma_f32_16x16x32_bf16 v[172:175], a[84:87], a[24:27], v[172:175]
    ds_read_b64_tr_b16 a[106:107], v242 offset:21504
    ds_read_b64_tr_b16 a[108:109], v243 offset:20480
    v_mfma_f32_16x16x32_bf16 v[180:183], a[84:87], a[40:43], v[180:183]
    v_exp_f32 v147, v147
    v_mfma_f32_16x16x32_bf16 v[188:191], a[84:87], a[56:59], v[188:191]
    ds_read_b64_tr_b16 a[110:111], v243 offset:21504
    v_cvt_pk_bf16_f32 v201, v146, v147
    v_mfma_f32_16x16x32_bf16 v[160:163], a[88:91], a[12:15], v[160:163]
    v_exp_f32 v148, v148
    v_mfma_f32_16x16x32_bf16 v[168:171], a[88:91], a[28:31], v[168:171]
    ds_read_b64_tr_b16 a[112:113], v244 offset:20480
    ds_read_b64_tr_b16 a[114:115], v244 offset:21504
    v_mfma_f32_16x16x32_bf16 v[176:179], a[88:91], a[44:47], v[176:179]
    v_exp_f32 v149, v149
    v_mfma_f32_16x16x32_bf16 v[184:187], a[88:91], a[60:63], v[184:187]
    ds_read_b64_tr_b16 a[116:117], v245 offset:20480
    v_cvt_pk_bf16_f32 v202, v148, v149
    v_mfma_f32_16x16x32_bf16 v[164:167], a[92:95], a[12:15], v[164:167]
    v_exp_f32 v150, v150
    v_mfma_f32_16x16x32_bf16 v[172:175], a[92:95], a[28:31], v[172:175]
    ds_read_b64_tr_b16 a[118:119], v245 offset:21504
    ds_read_b64_tr_b16 a[120:121], v246 offset:20480
    v_mfma_f32_16x16x32_bf16 v[180:183], a[92:95], a[44:47], v[180:183]
    s_waitcnt lgkmcnt(5)
    v_exp_f32 v151, v151
    v_mfma_f32_16x16x32_bf16 v[188:191], a[92:95], a[60:63], v[188:191]
    ds_read_b64_tr_b16 a[122:123], v246 offset:21504
    v_cvt_pk_bf16_f32 v203, v150, v151
    v_mfma_f32_16x16x32_bf16 v[0:3], a[96:99], v[192:195], v[0:3]
    v_exp_f32 v152, v152
    v_mfma_f32_16x16x32_bf16 v[4:7], a[96:99], v[196:199], v[4:7]
    ds_read_b64_tr_b16 a[124:125], v247 offset:20480
    v_add_f32 v224, v224, v128
    v_mfma_f32_16x16x32_bf16 v[16:19], a[100:103], v[192:195], v[16:19]
    v_exp_f32 v153, v153
    v_mfma_f32_16x16x32_bf16 v[20:23], a[100:103], v[196:199], v[20:23]
    ds_read_b64_tr_b16 a[126:127], v247 offset:21504
    v_cvt_pk_bf16_f32 v204, v152, v153
    v_mfma_f32_16x16x32_bf16 v[32:35], a[104:107], v[192:195], v[32:35]
    v_exp_f32 v154, v154
    v_mfma_f32_16x16x32_bf16 v[36:39], a[104:107], v[196:199], v[36:39]
    v_add_f32 v225, v225, v136
    v_mfma_f32_16x16x32_bf16 v[48:51], a[108:111], v[192:195], v[48:51]
    s_waitcnt lgkmcnt(2)
    v_exp_f32 v155, v155
    v_mfma_f32_16x16x32_bf16 v[52:55], a[108:111], v[196:199], v[52:55]
    v_cvt_pk_bf16_f32 v205, v154, v155
    v_mfma_f32_16x16x32_bf16 v[64:67], a[112:115], v[192:195], v[64:67]
    v_exp_f32 v156, v156
    v_mfma_f32_16x16x32_bf16 v[68:71], a[112:115], v[196:199], v[68:71]
    v_add_f32 v224, v224, v129
    v_mfma_f32_16x16x32_bf16 v[80:83], a[116:119], v[192:195], v[80:83]
    v_exp_f32 v157, v157
    v_mfma_f32_16x16x32_bf16 v[84:87], a[116:119], v[196:199], v[84:87]
    v_cvt_pk_bf16_f32 v206, v156, v157
    v_mfma_f32_16x16x32_bf16 v[96:99], a[120:123], v[192:195], v[96:99]
    s_waitcnt lgkmcnt(0)
    v_exp_f32 v158, v158
    v_mfma_f32_16x16x32_bf16 v[100:103], a[120:123], v[196:199], v[100:103]
    v_add_f32 v225, v225, v137
    v_mfma_f32_16x16x32_bf16 v[112:115], a[124:127], v[192:195], v[112:115]
    v_exp_f32 v159, v159
    v_mfma_f32_16x16x32_bf16 v[116:119], a[124:127], v[196:199], v[116:119]
    v_cvt_pk_bf16_f32 v207, v158, v159
    v_mfma_f32_16x16x32_bf16 v[8:11], a[96:99], v[200:203], v[8:11]
    v_exp_f32 v160, v160
    v_mfma_f32_16x16x32_bf16 v[12:15], a[96:99], v[204:207], v[12:15]
    v_add_f32 v224, v224, v130
    v_mfma_f32_16x16x32_bf16 v[24:27], a[100:103], v[200:203], v[24:27]
    v_exp_f32 v161, v161
    v_mfma_f32_16x16x32_bf16 v[28:31], a[100:103], v[204:207], v[28:31]
    v_cvt_pk_bf16_f32 v192, v160, v161
    v_mfma_f32_16x16x32_bf16 v[228:231], a[128:131], v[200:203], v[228:231]
    v_exp_f32 v162, v162
    v_mfma_f32_16x16x32_bf16 v[40:43], a[104:107], v[200:203], v[40:43]
    v_add_f32 v225, v225, v138
    v_add_f32 v224, v224, v131
    v_mfma_f32_16x16x32_bf16 v[44:47], a[104:107], v[204:207], v[44:47]
    v_exp_f32 v163, v163
    v_mfma_f32_16x16x32_bf16 v[56:59], a[108:111], v[200:203], v[56:59]
    v_cvt_pk_bf16_f32 v193, v162, v163
    v_add_f32 v225, v225, v139
    v_mfma_f32_16x16x32_bf16 v[60:63], a[108:111], v[204:207], v[60:63]
    v_exp_f32 v164, v164
    v_mfma_f32_16x16x32_bf16 v[72:75], a[112:115], v[200:203], v[72:75]
    v_add_f32 v224, v224, v132
    v_add_f32 v225, v225, v140
    v_mfma_f32_16x16x32_bf16 v[76:79], a[112:115], v[204:207], v[76:79]
    v_exp_f32 v165, v165
    v_mfma_f32_16x16x32_bf16 v[232:235], a[128:131], v[204:207], v[232:235]
    v_cvt_pk_bf16_f32 v194, v164, v165
    v_add_f32 v224, v224, v133
    v_mfma_f32_16x16x32_bf16 v[88:91], a[116:119], v[200:203], v[88:91]
    v_exp_f32 v166, v166
    v_mfma_f32_16x16x32_bf16 v[92:95], a[116:119], v[204:207], v[92:95]
    v_add_f32 v225, v225, v141
    v_add_f32 v224, v224, v134
    v_mfma_f32_16x16x32_bf16 v[104:107], a[120:123], v[200:203], v[104:107]
    s_waitcnt lgkmcnt(0)
    v_exp_f32 v167, v167
    v_mfma_f32_16x16x32_bf16 v[108:111], a[120:123], v[204:207], v[108:111]
    v_cvt_pk_bf16_f32 v195, v166, v167
    v_add_f32 v225, v225, v142
    v_mfma_f32_16x16x32_bf16 v[120:123], a[124:127], v[200:203], v[120:123]
    v_exp_f32 v168, v168
    v_mfma_f32_16x16x32_bf16 v[124:127], a[124:127], v[204:207], v[124:127]
    v_add_f32 v224, v224, v135
    v_add_f32 v225, v225, v143
    v_exp_f32 v169, v169
    ds_read_b64_tr_b16 a[96:97], v240 offset:22528
    v_cvt_pk_bf16_f32 v196, v168, v169
    s_add_u32 m0, s36, 36736
    v_exp_f32 v170, v170
    s_mov_b32 s39, 32768
    buffer_load_dwordx4 v252, s[24:27], s39 offen offset:128 lds
    v_exp_f32 v171, v171
    ds_read_b64_tr_b16 a[98:99], v240 offset:23552
    v_cvt_pk_bf16_f32 v197, v170, v171
    s_mov_b32 s39, 39936
    v_exp_f32 v172, v172
    buffer_load_dwordx4 v252, s[24:27], s39 offen offset:1152 lds
    v_exp_f32 v173, v173
    ds_read_b64_tr_b16 a[100:101], v241 offset:22528
    v_cvt_pk_bf16_f32 v198, v172, v173
    v_exp_f32 v174, v174
    s_mov_b32 s39, 47104
    buffer_load_dwordx4 v252, s[24:27], s39 offen offset:2176 lds
    v_exp_f32 v175, v175
    ds_read_b64_tr_b16 a[102:103], v241 offset:23552
    v_cvt_pk_bf16_f32 v199, v174, v175
    s_mov_b32 s39, 54272
    v_exp_f32 v176, v176
    buffer_load_dwordx4 v252, s[24:27], s39 offen offset:3200 lds
    v_exp_f32 v177, v177
    ds_read_b64_tr_b16 a[104:105], v242 offset:22528
    v_cvt_pk_bf16_f32 v200, v176, v177
    v_exp_f32 v178, v178
    ds_read_b64_tr_b16 a[106:107], v242 offset:23552
    ds_read_b64_tr_b16 a[108:109], v243 offset:22528
    v_exp_f32 v179, v179
    ds_read_b64_tr_b16 a[110:111], v243 offset:23552
    v_cvt_pk_bf16_f32 v201, v178, v179
    v_exp_f32 v180, v180
    ds_read_b64_tr_b16 a[112:113], v244 offset:22528
    ds_read_b64_tr_b16 a[114:115], v244 offset:23552
    v_exp_f32 v181, v181
    ds_read_b64_tr_b16 a[116:117], v245 offset:22528
    v_cvt_pk_bf16_f32 v202, v180, v181
    v_exp_f32 v182, v182
    ds_read_b64_tr_b16 a[118:119], v245 offset:23552
    ds_read_b64_tr_b16 a[120:121], v246 offset:22528
    s_waitcnt lgkmcnt(5)
    v_exp_f32 v183, v183
    ds_read_b64_tr_b16 a[122:123], v246 offset:23552
    v_cvt_pk_bf16_f32 v203, v182, v183
    v_mfma_f32_16x16x32_bf16 v[0:3], a[96:99], v[192:195], v[0:3]
    v_exp_f32 v184, v184
    v_mfma_f32_16x16x32_bf16 v[4:7], a[96:99], v[196:199], v[4:7]
    ds_read_b64_tr_b16 a[124:125], v247 offset:22528
    v_add_f32 v224, v224, v160
    v_mfma_f32_16x16x32_bf16 v[16:19], a[100:103], v[192:195], v[16:19]
    v_exp_f32 v185, v185
    v_mfma_f32_16x16x32_bf16 v[20:23], a[100:103], v[196:199], v[20:23]
    ds_read_b64_tr_b16 a[126:127], v247 offset:23552
    v_cvt_pk_bf16_f32 v204, v184, v185
    v_mfma_f32_16x16x32_bf16 v[32:35], a[104:107], v[192:195], v[32:35]
    v_exp_f32 v186, v186
    v_mfma_f32_16x16x32_bf16 v[36:39], a[104:107], v[196:199], v[36:39]
    v_add_f32 v225, v225, v168
    v_mfma_f32_16x16x32_bf16 v[48:51], a[108:111], v[192:195], v[48:51]
    s_waitcnt lgkmcnt(2)
    v_exp_f32 v187, v187
    v_mfma_f32_16x16x32_bf16 v[52:55], a[108:111], v[196:199], v[52:55]
    v_cvt_pk_bf16_f32 v205, v186, v187
    v_mfma_f32_16x16x32_bf16 v[64:67], a[112:115], v[192:195], v[64:67]
    v_exp_f32 v188, v188
    v_mfma_f32_16x16x32_bf16 v[68:71], a[112:115], v[196:199], v[68:71]
    v_add_f32 v224, v224, v161
    v_mfma_f32_16x16x32_bf16 v[80:83], a[116:119], v[192:195], v[80:83]
    v_exp_f32 v189, v189
    v_mfma_f32_16x16x32_bf16 v[84:87], a[116:119], v[196:199], v[84:87]
    v_cvt_pk_bf16_f32 v206, v188, v189
    v_mfma_f32_16x16x32_bf16 v[96:99], a[120:123], v[192:195], v[96:99]
    s_waitcnt lgkmcnt(0)
    v_exp_f32 v190, v190
    v_mfma_f32_16x16x32_bf16 v[100:103], a[120:123], v[196:199], v[100:103]
    v_add_f32 v225, v225, v169
    v_mfma_f32_16x16x32_bf16 v[112:115], a[124:127], v[192:195], v[112:115]
    v_exp_f32 v191, v191
    v_mfma_f32_16x16x32_bf16 v[116:119], a[124:127], v[196:199], v[116:119]
    v_cvt_pk_bf16_f32 v207, v190, v191
    v_mfma_f32_16x16x32_bf16 v[8:11], a[96:99], v[200:203], v[8:11]
    s_nop 0
    v_mfma_f32_16x16x32_bf16 v[12:15], a[96:99], v[204:207], v[12:15]
    v_add_f32 v224, v224, v162
    v_mfma_f32_16x16x32_bf16 v[24:27], a[100:103], v[200:203], v[24:27]
    v_mfma_f32_16x16x32_bf16 v[28:31], a[100:103], v[204:207], v[28:31]
    v_mfma_f32_16x16x32_bf16 v[228:231], a[128:131], v[200:203], v[228:231]
    v_mfma_f32_16x16x32_bf16 v[40:43], a[104:107], v[200:203], v[40:43]
    v_add_f32 v225, v225, v170
    v_add_f32 v224, v224, v163
    v_mfma_f32_16x16x32_bf16 v[44:47], a[104:107], v[204:207], v[44:47]
    v_mfma_f32_16x16x32_bf16 v[56:59], a[108:111], v[200:203], v[56:59]
    v_add_f32 v225, v225, v171
    v_mfma_f32_16x16x32_bf16 v[60:63], a[108:111], v[204:207], v[60:63]
    v_mfma_f32_16x16x32_bf16 v[72:75], a[112:115], v[200:203], v[72:75]
    v_add_f32 v224, v224, v164
    v_add_f32 v225, v225, v172
    v_mfma_f32_16x16x32_bf16 v[76:79], a[112:115], v[204:207], v[76:79]
    v_mfma_f32_16x16x32_bf16 v[232:235], a[128:131], v[204:207], v[232:235]
    v_add_f32 v224, v224, v165
    v_mfma_f32_16x16x32_bf16 v[88:91], a[116:119], v[200:203], v[88:91]
    v_mfma_f32_16x16x32_bf16 v[92:95], a[116:119], v[204:207], v[92:95]
    v_add_f32 v225, v225, v173
    v_add_f32 v224, v224, v166
    v_mfma_f32_16x16x32_bf16 v[104:107], a[120:123], v[200:203], v[104:107]
    s_waitcnt lgkmcnt(0)
    v_mfma_f32_16x16x32_bf16 v[108:111], a[120:123], v[204:207], v[108:111]
    v_add_f32 v225, v225, v174
    v_mfma_f32_16x16x32_bf16 v[120:123], a[124:127], v[200:203], v[120:123]
    v_mfma_f32_16x16x32_bf16 v[124:127], a[124:127], v[204:207], v[124:127]
    v_add_f32 v224, v224, v167
    v_add_f32 v225, v225, v175
    v_mov_b32 v128, v224
    v_mov_b32 v129, v225
    v_mov_b32 v130, v228
    v_mov_b32 v131, v232
    v_permlane32_swap_b32 v224, v128
    v_permlane32_swap_b32 v225, v129
    v_permlane32_swap_b32 v228, v130
    v_permlane32_swap_b32 v232, v131
    v_add_f32 v224, v224, v128
    v_add_f32 v225, v225, v129
    v_add_f32 v228, v228, v130
    v_add_f32 v232, v232, v131
    v_mov_b32 v128, v224
    v_mov_b32 v129, v225
    v_mov_b32 v130, v228
    v_mov_b32 v131, v232
    v_permlane16_swap_b32 v224, v128
    v_permlane16_swap_b32 v225, v129
    v_permlane16_swap_b32 v228, v130
    v_permlane16_swap_b32 v232, v131
    v_add_f32 v224, v224, v128
    v_add_f32 v225, v225, v129
    v_add_f32 v228, v228, v130
    v_add_f32 v232, v232, v131
    v_add_f32 v129, v224, v225
    v_add_f32 v130, v228, v232
    v_add_f32 v129, v129, v130
    v_cmp_ngt_f32 vcc, 0x5f800000, v129
    v_rcp_f32 v208, v224
    v_rcp_f32 v210, v225
    v_rcp_f32 v212, v228
    v_rcp_f32 v214, v232
    s_cmp_lg_u64 vcc, 0
    s_cselect_b32 s44, 1, 0
    s_lshl_b32 s45, s3, 2
    s_add_u32 s45, s45, 16384
    v_mov_b32 v130, s44
    v_mul_u32_u24 v131, 2560, v250
    v_add_u32 v131, s45, v131
    s_mov_b64 exec, 15
    ds_write_b32 v131, v130
    s_mov_b64 exec, -1
    v_add_u32 v254, s36, v250
    v_mov_b32 v209, v208
    v_mov_b32 v211, v210
    v_mov_b32 v213, v212
    v_mov_b32 v215, v214
    v_pk_mul_f32 v[0:1], v[0:1], v[208:209]
    v_pk_mul_f32 v[2:3], v[2:3], v[208:209]
    v_pk_mul_f32 v[16:17], v[16:17], v[208:209]
    v_pk_mul_f32 v[18:19], v[18:19], v[208:209]
    v_cvt_pk_bf16_f32 v160, v0, v1
    v_cvt_pk_bf16_f32 v161, v2, v3
    v_cvt_pk_bf16_f32 v162, v16, v17
    v_cvt_pk_bf16_f32 v163, v18, v19
    ds_write_b128 v254, v[160:163] offset:0
    v_pk_mul_f32 v[4:5], v[4:5], v[210:211]
    v_pk_mul_f32 v[6:7], v[6:7], v[210:211]
    v_pk_mul_f32 v[20:21], v[20:21], v[210:211]
    v_pk_mul_f32 v[22:23], v[22:23], v[210:211]
    v_cvt_pk_bf16_f32 v164, v4, v5
    v_cvt_pk_bf16_f32 v165, v6, v7
    v_cvt_pk_bf16_f32 v166, v20, v21
    v_cvt_pk_bf16_f32 v167, v22, v23
    ds_write_b128 v254, v[164:167] offset:1024
    v_pk_mul_f32 v[8:9], v[8:9], v[212:213]
    v_pk_mul_f32 v[10:11], v[10:11], v[212:213]
    v_pk_mul_f32 v[24:25], v[24:25], v[212:213]
    v_pk_mul_f32 v[26:27], v[26:27], v[212:213]
    v_cvt_pk_bf16_f32 v168, v8, v9
    v_cvt_pk_bf16_f32 v169, v10, v11
    v_cvt_pk_bf16_f32 v170, v24, v25
    v_cvt_pk_bf16_f32 v171, v26, v27
    ds_write_b128 v254, v[168:171] offset:2048
    v_pk_mul_f32 v[12:13], v[12:13], v[214:215]
    v_pk_mul_f32 v[14:15], v[14:15], v[214:215]
    v_pk_mul_f32 v[28:29], v[28:29], v[214:215]
    v_pk_mul_f32 v[30:31], v[30:31], v[214:215]
    v_cvt_pk_bf16_f32 v172, v12, v13
    v_cvt_pk_bf16_f32 v173, v14, v15
    v_cvt_pk_bf16_f32 v174, v28, v29
    v_cvt_pk_bf16_f32 v175, v30, v31
    ds_write_b128 v254, v[172:175] offset:3072
    v_pk_mul_f32 v[32:33], v[32:33], v[208:209]
    v_pk_mul_f32 v[34:35], v[34:35], v[208:209]
    v_pk_mul_f32 v[48:49], v[48:49], v[208:209]
    v_pk_mul_f32 v[50:51], v[50:51], v[208:209]
    v_cvt_pk_bf16_f32 v176, v32, v33
    v_cvt_pk_bf16_f32 v177, v34, v35
    v_cvt_pk_bf16_f32 v178, v48, v49
    v_cvt_pk_bf16_f32 v179, v50, v51
    ds_write_b128 v254, v[176:179] offset:4096
    v_pk_mul_f32 v[36:37], v[36:37], v[210:211]
    v_pk_mul_f32 v[38:39], v[38:39], v[210:211]
    v_pk_mul_f32 v[52:53], v[52:53], v[210:211]
    v_pk_mul_f32 v[54:55], v[54:55], v[210:211]
    v_cvt_pk_bf16_f32 v180, v36, v37
    v_cvt_pk_bf16_f32 v181, v38, v39
    v_cvt_pk_bf16_f32 v182, v52, v53
    v_cvt_pk_bf16_f32 v183, v54, v55
    ds_write_b128 v254, v[180:183] offset:5120
    v_pk_mul_f32 v[40:41], v[40:41], v[212:213]
    v_pk_mul_f32 v[42:43], v[42:43], v[212:213]
    v_pk_mul_f32 v[56:57], v[56:57], v[212:213]
    v_pk_mul_f32 v[58:59], v[58:59], v[212:213]
    v_cvt_pk_bf16_f32 v184, v40, v41
    v_cvt_pk_bf16_f32 v185, v42, v43
    v_cvt_pk_bf16_f32 v186, v56, v57
    v_cvt_pk_bf16_f32 v187, v58, v59
    ds_write_b128 v254, v[184:187] offset:6144
    v_pk_mul_f32 v[44:45], v[44:45], v[214:215]
    v_pk_mul_f32 v[46:47], v[46:47], v[214:215]
    v_pk_mul_f32 v[60:61], v[60:61], v[214:215]
    v_pk_mul_f32 v[62:63], v[62:63], v[214:215]
    v_cvt_pk_bf16_f32 v188, v44, v45
    v_cvt_pk_bf16_f32 v189, v46, v47
    v_cvt_pk_bf16_f32 v190, v60, v61
    v_cvt_pk_bf16_f32 v191, v62, v63
    ds_write_b128 v254, v[188:191] offset:7168
    v_pk_mul_f32 v[64:65], v[64:65], v[208:209]
    v_pk_mul_f32 v[66:67], v[66:67], v[208:209]
    v_pk_mul_f32 v[80:81], v[80:81], v[208:209]
    v_pk_mul_f32 v[82:83], v[82:83], v[208:209]
    v_cvt_pk_bf16_f32 v160, v64, v65
    v_cvt_pk_bf16_f32 v161, v66, v67
    v_cvt_pk_bf16_f32 v162, v80, v81
    v_cvt_pk_bf16_f32 v163, v82, v83
    ds_write_b128 v254, v[160:163] offset:8192
    v_pk_mul_f32 v[68:69], v[68:69], v[210:211]
    v_pk_mul_f32 v[70:71], v[70:71], v[210:211]
    v_pk_mul_f32 v[84:85], v[84:85], v[210:211]
    v_pk_mul_f32 v[86:87], v[86:87], v[210:211]
    v_cvt_pk_bf16_f32 v164, v68, v69
    v_cvt_pk_bf16_f32 v165, v70, v71
    v_cvt_pk_bf16_f32 v166, v84, v85
    v_cvt_pk_bf16_f32 v167, v86, v87
    ds_write_b128 v254, v[164:167] offset:9216
    v_pk_mul_f32 v[72:73], v[72:73], v[212:213]
    v_pk_mul_f32 v[74:75], v[74:75], v[212:213]
    v_pk_mul_f32 v[88:89], v[88:89], v[212:213]
    v_pk_mul_f32 v[90:91], v[90:91], v[212:213]
    v_cvt_pk_bf16_f32 v168, v72, v73
    v_cvt_pk_bf16_f32 v169, v74, v75
    v_cvt_pk_bf16_f32 v170, v88, v89
    v_cvt_pk_bf16_f32 v171, v90, v91
    ds_write_b128 v254, v[168:171] offset:10240
    v_pk_mul_f32 v[76:77], v[76:77], v[214:215]
    v_pk_mul_f32 v[78:79], v[78:79], v[214:215]
    v_pk_mul_f32 v[92:93], v[92:93], v[214:215]
    v_pk_mul_f32 v[94:95], v[94:95], v[214:215]
    v_cvt_pk_bf16_f32 v172, v76, v77
    v_cvt_pk_bf16_f32 v173, v78, v79
    v_cvt_pk_bf16_f32 v174, v92, v93
    v_cvt_pk_bf16_f32 v175, v94, v95
    ds_write_b128 v254, v[172:175] offset:11264
    v_pk_mul_f32 v[96:97], v[96:97], v[208:209]
    v_pk_mul_f32 v[98:99], v[98:99], v[208:209]
    v_pk_mul_f32 v[112:113], v[112:113], v[208:209]
    v_pk_mul_f32 v[114:115], v[114:115], v[208:209]
    v_cvt_pk_bf16_f32 v176, v96, v97
    v_cvt_pk_bf16_f32 v177, v98, v99
    v_cvt_pk_bf16_f32 v178, v112, v113
    v_cvt_pk_bf16_f32 v179, v114, v115
    ds_write_b128 v254, v[176:179] offset:12288
    v_pk_mul_f32 v[100:101], v[100:101], v[210:211]
    v_pk_mul_f32 v[102:103], v[102:103], v[210:211]
    v_pk_mul_f32 v[116:117], v[116:117], v[210:211]
    v_pk_mul_f32 v[118:119], v[118:119], v[210:211]
    v_cvt_pk_bf16_f32 v180, v100, v101
    v_cvt_pk_bf16_f32 v181, v102, v103
    v_cvt_pk_bf16_f32 v182, v116, v117
    v_cvt_pk_bf16_f32 v183, v118, v119
    ds_write_b128 v254, v[180:183] offset:13312
    v_pk_mul_f32 v[104:105], v[104:105], v[212:213]
    v_pk_mul_f32 v[106:107], v[106:107], v[212:213]
    v_pk_mul_f32 v[120:121], v[120:121], v[212:213]
    v_pk_mul_f32 v[122:123], v[122:123], v[212:213]
    v_cvt_pk_bf16_f32 v184, v104, v105
    v_cvt_pk_bf16_f32 v185, v106, v107
    v_cvt_pk_bf16_f32 v186, v120, v121
    v_cvt_pk_bf16_f32 v187, v122, v123
    ds_write_b128 v254, v[184:187] offset:14336
    v_pk_mul_f32 v[108:109], v[108:109], v[214:215]
    v_pk_mul_f32 v[110:111], v[110:111], v[214:215]
    v_pk_mul_f32 v[124:125], v[124:125], v[214:215]
    v_pk_mul_f32 v[126:127], v[126:127], v[214:215]
    v_cvt_pk_bf16_f32 v188, v108, v109
    v_cvt_pk_bf16_f32 v189, v110, v111
    v_cvt_pk_bf16_f32 v190, v124, v125
    v_cvt_pk_bf16_f32 v191, v126, v127
    ds_write_b128 v254, v[188:191] offset:15360
    v_mov_b32 v132, s36
    s_waitcnt lgkmcnt(0)
    s_barrier
    ds_read_b128 v[128:131], v132 offset:16384
    s_waitcnt lgkmcnt(0)
    v_or3_b32 v128, v128, v129, v130
    v_or_b32 v128, v128, v131
    s_nop 0
    v_readfirstlane_b32 s44, v128
    s_andn2_b32 s44, s44, s41
    s_cmp_lg_u32 s44, 0
    s_cbranch_scc1 L_kf_fb_5
    s_add_u32 m0, s36, 16384
    s_mov_b32 s39, 65536
    buffer_load_dwordx4 v252, s[24:27], s39 offen offset:0 lds
    s_mov_b32 s39, 72704
    buffer_load_dwordx4 v252, s[24:27], s39 offen offset:1024 lds
    s_mov_b32 s39, 79872
    buffer_load_dwordx4 v252, s[24:27], s39 offen offset:2048 lds
    s_mov_b32 s39, 87040
    buffer_load_dwordx4 v252, s[24:27], s39 offen offset:3072 lds
    s_add_u32 m0, s36, 20352
    s_mov_b32 s39, 65536
    buffer_load_dwordx4 v252, s[24:27], s39 offen offset:128 lds
    s_mov_b32 s39, 72704
    buffer_load_dwordx4 v252, s[24:27], s39 offen offset:1152 lds
    s_mov_b32 s39, 79872
    buffer_load_dwordx4 v252, s[24:27], s39 offen offset:2176 lds
    s_mov_b32 s39, 87040
    buffer_load_dwordx4 v252, s[24:27], s39 offen offset:3200 lds
    v_xor_b32 v244, 0, v253
    v_xor_b32 v245, 32, v253
    v_xor_b32 v246, 64, v253
    v_xor_b32 v247, 96, v253
    ds_read_b128 a[164:167], v250 offset:0
    ds_read_b128 a[168:171], v250 offset:1024
    ds_read_b128 a[172:175], v250 offset:2048
    ds_read_b128 a[176:179], v250 offset:3072
    s_lshl_b32 s44, s74, 19
    s_lshl_b32 s45, s3, 8
    s_add_u32 s44, s44, s45
    v_subrev_u32 v248, s44, v252
    v_lshrrev_b32 v249, 10, v248
    v_mul_u32_u24 v249, 2560, v249
    v_add_u32 v249, v249, v248
    s_lshl_b32 s54, s42, 2
    s_lshr_b32 s44, s43, 3
    s_add_u32 s54, s54, s44
    s_and_b32 s55, s43, 7
    s_lshl_b32 s78, s3, 17
    s_lshl_b32 s44, s55, 7
    s_add_u32 s78, s78, s44
    s_lshl_b32 s44, s3, 7
    s_min_u32 s44, s44, 320
    s_mul_i32 s79, s55, 448
    s_add_u32 s79, s79, s44
    s_lshl_b32 s44, s54, 2
    s_add_u32 s56, s44, s3
    s_lshl_b32 s56, s56, 14
    s_lshr_b32 s45, s55, 1
    s_add_u32 s44, s44, s45
    s_lshl_b32 s44, s44, 14
    s_and_b32 s45, s55, 1
    s_lshl_b32 s45, s45, 7
    s_add_u32 s44, s44, s45
    s_lshl_b32 s45, s3, 12
    s_add_u32 s57, s44, s45
    s_mov_b32 s16, s88
    s_mov_b32 s17, s89
    s_mov_b32 s18, 0x80000
    s_mov_b32 s19, 0x20000
    s_mov_b32 s20, s92
    s_mov_b32 s21, s93
    s_mov_b32 s22, 0x1c0000
    s_mov_b32 s23, 0x20000
    s_mov_b32 s28, s12
    s_mov_b32 s29, s13
    s_mov_b32 s30, 0x2e00000
    s_mov_b32 s31, 0x20000
    s_waitcnt vmcnt(16)
    ds_read_b64_tr_b16 a[132:133], v244 offset:24576
    ds_read_b64_tr_b16 a[134:135], v244 offset:26624
    ds_read_b64_tr_b16 a[136:137], v245 offset:24576
    ds_read_b64_tr_b16 a[138:139], v245 offset:26624
    ds_read_b64_tr_b16 a[140:141], v246 offset:24576
    ds_read_b64_tr_b16 a[142:143], v246 offset:26624
    ds_read_b64_tr_b16 a[144:145], v247 offset:24576
    ds_read_b64_tr_b16 a[146:147], v247 offset:26624
    ds_read_b64_tr_b16 a[148:149], v244 offset:28672
    ds_read_b64_tr_b16 a[150:151], v244 offset:30720
    ds_read_b64_tr_b16 a[152:153], v245 offset:28672
    ds_read_b64_tr_b16 a[154:155], v245 offset:30720
    ds_read_b64_tr_b16 a[156:157], v246 offset:28672
    ds_read_b64_tr_b16 a[158:159], v246 offset:30720
    ds_read_b64_tr_b16 a[160:161], v247 offset:28672
    ds_read_b64_tr_b16 a[162:163], v247 offset:30720
    s_waitcnt lgkmcnt(8)
    v_mfma_f32_16x16x32_bf16 v[0:3], a[132:135], a[164:167], 0
    ds_read_b128 a[180:183], v250 offset:4096
    v_mfma_f32_16x16x32_bf16 v[4:7], a[132:135], a[168:171], 0
    s_waitcnt vmcnt(12)
    s_add_u32 m0, s36, 24576
    s_mov_b32 s39, 98304
    v_mfma_f32_16x16x32_bf16 v[8:11], a[132:135], a[172:175], 0
    buffer_load_dwordx4 v252, s[24:27], s39 offen offset:0 lds
    v_mfma_f32_16x16x32_bf16 v[12:15], a[132:135], a[176:179], 0
    ds_read_b64_tr_b16 a[132:133], v244 offset:32768
    ds_read_b64_tr_b16 a[134:135], v244 offset:34816
    v_mfma_f32_16x16x32_bf16 v[16:19], a[136:139], a[164:167], 0
    ds_read_b128 a[184:187], v250 offset:5120
    v_mfma_f32_16x16x32_bf16 v[20:23], a[136:139], a[168:171], 0
    s_mov_b32 s39, 105472
    v_mfma_f32_16x16x32_bf16 v[24:27], a[136:139], a[172:175], 0
    buffer_load_dwordx4 v252, s[24:27], s39 offen offset:1024 lds
    v_mfma_f32_16x16x32_bf16 v[28:31], a[136:139], a[176:179], 0
    ds_read_b64_tr_b16 a[136:137], v245 offset:32768
    ds_read_b64_tr_b16 a[138:139], v245 offset:34816
    v_mfma_f32_16x16x32_bf16 v[32:35], a[140:143], a[164:167], 0
    ds_read_b128 a[188:191], v250 offset:6144
    v_mfma_f32_16x16x32_bf16 v[36:39], a[140:143], a[168:171], 0
    s_mov_b32 s39, 112640
    v_mfma_f32_16x16x32_bf16 v[40:43], a[140:143], a[172:175], 0
    buffer_load_dwordx4 v252, s[24:27], s39 offen offset:2048 lds
    v_mfma_f32_16x16x32_bf16 v[44:47], a[140:143], a[176:179], 0
    ds_read_b64_tr_b16 a[140:141], v246 offset:32768
    ds_read_b64_tr_b16 a[142:143], v246 offset:34816
    v_mfma_f32_16x16x32_bf16 v[48:51], a[144:147], a[164:167], 0
    ds_read_b128 a[192:195], v250 offset:7168
    v_mfma_f32_16x16x32_bf16 v[52:55], a[144:147], a[168:171], 0
    s_waitcnt lgkmcnt(10)
    s_mov_b32 s39, 119808
    v_mfma_f32_16x16x32_bf16 v[56:59], a[144:147], a[172:175], 0
    buffer_load_dwordx4 v252, s[24:27], s39 offen offset:3072 lds
    v_mfma_f32_16x16x32_bf16 v[60:63], a[144:147], a[176:179], 0
    ds_read_b64_tr_b16 a[144:145], v247 offset:32768
    ds_read_b64_tr_b16 a[146:147], v247 offset:34816
    v_mfma_f32_16x16x32_bf16 v[64:67], a[148:151], a[164:167], 0
    v_mfma_f32_16x16x32_bf16 v[68:71], a[148:151], a[168:171], 0
    s_waitcnt vmcnt(12)
    s_add_u32 m0, s36, 28544
    s_mov_b32 s39, 98304
    v_mfma_f32_16x16x32_bf16 v[72:75], a[148:151], a[172:175], 0
    buffer_load_dwordx4 v252, s[24:27], s39 offen offset:128 lds
    v_mfma_f32_16x16x32_bf16 v[76:79], a[148:151], a[176:179], 0
    ds_read_b64_tr_b16 a[148:149], v244 offset:36864
    ds_read_b64_tr_b16 a[150:151], v244 offset:38912
    v_mfma_f32_16x16x32_bf16 v[80:83], a[152:155], a[164:167], 0
    v_mfma_f32_16x16x32_bf16 v[84:87], a[152:155], a[168:171], 0
    s_mov_b32 s39, 105472
    v_mfma_f32_16x16x32_bf16 v[88:91], a[152:155], a[172:175], 0
    buffer_load_dwordx4 v252, s[24:27], s39 offen offset:1152 lds
    v_mfma_f32_16x16x32_bf16 v[92:95], a[152:155], a[176:179], 0
    ds_read_b64_tr_b16 a[152:153], v245 offset:36864
    ds_read_b64_tr_b16 a[154:155], v245 offset:38912
    v_mfma_f32_16x16x32_bf16 v[96:99], a[156:159], a[164:167], 0
    v_mfma_f32_16x16x32_bf16 v[100:103], a[156:159], a[168:171], 0
    s_mov_b32 s39, 112640
    v_mfma_f32_16x16x32_bf16 v[104:107], a[156:159], a[172:175], 0
    buffer_load_dwordx4 v252, s[24:27], s39 offen offset:2176 lds
    v_mfma_f32_16x16x32_bf16 v[108:111], a[156:159], a[176:179], 0
    ds_read_b64_tr_b16 a[156:157], v246 offset:36864
    ds_read_b64_tr_b16 a[158:159], v246 offset:38912
    v_mfma_f32_16x16x32_bf16 v[112:115], a[160:163], a[164:167], 0
    v_mfma_f32_16x16x32_bf16 v[116:119], a[160:163], a[168:171], 0
    s_waitcnt lgkmcnt(6)
    s_mov_b32 s39, 119808
    v_mfma_f32_16x16x32_bf16 v[120:123], a[160:163], a[172:175], 0
    buffer_load_dwordx4 v252, s[24:27], s39 offen offset:3200 lds
    v_mfma_f32_16x16x32_bf16 v[124:127], a[160:163], a[176:179], 0
    ds_read_b64_tr_b16 a[160:161], v247 offset:36864
    ds_read_b64_tr_b16 a[162:163], v247 offset:38912
    v_mfma_f32_16x16x32_bf16 v[0:3], a[132:135], a[180:183], v[0:3]
    ds_read_b128 a[164:167], v250 offset:8192
    v_mfma_f32_16x16x32_bf16 v[4:7], a[132:135], a[184:187], v[4:7]
    s_waitcnt vmcnt(12)
    s_add_u32 m0, s36, 32768
    s_mov_b32 s39, 131072
    v_mfma_f32_16x16x32_bf16 v[8:11], a[132:135], a[188:191], v[8:11]
    buffer_load_dwordx4 v252, s[24:27], s39 offen offset:0 lds
    v_mfma_f32_16x16x32_bf16 v[12:15], a[132:135], a[192:195], v[12:15]
    ds_read_b64_tr_b16 a[132:133], v244 offset:16384
    ds_read_b64_tr_b16 a[134:135], v244 offset:18432
    v_mfma_f32_16x16x32_bf16 v[16:19], a[136:139], a[180:183], v[16:19]
    ds_read_b128 a[168:171], v250 offset:9216
    v_mfma_f32_16x16x32_bf16 v[20:23], a[136:139], a[184:187], v[20:23]
    s_mov_b32 s39, 138240
    v_mfma_f32_16x16x32_bf16 v[24:27], a[136:139], a[188:191], v[24:27]
    buffer_load_dwordx4 v252, s[24:27], s39 offen offset:1024 lds
    v_mfma_f32_16x16x32_bf16 v[28:31], a[136:139], a[192:195], v[28:31]
    ds_read_b64_tr_b16 a[136:137], v245 offset:16384
    ds_read_b64_tr_b16 a[138:139], v245 offset:18432
    v_mfma_f32_16x16x32_bf16 v[32:35], a[140:143], a[180:183], v[32:35]
    ds_read_b128 a[172:175], v250 offset:10240
    v_mfma_f32_16x16x32_bf16 v[36:39], a[140:143], a[184:187], v[36:39]
    s_mov_b32 s39, 145408
    v_mfma_f32_16x16x32_bf16 v[40:43], a[140:143], a[188:191], v[40:43]
    buffer_load_dwordx4 v252, s[24:27], s39 offen offset:2048 lds
    v_mfma_f32_16x16x32_bf16 v[44:47], a[140:143], a[192:195], v[44:47]
    ds_read_b64_tr_b16 a[140:141], v246 offset:16384
    ds_read_b64_tr_b16 a[142:143], v246 offset:18432
    v_mfma_f32_16x16x32_bf16 v[48:51], a[144:147], a[180:183], v[48:51]
    ds_read_b128 a[176:179], v250 offset:11264
    v_mfma_f32_16x16x32_bf16 v[52:55], a[144:147], a[184:187], v[52:55]
    s_waitcnt lgkmcnt(10)
    s_mov_b32 s39, 152576
    v_mfma_f32_16x16x32_bf16 v[56:59], a[144:147], a[188:191], v[56:59]
    buffer_load_dwordx4 v252, s[24:27], s39 offen offset:3072 lds
    v_mfma_f32_16x16x32_bf16 v[60:63], a[144:147], a[192:195], v[60:63]
    ds_read_b64_tr_b16 a[144:145], v247 offset:16384
    ds_read_b64_tr_b16 a[146:147], v247 offset:18432
    v_mfma_f32_16x16x32_bf16 v[64:67], a[148:151], a[180:183], v[64:67]
    v_mfma_f32_16x16x32_bf16 v[68:71], a[148:151], a[184:187], v[68:71]
    s_waitcnt vmcnt(12)
    s_add_u32 m0, s36, 36736
    s_mov_b32 s39, 131072
    v_mfma_f32_16x16x32_bf16 v[72:75], a[148:151], a[188:191], v[72:75]
    buffer_load_dwordx4 v252, s[24:27], s39 offen offset:128 lds
    v_mfma_f32_16x16x32_bf16 v[76:79], a[148:151], a[192:195], v[76:79]
    ds_read_b64_tr_b16 a[148:149], v244 offset:20480
    ds_read_b64_tr_b16 a[150:151], v244 offset:22528
    v_mfma_f32_16x16x32_bf16 v[80:83], a[152:155], a[180:183], v[80:83]
    v_mfma_f32_16x16x32_bf16 v[84:87], a[152:155], a[184:187], v[84:87]
    s_mov_b32 s39, 138240
    v_mfma_f32_16x16x32_bf16 v[88:91], a[152:155], a[188:191], v[88:91]
    buffer_load_dwordx4 v252, s[24:27], s39 offen offset:1152 lds
    v_mfma_f32_16x16x32_bf16 v[92:95], a[152:155], a[192:195], v[92:95]
    ds_read_b64_tr_b16 a[152:153], v245 offset:20480
    ds_read_b64_tr_b16 a[154:155], v245 offset:22528
    v_mfma_f32_16x16x32_bf16 v[96:99], a[156:159], a[180:183], v[96:99]
    v_mfma_f32_16x16x32_bf16 v[100:103], a[156:159], a[184:187], v[100:103]
    s_mov_b32 s39, 145408
    v_mfma_f32_16x16x32_bf16 v[104:107], a[156:159], a[188:191], v[104:107]
    buffer_load_dwordx4 v252, s[24:27], s39 offen offset:2176 lds
    v_mfma_f32_16x16x32_bf16 v[108:111], a[156:159], a[192:195], v[108:111]
    ds_read_b64_tr_b16 a[156:157], v246 offset:20480
    ds_read_b64_tr_b16 a[158:159], v246 offset:22528
    v_mfma_f32_16x16x32_bf16 v[112:115], a[160:163], a[180:183], v[112:115]
    v_mfma_f32_16x16x32_bf16 v[116:119], a[160:163], a[184:187], v[116:119]
    s_waitcnt lgkmcnt(6)
    s_mov_b32 s39, 152576
    v_mfma_f32_16x16x32_bf16 v[120:123], a[160:163], a[188:191], v[120:123]
    buffer_load_dwordx4 v252, s[24:27], s39 offen offset:3200 lds
    v_mfma_f32_16x16x32_bf16 v[124:127], a[160:163], a[192:195], v[124:127]
    ds_read_b64_tr_b16 a[160:161], v247 offset:20480
    ds_read_b64_tr_b16 a[162:163], v247 offset:22528
    v_mfma_f32_16x16x32_bf16 v[0:3], a[132:135], a[164:167], v[0:3]
    ds_read_b128 a[180:183], v250 offset:12288
    v_mfma_f32_16x16x32_bf16 v[4:7], a[132:135], a[168:171], v[4:7]
    s_waitcnt vmcnt(12)
    s_add_u32 m0, s36, 16384
    s_mov_b32 s39, 163840
    v_mfma_f32_16x16x32_bf16 v[8:11], a[132:135], a[172:175], v[8:11]
    buffer_load_dwordx4 v252, s[24:27], s39 offen offset:0 lds
    v_mfma_f32_16x16x32_bf16 v[12:15], a[132:135], a[176:179], v[12:15]
    ds_read_b64_tr_b16 a[132:133], v244 offset:24576
    ds_read_b64_tr_b16 a[134:135], v244 offset:26624
    v_mfma_f32_16x16x32_bf16 v[16:19], a[136:139], a[164:167], v[16:19]
    ds_read_b128 a[184:187], v250 offset:13312
    v_mfma_f32_16x16x32_bf16 v[20:23], a[136:139], a[168:171], v[20:23]
    s_mov_b32 s39, 171008
    v_mfma_f32_16x16x32_bf16 v[24:27], a[136:139], a[172:175], v[24:27]
    buffer_load_dwordx4 v252, s[24:27], s39 offen offset:1024 lds
    v_mfma_f32_16x16x32_bf16 v[28:31], a[136:139], a[176:179], v[28:31]
    ds_read_b64_tr_b16 a[136:137], v245 offset:24576
    ds_read_b64_tr_b16 a[138:139], v245 offset:26624
    v_mfma_f32_16x16x32_bf16 v[32:35], a[140:143], a[164:167], v[32:35]
    ds_read_b128 a[188:191], v250 offset:14336
    v_mfma_f32_16x16x32_bf16 v[36:39], a[140:143], a[168:171], v[36:39]
    s_mov_b32 s39, 178176
    v_mfma_f32_16x16x32_bf16 v[40:43], a[140:143], a[172:175], v[40:43]
    buffer_load_dwordx4 v252, s[24:27], s39 offen offset:2048 lds
    v_mfma_f32_16x16x32_bf16 v[44:47], a[140:143], a[176:179], v[44:47]
    ds_read_b64_tr_b16 a[140:141], v246 offset:24576
    ds_read_b64_tr_b16 a[142:143], v246 offset:26624
    v_mfma_f32_16x16x32_bf16 v[48:51], a[144:147], a[164:167], v[48:51]
    ds_read_b128 a[192:195], v250 offset:15360
    v_mfma_f32_16x16x32_bf16 v[52:55], a[144:147], a[168:171], v[52:55]
    s_waitcnt lgkmcnt(10)
    s_mov_b32 s39, 185344
    v_mfma_f32_16x16x32_bf16 v[56:59], a[144:147], a[172:175], v[56:59]
    buffer_load_dwordx4 v252, s[24:27], s39 offen offset:3072 lds
    v_mfma_f32_16x16x32_bf16 v[60:63], a[144:147], a[176:179], v[60:63]
    ds_read_b64_tr_b16 a[144:145], v247 offset:24576
    ds_read_b64_tr_b16 a[146:147], v247 offset:26624
    v_mfma_f32_16x16x32_bf16 v[64:67], a[148:151], a[164:167], v[64:67]
    v_mfma_f32_16x16x32_bf16 v[68:71], a[148:151], a[168:171], v[68:71]
    s_waitcnt vmcnt(12)
    s_add_u32 m0, s36, 20352
    s_mov_b32 s39, 163840
    v_mfma_f32_16x16x32_bf16 v[72:75], a[148:151], a[172:175], v[72:75]
    buffer_load_dwordx4 v252, s[24:27], s39 offen offset:128 lds
    v_mfma_f32_16x16x32_bf16 v[76:79], a[148:151], a[176:179], v[76:79]
    ds_read_b64_tr_b16 a[148:149], v244 offset:28672
    ds_read_b64_tr_b16 a[150:151], v244 offset:30720
    v_mfma_f32_16x16x32_bf16 v[80:83], a[152:155], a[164:167], v[80:83]
    v_mfma_f32_16x16x32_bf16 v[84:87], a[152:155], a[168:171], v[84:87]
    s_mov_b32 s39, 171008
    v_mfma_f32_16x16x32_bf16 v[88:91], a[152:155], a[172:175], v[88:91]
    buffer_load_dwordx4 v252, s[24:27], s39 offen offset:1152 lds
    v_mfma_f32_16x16x32_bf16 v[92:95], a[152:155], a[176:179], v[92:95]
    ds_read_b64_tr_b16 a[152:153], v245 offset:28672
    ds_read_b64_tr_b16 a[154:155], v245 offset:30720
    v_mfma_f32_16x16x32_bf16 v[96:99], a[156:159], a[164:167], v[96:99]
    v_mfma_f32_16x16x32_bf16 v[100:103], a[156:159], a[168:171], v[100:103]
    s_mov_b32 s39, 178176
    v_mfma_f32_16x16x32_bf16 v[104:107], a[156:159], a[172:175], v[104:107]
    buffer_load_dwordx4 v252, s[24:27], s39 offen offset:2176 lds
    v_mfma_f32_16x16x32_bf16 v[108:111], a[156:159], a[176:179], v[108:111]
    ds_read_b64_tr_b16 a[156:157], v246 offset:28672
    ds_read_b64_tr_b16 a[158:159], v246 offset:30720
    v_mfma_f32_16x16x32_bf16 v[112:115], a[160:163], a[164:167], v[112:115]
    v_mfma_f32_16x16x32_bf16 v[116:119], a[160:163], a[168:171], v[116:119]
    s_waitcnt lgkmcnt(6)
    s_mov_b32 s39, 185344
    v_mfma_f32_16x16x32_bf16 v[120:123], a[160:163], a[172:175], v[120:123]
    buffer_load_dwordx4 v252, s[24:27], s39 offen offset:3200 lds
    v_mfma_f32_16x16x32_bf16 v[124:127], a[160:163], a[176:179], v[124:127]
    ds_read_b64_tr_b16 a[160:161], v247 offset:28672
    ds_read_b64_tr_b16 a[162:163], v247 offset:30720
    v_mfma_f32_16x16x32_bf16 v[0:3], a[132:135], a[180:183], v[0:3]
    ds_read_b128 a[164:167], v250 offset:40960
    v_mfma_f32_16x16x32_bf16 v[4:7], a[132:135], a[184:187], v[4:7]
    s_waitcnt vmcnt(12)
    s_add_u32 m0, s36, 24576
    s_mov_b32 s39, 196608
    v_mfma_f32_16x16x32_bf16 v[8:11], a[132:135], a[188:191], v[8:11]
    buffer_load_dwordx4 v252, s[24:27], s39 offen offset:0 lds
    v_mfma_f32_16x16x32_bf16 v[12:15], a[132:135], a[192:195], v[12:15]
    ds_read_b64_tr_b16 a[132:133], v244 offset:32768
    ds_read_b64_tr_b16 a[134:135], v244 offset:34816
    v_mfma_f32_16x16x32_bf16 v[16:19], a[136:139], a[180:183], v[16:19]
    ds_read_b128 a[168:171], v250 offset:41984
    v_mfma_f32_16x16x32_bf16 v[20:23], a[136:139], a[184:187], v[20:23]
    s_mov_b32 s39, 203776
    v_mfma_f32_16x16x32_bf16 v[24:27], a[136:139], a[188:191], v[24:27]
    buffer_load_dwordx4 v252, s[24:27], s39 offen offset:1024 lds
    v_mfma_f32_16x16x32_bf16 v[28:31], a[136:139], a[192:195], v[28:31]
    ds_read_b64_tr_b16 a[136:137], v245 offset:32768
    ds_read_b64_tr_b16 a[138:139], v245 offset:34816
    v_mfma_f32_16x16x32_bf16 v[32:35], a[140:143], a[180:183], v[32:35]
    ds_read_b128 a[172:175], v250 offset:43008
    v_mfma_f32_16x16x32_bf16 v[36:39], a[140:143], a[184:187], v[36:39]
    s_mov_b32 s39, 210944
    v_mfma_f32_16x16x32_bf16 v[40:43], a[140:143], a[188:191], v[40:43]
    buffer_load_dwordx4 v252, s[24:27], s39 offen offset:2048 lds
    v_mfma_f32_16x16x32_bf16 v[44:47], a[140:143], a[192:195], v[44:47]
    ds_read_b64_tr_b16 a[140:141], v246 offset:32768
    ds_read_b64_tr_b16 a[142:143], v246 offset:34816
    v_mfma_f32_16x16x32_bf16 v[48:51], a[144:147], a[180:183], v[48:51]
    ds_read_b128 a[176:179], v250 offset:44032
    v_mfma_f32_16x16x32_bf16 v[52:55], a[144:147], a[184:187], v[52:55]
    s_waitcnt lgkmcnt(10)
    s_mov_b32 s39, 218112
    v_mfma_f32_16x16x32_bf16 v[56:59], a[144:147], a[188:191], v[56:59]
    buffer_load_dwordx4 v252, s[24:27], s39 offen offset:3072 lds
    v_mfma_f32_16x16x32_bf16 v[60:63], a[144:147], a[192:195], v[60:63]
    ds_read_b64_tr_b16 a[144:145], v247 offset:32768
    ds_read_b64_tr_b16 a[146:147], v247 offset:34816
    v_mfma_f32_16x16x32_bf16 v[64:67], a[148:151], a[180:183], v[64:67]
    v_mfma_f32_16x16x32_bf16 v[68:71], a[148:151], a[184:187], v[68:71]
    s_waitcnt vmcnt(12)
    s_add_u32 m0, s36, 28544
    s_mov_b32 s39, 196608
    v_mfma_f32_16x16x32_bf16 v[72:75], a[148:151], a[188:191], v[72:75]
    buffer_load_dwordx4 v252, s[24:27], s39 offen offset:128 lds
    v_mfma_f32_16x16x32_bf16 v[76:79], a[148:151], a[192:195], v[76:79]
    ds_read_b64_tr_b16 a[148:149], v244 offset:36864
    ds_read_b64_tr_b16 a[150:151], v244 offset:38912
    v_mfma_f32_16x16x32_bf16 v[80:83], a[152:155], a[180:183], v[80:83]
    v_mfma_f32_16x16x32_bf16 v[84:87], a[152:155], a[184:187], v[84:87]
    s_mov_b32 s39, 203776
    v_mfma_f32_16x16x32_bf16 v[88:91], a[152:155], a[188:191], v[88:91]
    buffer_load_dwordx4 v252, s[24:27], s39 offen offset:1152 lds
    v_mfma_f32_16x16x32_bf16 v[92:95], a[152:155], a[192:195], v[92:95]
    ds_read_b64_tr_b16 a[152:153], v245 offset:36864
    ds_read_b64_tr_b16 a[154:155], v245 offset:38912
    v_mfma_f32_16x16x32_bf16 v[96:99], a[156:159], a[180:183], v[96:99]
    v_mfma_f32_16x16x32_bf16 v[100:103], a[156:159], a[184:187], v[100:103]
    s_mov_b32 s39, 210944
    v_mfma_f32_16x16x32_bf16 v[104:107], a[156:159], a[188:191], v[104:107]
    buffer_load_dwordx4 v252, s[24:27], s39 offen offset:2176 lds
    v_mfma_f32_16x16x32_bf16 v[108:111], a[156:159], a[192:195], v[108:111]
    ds_read_b64_tr_b16 a[156:157], v246 offset:36864
    ds_read_b64_tr_b16 a[158:159], v246 offset:38912
    v_mfma_f32_16x16x32_bf16 v[112:115], a[160:163], a[180:183], v[112:115]
    v_mfma_f32_16x16x32_bf16 v[116:119], a[160:163], a[184:187], v[116:119]
    s_waitcnt lgkmcnt(6)
    s_mov_b32 s39, 218112
    v_mfma_f32_16x16x32_bf16 v[120:123], a[160:163], a[188:191], v[120:123]
    buffer_load_dwordx4 v252, s[24:27], s39 offen offset:3200 lds
    v_mfma_f32_16x16x32_bf16 v[124:127], a[160:163], a[192:195], v[124:127]
    ds_read_b64_tr_b16 a[160:161], v247 offset:36864
    ds_read_b64_tr_b16 a[162:163], v247 offset:38912
    v_mfma_f32_16x16x32_bf16 v[0:3], a[132:135], a[164:167], v[0:3]
    ds_read_b128 a[180:183], v250 offset:45056
    v_mfma_f32_16x16x32_bf16 v[4:7], a[132:135], a[168:171], v[4:7]
    s_waitcnt vmcnt(12)
    s_add_u32 m0, s36, 32768
    s_mov_b32 s39, 229376
    v_mfma_f32_16x16x32_bf16 v[8:11], a[132:135], a[172:175], v[8:11]
    buffer_load_dwordx4 v252, s[24:27], s39 offen offset:0 lds
    v_mfma_f32_16x16x32_bf16 v[12:15], a[132:135], a[176:179], v[12:15]
    ds_read_b64_tr_b16 a[132:133], v244 offset:16384
    ds_read_b64_tr_b16 a[134:135], v244 offset:18432
    v_mfma_f32_16x16x32_bf16 v[16:19], a[136:139], a[164:167], v[16:19]
    ds_read_b128 a[184:187], v250 offset:46080
    v_mfma_f32_16x16x32_bf16 v[20:23], a[136:139], a[168:171], v[20:23]
    s_mov_b32 s39, 236544
    v_mfma_f32_16x16x32_bf16 v[24:27], a[136:139], a[172:175], v[24:27]
    buffer_load_dwordx4 v252, s[24:27], s39 offen offset:1024 lds
    v_mfma_f32_16x16x32_bf16 v[28:31], a[136:139], a[176:179], v[28:31]
    ds_read_b64_tr_b16 a[136:137], v245 offset:16384
    ds_read_b64_tr_b16 a[138:139], v245 offset:18432
    v_mfma_f32_16x16x32_bf16 v[32:35], a[140:143], a[164:167], v[32:35]
    ds_read_b128 a[188:191], v250 offset:47104
    v_mfma_f32_16x16x32_bf16 v[36:39], a[140:143], a[168:171], v[36:39]
    s_mov_b32 s39, 243712
    v_mfma_f32_16x16x32_bf16 v[40:43], a[140:143], a[172:175], v[40:43]
    buffer_load_dwordx4 v252, s[24:27], s39 offen offset:2048 lds
    v_mfma_f32_16x16x32_bf16 v[44:47], a[140:143], a[176:179], v[44:47]
    ds_read_b64_tr_b16 a[140:141], v246 offset:16384
    ds_read_b64_tr_b16 a[142:143], v246 offset:18432
    v_mfma_f32_16x16x32_bf16 v[48:51], a[144:147], a[164:167], v[48:51]
    ds_read_b128 a[192:195], v250 offset:48128
    v_mfma_f32_16x16x32_bf16 v[52:55], a[144:147], a[168:171], v[52:55]
    s_waitcnt lgkmcnt(10)
    s_mov_b32 s39, 250880
    v_mfma_f32_16x16x32_bf16 v[56:59], a[144:147], a[172:175], v[56:59]
    buffer_load_dwordx4 v252, s[24:27], s39 offen offset:3072 lds
    v_mfma_f32_16x16x32_bf16 v[60:63], a[144:147], a[176:179], v[60:63]
    ds_read_b64_tr_b16 a[144:145], v247 offset:16384
    ds_read_b64_tr_b16 a[146:147], v247 offset:18432
    v_mfma_f32_16x16x32_bf16 v[64:67], a[148:151], a[164:167], v[64:67]
    v_mfma_f32_16x16x32_bf16 v[68:71], a[148:151], a[168:171], v[68:71]
    s_waitcnt vmcnt(12)
    s_add_u32 m0, s36, 36736
    s_mov_b32 s39, 229376
    v_mfma_f32_16x16x32_bf16 v[72:75], a[148:151], a[172:175], v[72:75]
    buffer_load_dwordx4 v252, s[24:27], s39 offen offset:128 lds
    v_mfma_f32_16x16x32_bf16 v[76:79], a[148:151], a[176:179], v[76:79]
    ds_read_b64_tr_b16 a[148:149], v244 offset:20480
    ds_read_b64_tr_b16 a[150:151], v244 offset:22528
    v_mfma_f32_16x16x32_bf16 v[80:83], a[152:155], a[164:167], v[80:83]
    v_mfma_f32_16x16x32_bf16 v[84:87], a[152:155], a[168:171], v[84:87]
    s_mov_b32 s39, 236544
    v_mfma_f32_16x16x32_bf16 v[88:91], a[152:155], a[172:175], v[88:91]
    buffer_load_dwordx4 v252, s[24:27], s39 offen offset:1152 lds
    v_mfma_f32_16x16x32_bf16 v[92:95], a[152:155], a[176:179], v[92:95]
    ds_read_b64_tr_b16 a[152:153], v245 offset:20480
    ds_read_b64_tr_b16 a[154:155], v245 offset:22528
    v_mfma_f32_16x16x32_bf16 v[96:99], a[156:159], a[164:167], v[96:99]
    v_mfma_f32_16x16x32_bf16 v[100:103], a[156:159], a[168:171], v[100:103]
    s_mov_b32 s39, 243712
    v_mfma_f32_16x16x32_bf16 v[104:107], a[156:159], a[172:175], v[104:107]
    buffer_load_dwordx4 v252, s[24:27], s39 offen offset:2176 lds
    v_mfma_f32_16x16x32_bf16 v[108:111], a[156:159], a[176:179], v[108:111]
    ds_read_b64_tr_b16 a[156:157], v246 offset:20480
    ds_read_b64_tr_b16 a[158:159], v246 offset:22528
    v_mfma_f32_16x16x32_bf16 v[112:115], a[160:163], a[164:167], v[112:115]
    v_mfma_f32_16x16x32_bf16 v[116:119], a[160:163], a[168:171], v[116:119]
    s_waitcnt lgkmcnt(6)
    s_mov_b32 s39, 250880
    v_mfma_f32_16x16x32_bf16 v[120:123], a[160:163], a[172:175], v[120:123]
    buffer_load_dwordx4 v252, s[24:27], s39 offen offset:3200 lds
    v_mfma_f32_16x16x32_bf16 v[124:127], a[160:163], a[176:179], v[124:127]
    ds_read_b64_tr_b16 a[160:161], v247 offset:20480
    ds_read_b64_tr_b16 a[162:163], v247 offset:22528
    v_mfma_f32_16x16x32_bf16 v[0:3], a[132:135], a[180:183], v[0:3]
    ds_read_b128 a[164:167], v250 offset:49152
    v_mfma_f32_16x16x32_bf16 v[4:7], a[132:135], a[184:187], v[4:7]
    s_waitcnt vmcnt(12)
    s_add_u32 m0, s36, 16384
    s_mov_b32 s39, 262144
    v_mfma_f32_16x16x32_bf16 v[8:11], a[132:135], a[188:191], v[8:11]
    buffer_load_dwordx4 v252, s[24:27], s39 offen offset:0 lds
    v_mfma_f32_16x16x32_bf16 v[12:15], a[132:135], a[192:195], v[12:15]
    ds_read_b64_tr_b16 a[132:133], v244 offset:24576
    ds_read_b64_tr_b16 a[134:135], v244 offset:26624
    v_mfma_f32_16x16x32_bf16 v[16:19], a[136:139], a[180:183], v[16:19]
    ds_read_b128 a[168:171], v250 offset:50176
    v_mfma_f32_16x16x32_bf16 v[20:23], a[136:139], a[184:187], v[20:23]
    s_mov_b32 s39, 269312
    v_mfma_f32_16x16x32_bf16 v[24:27], a[136:139], a[188:191], v[24:27]
    buffer_load_dwordx4 v252, s[24:27], s39 offen offset:1024 lds
    v_mfma_f32_16x16x32_bf16 v[28:31], a[136:139], a[192:195], v[28:31]
    ds_read_b64_tr_b16 a[136:137], v245 offset:24576
    ds_read_b64_tr_b16 a[138:139], v245 offset:26624
    v_mfma_f32_16x16x32_bf16 v[32:35], a[140:143], a[180:183], v[32:35]
    ds_read_b128 a[172:175], v250 offset:51200
    v_mfma_f32_16x16x32_bf16 v[36:39], a[140:143], a[184:187], v[36:39]
    s_mov_b32 s39, 276480
    v_mfma_f32_16x16x32_bf16 v[40:43], a[140:143], a[188:191], v[40:43]
    buffer_load_dwordx4 v252, s[24:27], s39 offen offset:2048 lds
    v_mfma_f32_16x16x32_bf16 v[44:47], a[140:143], a[192:195], v[44:47]
    ds_read_b64_tr_b16 a[140:141], v246 offset:24576
    ds_read_b64_tr_b16 a[142:143], v246 offset:26624
    v_mfma_f32_16x16x32_bf16 v[48:51], a[144:147], a[180:183], v[48:51]
    ds_read_b128 a[176:179], v250 offset:52224
    v_mfma_f32_16x16x32_bf16 v[52:55], a[144:147], a[184:187], v[52:55]
    s_waitcnt lgkmcnt(10)
    s_mov_b32 s39, 283648
    v_mfma_f32_16x16x32_bf16 v[56:59], a[144:147], a[188:191], v[56:59]
    buffer_load_dwordx4 v252, s[24:27], s39 offen offset:3072 lds
    v_mfma_f32_16x16x32_bf16 v[60:63], a[144:147], a[192:195], v[60:63]
    ds_read_b64_tr_b16 a[144:145], v247 offset:24576
    ds_read_b64_tr_b16 a[146:147], v247 offset:26624
    v_mfma_f32_16x16x32_bf16 v[64:67], a[148:151], a[180:183], v[64:67]
    v_mfma_f32_16x16x32_bf16 v[68:71], a[148:151], a[184:187], v[68:71]
    s_waitcnt vmcnt(12)
    s_add_u32 m0, s36, 20352
    s_mov_b32 s39, 262144
    v_mfma_f32_16x16x32_bf16 v[72:75], a[148:151], a[188:191], v[72:75]
    buffer_load_dwordx4 v252, s[24:27], s39 offen offset:128 lds
    v_mfma_f32_16x16x32_bf16 v[76:79], a[148:151], a[192:195], v[76:79]
    ds_read_b64_tr_b16 a[148:149], v244 offset:28672
    ds_read_b64_tr_b16 a[150:151], v244 offset:30720
    v_mfma_f32_16x16x32_bf16 v[80:83], a[152:155], a[180:183], v[80:83]
    v_mfma_f32_16x16x32_bf16 v[84:87], a[152:155], a[184:187], v[84:87]
    s_mov_b32 s39, 269312
    v_mfma_f32_16x16x32_bf16 v[88:91], a[152:155], a[188:191], v[88:91]
    buffer_load_dwordx4 v252, s[24:27], s39 offen offset:1152 lds
    v_mfma_f32_16x16x32_bf16 v[92:95], a[152:155], a[192:195], v[92:95]
    ds_read_b64_tr_b16 a[152:153], v245 offset:28672
    ds_read_b64_tr_b16 a[154:155], v245 offset:30720
    v_mfma_f32_16x16x32_bf16 v[96:99], a[156:159], a[180:183], v[96:99]
    v_mfma_f32_16x16x32_bf16 v[100:103], a[156:159], a[184:187], v[100:103]
    s_mov_b32 s39, 276480
    v_mfma_f32_16x16x32_bf16 v[104:107], a[156:159], a[188:191], v[104:107]
    buffer_load_dwordx4 v252, s[24:27], s39 offen offset:2176 lds
    v_mfma_f32_16x16x32_bf16 v[108:111], a[156:159], a[192:195], v[108:111]
    ds_read_b64_tr_b16 a[156:157], v246 offset:28672
    ds_read_b64_tr_b16 a[158:159], v246 offset:30720
    v_mfma_f32_16x16x32_bf16 v[112:115], a[160:163], a[180:183], v[112:115]
    v_mfma_f32_16x16x32_bf16 v[116:119], a[160:163], a[184:187], v[116:119]
    s_waitcnt lgkmcnt(6)
    s_mov_b32 s39, 283648
    v_mfma_f32_16x16x32_bf16 v[120:123], a[160:163], a[188:191], v[120:123]
    buffer_load_dwordx4 v252, s[24:27], s39 offen offset:3200 lds
    v_mfma_f32_16x16x32_bf16 v[124:127], a[160:163], a[192:195], v[124:127]
    ds_read_b64_tr_b16 a[160:161], v247 offset:28672
    ds_read_b64_tr_b16 a[162:163], v247 offset:30720
    v_mfma_f32_16x16x32_bf16 v[0:3], a[132:135], a[164:167], v[0:3]
    ds_read_b128 a[180:183], v250 offset:53248
    v_mfma_f32_16x16x32_bf16 v[4:7], a[132:135], a[168:171], v[4:7]
    s_waitcnt vmcnt(12)
    s_add_u32 m0, s36, 24576
    s_mov_b32 s39, 294912
    v_mfma_f32_16x16x32_bf16 v[8:11], a[132:135], a[172:175], v[8:11]
    buffer_load_dwordx4 v252, s[24:27], s39 offen offset:0 lds
    v_mfma_f32_16x16x32_bf16 v[12:15], a[132:135], a[176:179], v[12:15]
    ds_read_b64_tr_b16 a[132:133], v244 offset:32768
    ds_read_b64_tr_b16 a[134:135], v244 offset:34816
    v_mfma_f32_16x16x32_bf16 v[16:19], a[136:139], a[164:167], v[16:19]
    ds_read_b128 a[184:187], v250 offset:54272
    v_mfma_f32_16x16x32_bf16 v[20:23], a[136:139], a[168:171], v[20:23]
    s_mov_b32 s39, 302080
    v_mfma_f32_16x16x32_bf16 v[24:27], a[136:139], a[172:175], v[24:27]
    buffer_load_dwordx4 v252, s[24:27], s39 offen offset:1024 lds
    v_mfma_f32_16x16x32_bf16 v[28:31], a[136:139], a[176:179], v[28:31]
    ds_read_b64_tr_b16 a[136:137], v245 offset:32768
    ds_read_b64_tr_b16 a[138:139], v245 offset:34816
    v_mfma_f32_16x16x32_bf16 v[32:35], a[140:143], a[164:167], v[32:35]
    ds_read_b128 a[188:191], v250 offset:55296
    v_mfma_f32_16x16x32_bf16 v[36:39], a[140:143], a[168:171], v[36:39]
    s_mov_b32 s39, 309248
    v_mfma_f32_16x16x32_bf16 v[40:43], a[140:143], a[172:175], v[40:43]
    buffer_load_dwordx4 v252, s[24:27], s39 offen offset:2048 lds
    v_mfma_f32_16x16x32_bf16 v[44:47], a[140:143], a[176:179], v[44:47]
    ds_read_b64_tr_b16 a[140:141], v246 offset:32768
    ds_read_b64_tr_b16 a[142:143], v246 offset:34816
    v_mfma_f32_16x16x32_bf16 v[48:51], a[144:147], a[164:167], v[48:51]
    ds_read_b128 a[192:195], v250 offset:56320
    v_mfma_f32_16x16x32_bf16 v[52:55], a[144:147], a[168:171], v[52:55]
    s_waitcnt lgkmcnt(10)
    s_mov_b32 s39, 316416
    v_mfma_f32_16x16x32_bf16 v[56:59], a[144:147], a[172:175], v[56:59]
    buffer_load_dwordx4 v252, s[24:27], s39 offen offset:3072 lds
    v_mfma_f32_16x16x32_bf16 v[60:63], a[144:147], a[176:179], v[60:63]
    ds_read_b64_tr_b16 a[144:145], v247 offset:32768
    ds_read_b64_tr_b16 a[146:147], v247 offset:34816
    v_mfma_f32_16x16x32_bf16 v[64:67], a[148:151], a[164:167], v[64:67]
    v_mfma_f32_16x16x32_bf16 v[68:71], a[148:151], a[168:171], v[68:71]
    s_waitcnt vmcnt(12)
    s_add_u32 m0, s36, 28544
    s_mov_b32 s39, 294912
    v_mfma_f32_16x16x32_bf16 v[72:75], a[148:151], a[172:175], v[72:75]
    buffer_load_dwordx4 v252, s[24:27], s39 offen offset:128 lds
    v_mfma_f32_16x16x32_bf16 v[76:79], a[148:151], a[176:179], v[76:79]
    ds_read_b64_tr_b16 a[148:149], v244 offset:36864
    ds_read_b64_tr_b16 a[150:151], v244 offset:38912
    v_mfma_f32_16x16x32_bf16 v[80:83], a[152:155], a[164:167], v[80:83]
    v_mfma_f32_16x16x32_bf16 v[84:87], a[152:155], a[168:171], v[84:87]
    s_mov_b32 s39, 302080
    v_mfma_f32_16x16x32_bf16 v[88:91], a[152:155], a[172:175], v[88:91]
    buffer_load_dwordx4 v252, s[24:27], s39 offen offset:1152 lds
    v_mfma_f32_16x16x32_bf16 v[92:95], a[152:155], a[176:179], v[92:95]
    ds_read_b64_tr_b16 a[152:153], v245 offset:36864
    ds_read_b64_tr_b16 a[154:155], v245 offset:38912
    v_mfma_f32_16x16x32_bf16 v[96:99], a[156:159], a[164:167], v[96:99]
    v_mfma_f32_16x16x32_bf16 v[100:103], a[156:159], a[168:171], v[100:103]
    s_mov_b32 s39, 309248
    v_mfma_f32_16x16x32_bf16 v[104:107], a[156:159], a[172:175], v[104:107]
    buffer_load_dwordx4 v252, s[24:27], s39 offen offset:2176 lds
    v_mfma_f32_16x16x32_bf16 v[108:111], a[156:159], a[176:179], v[108:111]
    ds_read_b64_tr_b16 a[156:157], v246 offset:36864
    ds_read_b64_tr_b16 a[158:159], v246 offset:38912
    v_mfma_f32_16x16x32_bf16 v[112:115], a[160:163], a[164:167], v[112:115]
    v_mfma_f32_16x16x32_bf16 v[116:119], a[160:163], a[168:171], v[116:119]
    s_waitcnt lgkmcnt(6)
    s_mov_b32 s39, 316416
    v_mfma_f32_16x16x32_bf16 v[120:123], a[160:163], a[172:175], v[120:123]
    buffer_load_dwordx4 v252, s[24:27], s39 offen offset:3200 lds
    v_mfma_f32_16x16x32_bf16 v[124:127], a[160:163], a[176:179], v[124:127]
    ds_read_b64_tr_b16 a[160:161], v247 offset:36864
    ds_read_b64_tr_b16 a[162:163], v247 offset:38912
    v_mfma_f32_16x16x32_bf16 v[0:3], a[132:135], a[180:183], v[0:3]
    ds_read_b128 a[164:167], v251 offset:0
    v_mfma_f32_16x16x32_bf16 v[4:7], a[132:135], a[184:187], v[4:7]
    s_waitcnt vmcnt(12)
    s_add_u32 m0, s36, 32768
    s_mov_b32 s39, 327680
    v_mfma_f32_16x16x32_bf16 v[8:11], a[132:135], a[188:191], v[8:11]
    buffer_load_dwordx4 v252, s[24:27], s39 offen offset:0 lds
    v_mfma_f32_16x16x32_bf16 v[12:15], a[132:135], a[192:195], v[12:15]
    ds_read_b64_tr_b16 a[132:133], v244 offset:16384
    ds_read_b64_tr_b16 a[134:135], v244 offset:18432
    v_mfma_f32_16x16x32_bf16 v[16:19], a[136:139], a[180:183], v[16:19]
    ds_read_b128 a[168:171], v251 offset:1024
    v_mfma_f32_16x16x32_bf16 v[20:23], a[136:139], a[184:187], v[20:23]
    s_mov_b32 s39, 334848
    v_mfma_f32_16x16x32_bf16 v[24:27], a[136:139], a[188:191], v[24:27]
    buffer_load_dwordx4 v252, s[24:27], s39 offen offset:1024 lds
    v_mfma_f32_16x16x32_bf16 v[28:31], a[136:139], a[192:195], v[28:31]
    ds_read_b64_tr_b16 a[136:137], v245 offset:16384
    ds_read_b64_tr_b16 a[138:139], v245 offset:18432
    v_mfma_f32_16x16x32_bf16 v[32:35], a[140:143], a[180:183], v[32:35]
    ds_read_b128 a[172:175], v251 offset:2048
    v_mfma_f32_16x16x32_bf16 v[36:39], a[140:143], a[184:187], v[36:39]
    s_mov_b32 s39, 342016
    v_mfma_f32_16x16x32_bf16 v[40:43], a[140:143], a[188:191], v[40:43]
    buffer_load_dwordx4 v252, s[24:27], s39 offen offset:2048 lds
    v_mfma_f32_16x16x32_bf16 v[44:47], a[140:143], a[192:195], v[44:47]
    ds_read_b64_tr_b16 a[140:141], v246 offset:16384
    ds_read_b64_tr_b16 a[142:143], v246 offset:18432
    v_mfma_f32_16x16x32_bf16 v[48:51], a[144:147], a[180:183], v[48:51]
    ds_read_b128 a[176:179], v251 offset:3072
    v_mfma_f32_16x16x32_bf16 v[52:55], a[144:147], a[184:187], v[52:55]
    s_waitcnt lgkmcnt(10)
    s_mov_b32 s39, 349184
    v_mfma_f32_16x16x32_bf16 v[56:59], a[144:147], a[188:191], v[56:59]
    buffer_load_dwordx4 v252, s[24:27], s39 offen offset:3072 lds
    v_mfma_f32_16x16x32_bf16 v[60:63], a[144:147], a[192:195], v[60:63]
    ds_read_b64_tr_b16 a[144:145], v247 offset:16384
    ds_read_b64_tr_b16 a[146:147], v247 offset:18432
    v_mfma_f32_16x16x32_bf16 v[64:67], a[148:151], a[180:183], v[64:67]
    v_mfma_f32_16x16x32_bf16 v[68:71], a[148:151], a[184:187], v[68:71]
    s_waitcnt vmcnt(12)
    s_add_u32 m0, s36, 36736
    s_mov_b32 s39, 327680
    v_mfma_f32_16x16x32_bf16 v[72:75], a[148:151], a[188:191], v[72:75]
    buffer_load_dwordx4 v252, s[24:27], s39 offen offset:128 lds
    v_mfma_f32_16x16x32_bf16 v[76:79], a[148:151], a[192:195], v[76:79]
    ds_read_b64_tr_b16 a[148:149], v244 offset:20480
    ds_read_b64_tr_b16 a[150:151], v244 offset:22528
    v_mfma_f32_16x16x32_bf16 v[80:83], a[152:155], a[180:183], v[80:83]
    v_mfma_f32_16x16x32_bf16 v[84:87], a[152:155], a[184:187], v[84:87]
    s_mov_b32 s39, 334848
    v_mfma_f32_16x16x32_bf16 v[88:91], a[152:155], a[188:191], v[88:91]
    buffer_load_dwordx4 v252, s[24:27], s39 offen offset:1152 lds
    v_mfma_f32_16x16x32_bf16 v[92:95], a[152:155], a[192:195], v[92:95]
    ds_read_b64_tr_b16 a[152:153], v245 offset:20480
    ds_read_b64_tr_b16 a[154:155], v245 offset:22528
    v_mfma_f32_16x16x32_bf16 v[96:99], a[156:159], a[180:183], v[96:99]
    v_mfma_f32_16x16x32_bf16 v[100:103], a[156:159], a[184:187], v[100:103]
    s_mov_b32 s39, 342016
    v_mfma_f32_16x16x32_bf16 v[104:107], a[156:159], a[188:191], v[104:107]
    buffer_load_dwordx4 v252, s[24:27], s39 offen offset:2176 lds
    v_mfma_f32_16x16x32_bf16 v[108:111], a[156:159], a[192:195], v[108:111]
    ds_read_b64_tr_b16 a[156:157], v246 offset:20480
    ds_read_b64_tr_b16 a[158:159], v246 offset:22528
    v_mfma_f32_16x16x32_bf16 v[112:115], a[160:163], a[180:183], v[112:115]
    v_mfma_f32_16x16x32_bf16 v[116:119], a[160:163], a[184:187], v[116:119]
    s_waitcnt lgkmcnt(6)
    s_mov_b32 s39, 349184
    v_mfma_f32_16x16x32_bf16 v[120:123], a[160:163], a[188:191], v[120:123]
    buffer_load_dwordx4 v252, s[24:27], s39 offen offset:3200 lds
    v_mfma_f32_16x16x32_bf16 v[124:127], a[160:163], a[192:195], v[124:127]
    ds_read_b64_tr_b16 a[160:161], v247 offset:20480
    ds_read_b64_tr_b16 a[162:163], v247 offset:22528
    v_mfma_f32_16x16x32_bf16 v[0:3], a[132:135], a[164:167], v[0:3]
    ds_read_b128 a[180:183], v251 offset:4096
    v_mfma_f32_16x16x32_bf16 v[4:7], a[132:135], a[168:171], v[4:7]
    s_waitcnt vmcnt(12)
    s_add_u32 m0, s36, 16384
    s_mov_b32 s39, 360448
    v_mfma_f32_16x16x32_bf16 v[8:11], a[132:135], a[172:175], v[8:11]
    buffer_load_dwordx4 v252, s[24:27], s39 offen offset:0 lds
    v_mfma_f32_16x16x32_bf16 v[12:15], a[132:135], a[176:179], v[12:15]
    ds_read_b64_tr_b16 a[132:133], v244 offset:24576
    ds_read_b64_tr_b16 a[134:135], v244 offset:26624
    v_mfma_f32_16x16x32_bf16 v[16:19], a[136:139], a[164:167], v[16:19]
    ds_read_b128 a[184:187], v251 offset:5120
    v_mfma_f32_16x16x32_bf16 v[20:23], a[136:139], a[168:171], v[20:23]
    s_mov_b32 s39, 367616
    v_mfma_f32_16x16x32_bf16 v[24:27], a[136:139], a[172:175], v[24:27]
    buffer_load_dwordx4 v252, s[24:27], s39 offen offset:1024 lds
    v_mfma_f32_16x16x32_bf16 v[28:31], a[136:139], a[176:179], v[28:31]
    ds_read_b64_tr_b16 a[136:137], v245 offset:24576
    ds_read_b64_tr_b16 a[138:139], v245 offset:26624
    v_mfma_f32_16x16x32_bf16 v[32:35], a[140:143], a[164:167], v[32:35]
    ds_read_b128 a[188:191], v251 offset:6144
    v_mfma_f32_16x16x32_bf16 v[36:39], a[140:143], a[168:171], v[36:39]
    s_mov_b32 s39, 374784
    v_mfma_f32_16x16x32_bf16 v[40:43], a[140:143], a[172:175], v[40:43]
    buffer_load_dwordx4 v252, s[24:27], s39 offen offset:2048 lds
    v_mfma_f32_16x16x32_bf16 v[44:47], a[140:143], a[176:179], v[44:47]
    ds_read_b64_tr_b16 a[140:141], v246 offset:24576
    ds_read_b64_tr_b16 a[142:143], v246 offset:26624
    v_mfma_f32_16x16x32_bf16 v[48:51], a[144:147], a[164:167], v[48:51]
    ds_read_b128 a[192:195], v251 offset:7168
    v_mfma_f32_16x16x32_bf16 v[52:55], a[144:147], a[168:171], v[52:55]
    s_waitcnt lgkmcnt(10)
    s_mov_b32 s39, 381952
    v_mfma_f32_16x16x32_bf16 v[56:59], a[144:147], a[172:175], v[56:59]
    buffer_load_dwordx4 v252, s[24:27], s39 offen offset:3072 lds
    v_mfma_f32_16x16x32_bf16 v[60:63], a[144:147], a[176:179], v[60:63]
    ds_read_b64_tr_b16 a[144:145], v247 offset:24576
    ds_read_b64_tr_b16 a[146:147], v247 offset:26624
    v_mfma_f32_16x16x32_bf16 v[64:67], a[148:151], a[164:167], v[64:67]
    v_mfma_f32_16x16x32_bf16 v[68:71], a[148:151], a[168:171], v[68:71]
    s_waitcnt vmcnt(12)
    s_add_u32 m0, s36, 20352
    s_mov_b32 s39, 360448
    v_mfma_f32_16x16x32_bf16 v[72:75], a[148:151], a[172:175], v[72:75]
    buffer_load_dwordx4 v252, s[24:27], s39 offen offset:128 lds
    v_mfma_f32_16x16x32_bf16 v[76:79], a[148:151], a[176:179], v[76:79]
    ds_read_b64_tr_b16 a[148:149], v244 offset:28672
    ds_read_b64_tr_b16 a[150:151], v244 offset:30720
    v_mfma_f32_16x16x32_bf16 v[80:83], a[152:155], a[164:167], v[80:83]
    v_mfma_f32_16x16x32_bf16 v[84:87], a[152:155], a[168:171], v[84:87]
    s_mov_b32 s39, 367616
    v_mfma_f32_16x16x32_bf16 v[88:91], a[152:155], a[172:175], v[88:91]
    buffer_load_dwordx4 v252, s[24:27], s39 offen offset:1152 lds
    v_mfma_f32_16x16x32_bf16 v[92:95], a[152:155], a[176:179], v[92:95]
    ds_read_b64_tr_b16 a[152:153], v245 offset:28672
    ds_read_b64_tr_b16 a[154:155], v245 offset:30720
    v_mfma_f32_16x16x32_bf16 v[96:99], a[156:159], a[164:167], v[96:99]
    v_mfma_f32_16x16x32_bf16 v[100:103], a[156:159], a[168:171], v[100:103]
    s_mov_b32 s39, 374784
    v_mfma_f32_16x16x32_bf16 v[104:107], a[156:159], a[172:175], v[104:107]
    buffer_load_dwordx4 v252, s[24:27], s39 offen offset:2176 lds
    v_mfma_f32_16x16x32_bf16 v[108:111], a[156:159], a[176:179], v[108:111]
    ds_read_b64_tr_b16 a[156:157], v246 offset:28672
    ds_read_b64_tr_b16 a[158:159], v246 offset:30720
    v_mfma_f32_16x16x32_bf16 v[112:115], a[160:163], a[164:167], v[112:115]
    v_mfma_f32_16x16x32_bf16 v[116:119], a[160:163], a[168:171], v[116:119]
    s_waitcnt lgkmcnt(6)
    s_mov_b32 s39, 381952
    v_mfma_f32_16x16x32_bf16 v[120:123], a[160:163], a[172:175], v[120:123]
    buffer_load_dwordx4 v252, s[24:27], s39 offen offset:3200 lds
    v_mfma_f32_16x16x32_bf16 v[124:127], a[160:163], a[176:179], v[124:127]
    ds_read_b64_tr_b16 a[160:161], v247 offset:28672
    ds_read_b64_tr_b16 a[162:163], v247 offset:30720
    v_mfma_f32_16x16x32_bf16 v[0:3], a[132:135], a[180:183], v[0:3]
    ds_read_b128 a[164:167], v251 offset:8192
    v_mfma_f32_16x16x32_bf16 v[4:7], a[132:135], a[184:187], v[4:7]
    s_waitcnt vmcnt(12)
    s_add_u32 m0, s36, 24576
    s_mov_b32 s39, 393216
    v_mfma_f32_16x16x32_bf16 v[8:11], a[132:135], a[188:191], v[8:11]
    buffer_load_dwordx4 v252, s[24:27], s39 offen offset:0 lds
    v_mfma_f32_16x16x32_bf16 v[12:15], a[132:135], a[192:195], v[12:15]
    ds_read_b64_tr_b16 a[132:133], v244 offset:32768
    ds_read_b64_tr_b16 a[134:135], v244 offset:34816
    v_mfma_f32_16x16x32_bf16 v[16:19], a[136:139], a[180:183], v[16:19]
    ds_read_b128 a[168:171], v251 offset:9216
    v_mfma_f32_16x16x32_bf16 v[20:23], a[136:139], a[184:187], v[20:23]
    s_mov_b32 s39, 400384
    v_mfma_f32_16x16x32_bf16 v[24:27], a[136:139], a[188:191], v[24:27]
    buffer_load_dwordx4 v252, s[24:27], s39 offen offset:1024 lds
    v_mfma_f32_16x16x32_bf16 v[28:31], a[136:139], a[192:195], v[28:31]
    ds_read_b64_tr_b16 a[136:137], v245 offset:32768
    ds_read_b64_tr_b16 a[138:139], v245 offset:34816
    v_mfma_f32_16x16x32_bf16 v[32:35], a[140:143], a[180:183], v[32:35]
    ds_read_b128 a[172:175], v251 offset:10240
    v_mfma_f32_16x16x32_bf16 v[36:39], a[140:143], a[184:187], v[36:39]
    s_mov_b32 s39, 407552
    v_mfma_f32_16x16x32_bf16 v[40:43], a[140:143], a[188:191], v[40:43]
    buffer_load_dwordx4 v252, s[24:27], s39 offen offset:2048 lds
    v_mfma_f32_16x16x32_bf16 v[44:47], a[140:143], a[192:195], v[44:47]
    ds_read_b64_tr_b16 a[140:141], v246 offset:32768
    ds_read_b64_tr_b16 a[142:143], v246 offset:34816
    v_mfma_f32_16x16x32_bf16 v[48:51], a[144:147], a[180:183], v[48:51]
    ds_read_b128 a[176:179], v251 offset:11264
    v_mfma_f32_16x16x32_bf16 v[52:55], a[144:147], a[184:187], v[52:55]
    s_waitcnt lgkmcnt(10)
    s_mov_b32 s39, 414720
    v_mfma_f32_16x16x32_bf16 v[56:59], a[144:147], a[188:191], v[56:59]
    buffer_load_dwordx4 v252, s[24:27], s39 offen offset:3072 lds
    v_mfma_f32_16x16x32_bf16 v[60:63], a[144:147], a[192:195], v[60:63]
    ds_read_b64_tr_b16 a[144:145], v247 offset:32768
    ds_read_b64_tr_b16 a[146:147], v247 offset:34816
    v_mfma_f32_16x16x32_bf16 v[64:67], a[148:151], a[180:183], v[64:67]
    v_mfma_f32_16x16x32_bf16 v[68:71], a[148:151], a[184:187], v[68:71]
    s_waitcnt vmcnt(12)
    s_add_u32 m0, s36, 28544
    s_mov_b32 s39, 393216
    v_mfma_f32_16x16x32_bf16 v[72:75], a[148:151], a[188:191], v[72:75]
    buffer_load_dwordx4 v252, s[24:27], s39 offen offset:128 lds
    v_mfma_f32_16x16x32_bf16 v[76:79], a[148:151], a[192:195], v[76:79]
    ds_read_b64_tr_b16 a[148:149], v244 offset:36864
    ds_read_b64_tr_b16 a[150:151], v244 offset:38912
    v_mfma_f32_16x16x32_bf16 v[80:83], a[152:155], a[180:183], v[80:83]
    v_mfma_f32_16x16x32_bf16 v[84:87], a[152:155], a[184:187], v[84:87]
    s_mov_b32 s39, 400384
    v_mfma_f32_16x16x32_bf16 v[88:91], a[152:155], a[188:191], v[88:91]
    buffer_load_dwordx4 v252, s[24:27], s39 offen offset:1152 lds
    v_mfma_f32_16x16x32_bf16 v[92:95], a[152:155], a[192:195], v[92:95]
    ds_read_b64_tr_b16 a[152:153], v245 offset:36864
    ds_read_b64_tr_b16 a[154:155], v245 offset:38912
    v_mfma_f32_16x16x32_bf16 v[96:99], a[156:159], a[180:183], v[96:99]
    v_mfma_f32_16x16x32_bf16 v[100:103], a[156:159], a[184:187], v[100:103]
    s_mov_b32 s39, 407552
    v_mfma_f32_16x16x32_bf16 v[104:107], a[156:159], a[188:191], v[104:107]
    buffer_load_dwordx4 v252, s[24:27], s39 offen offset:2176 lds
    v_mfma_f32_16x16x32_bf16 v[108:111], a[156:159], a[192:195], v[108:111]
    ds_read_b64_tr_b16 a[156:157], v246 offset:36864
    ds_read_b64_tr_b16 a[158:159], v246 offset:38912
    v_mfma_f32_16x16x32_bf16 v[112:115], a[160:163], a[180:183], v[112:115]
    v_mfma_f32_16x16x32_bf16 v[116:119], a[160:163], a[184:187], v[116:119]
    s_waitcnt lgkmcnt(6)
    s_mov_b32 s39, 414720
    v_mfma_f32_16x16x32_bf16 v[120:123], a[160:163], a[188:191], v[120:123]
    buffer_load_dwordx4 v252, s[24:27], s39 offen offset:3200 lds
    v_mfma_f32_16x16x32_bf16 v[124:127], a[160:163], a[192:195], v[124:127]
    ds_read_b64_tr_b16 a[160:161], v247 offset:36864
    ds_read_b64_tr_b16 a[162:163], v247 offset:38912
    v_mfma_f32_16x16x32_bf16 v[0:3], a[132:135], a[164:167], v[0:3]
    ds_read_b128 a[180:183], v251 offset:12288
    v_mfma_f32_16x16x32_bf16 v[4:7], a[132:135], a[168:171], v[4:7]
    s_waitcnt vmcnt(12)
    s_add_u32 m0, s36, 32768
    s_mov_b32 s39, 425984
    v_mfma_f32_16x16x32_bf16 v[8:11], a[132:135], a[172:175], v[8:11]
    buffer_load_dwordx4 v252, s[24:27], s39 offen offset:0 lds
    v_mfma_f32_16x16x32_bf16 v[12:15], a[132:135], a[176:179], v[12:15]
    ds_read_b64_tr_b16 a[132:133], v244 offset:16384
    ds_read_b64_tr_b16 a[134:135], v244 offset:18432
    v_mfma_f32_16x16x32_bf16 v[16:19], a[136:139], a[164:167], v[16:19]
    ds_read_b128 a[184:187], v251 offset:13312
    v_mfma_f32_16x16x32_bf16 v[20:23], a[136:139], a[168:171], v[20:23]
    s_mov_b32 s39, 433152
    v_mfma_f32_16x16x32_bf16 v[24:27], a[136:139], a[172:175], v[24:27]
    buffer_load_dwordx4 v252, s[24:27], s39 offen offset:1024 lds
    v_mfma_f32_16x16x32_bf16 v[28:31], a[136:139], a[176:179], v[28:31]
    ds_read_b64_tr_b16 a[136:137], v245 offset:16384
    ds_read_b64_tr_b16 a[138:139], v245 offset:18432
    v_mfma_f32_16x16x32_bf16 v[32:35], a[140:143], a[164:167], v[32:35]
    ds_read_b128 a[188:191], v251 offset:14336
    v_mfma_f32_16x16x32_bf16 v[36:39], a[140:143], a[168:171], v[36:39]
    s_mov_b32 s39, 440320
    v_mfma_f32_16x16x32_bf16 v[40:43], a[140:143], a[172:175], v[40:43]
    buffer_load_dwordx4 v252, s[24:27], s39 offen offset:2048 lds
    v_mfma_f32_16x16x32_bf16 v[44:47], a[140:143], a[176:179], v[44:47]
    ds_read_b64_tr_b16 a[140:141], v246 offset:16384
    ds_read_b64_tr_b16 a[142:143], v246 offset:18432
    v_mfma_f32_16x16x32_bf16 v[48:51], a[144:147], a[164:167], v[48:51]
    ds_read_b128 a[192:195], v251 offset:15360
    v_mfma_f32_16x16x32_bf16 v[52:55], a[144:147], a[168:171], v[52:55]
    s_waitcnt lgkmcnt(10)
    s_mov_b32 s39, 447488
    v_mfma_f32_16x16x32_bf16 v[56:59], a[144:147], a[172:175], v[56:59]
    buffer_load_dwordx4 v252, s[24:27], s39 offen offset:3072 lds
    v_mfma_f32_16x16x32_bf16 v[60:63], a[144:147], a[176:179], v[60:63]
    ds_read_b64_tr_b16 a[144:145], v247 offset:16384
    ds_read_b64_tr_b16 a[146:147], v247 offset:18432
    v_mfma_f32_16x16x32_bf16 v[64:67], a[148:151], a[164:167], v[64:67]
    v_mfma_f32_16x16x32_bf16 v[68:71], a[148:151], a[168:171], v[68:71]
    s_waitcnt vmcnt(12)
    s_add_u32 m0, s36, 36736
    s_mov_b32 s39, 425984
    v_mfma_f32_16x16x32_bf16 v[72:75], a[148:151], a[172:175], v[72:75]
    buffer_load_dwordx4 v252, s[24:27], s39 offen offset:128 lds
    v_mfma_f32_16x16x32_bf16 v[76:79], a[148:151], a[176:179], v[76:79]
    ds_read_b64_tr_b16 a[148:149], v244 offset:20480
    ds_read_b64_tr_b16 a[150:151], v244 offset:22528
    v_mfma_f32_16x16x32_bf16 v[80:83], a[152:155], a[164:167], v[80:83]
    v_mfma_f32_16x16x32_bf16 v[84:87], a[152:155], a[168:171], v[84:87]
    s_mov_b32 s39, 433152
    v_mfma_f32_16x16x32_bf16 v[88:91], a[152:155], a[172:175], v[88:91]
    buffer_load_dwordx4 v252, s[24:27], s39 offen offset:1152 lds
    v_mfma_f32_16x16x32_bf16 v[92:95], a[152:155], a[176:179], v[92:95]
    ds_read_b64_tr_b16 a[152:153], v245 offset:20480
    ds_read_b64_tr_b16 a[154:155], v245 offset:22528
    v_mfma_f32_16x16x32_bf16 v[96:99], a[156:159], a[164:167], v[96:99]
    v_mfma_f32_16x16x32_bf16 v[100:103], a[156:159], a[168:171], v[100:103]
    s_mov_b32 s39, 440320
    v_mfma_f32_16x16x32_bf16 v[104:107], a[156:159], a[172:175], v[104:107]
    buffer_load_dwordx4 v252, s[24:27], s39 offen offset:2176 lds
    v_mfma_f32_16x16x32_bf16 v[108:111], a[156:159], a[176:179], v[108:111]
    ds_read_b64_tr_b16 a[156:157], v246 offset:20480
    ds_read_b64_tr_b16 a[158:159], v246 offset:22528
    v_mfma_f32_16x16x32_bf16 v[112:115], a[160:163], a[164:167], v[112:115]
    v_mfma_f32_16x16x32_bf16 v[116:119], a[160:163], a[168:171], v[116:119]
    s_waitcnt lgkmcnt(6)
    s_mov_b32 s39, 447488
    v_mfma_f32_16x16x32_bf16 v[120:123], a[160:163], a[172:175], v[120:123]
    buffer_load_dwordx4 v252, s[24:27], s39 offen offset:3200 lds
    v_mfma_f32_16x16x32_bf16 v[124:127], a[160:163], a[176:179], v[124:127]
    ds_read_b64_tr_b16 a[160:161], v247 offset:20480
    ds_read_b64_tr_b16 a[162:163], v247 offset:22528
    v_mfma_f32_16x16x32_bf16 v[0:3], a[132:135], a[180:183], v[0:3]
    ds_read_b128 a[164:167], v251 offset:40960
    v_mfma_f32_16x16x32_bf16 v[4:7], a[132:135], a[184:187], v[4:7]
    s_waitcnt vmcnt(12)
    s_add_u32 m0, s36, 16384
    s_mov_b32 s39, 458752
    v_mfma_f32_16x16x32_bf16 v[8:11], a[132:135], a[188:191], v[8:11]
    buffer_load_dwordx4 v252, s[24:27], s39 offen offset:0 lds
    v_mfma_f32_16x16x32_bf16 v[12:15], a[132:135], a[192:195], v[12:15]
    ds_read_b64_tr_b16 a[132:133], v244 offset:24576
    ds_read_b64_tr_b16 a[134:135], v244 offset:26624
    v_mfma_f32_16x16x32_bf16 v[16:19], a[136:139], a[180:183], v[16:19]
    ds_read_b128 a[168:171], v251 offset:41984
    v_mfma_f32_16x16x32_bf16 v[20:23], a[136:139], a[184:187], v[20:23]
    s_mov_b32 s39, 465920
    v_mfma_f32_16x16x32_bf16 v[24:27], a[136:139], a[188:191], v[24:27]
    buffer_load_dwordx4 v252, s[24:27], s39 offen offset:1024 lds
    v_mfma_f32_16x16x32_bf16 v[28:31], a[136:139], a[192:195], v[28:31]
    ds_read_b64_tr_b16 a[136:137], v245 offset:24576
    ds_read_b64_tr_b16 a[138:139], v245 offset:26624
    v_mfma_f32_16x16x32_bf16 v[32:35], a[140:143], a[180:183], v[32:35]
    ds_read_b128 a[172:175], v251 offset:43008
    v_mfma_f32_16x16x32_bf16 v[36:39], a[140:143], a[184:187], v[36:39]
    s_mov_b32 s39, 473088
    v_mfma_f32_16x16x32_bf16 v[40:43], a[140:143], a[188:191], v[40:43]
    buffer_load_dwordx4 v252, s[24:27], s39 offen offset:2048 lds
    v_mfma_f32_16x16x32_bf16 v[44:47], a[140:143], a[192:195], v[44:47]
    ds_read_b64_tr_b16 a[140:141], v246 offset:24576
    ds_read_b64_tr_b16 a[142:143], v246 offset:26624
    v_mfma_f32_16x16x32_bf16 v[48:51], a[144:147], a[180:183], v[48:51]
    ds_read_b128 a[176:179], v251 offset:44032
    v_mfma_f32_16x16x32_bf16 v[52:55], a[144:147], a[184:187], v[52:55]
    s_waitcnt lgkmcnt(10)
    s_mov_b32 s39, 480256
    v_mfma_f32_16x16x32_bf16 v[56:59], a[144:147], a[188:191], v[56:59]
    buffer_load_dwordx4 v252, s[24:27], s39 offen offset:3072 lds
    v_mfma_f32_16x16x32_bf16 v[60:63], a[144:147], a[192:195], v[60:63]
    ds_read_b64_tr_b16 a[144:145], v247 offset:24576
    ds_read_b64_tr_b16 a[146:147], v247 offset:26624
    v_mfma_f32_16x16x32_bf16 v[64:67], a[148:151], a[180:183], v[64:67]
    v_mfma_f32_16x16x32_bf16 v[68:71], a[148:151], a[184:187], v[68:71]
    s_waitcnt vmcnt(12)
    s_add_u32 m0, s36, 20352
    s_mov_b32 s39, 458752
    v_mfma_f32_16x16x32_bf16 v[72:75], a[148:151], a[188:191], v[72:75]
    buffer_load_dwordx4 v252, s[24:27], s39 offen offset:128 lds
    v_mfma_f32_16x16x32_bf16 v[76:79], a[148:151], a[192:195], v[76:79]
    ds_read_b64_tr_b16 a[148:149], v244 offset:28672
    ds_read_b64_tr_b16 a[150:151], v244 offset:30720
    v_mfma_f32_16x16x32_bf16 v[80:83], a[152:155], a[180:183], v[80:83]
    v_mfma_f32_16x16x32_bf16 v[84:87], a[152:155], a[184:187], v[84:87]
    s_mov_b32 s39, 465920
    v_mfma_f32_16x16x32_bf16 v[88:91], a[152:155], a[188:191], v[88:91]
    buffer_load_dwordx4 v252, s[24:27], s39 offen offset:1152 lds
    v_mfma_f32_16x16x32_bf16 v[92:95], a[152:155], a[192:195], v[92:95]
    ds_read_b64_tr_b16 a[152:153], v245 offset:28672
    ds_read_b64_tr_b16 a[154:155], v245 offset:30720
    v_mfma_f32_16x16x32_bf16 v[96:99], a[156:159], a[180:183], v[96:99]
    v_mfma_f32_16x16x32_bf16 v[100:103], a[156:159], a[184:187], v[100:103]
    s_mov_b32 s39, 473088
    v_mfma_f32_16x16x32_bf16 v[104:107], a[156:159], a[188:191], v[104:107]
    buffer_load_dwordx4 v252, s[24:27], s39 offen offset:2176 lds
    v_mfma_f32_16x16x32_bf16 v[108:111], a[156:159], a[192:195], v[108:111]
    ds_read_b64_tr_b16 a[156:157], v246 offset:28672
    ds_read_b64_tr_b16 a[158:159], v246 offset:30720
    v_mfma_f32_16x16x32_bf16 v[112:115], a[160:163], a[180:183], v[112:115]
    v_mfma_f32_16x16x32_bf16 v[116:119], a[160:163], a[184:187], v[116:119]
    s_waitcnt lgkmcnt(6)
    s_mov_b32 s39, 480256
    v_mfma_f32_16x16x32_bf16 v[120:123], a[160:163], a[188:191], v[120:123]
    buffer_load_dwordx4 v252, s[24:27], s39 offen offset:3200 lds
    v_mfma_f32_16x16x32_bf16 v[124:127], a[160:163], a[192:195], v[124:127]
    ds_read_b64_tr_b16 a[160:161], v247 offset:28672
    ds_read_b64_tr_b16 a[162:163], v247 offset:30720
    v_mfma_f32_16x16x32_bf16 v[0:3], a[132:135], a[164:167], v[0:3]
    ds_read_b128 a[180:183], v251 offset:45056
    v_mfma_f32_16x16x32_bf16 v[4:7], a[132:135], a[168:171], v[4:7]
    s_waitcnt vmcnt(12)
    s_add_u32 m0, s36, 24576
    s_mov_b32 s39, 491520
    v_mfma_f32_16x16x32_bf16 v[8:11], a[132:135], a[172:175], v[8:11]
    buffer_load_dwordx4 v252, s[24:27], s39 offen offset:0 lds
    v_mfma_f32_16x16x32_bf16 v[12:15], a[132:135], a[176:179], v[12:15]
    ds_read_b64_tr_b16 a[132:133], v244 offset:32768
    ds_read_b64_tr_b16 a[134:135], v244 offset:34816
    v_mfma_f32_16x16x32_bf16 v[16:19], a[136:139], a[164:167], v[16:19]
    ds_read_b128 a[184:187], v251 offset:46080
    v_mfma_f32_16x16x32_bf16 v[20:23], a[136:139], a[168:171], v[20:23]
    s_mov_b32 s39, 498688
    v_mfma_f32_16x16x32_bf16 v[24:27], a[136:139], a[172:175], v[24:27]
    buffer_load_dwordx4 v252, s[24:27], s39 offen offset:1024 lds
    v_mfma_f32_16x16x32_bf16 v[28:31], a[136:139], a[176:179], v[28:31]
    ds_read_b64_tr_b16 a[136:137], v245 offset:32768
    ds_read_b64_tr_b16 a[138:139], v245 offset:34816
    v_mfma_f32_16x16x32_bf16 v[32:35], a[140:143], a[164:167], v[32:35]
    ds_read_b128 a[188:191], v251 offset:47104
    v_mfma_f32_16x16x32_bf16 v[36:39], a[140:143], a[168:171], v[36:39]
    s_mov_b32 s39, 505856
    v_mfma_f32_16x16x32_bf16 v[40:43], a[140:143], a[172:175], v[40:43]
    buffer_load_dwordx4 v252, s[24:27], s39 offen offset:2048 lds
    v_mfma_f32_16x16x32_bf16 v[44:47], a[140:143], a[176:179], v[44:47]
    ds_read_b64_tr_b16 a[140:141], v246 offset:32768
    ds_read_b64_tr_b16 a[142:143], v246 offset:34816
    v_mfma_f32_16x16x32_bf16 v[48:51], a[144:147], a[164:167], v[48:51]
    ds_read_b128 a[192:195], v251 offset:48128
    v_mfma_f32_16x16x32_bf16 v[52:55], a[144:147], a[168:171], v[52:55]
    s_waitcnt lgkmcnt(10)
    s_mov_b32 s39, 513024
    v_mfma_f32_16x16x32_bf16 v[56:59], a[144:147], a[172:175], v[56:59]
    buffer_load_dwordx4 v252, s[24:27], s39 offen offset:3072 lds
    v_mfma_f32_16x16x32_bf16 v[60:63], a[144:147], a[176:179], v[60:63]
    ds_read_b64_tr_b16 a[144:145], v247 offset:32768
    ds_read_b64_tr_b16 a[146:147], v247 offset:34816
    v_mfma_f32_16x16x32_bf16 v[64:67], a[148:151], a[164:167], v[64:67]
    v_mfma_f32_16x16x32_bf16 v[68:71], a[148:151], a[168:171], v[68:71]
    s_waitcnt vmcnt(12)
    s_add_u32 m0, s36, 28544
    s_mov_b32 s39, 491520
    v_mfma_f32_16x16x32_bf16 v[72:75], a[148:151], a[172:175], v[72:75]
    buffer_load_dwordx4 v252, s[24:27], s39 offen offset:128 lds
    v_mfma_f32_16x16x32_bf16 v[76:79], a[148:151], a[176:179], v[76:79]
    ds_read_b64_tr_b16 a[148:149], v244 offset:36864
    ds_read_b64_tr_b16 a[150:151], v244 offset:38912
    v_mfma_f32_16x16x32_bf16 v[80:83], a[152:155], a[164:167], v[80:83]
    v_mfma_f32_16x16x32_bf16 v[84:87], a[152:155], a[168:171], v[84:87]
    s_mov_b32 s39, 498688
    v_mfma_f32_16x16x32_bf16 v[88:91], a[152:155], a[172:175], v[88:91]
    buffer_load_dwordx4 v252, s[24:27], s39 offen offset:1152 lds
    v_mfma_f32_16x16x32_bf16 v[92:95], a[152:155], a[176:179], v[92:95]
    ds_read_b64_tr_b16 a[152:153], v245 offset:36864
    ds_read_b64_tr_b16 a[154:155], v245 offset:38912
    v_mfma_f32_16x16x32_bf16 v[96:99], a[156:159], a[164:167], v[96:99]
    v_mfma_f32_16x16x32_bf16 v[100:103], a[156:159], a[168:171], v[100:103]
    s_mov_b32 s39, 505856
    v_mfma_f32_16x16x32_bf16 v[104:107], a[156:159], a[172:175], v[104:107]
    buffer_load_dwordx4 v252, s[24:27], s39 offen offset:2176 lds
    v_mfma_f32_16x16x32_bf16 v[108:111], a[156:159], a[176:179], v[108:111]
    ds_read_b64_tr_b16 a[156:157], v246 offset:36864
    ds_read_b64_tr_b16 a[158:159], v246 offset:38912
    v_mfma_f32_16x16x32_bf16 v[112:115], a[160:163], a[164:167], v[112:115]
    v_mfma_f32_16x16x32_bf16 v[116:119], a[160:163], a[168:171], v[116:119]
    s_waitcnt lgkmcnt(6)
    s_mov_b32 s39, 513024
    v_mfma_f32_16x16x32_bf16 v[120:123], a[160:163], a[172:175], v[120:123]
    buffer_load_dwordx4 v252, s[24:27], s39 offen offset:3200 lds
    v_mfma_f32_16x16x32_bf16 v[124:127], a[160:163], a[176:179], v[124:127]
    ds_read_b64_tr_b16 a[160:161], v247 offset:36864
    ds_read_b64_tr_b16 a[162:163], v247 offset:38912
    v_mfma_f32_16x16x32_bf16 v[0:3], a[132:135], a[180:183], v[0:3]
    ds_read_b128 a[164:167], v251 offset:49152
    v_mfma_f32_16x16x32_bf16 v[4:7], a[132:135], a[184:187], v[4:7]
    s_waitcnt vmcnt(12)
    s_add_u32 m0, s36, 32768
    s_add_u32 s39, s78, 0
    v_mfma_f32_16x16x32_bf16 v[8:11], a[132:135], a[188:191], v[8:11]
    buffer_load_dwordx4 v248, s[16:19], s39 offen offset:0 lds
    v_mfma_f32_16x16x32_bf16 v[12:15], a[132:135], a[192:195], v[12:15]
    ds_read_b64_tr_b16 a[132:133], v244 offset:16384
    ds_read_b64_tr_b16 a[134:135], v244 offset:18432
    v_mfma_f32_16x16x32_bf16 v[16:19], a[136:139], a[180:183], v[16:19]
    ds_read_b128 a[168:171], v251 offset:50176
    v_mfma_f32_16x16x32_bf16 v[20:23], a[136:139], a[184:187], v[20:23]
    s_add_u32 s39, s78, 7168
    v_mfma_f32_16x16x32_bf16 v[24:27], a[136:139], a[188:191], v[24:27]
    buffer_load_dwordx4 v248, s[16:19], s39 offen offset:1024 lds
    v_mfma_f32_16x16x32_bf16 v[28:31], a[136:139], a[192:195], v[28:31]
    ds_read_b64_tr_b16 a[136:137], v245 offset:16384
    ds_read_b64_tr_b16 a[138:139], v245 offset:18432
    v_mfma_f32_16x16x32_bf16 v[32:35], a[140:143], a[180:183], v[32:35]
    ds_read_b128 a[172:175], v251 offset:51200
    v_mfma_f32_16x16x32_bf16 v[36:39], a[140:143], a[184:187], v[36:39]
    s_add_u32 s39, s78, 14336
    v_mfma_f32_16x16x32_bf16 v[40:43], a[140:143], a[188:191], v[40:43]
    buffer_load_dwordx4 v248, s[16:19], s39 offen offset:2048 lds
    v_mfma_f32_16x16x32_bf16 v[44:47], a[140:143], a[192:195], v[44:47]
    ds_read_b64_tr_b16 a[140:141], v246 offset:16384
    ds_read_b64_tr_b16 a[142:143], v246 offset:18432
    v_mfma_f32_16x16x32_bf16 v[48:51], a[144:147], a[180:183], v[48:51]
    ds_read_b128 a[176:179], v251 offset:52224
    v_mfma_f32_16x16x32_bf16 v[52:55], a[144:147], a[184:187], v[52:55]
    s_waitcnt lgkmcnt(10)
    s_add_u32 s39, s78, 21504
    v_mfma_f32_16x16x32_bf16 v[56:59], a[144:147], a[188:191], v[56:59]
    buffer_load_dwordx4 v248, s[16:19], s39 offen offset:3072 lds
    v_mfma_f32_16x16x32_bf16 v[60:63], a[144:147], a[192:195], v[60:63]
    ds_read_b64_tr_b16 a[144:145], v247 offset:16384
    ds_read_b64_tr_b16 a[146:147], v247 offset:18432
    v_mfma_f32_16x16x32_bf16 v[64:67], a[148:151], a[180:183], v[64:67]
    v_mfma_f32_16x16x32_bf16 v[68:71], a[148:151], a[184:187], v[68:71]
    s_waitcnt vmcnt(12)
    s_add_u32 m0, s36, 36864
    s_add_u32 s39, s78, 32768
    v_mfma_f32_16x16x32_bf16 v[72:75], a[148:151], a[188:191], v[72:75]
    buffer_load_dwordx4 v248, s[16:19], s39 offen offset:0 lds
    v_mfma_f32_16x16x32_bf16 v[76:79], a[148:151], a[192:195], v[76:79]
    ds_read_b64_tr_b16 a[148:149], v244 offset:20480
    ds_read_b64_tr_b16 a[150:151], v244 offset:22528
    v_mfma_f32_16x16x32_bf16 v[80:83], a[152:155], a[180:183], v[80:83]
    v_mfma_f32_16x16x32_bf16 v[84:87], a[152:155], a[184:187], v[84:87]
    s_add_u32 s39, s78, 39936
    v_mfma_f32_16x16x32_bf16 v[88:91], a[152:155], a[188:191], v[88:91]
    buffer_load_dwordx4 v248, s[16:19], s39 offen offset:1024 lds
    v_mfma_f32_16x16x32_bf16 v[92:95], a[152:155], a[192:195], v[92:95]
    ds_read_b64_tr_b16 a[152:153], v245 offset:20480
    ds_read_b64_tr_b16 a[154:155], v245 offset:22528
    v_mfma_f32_16x16x32_bf16 v[96:99], a[156:159], a[180:183], v[96:99]
    v_mfma_f32_16x16x32_bf16 v[100:103], a[156:159], a[184:187], v[100:103]
    s_add_u32 s39, s78, 47104
    v_mfma_f32_16x16x32_bf16 v[104:107], a[156:159], a[188:191], v[104:107]
    buffer_load_dwordx4 v248, s[16:19], s39 offen offset:2048 lds
    v_mfma_f32_16x16x32_bf16 v[108:111], a[156:159], a[192:195], v[108:111]
    ds_read_b64_tr_b16 a[156:157], v246 offset:20480
    ds_read_b64_tr_b16 a[158:159], v246 offset:22528
    v_mfma_f32_16x16x32_bf16 v[112:115], a[160:163], a[180:183], v[112:115]
    v_mfma_f32_16x16x32_bf16 v[116:119], a[160:163], a[184:187], v[116:119]
    s_waitcnt lgkmcnt(6)
    s_add_u32 s39, s78, 54272
    v_mfma_f32_16x16x32_bf16 v[120:123], a[160:163], a[188:191], v[120:123]
    buffer_load_dwordx4 v248, s[16:19], s39 offen offset:3072 lds
    v_mfma_f32_16x16x32_bf16 v[124:127], a[160:163], a[192:195], v[124:127]
    ds_read_b64_tr_b16 a[160:161], v247 offset:20480
    ds_read_b64_tr_b16 a[162:163], v247 offset:22528
    v_mfma_f32_16x16x32_bf16 v[0:3], a[132:135], a[164:167], v[0:3]
    ds_read_b128 a[180:183], v251 offset:53248
    v_mfma_f32_16x16x32_bf16 v[4:7], a[132:135], a[168:171], v[4:7]
    s_waitcnt vmcnt(12)
    s_add_u32 m0, s36, 16384
    s_add_u32 s39, s78, 65536
    v_mfma_f32_16x16x32_bf16 v[8:11], a[132:135], a[172:175], v[8:11]
    buffer_load_dwordx4 v248, s[16:19], s39 offen offset:0 lds
    v_mfma_f32_16x16x32_bf16 v[12:15], a[132:135], a[176:179], v[12:15]
    ds_read_b64_tr_b16 a[132:133], v244 offset:24576
    ds_read_b64_tr_b16 a[134:135], v244 offset:26624
    v_mfma_f32_16x16x32_bf16 v[16:19], a[136:139], a[164:167], v[16:19]
    ds_read_b128 a[184:187], v251 offset:54272
    v_mfma_f32_16x16x32_bf16 v[20:23], a[136:139], a[168:171], v[20:23]
    s_add_u32 s39, s78, 72704
    v_mfma_f32_16x16x32_bf16 v[24:27], a[136:139], a[172:175], v[24:27]
    buffer_load_dwordx4 v248, s[16:19], s39 offen offset:1024 lds
    v_mfma_f32_16x16x32_bf16 v[28:31], a[136:139], a[176:179], v[28:31]
    ds_read_b64_tr_b16 a[136:137], v245 offset:24576
    ds_read_b64_tr_b16 a[138:139], v245 offset:26624
    v_mfma_f32_16x16x32_bf16 v[32:35], a[140:143], a[164:167], v[32:35]
    ds_read_b128 a[188:191], v251 offset:55296
    v_mfma_f32_16x16x32_bf16 v[36:39], a[140:143], a[168:171], v[36:39]
    s_add_u32 s39, s78, 79872
    v_mfma_f32_16x16x32_bf16 v[40:43], a[140:143], a[172:175], v[40:43]
    buffer_load_dwordx4 v248, s[16:19], s39 offen offset:2048 lds
    v_mfma_f32_16x16x32_bf16 v[44:47], a[140:143], a[176:179], v[44:47]
    ds_read_b64_tr_b16 a[140:141], v246 offset:24576
    ds_read_b64_tr_b16 a[142:143], v246 offset:26624
    v_mfma_f32_16x16x32_bf16 v[48:51], a[144:147], a[164:167], v[48:51]
    ds_read_b128 a[192:195], v251 offset:56320
    v_mfma_f32_16x16x32_bf16 v[52:55], a[144:147], a[168:171], v[52:55]
    s_waitcnt lgkmcnt(10)
    s_add_u32 s39, s78, 87040
    v_mfma_f32_16x16x32_bf16 v[56:59], a[144:147], a[172:175], v[56:59]
    buffer_load_dwordx4 v248, s[16:19], s39 offen offset:3072 lds
    v_mfma_f32_16x16x32_bf16 v[60:63], a[144:147], a[176:179], v[60:63]
    ds_read_b64_tr_b16 a[144:145], v247 offset:24576
    ds_read_b64_tr_b16 a[146:147], v247 offset:26624
    v_mfma_f32_16x16x32_bf16 v[64:67], a[148:151], a[164:167], v[64:67]
    v_mfma_f32_16x16x32_bf16 v[68:71], a[148:151], a[168:171], v[68:71]
    s_waitcnt vmcnt(12)
    s_add_u32 m0, s36, 20480
    s_add_u32 s39, s78, 98304
    v_mfma_f32_16x16x32_bf16 v[72:75], a[148:151], a[172:175], v[72:75]
    buffer_load_dwordx4 v248, s[16:19], s39 offen offset:0 lds
    v_mfma_f32_16x16x32_bf16 v[76:79], a[148:151], a[176:179], v[76:79]
    ds_read_b64_tr_b16 a[148:149], v244 offset:28672
    ds_read_b64_tr_b16 a[150:151], v244 offset:30720
    v_mfma_f32_16x16x32_bf16 v[80:83], a[152:155], a[164:167], v[80:83]
    v_mfma_f32_16x16x32_bf16 v[84:87], a[152:155], a[168:171], v[84:87]
    s_add_u32 s39, s78, 105472
    v_mfma_f32_16x16x32_bf16 v[88:91], a[152:155], a[172:175], v[88:91]
    buffer_load_dwordx4 v248, s[16:19], s39 offen offset:1024 lds
    v_mfma_f32_16x16x32_bf16 v[92:95], a[152:155], a[176:179], v[92:95]
    ds_read_b64_tr_b16 a[152:153], v245 offset:28672
    ds_read_b64_tr_b16 a[154:155], v245 offset:30720
    v_mfma_f32_16x16x32_bf16 v[96:99], a[156:159], a[164:167], v[96:99]
    v_mfma_f32_16x16x32_bf16 v[100:103], a[156:159], a[168:171], v[100:103]
    s_add_u32 s39, s78, 112640
    v_mfma_f32_16x16x32_bf16 v[104:107], a[156:159], a[172:175], v[104:107]
    buffer_load_dwordx4 v248, s[16:19], s39 offen offset:2048 lds
    v_mfma_f32_16x16x32_bf16 v[108:111], a[156:159], a[176:179], v[108:111]
    ds_read_b64_tr_b16 a[156:157], v246 offset:28672
    ds_read_b64_tr_b16 a[158:159], v246 offset:30720
    v_mfma_f32_16x16x32_bf16 v[112:115], a[160:163], a[164:167], v[112:115]
    v_mfma_f32_16x16x32_bf16 v[116:119], a[160:163], a[168:171], v[116:119]
    s_waitcnt lgkmcnt(6)
    s_add_u32 s39, s78, 119808
    v_mfma_f32_16x16x32_bf16 v[120:123], a[160:163], a[172:175], v[120:123]
    buffer_load_dwordx4 v248, s[16:19], s39 offen offset:3072 lds
    v_mfma_f32_16x16x32_bf16 v[124:127], a[160:163], a[176:179], v[124:127]
    ds_read_b64_tr_b16 a[160:161], v247 offset:28672
    ds_read_b64_tr_b16 a[162:163], v247 offset:30720
    v_mfma_f32_16x16x32_bf16 v[0:3], a[132:135], a[180:183], v[0:3]
    v_mfma_f32_16x16x32_bf16 v[4:7], a[132:135], a[184:187], v[4:7]
    s_add_u32 m0, s36, 24576
    s_add_u32 s39, s79, 0
    v_mfma_f32_16x16x32_bf16 v[8:11], a[132:135], a[188:191], v[8:11]
    buffer_load_dwordx4 v249, s[20:23], s39 offen offset:0 lds
    v_mfma_f32_16x16x32_bf16 v[12:15], a[132:135], a[192:195], v[12:15]
    v_mfma_f32_16x16x32_bf16 v[16:19], a[136:139], a[180:183], v[16:19]
    v_mfma_f32_16x16x32_bf16 v[20:23], a[136:139], a[184:187], v[20:23]
    s_add_u32 s39, s79, 27648
    v_mfma_f32_16x16x32_bf16 v[24:27], a[136:139], a[188:191], v[24:27]
    buffer_load_dwordx4 v249, s[20:23], s39 offen offset:1024 lds
    v_mfma_f32_16x16x32_bf16 v[28:31], a[136:139], a[192:195], v[28:31]
    v_mfma_f32_16x16x32_bf16 v[32:35], a[140:143], a[180:183], v[32:35]
    v_mfma_f32_16x16x32_bf16 v[36:39], a[140:143], a[184:187], v[36:39]
    s_add_u32 s39, s79, 55296
    v_mfma_f32_16x16x32_bf16 v[40:43], a[140:143], a[188:191], v[40:43]
    buffer_load_dwordx4 v249, s[20:23], s39 offen offset:2048 lds
    v_mfma_f32_16x16x32_bf16 v[44:47], a[140:143], a[192:195], v[44:47]
    v_mfma_f32_16x16x32_bf16 v[48:51], a[144:147], a[180:183], v[48:51]
    v_mfma_f32_16x16x32_bf16 v[52:55], a[144:147], a[184:187], v[52:55]
    s_waitcnt lgkmcnt(0)
    s_add_u32 s39, s79, 82944
    v_mfma_f32_16x16x32_bf16 v[56:59], a[144:147], a[188:191], v[56:59]
    buffer_load_dwordx4 v249, s[20:23], s39 offen offset:3072 lds
    v_mfma_f32_16x16x32_bf16 v[60:63], a[144:147], a[192:195], v[60:63]
    v_mfma_f32_16x16x32_bf16 v[64:67], a[148:151], a[180:183], v[64:67]
    v_mfma_f32_16x16x32_bf16 v[68:71], a[148:151], a[184:187], v[68:71]
    s_add_u32 m0, s36, 28672
    s_add_u32 s39, s79, 114688
    v_mfma_f32_16x16x32_bf16 v[72:75], a[148:151], a[188:191], v[72:75]
    buffer_load_dwordx4 v249, s[20:23], s39 offen offset:0 lds
    v_mfma_f32_16x16x32_bf16 v[76:79], a[148:151], a[192:195], v[76:79]
    v_mfma_f32_16x16x32_bf16 v[80:83], a[152:155], a[180:183], v[80:83]
    v_mfma_f32_16x16x32_bf16 v[84:87], a[152:155], a[184:187], v[84:87]
    s_add_u32 s39, s79, 142336
    v_mfma_f32_16x16x32_bf16 v[88:91], a[152:155], a[188:191], v[88:91]
    buffer_load_dwordx4 v249, s[20:23], s39 offen offset:1024 lds
    v_mfma_f32_16x16x32_bf16 v[92:95], a[152:155], a[192:195], v[92:95]
    v_mfma_f32_16x16x32_bf16 v[96:99], a[156:159], a[180:183], v[96:99]
    v_mfma_f32_16x16x32_bf16 v[100:103], a[156:159], a[184:187], v[100:103]
    s_add_u32 s39, s79, 169984
    v_mfma_f32_16x16x32_bf16 v[104:107], a[156:159], a[188:191], v[104:107]
    buffer_load_dwordx4 v249, s[20:23], s39 offen offset:2048 lds
    v_mfma_f32_16x16x32_bf16 v[108:111], a[156:159], a[192:195], v[108:111]
    v_mfma_f32_16x16x32_bf16 v[112:115], a[160:163], a[180:183], v[112:115]
    v_mfma_f32_16x16x32_bf16 v[116:119], a[160:163], a[184:187], v[116:119]
    s_add_u32 s39, s79, 197632
    v_mfma_f32_16x16x32_bf16 v[120:123], a[160:163], a[188:191], v[120:123]
    buffer_load_dwordx4 v249, s[20:23], s39 offen offset:3072 lds
    v_mfma_f32_16x16x32_bf16 v[124:127], a[160:163], a[192:195], v[124:127]
    s_lshl_b32 s45, s74, 21
    s_lshl_b32 s46, s75, 16
    s_add_u32 s45, s45, s46
    s_lshl_b32 s46, s3, 12
    s_add_u32 s45, s45, s46
    s_add_u32 s45, s45, 4194304
    s_mov_b32 s44, s45
    v_cvt_pk_bf16_f32 v128, v0, v1
    v_cvt_pk_bf16_f32 v129, v2, v3
    v_cvt_pk_bf16_f32 v130, v16, v17
    v_cvt_pk_bf16_f32 v131, v18, v19
    buffer_store_dwordx4 v[128:131], v250, s[28:31], s44 offen offset:0 sc1
    v_cvt_pk_bf16_f32 v132, v32, v33
    v_cvt_pk_bf16_f32 v133, v34, v35
    v_cvt_pk_bf16_f32 v134, v48, v49
    v_cvt_pk_bf16_f32 v135, v50, v51
    buffer_store_dwordx4 v[132:135], v250, s[28:31], s44 offen offset:1024 sc1
    v_cvt_pk_bf16_f32 v136, v64, v65
    v_cvt_pk_bf16_f32 v137, v66, v67
    v_cvt_pk_bf16_f32 v138, v80, v81
    v_cvt_pk_bf16_f32 v139, v82, v83
    buffer_store_dwordx4 v[136:139], v250, s[28:31], s44 offen offset:2048 sc1
    v_cvt_pk_bf16_f32 v140, v96, v97
    v_cvt_pk_bf16_f32 v141, v98, v99
    v_cvt_pk_bf16_f32 v142, v112, v113
    v_cvt_pk_bf16_f32 v143, v114, v115
    buffer_store_dwordx4 v[140:143], v250, s[28:31], s44 offen offset:3072 sc1
    s_add_u32 s44, s44, 0x4000
    v_cvt_pk_bf16_f32 v144, v4, v5
    v_cvt_pk_bf16_f32 v145, v6, v7
    v_cvt_pk_bf16_f32 v146, v20, v21
    v_cvt_pk_bf16_f32 v147, v22, v23
    buffer_store_dwordx4 v[144:147], v250, s[28:31], s44 offen offset:0 sc1
    v_cvt_pk_bf16_f32 v148, v36, v37
    v_cvt_pk_bf16_f32 v149, v38, v39
    v_cvt_pk_bf16_f32 v150, v52, v53
    v_cvt_pk_bf16_f32 v151, v54, v55
    buffer_store_dwordx4 v[148:151], v250, s[28:31], s44 offen offset:1024 sc1
    v_cvt_pk_bf16_f32 v152, v68, v69
    v_cvt_pk_bf16_f32 v153, v70, v71
    v_cvt_pk_bf16_f32 v154, v84, v85
    v_cvt_pk_bf16_f32 v155, v86, v87
    buffer_store_dwordx4 v[152:155], v250, s[28:31], s44 offen offset:2048 sc1
    v_cvt_pk_bf16_f32 v156, v100, v101
    v_cvt_pk_bf16_f32 v157, v102, v103
    v_cvt_pk_bf16_f32 v158, v116, v117
    v_cvt_pk_bf16_f32 v159, v118, v119
    buffer_store_dwordx4 v[156:159], v250, s[28:31], s44 offen offset:3072 sc1
    s_add_u32 s44, s44, 0x4000
    v_cvt_pk_bf16_f32 v160, v8, v9
    v_cvt_pk_bf16_f32 v161, v10, v11
    v_cvt_pk_bf16_f32 v162, v24, v25
    v_cvt_pk_bf16_f32 v163, v26, v27
    buffer_store_dwordx4 v[160:163], v250, s[28:31], s44 offen offset:0 sc1
    v_cvt_pk_bf16_f32 v164, v40, v41
    v_cvt_pk_bf16_f32 v165, v42, v43
    v_cvt_pk_bf16_f32 v166, v56, v57
    v_cvt_pk_bf16_f32 v167, v58, v59
    buffer_store_dwordx4 v[164:167], v250, s[28:31], s44 offen offset:1024 sc1
    v_cvt_pk_bf16_f32 v168, v72, v73
    v_cvt_pk_bf16_f32 v169, v74, v75
    v_cvt_pk_bf16_f32 v170, v88, v89
    v_cvt_pk_bf16_f32 v171, v90, v91
    buffer_store_dwordx4 v[168:171], v250, s[28:31], s44 offen offset:2048 sc1
    v_cvt_pk_bf16_f32 v172, v104, v105
    v_cvt_pk_bf16_f32 v173, v106, v107
    v_cvt_pk_bf16_f32 v174, v120, v121
    v_cvt_pk_bf16_f32 v175, v122, v123
    buffer_store_dwordx4 v[172:175], v250, s[28:31], s44 offen offset:3072 sc1
    s_add_u32 s44, s44, 0x4000
    v_cvt_pk_bf16_f32 v176, v12, v13
    v_cvt_pk_bf16_f32 v177, v14, v15
    v_cvt_pk_bf16_f32 v178, v28, v29
    v_cvt_pk_bf16_f32 v179, v30, v31
    buffer_store_dwordx4 v[176:179], v250, s[28:31], s44 offen offset:0 sc1
    v_cvt_pk_bf16_f32 v180, v44, v45
    v_cvt_pk_bf16_f32 v181, v46, v47
    v_cvt_pk_bf16_f32 v182, v60, v61
    v_cvt_pk_bf16_f32 v183, v62, v63
    buffer_store_dwordx4 v[180:183], v250, s[28:31], s44 offen offset:1024 sc1
    v_cvt_pk_bf16_f32 v184, v76, v77
    v_cvt_pk_bf16_f32 v185, v78, v79
    v_cvt_pk_bf16_f32 v186, v92, v93
    v_cvt_pk_bf16_f32 v187, v94, v95
    buffer_store_dwordx4 v[184:187], v250, s[28:31], s44 offen offset:2048 sc1
    v_cvt_pk_bf16_f32 v188, v108, v109
    v_cvt_pk_bf16_f32 v189, v110, v111
    v_cvt_pk_bf16_f32 v190, v124, v125
    v_cvt_pk_bf16_f32 v191, v126, v127
    buffer_store_dwordx4 v[188:191], v250, s[28:31], s44 offen offset:3072 sc1
    v_lshrrev_b32 v253, 4, v250
    v_and_b32 v201, 7, v253
    v_bfe_u32 v202, v253, 3, 2
    v_bfe_u32 v203, v253, 5, 1
    v_lshlrev_b32 v193, 10, v201
    v_lshl_add_u32 v193, v203, 6, v193
    v_lshl_add_u32 v193, v202, 3, v193
    v_lshlrev_b32 v194, 7, v203
    v_lshl_add_u32 v194, v202, 4, v194
    s_lshl_b32 s44, s42, 5
    s_add_u32 s44, s44, s43
    s_lshl_b32 s44, s44, 13
    s_lshl_b32 s45, s3, 8
    s_add_u32 s44, s44, s45
    s_lshl_b32 s45, s3, 9
    s_add_u32 s45, s45, 4096
    s_waitcnt vmcnt(24)
    s_barrier
L_kf_cen_20:
    v_lshrrev_b32 v187, 16, v227
    v_cmp_ne_u32 vcc, 32, v187
    s_cbranch_vccz L_kf_all_21
    s_sleep 1
    v_lshlrev_b32 v186, 3, v201
    global_load_dwordx2 v[226:227], v186, s[98:99] sc1
    s_sub_i32 s52, s52, 1
    s_cmp_gt_i32 s52, 0
    s_waitcnt vmcnt(0)
    s_cbranch_scc1 L_kf_cen_20
L_kf_all_21:
    v_mov_b32 v184, v226
    v_mov_b32 v185, v227
    v_lshlrev_b32 v192, 4, v201
    v_lshl_add_u32 v192, v202, 8, v192
    v_lshl_add_u32 v192, v203, 10, v192
    v_lshlrev_b32 v234, 2, v201
    v_lshlrev_b32 v186, 3, v201
    v_add_u32 v195, 28672, v186
    v_add_u32 v196, 81920, v195
    v_add_u32 v197, s36, v195
    v_mov_b32 v198, 0x3727c5ac
    v_mov_b32 v235, s51
    v_lshrrev_b32 v168, 4, v253
    v_bfe_u32 v169, v253, 2, 2
    v_and_b32 v170, 1, v253
    v_lshlrev_b32 v170, 4, v170
    v_mov_b32 v171, 0x3f80
    v_lshlrev_b32 v170, v170, v171
    v_cmp_eq_u32 vcc, v168, v169
    s_nop 1
    v_cndmask_b32 v170, 0, v170, vcc
    v_and_b32 v171, 2, v253
    v_cmp_eq_u32 vcc, 0, v171
    s_nop 1
    v_cndmask_b32 v226, 0, v170, vcc
    v_cndmask_b32 v227, v170, 0, vcc
    v_mov_b32 v224, 0
    v_mov_b32 v225, 0
    v_mov_b32 v228, 0
    v_mov_b32 v229, 0
    s_sub_u32 s46, 16384, s36
    v_add_u32 v236, s46, v244
    v_add_u32 v237, 81920, v236
    v_add_u32 v238, s46, v245
    v_add_u32 v239, 81920, v238
    v_add_u32 v240, s46, v246
    v_add_u32 v241, 81920, v240
    v_add_u32 v242, s46, v247
    v_add_u32 v243, 81920, v242
    ds_read_b64_tr_b16 a[96:97], v236 offset:16384
    ds_read_b64_tr_b16 a[98:99], v236 offset:18432
    ds_read_b64_tr_b16 a[100:101], v238 offset:16384
    ds_read_b64_tr_b16 a[102:103], v238 offset:18432
    ds_read_b64_tr_b16 a[104:105], v240 offset:16384
    ds_read_b64_tr_b16 a[106:107], v240 offset:18432
    ds_read_b64_tr_b16 a[108:109], v242 offset:16384
    ds_read_b64_tr_b16 a[110:111], v242 offset:18432
    ds_read_b64_tr_b16 a[112:113], v236 offset:20480
    ds_read_b64_tr_b16 a[114:115], v236 offset:22528
    ds_read_b64_tr_b16 a[116:117], v238 offset:20480
    ds_read_b64_tr_b16 a[118:119], v238 offset:22528
    ds_read_b64_tr_b16 a[120:121], v240 offset:20480
    ds_read_b64_tr_b16 a[122:123], v240 offset:22528
    ds_read_b64_tr_b16 a[124:125], v242 offset:20480
    ds_read_b64_tr_b16 a[126:127], v242 offset:22528
    ds_read_b64_tr_b16 a[128:129], v236 offset:0
    ds_read_b64_tr_b16 a[130:131], v236 offset:2048
    ds_read_b64_tr_b16 a[132:133], v238 offset:0
    ds_read_b64_tr_b16 a[134:135], v238 offset:2048
    ds_read_b64_tr_b16 a[136:137], v240 offset:0
    ds_read_b64_tr_b16 a[138:139], v240 offset:2048
    ds_read_b64_tr_b16 a[140:141], v242 offset:0
    ds_read_b64_tr_b16 a[142:143], v242 offset:2048
    ds_read_b64_tr_b16 a[144:145], v236 offset:4096
    ds_read_b64_tr_b16 a[146:147], v236 offset:6144
    ds_read_b64_tr_b16 a[148:149], v238 offset:4096
    ds_read_b64_tr_b16 a[150:151], v238 offset:6144
    ds_read_b64_tr_b16 a[152:153], v240 offset:4096
    ds_read_b64_tr_b16 a[154:155], v240 offset:6144
    ds_read_b64_tr_b16 a[156:157], v242 offset:4096
    ds_read_b64_tr_b16 a[158:159], v242 offset:6144
    ds_read_b64_tr_b16 a[160:161], v236 offset:57344
    ds_read_b64_tr_b16 a[162:163], v236 offset:59392
    ds_read_b64_tr_b16 a[164:165], v238 offset:57344
    ds_read_b64_tr_b16 a[166:167], v238 offset:59392
    ds_read_b64_tr_b16 a[168:169], v240 offset:57344
    ds_read_b64_tr_b16 a[170:171], v240 offset:59392
    ds_read_b64_tr_b16 a[172:173], v242 offset:57344
    ds_read_b64_tr_b16 a[174:175], v242 offset:59392
    ds_read_b64_tr_b16 a[176:177], v236 offset:61440
    ds_read_b64_tr_b16 a[178:179], v236 offset:63488
    ds_read_b64_tr_b16 a[180:181], v238 offset:61440
    ds_read_b64_tr_b16 a[182:183], v238 offset:63488
    ds_read_b64_tr_b16 a[184:185], v240 offset:61440
    ds_read_b64_tr_b16 a[186:187], v240 offset:63488
    ds_read_b64_tr_b16 a[188:189], v242 offset:61440
    ds_read_b64_tr_b16 a[190:191], v242 offset:63488
    ds_read_b64_tr_b16 a[192:193], v236 offset:40960
    ds_read_b64_tr_b16 a[194:195], v236 offset:43008
    ds_read_b64_tr_b16 a[196:197], v238 offset:40960
    ds_read_b64_tr_b16 a[198:199], v238 offset:43008
    ds_read_b64_tr_b16 a[200:201], v240 offset:40960
    ds_read_b64_tr_b16 a[202:203], v240 offset:43008
    ds_read_b64_tr_b16 a[204:205], v242 offset:40960
    ds_read_b64_tr_b16 a[206:207], v242 offset:43008
    ds_read_b64_tr_b16 a[208:209], v236 offset:45056
    ds_read_b64_tr_b16 a[210:211], v236 offset:47104
    ds_read_b64_tr_b16 a[212:213], v238 offset:45056
    ds_read_b64_tr_b16 a[214:215], v238 offset:47104
    ds_read_b64_tr_b16 a[216:217], v240 offset:45056
    ds_read_b64_tr_b16 a[218:219], v240 offset:47104
    ds_read_b64_tr_b16 a[220:221], v242 offset:45056
    ds_read_b64_tr_b16 a[222:223], v242 offset:47104
    ds_read_b64_tr_b16 a[224:225], v237 offset:16384
    ds_read_b64_tr_b16 a[226:227], v237 offset:18432
    ds_read_b64_tr_b16 a[228:229], v239 offset:16384
    ds_read_b64_tr_b16 a[230:231], v239 offset:18432
    ds_read_b64_tr_b16 a[232:233], v241 offset:16384
    ds_read_b64_tr_b16 a[234:235], v241 offset:18432
    ds_read_b64_tr_b16 a[236:237], v243 offset:16384
    ds_read_b64_tr_b16 a[238:239], v243 offset:18432
    ds_read_b64_tr_b16 a[240:241], v237 offset:20480
    ds_read_b64_tr_b16 a[242:243], v237 offset:22528
    ds_read_b64_tr_b16 a[244:245], v239 offset:20480
    ds_read_b64_tr_b16 a[246:247], v239 offset:22528
    ds_read_b64_tr_b16 a[248:249], v241 offset:20480
    ds_read_b64_tr_b16 a[250:251], v241 offset:22528
    ds_read_b64_tr_b16 a[252:253], v243 offset:20480
    ds_read_b64_tr_b16 a[254:255], v243 offset:22528
    s_mov_b32 s32, s86
    s_mov_b32 s33, s87
    s_mov_b32 s34, 0x200000
    s_mov_b32 s35, 0x20000
    buffer_load_dwordx2 v[0:1], v193, s[32:35], s44 offen offset:0
    buffer_load_dwordx2 v[2:3], v193, s[32:35], s44 offen offset:32
    buffer_load_dwordx2 v[4:5], v193, s[32:35], s44 offen offset:128
    buffer_load_dwordx2 v[6:7], v193, s[32:35], s44 offen offset:160
    buffer_load_dwordx4 v[8:11], v194, s[28:31], s45 offen offset:0 sc1
    buffer_load_dwordx4 v[12:15], v194, s[28:31], s45 offen offset:64 sc1
    buffer_load_dwordx4 v[16:19], v194, s[28:31], s45 offen offset:256 sc1
    buffer_load_dwordx4 v[20:23], v194, s[28:31], s45 offen offset:320 sc1
    s_add_u32 s45, s45, 2048
    buffer_load_dwordx4 v[24:27], v194, s[28:31], s45 offen offset:0 sc1
    buffer_load_dwordx4 v[28:31], v194, s[28:31], s45 offen offset:64 sc1
    buffer_load_dwordx4 v[32:35], v194, s[28:31], s45 offen offset:256 sc1
    buffer_load_dwordx4 v[36:39], v194, s[28:31], s45 offen offset:320 sc1
    s_add_u32 s45, s45, 2048
    buffer_load_dwordx4 v[40:43], v194, s[28:31], s45 offen offset:0 sc1
    buffer_load_dwordx4 v[44:47], v194, s[28:31], s45 offen offset:64 sc1
    buffer_load_dwordx4 v[48:51], v194, s[28:31], s45 offen offset:256 sc1
    buffer_load_dwordx4 v[52:55], v194, s[28:31], s45 offen offset:320 sc1
    s_add_u32 m0, s36, 0
    s_add_u32 s39, s79, 229376
    buffer_load_dwordx4 v249, s[20:23], s39 offen offset:0 lds
    s_add_u32 s39, s79, 257024
    buffer_load_dwordx4 v249, s[20:23], s39 offen offset:1024 lds
    s_add_u32 s39, s79, 284672
    buffer_load_dwordx4 v249, s[20:23], s39 offen offset:2048 lds
    s_add_u32 s39, s79, 312320
    buffer_load_dwordx4 v249, s[20:23], s39 offen offset:3072 lds
    s_add_u32 m0, s36, 4096
    s_add_u32 s39, s79, 344064
    buffer_load_dwordx4 v249, s[20:23], s39 offen offset:0 lds
    s_add_u32 s39, s79, 371712
    buffer_load_dwordx4 v249, s[20:23], s39 offen offset:1024 lds
    s_add_u32 s39, s79, 399360
    buffer_load_dwordx4 v249, s[20:23], s39 offen offset:2048 lds
    s_add_u32 s39, s79, 427008
    buffer_load_dwordx4 v249, s[20:23], s39 offen offset:3072 lds
    s_add_u32 m0, s36, 8192
    s_add_u32 s39, s79, 458752
    buffer_load_dwordx4 v249, s[20:23], s39 offen offset:0 lds
    s_add_u32 s39, s79, 486400
    buffer_load_dwordx4 v249, s[20:23], s39 offen offset:1024 lds
    s_add_u32 s39, s79, 514048
    buffer_load_dwordx4 v249, s[20:23], s39 offen offset:2048 lds
    s_add_u32 s39, s79, 541696
    buffer_load_dwordx4 v249, s[20:23], s39 offen offset:3072 lds
    s_add_u32 m0, s36, 12288
    s_add_u32 s39, s79, 573440
    buffer_load_dwordx4 v249, s[20:23], s39 offen offset:0 lds
    s_add_u32 s39, s79, 601088
    buffer_load_dwordx4 v249, s[20:23], s39 offen offset:1024 lds
    s_add_u32 s39, s79, 628736
    buffer_load_dwordx4 v249, s[20:23], s39 offen offset:2048 lds
    s_add_u32 s39, s79, 656384
    buffer_load_dwordx4 v249, s[20:23], s39 offen offset:3072 lds
    s_lshr_b32 s100, s56, 7
    s_lshl_b32 s44, s55, 2
    s_add_u32 s101, s100, s44
    s_lshr_b32 s15, s57, 14
    s_lshl_b32 s15, s15, 7
    s_lshl_b32 s45, s75, 2
    s_add_u32 s45, s45, s3
    s_lshl_b32 s45, s45, 7
    s_lshl_b32 s46, s74, 2
    s_add_u32 s45, s45, s46
    s_mov_b32 s16, s90
    s_mov_b32 s17, s91
    s_mov_b32 s18, 0x80000
    s_mov_b32 s19, 0x20000
    s_waitcnt vmcnt(0)
    s_add_u32 s44, s45, 262144
    s_mov_b64 exec, 1
    buffer_store_dword v235, off, s[28:31], s44 sc1
    s_mov_b64 exec, -1
    s_add_u32 s59, s100, 262144
    buffer_load_dword v255, v234, s[28:31], s59 offen sc1
    s_mov_b32 s4, 0
    ds_read_b64_tr_b16 a[0:1], v244 offset:24576
    ds_read_b64_tr_b16 a[2:3], v244 offset:26624
    ds_read_b64_tr_b16 a[4:5], v245 offset:24576
    ds_read_b64_tr_b16 a[6:7], v245 offset:26624
    ds_read_b64_tr_b16 a[8:9], v246 offset:24576
    ds_read_b64_tr_b16 a[10:11], v246 offset:26624
    ds_read_b64_tr_b16 a[12:13], v247 offset:24576
    ds_read_b64_tr_b16 a[14:15], v247 offset:26624
    ds_read_b64_tr_b16 a[16:17], v244 offset:28672
    ds_read_b64_tr_b16 a[18:19], v244 offset:30720
    ds_read_b64_tr_b16 a[20:21], v245 offset:28672
    ds_read_b64_tr_b16 a[22:23], v245 offset:30720
    ds_read_b64_tr_b16 a[24:25], v246 offset:28672
    ds_read_b64_tr_b16 a[26:27], v246 offset:30720
    ds_read_b64_tr_b16 a[28:29], v247 offset:28672
    ds_read_b64_tr_b16 a[30:31], v247 offset:30720
    ds_read_b64_tr_b16 a[32:33], v244 offset:0
    ds_read_b64_tr_b16 a[34:35], v244 offset:2048
    ds_read_b64_tr_b16 a[36:37], v245 offset:0
    ds_read_b64_tr_b16 a[38:39], v245 offset:2048
    ds_read_b64_tr_b16 a[40:41], v246 offset:0
    ds_read_b64_tr_b16 a[42:43], v246 offset:2048
    ds_read_b64_tr_b16 a[44:45], v247 offset:0
    ds_read_b64_tr_b16 a[46:47], v247 offset:2048
    ds_read_b64_tr_b16 a[48:49], v244 offset:4096
    ds_read_b64_tr_b16 a[50:51], v244 offset:6144
    ds_read_b64_tr_b16 a[52:53], v245 offset:4096
    ds_read_b64_tr_b16 a[54:55], v245 offset:6144
    ds_read_b64_tr_b16 a[56:57], v246 offset:4096
    ds_read_b64_tr_b16 a[58:59], v246 offset:6144
    ds_read_b64_tr_b16 a[60:61], v247 offset:4096
    ds_read_b64_tr_b16 a[62:63], v247 offset:6144
    ds_read_b64_tr_b16 a[64:65], v244 offset:8192
    ds_read_b64_tr_b16 a[66:67], v244 offset:10240
    ds_read_b64_tr_b16 a[68:69], v245 offset:8192
    ds_read_b64_tr_b16 a[70:71], v245 offset:10240
    ds_read_b64_tr_b16 a[72:73], v246 offset:8192
    ds_read_b64_tr_b16 a[74:75], v246 offset:10240
    ds_read_b64_tr_b16 a[76:77], v247 offset:8192
    ds_read_b64_tr_b16 a[78:79], v247 offset:10240
    ds_read_b64_tr_b16 a[80:81], v244 offset:12288
    ds_read_b64_tr_b16 a[82:83], v244 offset:14336
    ds_read_b64_tr_b16 a[84:85], v245 offset:12288
    ds_read_b64_tr_b16 a[86:87], v245 offset:14336
    ds_read_b64_tr_b16 a[88:89], v246 offset:12288
    ds_read_b64_tr_b16 a[90:91], v246 offset:14336
    ds_read_b64_tr_b16 a[92:93], v247 offset:12288
    ds_read_b64_tr_b16 a[94:95], v247 offset:14336
L_kf_poll_22:
    s_waitcnt vmcnt(0)
    v_cmp_eq_u32 vcc, s51, v255
    v_lshrrev_b32 v187, 16, v185
    v_cmp_ne_u32 s[46:47], 32, v187
    s_and_b32 s5, vcc_lo, 0xff
    s_andn2_b32 s6, s5, s4
    s_add_u32 s44, s57, 4194304
    s_bitcmp0_b32 s6, 0
    s_cbranch_scc1 L_kf_pk_24
    buffer_load_dwordx4 v[64:67], v192, s[28:31], s44 offen offset:0 sc1
    buffer_load_dwordx4 v[68:71], v192, s[28:31], s44 offen offset:2048 sc1
L_kf_pk_24:
    s_add_u32 s44, s44, 2097152
    s_bitcmp0_b32 s6, 1
    s_cbranch_scc1 L_kf_pk_25
    buffer_load_dwordx4 v[72:75], v192, s[28:31], s44 offen offset:0 sc1
    buffer_load_dwordx4 v[76:79], v192, s[28:31], s44 offen offset:2048 sc1
L_kf_pk_25:
    s_add_u32 s44, s44, 2097152
    s_bitcmp0_b32 s6, 2
    s_cbranch_scc1 L_kf_pk_26
    buffer_load_dwordx4 v[80:83], v192, s[28:31], s44 offen offset:0 sc1
    buffer_load_dwordx4 v[84:87], v192, s[28:31], s44 offen offset:2048 sc1
L_kf_pk_26:
    s_add_u32 s44, s44, 2097152
    s_bitcmp0_b32 s6, 3
    s_cbranch_scc1 L_kf_pk_27
    buffer_load_dwordx4 v[88:91], v192, s[28:31], s44 offen offset:0 sc1
    buffer_load_dwordx4 v[92:95], v192, s[28:31], s44 offen offset:2048 sc1
L_kf_pk_27:
    s_add_u32 s44, s44, 2097152
    s_bitcmp0_b32 s6, 4
    s_cbranch_scc1 L_kf_pk_28
    buffer_load_dwordx4 v[96:99], v192, s[28:31], s44 offen offset:0 sc1
    buffer_load_dwordx4 v[100:103], v192, s[28:31], s44 offen offset:2048 sc1
L_kf_pk_28:
    s_add_u32 s44, s44, 2097152
    s_bitcmp0_b32 s6, 5
    s_cbranch_scc1 L_kf_pk_29
    buffer_load_dwordx4 v[104:107], v192, s[28:31], s44 offen offset:0 sc1
    buffer_load_dwordx4 v[108:111], v192, s[28:31], s44 offen offset:2048 sc1
L_kf_pk_29:
    s_add_u32 s44, s44, 2097152
    s_bitcmp0_b32 s6, 6
    s_cbranch_scc1 L_kf_pk_30
    buffer_load_dwordx4 v[112:115], v192, s[28:31], s44 offen offset:0 sc1
    buffer_load_dwordx4 v[116:119], v192, s[28:31], s44 offen offset:2048 sc1
L_kf_pk_30:
    s_add_u32 s44, s44, 2097152
    s_bitcmp0_b32 s6, 7
    s_cbranch_scc1 L_kf_pk_31
    buffer_load_dwordx4 v[120:123], v192, s[28:31], s44 offen offset:0 sc1
    buffer_load_dwordx4 v[124:127], v192, s[28:31], s44 offen offset:2048 sc1
L_kf_pk_31:
    s_or_b32 s4, s4, s5
    s_xor_b32 s5, s4, 0xff
    s_or_b32 s5, s5, s46
    s_cmp_eq_u32 s5, 0
    s_cbranch_scc1 L_kf_seen_23
    s_sleep 1
    buffer_load_dword v255, v234, s[28:31], s59 offen sc1
    s_sub_i32 s52, s52, 1
    s_cmp_gt_i32 s52, 0
    s_cbranch_scc1 L_kf_poll_22
    s_waitcnt vmcnt(0)
L_kf_seen_23:
    v_readlane_b32 s46, v184, s42
    v_readlane_b32 s47, v185, s42
    s_mul_i32 s44, s85, 6
    s_lshr_b64 s[46:47], s[46:47], s44
    s_and_b32 s46, s46, 63
    s_cmp_lg_u32 s46, 32
    s_cselect_b32 s53, 1, 0
    s_lshr_b32 s44, s56, 14
    s_add_u32 s44, s44, 1
    s_and_b32 s44, s44, 14
    s_cmp_eq_u32 s44, 0
    s_cselect_b32 s58, 1, s53
    s_or_b32 s44, s2, s3
    s_cmp_lg_u32 s44, 0
    s_cbranch_scc1 L_kf_ne_32
    s_mov_b32 s44, 24576
    s_mov_b64 exec, 1
    buffer_store_dword v235, off, s[28:31], s44
    s_mov_b64 exec, -1
L_kf_ne_32:
    s_waitcnt vmcnt(0)
    v_mfma_f32_16x16x32_bf16 v[128:131], v[226:229], v[64:67], 0
    v_mfma_f32_16x16x32_bf16 v[132:135], v[224:227], v[64:67], 0
    v_mfma_f32_16x16x32_bf16 v[136:139], v[226:229], v[68:71], 0
    v_mfma_f32_16x16x32_bf16 v[140:143], v[224:227], v[68:71], 0
    v_mfma_f32_16x16x32_bf16 v[128:131], v[226:229], v[72:75], v[128:131]
    v_mfma_f32_16x16x32_bf16 v[132:135], v[224:227], v[72:75], v[132:135]
    v_mfma_f32_16x16x32_bf16 v[136:139], v[226:229], v[76:79], v[136:139]
    v_mfma_f32_16x16x32_bf16 v[140:143], v[224:227], v[76:79], v[140:143]
    v_mfma_f32_16x16x32_bf16 v[128:131], v[226:229], v[80:83], v[128:131]
    v_mfma_f32_16x16x32_bf16 v[132:135], v[224:227], v[80:83], v[132:135]
    v_mfma_f32_16x16x32_bf16 v[136:139], v[226:229], v[84:87], v[136:139]
    v_mfma_f32_16x16x32_bf16 v[140:143], v[224:227], v[84:87], v[140:143]
    v_mfma_f32_16x16x32_bf16 v[128:131], v[226:229], v[88:91], v[128:131]
    v_mfma_f32_16x16x32_bf16 v[132:135], v[224:227], v[88:91], v[132:135]
    v_mfma_f32_16x16x32_bf16 v[136:139], v[226:229], v[92:95], v[136:139]
    v_mfma_f32_16x16x32_bf16 v[140:143], v[224:227], v[92:95], v[140:143]
    v_mfma_f32_16x16x32_bf16 v[128:131], v[226:229], v[96:99], v[128:131]
    v_mfma_f32_16x16x32_bf16 v[132:135], v[224:227], v[96:99], v[132:135]
    v_mfma_f32_16x16x32_bf16 v[136:139], v[226:229], v[100:103], v[136:139]
    v_mfma_f32_16x16x32_bf16 v[140:143], v[224:227], v[100:103], v[140:143]
    v_mfma_f32_16x16x32_bf16 v[128:131], v[226:229], v[104:107], v[128:131]
    v_mfma_f32_16x16x32_bf16 v[132:135], v[224:227], v[104:107], v[132:135]
    v_mfma_f32_16x16x32_bf16 v[136:139], v[226:229], v[108:111], v[136:139]
    v_mfma_f32_16x16x32_bf16 v[140:143], v[224:227], v[108:111], v[140:143]
    v_mfma_f32_16x16x32_bf16 v[128:131], v[226:229], v[112:115], v[128:131]
    v_mfma_f32_16x16x32_bf16 v[132:135], v[224:227], v[112:115], v[132:135]
    v_mfma_f32_16x16x32_bf16 v[136:139], v[226:229], v[116:119], v[136:139]
    v_mfma_f32_16x16x32_bf16 v[140:143], v[224:227], v[116:119], v[140:143]
    v_mfma_f32_16x16x32_bf16 v[128:131], v[226:229], v[120:123], v[128:131]
    v_mfma_f32_16x16x32_bf16 v[132:135], v[224:227], v[120:123], v[132:135]
    v_mfma_f32_16x16x32_bf16 v[136:139], v[226:229], v[124:127], v[136:139]
    v_mfma_f32_16x16x32_bf16 v[140:143], v[224:227], v[124:127], v[140:143]
    s_waitcnt lgkmcnt(0)
    v_lshlrev_b32 v152, 16, v0
    v_and_b32 v153, 0xffff0000, v0
    v_lshlrev_b32 v154, 16, v1
    v_and_b32 v155, 0xffff0000, v1
    s_add_u32 m0, s36, 0
    s_add_u32 s39, s78, 0
    buffer_load_dwordx4 v248, s[16:19], s39 offen offset:0 lds
    v_lshlrev_b32 v156, 16, v2
    v_and_b32 v157, 0xffff0000, v2
    v_lshlrev_b32 v158, 16, v3
    v_and_b32 v159, 0xffff0000, v3
    s_add_u32 s39, s78, 7168
    buffer_load_dwordx4 v248, s[16:19], s39 offen offset:1024 lds
    v_lshlrev_b32 v160, 16, v4
    v_and_b32 v161, 0xffff0000, v4
    v_lshlrev_b32 v162, 16, v5
    v_and_b32 v163, 0xffff0000, v5
    s_add_u32 s39, s78, 14336
    buffer_load_dwordx4 v248, s[16:19], s39 offen offset:2048 lds
    v_lshlrev_b32 v164, 16, v6
    v_and_b32 v165, 0xffff0000, v6
    v_lshlrev_b32 v166, 16, v7
    v_and_b32 v167, 0xffff0000, v7
    s_add_u32 s39, s78, 21504
    buffer_load_dwordx4 v248, s[16:19], s39 offen offset:3072 lds
    v_fmac_f32 v152, v8, v128
    v_fmac_f32 v153, v9, v129
    v_fmac_f32 v154, v10, v130
    v_fmac_f32 v155, v11, v131
    s_add_u32 m0, s36, 4096
    s_add_u32 s39, s78, 32768
    buffer_load_dwordx4 v248, s[16:19], s39 offen offset:0 lds
    v_fmac_f32 v156, v12, v132
    v_fmac_f32 v157, v13, v133
    v_fmac_f32 v158, v14, v134
    v_fmac_f32 v159, v15, v135
    s_add_u32 s39, s78, 39936
    buffer_load_dwordx4 v248, s[16:19], s39 offen offset:1024 lds
    v_fmac_f32 v160, v16, v136
    v_fmac_f32 v161, v17, v137
    v_fmac_f32 v162, v18, v138
    v_fmac_f32 v163, v19, v139
    s_add_u32 s39, s78, 47104
    buffer_load_dwordx4 v248, s[16:19], s39 offen offset:2048 lds
    v_fmac_f32 v164, v20, v140
    v_fmac_f32 v165, v21, v141
    v_fmac_f32 v166, v22, v142
    v_fmac_f32 v167, v23, v143
    s_add_u32 s39, s78, 54272
    buffer_load_dwordx4 v248, s[16:19], s39 offen offset:3072 lds
    v_cvt_pk_bf16_f32 v64, v152, v153
    v_cvt_pk_bf16_f32 v65, v154, v155
    v_cvt_pk_bf16_f32 v66, v156, v157
    v_cvt_pk_bf16_f32 v67, v158, v159
    v_cvt_pk_bf16_f32 v68, v160, v161
    v_cvt_pk_bf16_f32 v69, v162, v163
    v_cvt_pk_bf16_f32 v70, v164, v165
    v_cvt_pk_bf16_f32 v71, v166, v167
    s_add_u32 s44, s57, 20971520
    s_cmp_lg_u32 s53, 0
    s_cbranch_scc1 L_kf_wt_33
    buffer_store_dwordx4 v[64:67], v192, s[28:31], s44 offen offset:0
    buffer_store_dwordx4 v[68:71], v192, s[28:31], s44 offen offset:2048
L_kf_wb_34:
    v_lshlrev_b32 v152, 16, v64
    v_and_b32 v153, 0xffff0000, v64
    v_lshlrev_b32 v154, 16, v65
    v_and_b32 v155, 0xffff0000, v65
    v_lshlrev_b32 v156, 16, v66
    v_and_b32 v157, 0xffff0000, v66
    v_lshlrev_b32 v158, 16, v67
    v_and_b32 v159, 0xffff0000, v67
    s_add_u32 m0, s36, 8192
    s_add_u32 s39, s78, 65536
    buffer_load_dwordx4 v248, s[16:19], s39 offen offset:0 lds
    v_lshlrev_b32 v160, 16, v68
    v_and_b32 v161, 0xffff0000, v68
    v_lshlrev_b32 v162, 16, v69
    v_and_b32 v163, 0xffff0000, v69
    v_lshlrev_b32 v164, 16, v70
    v_and_b32 v165, 0xffff0000, v70
    v_lshlrev_b32 v166, 16, v71
    v_and_b32 v167, 0xffff0000, v71
    s_add_u32 s39, s78, 72704
    buffer_load_dwordx4 v248, s[16:19], s39 offen offset:1024 lds
    v_add_f32 v168, v152, v156
    v_add_f32 v169, v153, v157
    v_add_f32 v170, v154, v158
    v_add_f32 v171, v155, v159
    s_add_u32 s39, s78, 79872
    buffer_load_dwordx4 v248, s[16:19], s39 offen offset:2048 lds
    v_add_f32 v168, v168, v160
    v_add_f32 v169, v169, v161
    v_add_f32 v170, v170, v162
    v_add_f32 v171, v171, v163
    s_add_u32 s39, s78, 87040
    buffer_load_dwordx4 v248, s[16:19], s39 offen offset:3072 lds
    v_add_f32 v168, v168, v164
    v_add_f32 v169, v169, v165
    v_add_f32 v170, v170, v166
    v_add_f32 v171, v171, v167
    s_add_u32 m0, s36, 12288
    s_add_u32 s39, s78, 98304
    buffer_load_dwordx4 v248, s[16:19], s39 offen offset:0 lds
    v_add_f32 v168, v168, v169
    v_add_f32 v170, v170, v171
    v_add_f32 v168, v168, v170
    s_nop 1
    v_add_f32_dpp v168, v168, v168 row_ror:8 row_mask:0xf bank_mask:0xf
    v_mov_b32 v176, v168
    s_nop 1
    v_permlane32_swap_b32 v168, v176
    v_add_f32 v168, v168, v176
    v_mov_b32 v176, v168
    s_nop 1
    v_permlane16_swap_b32 v168, v176
    v_add_f32 v168, v168, v176
    v_mul_f32 v168, 0x3c000000, v168
    v_sub_f32 v152, v152, v168
    v_sub_f32 v153, v153, v168
    v_sub_f32 v154, v154, v168
    v_sub_f32 v155, v155, v168
    s_add_u32 s39, s78, 105472
    buffer_load_dwordx4 v248, s[16:19], s39 offen offset:1024 lds
    v_sub_f32 v156, v156, v168
    v_sub_f32 v157, v157, v168
    v_sub_f32 v158, v158, v168
    v_sub_f32 v159, v159, v168
    s_add_u32 s39, s78, 112640
    buffer_load_dwordx4 v248, s[16:19], s39 offen offset:2048 lds
    v_sub_f32 v160, v160, v168
    v_sub_f32 v161, v161, v168
    v_sub_f32 v162, v162, v168
    v_sub_f32 v163, v163, v168
    s_add_u32 s39, s78, 119808
    buffer_load_dwordx4 v248, s[16:19], s39 offen offset:3072 lds
    v_sub_f32 v164, v164, v168
    v_sub_f32 v165, v165, v168
    v_sub_f32 v166, v166, v168
    v_sub_f32 v167, v167, v168
    s_add_u32 m0, s36, 24576
    s_add_u32 s39, s79, 688128
    buffer_load_dwordx4 v249, s[20:23], s39 offen offset:0 lds
    v_mul_f32 v169, v152, v152
    v_mul_f32 v170, v153, v153
    v_mul_f32 v171, v154, v154
    v_mul_f32 v172, v155, v155
    s_add_u32 s39, s79, 715776
    buffer_load_dwordx4 v249, s[20:23], s39 offen offset:1024 lds
    v_fmac_f32 v169, v156, v156
    v_fmac_f32 v170, v157, v157
    v_fmac_f32 v171, v158, v158
    v_fmac_f32 v172, v159, v159
    s_add_u32 s39, s79, 743424
    buffer_load_dwordx4 v249, s[20:23], s39 offen offset:2048 lds
    v_fmac_f32 v169, v160, v160
    v_fmac_f32 v170, v161, v161
    v_fmac_f32 v171, v162, v162
    v_fmac_f32 v172, v163, v163
    s_add_u32 s39, s79, 771072
    buffer_load_dwordx4 v249, s[20:23], s39 offen offset:3072 lds
    v_fmac_f32 v169, v164, v164
    v_fmac_f32 v170, v165, v165
    v_fmac_f32 v171, v166, v166
    v_fmac_f32 v172, v167, v167
    v_add_f32 v169, v169, v170
    v_add_f32 v171, v171, v172
    v_add_f32 v169, v169, v171
    s_nop 1
    v_add_f32_dpp v169, v169, v169 row_ror:8 row_mask:0xf bank_mask:0xf
    v_mov_b32 v176, v169
    s_nop 1
    v_permlane32_swap_b32 v169, v176
    v_add_f32 v169, v169, v176
    v_mov_b32 v176, v169
    s_nop 1
    v_permlane16_swap_b32 v169, v176
    v_add_f32 v169, v169, v176
    s_mov_b64 exec, 0xff
    ds_write_b64 v197, v[168:169] offset:0
    s_mov_b64 exec, -1
    s_waitcnt lgkmcnt(0)
    s_barrier
    ds_read_b64 v[128:129], v195 offset:0
    ds_read_b64 v[130:131], v195 offset:40960
    ds_read_b64 v[132:133], v196 offset:0
    ds_read_b64 v[134:135], v196 offset:40960
    s_waitcnt lgkmcnt(0)
    v_add_f32 v170, v128, v130
    v_add_f32 v171, v132, v134
    v_add_f32 v172, v129, v131
    v_add_f32 v170, v170, v171
    v_add_f32 v173, v133, v135
    v_mul_f32 v170, 0x3e800000, v170
    v_add_f32 v172, v172, v173
    v_sub_f32 v128, v128, v170
    v_sub_f32 v130, v130, v170
    v_sub_f32 v132, v132, v170
    v_sub_f32 v134, v134, v170
    v_mul_f32 v171, v128, v128
    v_fmac_f32 v171, v130, v130
    v_fmac_f32 v171, v132, v132
    v_fmac_f32 v171, v134, v134
    v_fmamk_f32 v172, v171, 0x43000000, v172
    v_fmamk_f32 v172, v172, 0x3b000000, v198
    v_rsq_f32 v172, v172
    v_sub_f32 v170, v168, v170
    v_mul_f32 v170, v170, v172
    v_fma_f32 v152, v152, v172, v170
    v_fma_f32 v153, v153, v172, v170
    v_fma_f32 v154, v154, v172, v170
    v_fma_f32 v155, v155, v172, v170
    v_fma_f32 v156, v156, v172, v170
    v_fma_f32 v157, v157, v172, v170
    v_fma_f32 v158, v158, v172, v170
    v_fma_f32 v159, v159, v172, v170
    v_fma_f32 v160, v160, v172, v170
    v_fma_f32 v161, v161, v172, v170
    v_fma_f32 v162, v162, v172, v170
    v_fma_f32 v163, v163, v172, v170
    v_fma_f32 v164, v164, v172, v170
    v_fma_f32 v165, v165, v172, v170
    v_fma_f32 v166, v166, v172, v170
    v_fma_f32 v167, v167, v172, v170
    v_fma_f32 v152, v152, v40, v24
    v_fma_f32 v153, v153, v41, v25
    v_fma_f32 v154, v154, v42, v26
    v_fma_f32 v155, v155, v43, v27
    v_fma_f32 v156, v156, v44, v28
    v_fma_f32 v157, v157, v45, v29
    v_fma_f32 v158, v158, v46, v30
    v_fma_f32 v159, v159, v47, v31
    v_fma_f32 v160, v160, v48, v32
    v_fma_f32 v161, v161, v49, v33
    v_fma_f32 v162, v162, v50, v34
    v_fma_f32 v163, v163, v51, v35
    v_fma_f32 v164, v164, v52, v36
    v_fma_f32 v165, v165, v53, v37
    v_fma_f32 v166, v166, v54, v38
    v_fma_f32 v167, v167, v55, v39
    v_cvt_pk_bf16_f32 v72, v152, v153
    v_cvt_pk_bf16_f32 v73, v154, v155
    v_cvt_pk_bf16_f32 v74, v156, v157
    v_cvt_pk_bf16_f32 v75, v158, v159
    v_cvt_pk_bf16_f32 v76, v160, v161
    v_cvt_pk_bf16_f32 v77, v162, v163
    v_cvt_pk_bf16_f32 v78, v164, v165
    v_cvt_pk_bf16_f32 v79, v166, v167
    s_add_u32 s44, s57, 23068672
    s_cmp_lg_u32 s53, 0
    s_cbranch_scc1 L_kf_wt_35
    buffer_store_dwordx4 v[72:75], v192, s[28:31], s44 offen offset:0
    buffer_store_dwordx4 v[76:79], v192, s[28:31], s44 offen offset:2048
L_kf_wb_36:
    v_lshlrev_b32 v152, 16, v72
    v_and_b32 v153, 0xffff0000, v72
    v_lshlrev_b32 v154, 16, v73
    v_and_b32 v155, 0xffff0000, v73
    v_lshlrev_b32 v156, 16, v74
    v_and_b32 v157, 0xffff0000, v74
    v_lshlrev_b32 v158, 16, v75
    v_and_b32 v159, 0xffff0000, v75
    v_lshlrev_b32 v160, 16, v76
    v_and_b32 v161, 0xffff0000, v76
    v_lshlrev_b32 v162, 16, v77
    v_and_b32 v163, 0xffff0000, v77
    v_lshlrev_b32 v164, 16, v78
    v_and_b32 v165, 0xffff0000, v78
    v_lshlrev_b32 v166, 16, v79
    v_and_b32 v167, 0xffff0000, v79
    v_add_f32 v168, v152, v156
    v_add_f32 v169, v153, v157
    v_add_f32 v170, v154, v158
    v_add_f32 v171, v155, v159
    v_add_f32 v168, v168, v160
    v_add_f32 v169, v169, v161
    v_add_f32 v170, v170, v162
    v_add_f32 v171, v171, v163
    v_add_f32 v168, v168, v164
    v_add_f32 v169, v169, v165
    v_add_f32 v170, v170, v166
    v_add_f32 v171, v171, v167
    v_add_f32 v168, v168, v169
    v_add_f32 v170, v170, v171
    v_add_f32 v168, v168, v170
    s_nop 1
    v_add_f32_dpp v168, v168, v168 row_ror:8 row_mask:0xf bank_mask:0xf
    v_mov_b32 v176, v168
    s_nop 1
    v_permlane32_swap_b32 v168, v176
    v_add_f32 v168, v168, v176
    v_mov_b32 v176, v168
    s_nop 1
    v_permlane16_swap_b32 v168, v176
    v_add_f32 v168, v168, v176
    v_mul_f32 v168, 0x3c000000, v168
    v_sub_f32 v152, v152, v168
    v_sub_f32 v153, v153, v168
    v_sub_f32 v154, v154, v168
    v_sub_f32 v155, v155, v168
    v_sub_f32 v156, v156, v168
    v_sub_f32 v157, v157, v168
    v_sub_f32 v158, v158, v168
    v_sub_f32 v159, v159, v168
    v_sub_f32 v160, v160, v168
    v_sub_f32 v161, v161, v168
    v_sub_f32 v162, v162, v168
    v_sub_f32 v163, v163, v168
    v_sub_f32 v164, v164, v168
    v_sub_f32 v165, v165, v168
    v_sub_f32 v166, v166, v168
    v_sub_f32 v167, v167, v168
    v_mul_f32 v169, v152, v152
    v_mul_f32 v170, v153, v153
    v_mul_f32 v171, v154, v154
    v_mul_f32 v172, v155, v155
    v_fmac_f32 v169, v156, v156
    v_fmac_f32 v170, v157, v157
    v_fmac_f32 v171, v158, v158
    v_fmac_f32 v172, v159, v159
    v_fmac_f32 v169, v160, v160
    v_fmac_f32 v170, v161, v161
    v_fmac_f32 v171, v162, v162
    v_fmac_f32 v172, v163, v163
    v_fmac_f32 v169, v164, v164
    v_fmac_f32 v170, v165, v165
    v_fmac_f32 v171, v166, v166
    v_fmac_f32 v172, v167, v167
    v_add_f32 v169, v169, v170
    v_add_f32 v171, v171, v172
    v_add_f32 v169, v169, v171
    s_nop 1
    v_add_f32_dpp v169, v169, v169 row_ror:8 row_mask:0xf bank_mask:0xf
    v_mov_b32 v176, v169
    s_nop 1
    v_permlane32_swap_b32 v169, v176
    v_add_f32 v169, v169, v176
    v_mov_b32 v176, v169
    s_nop 1
    v_permlane16_swap_b32 v169, v176
    v_add_f32 v169, v169, v176
    s_mov_b64 exec, 0xff
    ds_write_b64 v197, v[168:169] offset:256
    s_mov_b64 exec, -1
    s_waitcnt lgkmcnt(0)
    s_barrier
    ds_read_b64 v[128:129], v195 offset:256
    ds_read_b64 v[130:131], v195 offset:41216
    ds_read_b64 v[132:133], v196 offset:256
    ds_read_b64 v[134:135], v196 offset:41216
    s_waitcnt lgkmcnt(0)
    v_add_f32 v170, v128, v130
    v_add_f32 v171, v132, v134
    v_add_f32 v172, v129, v131
    v_add_f32 v170, v170, v171
    v_add_f32 v173, v133, v135
    v_mul_f32 v170, 0x3e800000, v170
    v_add_f32 v172, v172, v173
    v_sub_f32 v128, v128, v170
    v_sub_f32 v130, v130, v170
    v_sub_f32 v132, v132, v170
    v_sub_f32 v134, v134, v170
    v_mul_f32 v171, v128, v128
    v_fmac_f32 v171, v130, v130
    v_fmac_f32 v171, v132, v132
    v_fmac_f32 v171, v134, v134
    v_fmamk_f32 v172, v171, 0x43000000, v172
    v_fmamk_f32 v172, v172, 0x3b000000, v198
    v_rsq_f32 v172, v172
    v_sub_f32 v170, v168, v170
    v_mul_f32 v170, v170, v172
    v_fma_f32 v152, v152, v172, v170
    v_fma_f32 v153, v153, v172, v170
    v_fma_f32 v154, v154, v172, v170
    v_fma_f32 v155, v155, v172, v170
    v_fma_f32 v156, v156, v172, v170
    v_fma_f32 v157, v157, v172, v170
    v_fma_f32 v158, v158, v172, v170
    v_fma_f32 v159, v159, v172, v170
    v_fma_f32 v160, v160, v172, v170
    v_fma_f32 v161, v161, v172, v170
    v_fma_f32 v162, v162, v172, v170
    v_fma_f32 v163, v163, v172, v170
    v_fma_f32 v164, v164, v172, v170
    v_fma_f32 v165, v165, v172, v170
    v_fma_f32 v166, v166, v172, v170
    v_fma_f32 v167, v167, v172, v170
    v_cvt_pk_bf16_f32 v80, v152, v153
    v_cvt_pk_bf16_f32 v81, v154, v155
    v_cvt_pk_bf16_f32 v82, v156, v157
    v_cvt_pk_bf16_f32 v83, v158, v159
    v_cvt_pk_bf16_f32 v84, v160, v161
    v_cvt_pk_bf16_f32 v85, v162, v163
    v_cvt_pk_bf16_f32 v86, v164, v165
    v_cvt_pk_bf16_f32 v87, v166, v167
    s_add_u32 s44, s57, 25165824
    s_cmp_lg_u32 s53, 0
    s_cbranch_scc1 L_kf_wt_37
    buffer_store_dwordx4 v[80:83], v192, s[28:31], s44 offen offset:0
    buffer_store_dwordx4 v[84:87], v192, s[28:31], s44 offen offset:2048
L_kf_wb_38:
    ds_read_b64_tr_b16 v[0:1], v237 offset:0
    ds_read_b64_tr_b16 v[2:3], v237 offset:2048
    ds_read_b64_tr_b16 v[4:5], v239 offset:0
    ds_read_b64_tr_b16 v[6:7], v239 offset:2048
    ds_read_b64_tr_b16 v[8:9], v241 offset:0
    ds_read_b64_tr_b16 v[10:11], v241 offset:2048
    ds_read_b64_tr_b16 v[12:13], v243 offset:0
    ds_read_b64_tr_b16 v[14:15], v243 offset:2048
    ds_read_b64_tr_b16 v[16:17], v237 offset:4096
    ds_read_b64_tr_b16 v[18:19], v237 offset:6144
    ds_read_b64_tr_b16 v[20:21], v239 offset:4096
    ds_read_b64_tr_b16 v[22:23], v239 offset:6144
    ds_read_b64_tr_b16 v[24:25], v241 offset:4096
    ds_read_b64_tr_b16 v[26:27], v241 offset:6144
    ds_read_b64_tr_b16 v[28:29], v243 offset:4096
    ds_read_b64_tr_b16 v[30:31], v243 offset:6144
    ds_read_b64_tr_b16 v[32:33], v237 offset:57344
    ds_read_b64_tr_b16 v[34:35], v237 offset:59392
    ds_read_b64_tr_b16 v[36:37], v239 offset:57344
    ds_read_b64_tr_b16 v[38:39], v239 offset:59392
    ds_read_b64_tr_b16 v[40:41], v241 offset:57344
    ds_read_b64_tr_b16 v[42:43], v241 offset:59392
    ds_read_b64_tr_b16 v[44:45], v243 offset:57344
    ds_read_b64_tr_b16 v[46:47], v243 offset:59392
    s_bfe_u32 s45, s57, 0x10007
    s_lshl_b32 s45, s45, 2
    s_add_u32 s45, s45, s3
    s_lshl_b32 s45, s45, 2
    s_add_u32 s45, s45, s15
    s_waitcnt vmcnt(0)
    s_add_u32 s44, s45, 278528
    s_mov_b64 exec, 1
    s_cmp_lg_u32 s53, 0
    s_cbranch_scc1 L_kf_wt_39
    buffer_store_dword v235, off, s[28:31], s44
L_kf_wb_40:
    s_mov_b64 exec, -1
    s_add_u32 s59, s100, 278528
    buffer_load_dword v255, v234, s[28:31], s59 offen sc1
    ds_read_b64_tr_b16 v[48:49], v237 offset:61440
    ds_read_b64_tr_b16 v[50:51], v237 offset:63488
    ds_read_b64_tr_b16 v[52:53], v239 offset:61440
    ds_read_b64_tr_b16 v[54:55], v239 offset:63488
    ds_read_b64_tr_b16 v[56:57], v241 offset:61440
    ds_read_b64_tr_b16 v[58:59], v241 offset:63488
    ds_read_b64_tr_b16 v[60:61], v243 offset:61440
    ds_read_b64_tr_b16 v[62:63], v243 offset:63488
    ds_read_b64_tr_b16 v[144:145], v237 offset:40960
    ds_read_b64_tr_b16 v[146:147], v237 offset:43008
    ds_read_b64_tr_b16 v[148:149], v239 offset:40960
    ds_read_b64_tr_b16 v[150:151], v239 offset:43008
    ds_read_b64_tr_b16 v[152:153], v241 offset:40960
    ds_read_b64_tr_b16 v[154:155], v241 offset:43008
    ds_read_b64_tr_b16 v[156:157], v243 offset:40960
    ds_read_b64_tr_b16 v[158:159], v243 offset:43008
    ds_read_b64_tr_b16 v[160:161], v237 offset:45056
    ds_read_b64_tr_b16 v[162:163], v237 offset:47104
    ds_read_b64_tr_b16 v[164:165], v239 offset:45056
    ds_read_b64_tr_b16 v[166:167], v239 offset:47104
    ds_read_b64_tr_b16 v[168:169], v241 offset:45056
    ds_read_b64_tr_b16 v[170:171], v241 offset:47104
    ds_read_b64_tr_b16 v[172:173], v243 offset:45056
    ds_read_b64_tr_b16 v[174:175], v243 offset:47104
    v_subrev_u32 v236, 16384, v236
    v_subrev_u32 v237, 16384, v237
    v_subrev_u32 v238, 16384, v238
    v_subrev_u32 v239, 16384, v239
    v_subrev_u32 v240, 16384, v240
    v_subrev_u32 v241, 16384, v241
    v_subrev_u32 v242, 16384, v242
    v_subrev_u32 v243, 16384, v243
    v_mov_b32 v204, 0xc0135761
    v_mov_b32 v205, 0xc0135761
    v_mov_b32 v206, 0xbdd2d3e8
    v_mov_b32 v207, 0xbdd2d3e8
    s_lshr_b32 s44, s56, 10
    v_and_b32 v176, 15, v253
    v_add_u32 v176, s44, v176
    v_lshrrev_b32 v177, 4, v253
    v_mov_b32 v178, 0x40000000
    v_add_u32 v179, -1, v176
    v_lshrrev_b32 v180, 4, v179
    v_lshlrev_b32 v180, 14, v180
    v_lshl_add_u32 v180, v177, 8, v180
    v_and_b32 v181, 15, v179
    v_lshl_add_u32 v180, v181, 4, v180
    v_cmp_gt_u32 vcc, 2048, v179
    s_nop 1
    v_cndmask_b32 v230, v178, v180, vcc
    v_add_u32 v179, 1, v176
    v_lshrrev_b32 v180, 4, v179
    v_lshlrev_b32 v180, 14, v180
    v_lshl_add_u32 v180, v177, 8, v180
    v_and_b32 v181, 15, v179
    v_lshl_add_u32 v180, v181, 4, v180
    v_cmp_gt_u32 vcc, 2048, v179
    s_nop 1
    v_cndmask_b32 v231, v178, v180, vcc
    v_add_u32 v179, -2, v176
    v_lshrrev_b32 v180, 4, v179
    v_lshlrev_b32 v180, 14, v180
    v_lshl_add_u32 v180, v177, 8, v180
    v_and_b32 v181, 15, v179
    v_lshl_add_u32 v180, v181, 4, v180
    v_cmp_gt_u32 vcc, 2048, v179
    s_nop 1
    v_cndmask_b32 v232, v178, v180, vcc
    v_add_u32 v179, 2, v176
    v_lshrrev_b32 v180, 4, v179
    v_lshlrev_b32 v180, 14, v180
    v_lshl_add_u32 v180, v177, 8, v180
    v_and_b32 v181, 15, v179
    v_lshl_add_u32 v180, v181, 4, v180
    v_cmp_gt_u32 vcc, 2048, v179
    s_nop 1
    v_cndmask_b32 v233, v178, v180, vcc
    v_and_b32 v179, 2, v253
    v_lshlrev_b32 v179, 7, v179
    v_add_u32 v179, 0xffffff80, v179
    v_add_u32 v179, s100, v179
    v_mov_b32 v180, s100
    v_cmp_gt_u32 vcc, 0x4000, v179
    s_nop 1
    v_cndmask_b32 v179, v180, v179, vcc
    v_and_b32 v181, 8, v253
    v_cmp_eq_u32 vcc, 0, v181
    s_nop 1
    v_cndmask_b32 v179, v179, v180, vcc
    v_add_u32 v254, v179, v234
    s_waitcnt lgkmcnt(0)
    s_barrier
L_kf_poll_41:
    s_waitcnt vmcnt(0)
    v_cmp_ne_u32 vcc, s51, v255
    s_cbranch_vccz L_kf_seen_42
    s_sleep 1
    buffer_load_dword v255, v234, s[28:31], s59 offen sc1
    s_sub_i32 s52, s52, 1
    s_cmp_gt_i32 s52, 0
    s_cbranch_scc1 L_kf_poll_41
    s_waitcnt vmcnt(0)
L_kf_seen_42:
    s_add_u32 s44, s56, 25165824
    buffer_load_dwordx4 v[64:67], v250, s[28:31], s44 offen offset:0 sc1
    buffer_load_dwordx4 v[68:71], v250, s[28:31], s44 offen offset:1024 sc1
    buffer_load_dwordx4 v[72:75], v250, s[28:31], s44 offen offset:2048 sc1
    buffer_load_dwordx4 v[76:79], v250, s[28:31], s44 offen offset:3072 sc1
    s_add_u32 s44, s56, 25169920
    buffer_load_dwordx4 v[80:83], v250, s[28:31], s44 offen offset:0 sc1
    buffer_load_dwordx4 v[84:87], v250, s[28:31], s44 offen offset:1024 sc1
    buffer_load_dwordx4 v[88:91], v250, s[28:31], s44 offen offset:2048 sc1
    buffer_load_dwordx4 v[92:95], v250, s[28:31], s44 offen offset:3072 sc1
    s_add_u32 s44, s56, 25174016
    buffer_load_dwordx4 v[96:99], v250, s[28:31], s44 offen offset:0 sc1
    buffer_load_dwordx4 v[100:103], v250, s[28:31], s44 offen offset:1024 sc1
    buffer_load_dwordx4 v[104:107], v250, s[28:31], s44 offen offset:2048 sc1
    buffer_load_dwordx4 v[108:111], v250, s[28:31], s44 offen offset:3072 sc1
    s_add_u32 s44, s56, 25178112
    buffer_load_dwordx4 v[112:115], v250, s[28:31], s44 offen offset:0 sc1
    buffer_load_dwordx4 v[116:119], v250, s[28:31], s44 offen offset:1024 sc1
    buffer_load_dwordx4 v[120:123], v250, s[28:31], s44 offen offset:2048 sc1
    buffer_load_dwordx4 v[124:127], v250, s[28:31], s44 offen offset:3072 sc1
    s_lshl_b32 s44, s55, 11
    s_add_u32 s14, s56, s44
    s_waitcnt vmcnt(15)
    v_mfma_f32_16x16x32_bf16 v[128:131], a[96:99], v[64:67], 0
    ds_read_b64_tr_b16 a[96:97], v236 offset:0
    ds_read_b64_tr_b16 a[98:99], v236 offset:2048
    v_mfma_f32_16x16x32_bf16 v[132:135], a[100:103], v[64:67], 0
    ds_read_b64_tr_b16 a[100:101], v238 offset:0
    ds_read_b64_tr_b16 a[102:103], v238 offset:2048
    s_add_u32 s44, s14, 23068672
    buffer_load_dwordx4 v[208:211], v250, s[28:31], s44 offen offset:0 sc1
    v_mfma_f32_16x16x32_bf16 v[136:139], a[104:107], v[64:67], 0
    ds_read_b64_tr_b16 a[104:105], v240 offset:0
    ds_read_b64_tr_b16 a[106:107], v240 offset:2048
    v_mfma_f32_16x16x32_bf16 v[140:143], a[108:111], v[64:67], 0
    ds_read_b64_tr_b16 a[108:109], v242 offset:0
    ds_read_b64_tr_b16 a[110:111], v242 offset:2048
    s_add_u32 s44, s14, 23068672
    buffer_load_dwordx4 v[212:215], v250, s[28:31], s44 offen offset:1024 sc1
    s_waitcnt vmcnt(16)
    v_mfma_f32_16x16x32_bf16 v[128:131], a[112:115], v[68:71], v[128:131]
    ds_read_b64_tr_b16 a[112:113], v236 offset:4096
    ds_read_b64_tr_b16 a[114:115], v236 offset:6144
    v_mfma_f32_16x16x32_bf16 v[132:135], a[116:119], v[68:71], v[132:135]
    ds_read_b64_tr_b16 a[116:117], v238 offset:4096
    ds_read_b64_tr_b16 a[118:119], v238 offset:6144
    s_add_u32 s44, s14, 20971520
    buffer_load_dwordx4 v[216:219], v250, s[28:31], s44 offen offset:0 sc1
    v_mfma_f32_16x16x32_bf16 v[136:139], a[120:123], v[68:71], v[136:139]
    ds_read_b64_tr_b16 a[120:121], v240 offset:4096
    ds_read_b64_tr_b16 a[122:123], v240 offset:6144
    v_mfma_f32_16x16x32_bf16 v[140:143], a[124:127], v[68:71], v[140:143]
    ds_read_b64_tr_b16 a[124:125], v242 offset:4096
    ds_read_b64_tr_b16 a[126:127], v242 offset:6144
    s_add_u32 s44, s14, 20971520
    buffer_load_dwordx4 v[220:223], v250, s[28:31], s44 offen offset:1024 sc1
    s_waitcnt vmcnt(17)
    v_mfma_f32_16x16x32_bf16 v[128:131], a[128:131], v[72:75], v[128:131]
    ds_read_b64_tr_b16 a[128:129], v236 offset:8192
    ds_read_b64_tr_b16 a[130:131], v236 offset:10240
    v_mfma_f32_16x16x32_bf16 v[132:135], a[132:135], v[72:75], v[132:135]
    ds_read_b64_tr_b16 a[132:133], v238 offset:8192
    ds_read_b64_tr_b16 a[134:135], v238 offset:10240
    s_add_u32 m0, s36, 28672
    s_add_u32 s39, s79, 802816
    buffer_load_dwordx4 v249, s[20:23], s39 offen offset:0 lds
    v_mfma_f32_16x16x32_bf16 v[136:139], a[136:139], v[72:75], v[136:139]
    ds_read_b64_tr_b16 a[136:137], v240 offset:8192
    ds_read_b64_tr_b16 a[138:139], v240 offset:10240
    v_mfma_f32_16x16x32_bf16 v[140:143], a[140:143], v[72:75], v[140:143]
    ds_read_b64_tr_b16 a[140:141], v242 offset:8192
    ds_read_b64_tr_b16 a[142:143], v242 offset:10240
    s_add_u32 s39, s79, 830464
    buffer_load_dwordx4 v249, s[20:23], s39 offen offset:1024 lds
    s_waitcnt vmcnt(18)
    v_mfma_f32_16x16x32_bf16 v[128:131], a[144:147], v[76:79], v[128:131]
    ds_read_b64_tr_b16 a[144:145], v236 offset:12288
    ds_read_b64_tr_b16 a[146:147], v236 offset:14336
    v_mfma_f32_16x16x32_bf16 v[132:135], a[148:151], v[76:79], v[132:135]
    ds_read_b64_tr_b16 a[148:149], v238 offset:12288
    ds_read_b64_tr_b16 a[150:151], v238 offset:14336
    s_add_u32 s39, s79, 858112
    buffer_load_dwordx4 v249, s[20:23], s39 offen offset:2048 lds
    v_mfma_f32_16x16x32_bf16 v[136:139], a[152:155], v[76:79], v[136:139]
    ds_read_b64_tr_b16 a[152:153], v240 offset:12288
    ds_read_b64_tr_b16 a[154:155], v240 offset:14336
    v_mfma_f32_16x16x32_bf16 v[140:143], a[156:159], v[76:79], v[140:143]
    ds_read_b64_tr_b16 a[156:157], v242 offset:12288
    ds_read_b64_tr_b16 a[158:159], v242 offset:14336
    s_add_u32 s39, s79, 885760
    buffer_load_dwordx4 v249, s[20:23], s39 offen offset:3072 lds
    s_waitcnt vmcnt(19)
    v_mfma_f32_16x16x32_bf16 v[128:131], a[160:163], v[80:83], v[128:131]
    ds_read_b64_tr_b16 a[160:161], v236 offset:40960
    ds_read_b64_tr_b16 a[162:163], v236 offset:43008
    v_mfma_f32_16x16x32_bf16 v[132:135], a[164:167], v[80:83], v[132:135]
    ds_read_b64_tr_b16 a[164:165], v238 offset:40960
    ds_read_b64_tr_b16 a[166:167], v238 offset:43008
    s_add_u32 m0, s36, 16384
    s_add_u32 s39, s79, 917504
    buffer_load_dwordx4 v249, s[20:23], s39 offen offset:0 lds
    v_mfma_f32_16x16x32_bf16 v[136:139], a[168:171], v[80:83], v[136:139]
    ds_read_b64_tr_b16 a[168:169], v240 offset:40960
    ds_read_b64_tr_b16 a[170:171], v240 offset:43008
    v_mfma_f32_16x16x32_bf16 v[140:143], a[172:175], v[80:83], v[140:143]
    ds_read_b64_tr_b16 a[172:173], v242 offset:40960
    ds_read_b64_tr_b16 a[174:175], v242 offset:43008
    s_add_u32 s39, s79, 945152
    buffer_load_dwordx4 v249, s[20:23], s39 offen offset:1024 lds
    s_waitcnt vmcnt(20)
    v_mfma_f32_16x16x32_bf16 v[128:131], a[176:179], v[84:87], v[128:131]
    ds_read_b64_tr_b16 a[176:177], v236 offset:45056
    ds_read_b64_tr_b16 a[178:179], v236 offset:47104
    v_mfma_f32_16x16x32_bf16 v[132:135], a[180:183], v[84:87], v[132:135]
    ds_read_b64_tr_b16 a[180:181], v238 offset:45056
    ds_read_b64_tr_b16 a[182:183], v238 offset:47104
    s_add_u32 s39, s79, 972800
    buffer_load_dwordx4 v249, s[20:23], s39 offen offset:2048 lds
    v_mfma_f32_16x16x32_bf16 v[136:139], a[184:187], v[84:87], v[136:139]
    ds_read_b64_tr_b16 a[184:185], v240 offset:45056
    ds_read_b64_tr_b16 a[186:187], v240 offset:47104
    v_mfma_f32_16x16x32_bf16 v[140:143], a[188:191], v[84:87], v[140:143]
    ds_read_b64_tr_b16 a[188:189], v242 offset:45056
    ds_read_b64_tr_b16 a[190:191], v242 offset:47104
    s_add_u32 s39, s79, 1000448
    buffer_load_dwordx4 v249, s[20:23], s39 offen offset:3072 lds
    s_waitcnt vmcnt(21)
    v_mfma_f32_16x16x32_bf16 v[128:131], a[192:195], v[88:91], v[128:131]
    ds_read_b64_tr_b16 a[192:193], v236 offset:49152
    ds_read_b64_tr_b16 a[194:195], v236 offset:51200
    v_mfma_f32_16x16x32_bf16 v[132:135], a[196:199], v[88:91], v[132:135]
    ds_read_b64_tr_b16 a[196:197], v238 offset:49152
    ds_read_b64_tr_b16 a[198:199], v238 offset:51200
    s_add_u32 m0, s36, 20480
    s_add_u32 s39, s79, 1032192
    buffer_load_dwordx4 v249, s[20:23], s39 offen offset:0 lds
    v_mfma_f32_16x16x32_bf16 v[136:139], a[200:203], v[88:91], v[136:139]
    ds_read_b64_tr_b16 a[200:201], v240 offset:49152
    ds_read_b64_tr_b16 a[202:203], v240 offset:51200
    v_mfma_f32_16x16x32_bf16 v[140:143], a[204:207], v[88:91], v[140:143]
    ds_read_b64_tr_b16 a[204:205], v242 offset:49152
    ds_read_b64_tr_b16 a[206:207], v242 offset:51200
    s_add_u32 s39, s79, 1059840
    buffer_load_dwordx4 v249, s[20:23], s39 offen offset:1024 lds
    s_waitcnt vmcnt(22)
    v_mfma_f32_16x16x32_bf16 v[128:131], a[208:211], v[92:95], v[128:131]
    ds_read_b64_tr_b16 a[208:209], v236 offset:53248
    ds_read_b64_tr_b16 a[210:211], v236 offset:55296
    v_mfma_f32_16x16x32_bf16 v[132:135], a[212:215], v[92:95], v[132:135]
    ds_read_b64_tr_b16 a[212:213], v238 offset:53248
    ds_read_b64_tr_b16 a[214:215], v238 offset:55296
    s_add_u32 s39, s79, 1087488
    buffer_load_dwordx4 v249, s[20:23], s39 offen offset:2048 lds
    v_mfma_f32_16x16x32_bf16 v[136:139], a[216:219], v[92:95], v[136:139]
    ds_read_b64_tr_b16 a[216:217], v240 offset:53248
    ds_read_b64_tr_b16 a[218:219], v240 offset:55296
    v_mfma_f32_16x16x32_bf16 v[140:143], a[220:223], v[92:95], v[140:143]
    ds_read_b64_tr_b16 a[220:221], v242 offset:53248
    ds_read_b64_tr_b16 a[222:223], v242 offset:55296
    s_add_u32 s39, s79, 1115136
    buffer_load_dwordx4 v249, s[20:23], s39 offen offset:3072 lds
    s_waitcnt vmcnt(23)
    v_mfma_f32_16x16x32_bf16 v[128:131], a[224:227], v[96:99], v[128:131]
    ds_read_b64_tr_b16 a[224:225], v237 offset:0
    ds_read_b64_tr_b16 a[226:227], v237 offset:2048
    v_mfma_f32_16x16x32_bf16 v[132:135], a[228:231], v[96:99], v[132:135]
    ds_read_b64_tr_b16 a[228:229], v239 offset:0
    ds_read_b64_tr_b16 a[230:231], v239 offset:2048
    s_add_u32 m0, s36, 32768
    s_add_u32 s39, s79, 1146880
    buffer_load_dwordx4 v249, s[20:23], s39 offen offset:0 lds
    v_mfma_f32_16x16x32_bf16 v[136:139], a[232:235], v[96:99], v[136:139]
    ds_read_b64_tr_b16 a[232:233], v241 offset:0
    ds_read_b64_tr_b16 a[234:235], v241 offset:2048
    v_mfma_f32_16x16x32_bf16 v[140:143], a[236:239], v[96:99], v[140:143]
    ds_read_b64_tr_b16 a[236:237], v243 offset:0
    ds_read_b64_tr_b16 a[238:239], v243 offset:2048
    s_add_u32 s39, s79, 1174528
    buffer_load_dwordx4 v249, s[20:23], s39 offen offset:1024 lds
    s_waitcnt vmcnt(24)
    v_mfma_f32_16x16x32_bf16 v[128:131], a[240:243], v[100:103], v[128:131]
    ds_read_b64_tr_b16 a[240:241], v237 offset:4096
    ds_read_b64_tr_b16 a[242:243], v237 offset:6144
    v_mfma_f32_16x16x32_bf16 v[132:135], a[244:247], v[100:103], v[132:135]
    ds_read_b64_tr_b16 a[244:245], v239 offset:4096
    ds_read_b64_tr_b16 a[246:247], v239 offset:6144
    s_add_u32 s39, s79, 1202176
    buffer_load_dwordx4 v249, s[20:23], s39 offen offset:2048 lds
    v_mfma_f32_16x16x32_bf16 v[136:139], a[248:251], v[100:103], v[136:139]
    ds_read_b64_tr_b16 a[248:249], v241 offset:4096
    ds_read_b64_tr_b16 a[250:251], v241 offset:6144
    v_mfma_f32_16x16x32_bf16 v[140:143], a[252:255], v[100:103], v[140:143]
    ds_read_b64_tr_b16 a[252:253], v243 offset:4096
    ds_read_b64_tr_b16 a[254:255], v243 offset:6144
    s_add_u32 s39, s79, 1229824
    buffer_load_dwordx4 v249, s[20:23], s39 offen offset:3072 lds
    s_waitcnt vmcnt(25)
    v_mfma_f32_16x16x32_bf16 v[128:131], v[0:3], v[104:107], v[128:131]
    ds_read_b64_tr_b16 v[0:1], v237 offset:8192
    ds_read_b64_tr_b16 v[2:3], v237 offset:10240
    v_mfma_f32_16x16x32_bf16 v[132:135], v[4:7], v[104:107], v[132:135]
    ds_read_b64_tr_b16 v[4:5], v239 offset:8192
    ds_read_b64_tr_b16 v[6:7], v239 offset:10240
    s_add_u32 m0, s36, 36864
    s_add_u32 s39, s79, 1261568
    buffer_load_dwordx4 v249, s[20:23], s39 offen offset:0 lds
    v_mfma_f32_16x16x32_bf16 v[136:139], v[8:11], v[104:107], v[136:139]
    ds_read_b64_tr_b16 v[8:9], v241 offset:8192
    ds_read_b64_tr_b16 v[10:11], v241 offset:10240
    v_mfma_f32_16x16x32_bf16 v[140:143], v[12:15], v[104:107], v[140:143]
    ds_read_b64_tr_b16 v[12:13], v243 offset:8192
    ds_read_b64_tr_b16 v[14:15], v243 offset:10240
    s_add_u32 s39, s79, 1289216
    buffer_load_dwordx4 v249, s[20:23], s39 offen offset:1024 lds
    s_waitcnt vmcnt(26)
    v_mfma_f32_16x16x32_bf16 v[128:131], v[16:19], v[108:111], v[128:131]
    ds_read_b64_tr_b16 v[16:17], v237 offset:12288
    ds_read_b64_tr_b16 v[18:19], v237 offset:14336
    v_mfma_f32_16x16x32_bf16 v[132:135], v[20:23], v[108:111], v[132:135]
    ds_read_b64_tr_b16 v[20:21], v239 offset:12288
    ds_read_b64_tr_b16 v[22:23], v239 offset:14336
    s_add_u32 s39, s79, 1316864
    buffer_load_dwordx4 v249, s[20:23], s39 offen offset:2048 lds
    v_mfma_f32_16x16x32_bf16 v[136:139], v[24:27], v[108:111], v[136:139]
    ds_read_b64_tr_b16 v[24:25], v241 offset:12288
    ds_read_b64_tr_b16 v[26:27], v241 offset:14336
    v_mfma_f32_16x16x32_bf16 v[140:143], v[28:31], v[108:111], v[140:143]
    ds_read_b64_tr_b16 v[28:29], v243 offset:12288
    ds_read_b64_tr_b16 v[30:31], v243 offset:14336
    s_add_u32 s39, s79, 1344512
    buffer_load_dwordx4 v249, s[20:23], s39 offen offset:3072 lds
    s_waitcnt vmcnt(27)
    v_mfma_f32_16x16x32_bf16 v[128:131], v[32:35], v[112:115], v[128:131]
    ds_read_b64_tr_b16 v[32:33], v237 offset:40960
    ds_read_b64_tr_b16 v[34:35], v237 offset:43008
    v_mfma_f32_16x16x32_bf16 v[132:135], v[36:39], v[112:115], v[132:135]
    ds_read_b64_tr_b16 v[36:37], v239 offset:40960
    ds_read_b64_tr_b16 v[38:39], v239 offset:43008
    v_mfma_f32_16x16x32_bf16 v[136:139], v[40:43], v[112:115], v[136:139]
    ds_read_b64_tr_b16 v[40:41], v241 offset:40960
    ds_read_b64_tr_b16 v[42:43], v241 offset:43008
    v_mfma_f32_16x16x32_bf16 v[140:143], v[44:47], v[112:115], v[140:143]
    ds_read_b64_tr_b16 v[44:45], v243 offset:40960
    ds_read_b64_tr_b16 v[46:47], v243 offset:43008
    s_waitcnt vmcnt(26)
    v_mfma_f32_16x16x32_bf16 v[128:131], v[48:51], v[116:119], v[128:131]
    ds_read_b64_tr_b16 v[48:49], v237 offset:45056
    ds_read_b64_tr_b16 v[50:51], v237 offset:47104
    v_mfma_f32_16x16x32_bf16 v[132:135], v[52:55], v[116:119], v[132:135]
    ds_read_b64_tr_b16 v[52:53], v239 offset:45056
    ds_read_b64_tr_b16 v[54:55], v239 offset:47104
    v_mfma_f32_16x16x32_bf16 v[136:139], v[56:59], v[116:119], v[136:139]
    ds_read_b64_tr_b16 v[56:57], v241 offset:45056
    ds_read_b64_tr_b16 v[58:59], v241 offset:47104
    v_mfma_f32_16x16x32_bf16 v[140:143], v[60:63], v[116:119], v[140:143]
    ds_read_b64_tr_b16 v[60:61], v243 offset:45056
    ds_read_b64_tr_b16 v[62:63], v243 offset:47104
    s_waitcnt vmcnt(25)
    v_mfma_f32_16x16x32_bf16 v[128:131], v[144:147], v[120:123], v[128:131]
    ds_read_b64_tr_b16 v[144:145], v237 offset:49152
    ds_read_b64_tr_b16 v[146:147], v237 offset:51200
    v_mfma_f32_16x16x32_bf16 v[132:135], v[148:151], v[120:123], v[132:135]
    ds_read_b64_tr_b16 v[148:149], v239 offset:49152
    ds_read_b64_tr_b16 v[150:151], v239 offset:51200
    v_mfma_f32_16x16x32_bf16 v[136:139], v[152:155], v[120:123], v[136:139]
    ds_read_b64_tr_b16 v[152:153], v241 offset:49152
    ds_read_b64_tr_b16 v[154:155], v241 offset:51200
    v_mfma_f32_16x16x32_bf16 v[140:143], v[156:159], v[120:123], v[140:143]
    ds_read_b64_tr_b16 v[156:157], v243 offset:49152
    ds_read_b64_tr_b16 v[158:159], v243 offset:51200
    s_waitcnt vmcnt(24)
    v_mfma_f32_16x16x32_bf16 v[128:131], v[160:163], v[124:127], v[128:131]
    ds_read_b64_tr_b16 v[160:161], v237 offset:53248
    ds_read_b64_tr_b16 v[162:163], v237 offset:55296
    v_mfma_f32_16x16x32_bf16 v[132:135], v[164:167], v[124:127], v[132:135]
    ds_read_b64_tr_b16 v[164:165], v239 offset:53248
    ds_read_b64_tr_b16 v[166:167], v239 offset:55296
    v_mfma_f32_16x16x32_bf16 v[136:139], v[168:171], v[124:127], v[136:139]
    ds_read_b64_tr_b16 v[168:169], v241 offset:53248
    ds_read_b64_tr_b16 v[170:171], v241 offset:55296
    v_mfma_f32_16x16x32_bf16 v[140:143], v[172:175], v[124:127], v[140:143]
    ds_read_b64_tr_b16 v[172:173], v243 offset:53248
    ds_read_b64_tr_b16 v[174:175], v243 offset:55296
    v_pk_mul_f32 v[176:177], v[128:129], v[128:129]
    v_pk_mul_f32 v[178:179], v[130:131], v[130:131]
    v_pk_mul_f32 v[180:181], v[132:133], v[132:133]
    v_pk_mul_f32 v[182:183], v[134:135], v[134:135]
    v_pk_mul_f32 v[184:185], v[136:137], v[136:137]
    v_pk_mul_f32 v[186:187], v[138:139], v[138:139]
    v_pk_mul_f32 v[188:189], v[140:141], v[140:141]
    v_pk_mul_f32 v[190:191], v[142:143], v[142:143]
    v_pk_fma_f32 v[176:177], v[176:177], v[206:207], v[204:205]
    v_pk_fma_f32 v[178:179], v[178:179], v[206:207], v[204:205]
    v_pk_fma_f32 v[180:181], v[180:181], v[206:207], v[204:205]
    v_pk_fma_f32 v[182:183], v[182:183], v[206:207], v[204:205]
    v_pk_fma_f32 v[184:185], v[184:185], v[206:207], v[204:205]
    v_pk_fma_f32 v[186:187], v[186:187], v[206:207], v[204:205]
    v_pk_fma_f32 v[188:189], v[188:189], v[206:207], v[204:205]
    v_pk_fma_f32 v[190:191], v[190:191], v[206:207], v[204:205]
    v_pk_mul_f32 v[176:177], v[176:177], v[128:129]
    v_pk_mul_f32 v[178:179], v[178:179], v[130:131]
    v_pk_mul_f32 v[180:181], v[180:181], v[132:133]
    v_pk_mul_f32 v[182:183], v[182:183], v[134:135]
    v_pk_mul_f32 v[184:185], v[184:185], v[136:137]
    v_pk_mul_f32 v[186:187], v[186:187], v[138:139]
    v_pk_mul_f32 v[188:189], v[188:189], v[140:141]
    v_pk_mul_f32 v[190:191], v[190:191], v[142:143]
    v_exp_f32 v176, v176
    v_exp_f32 v177, v177
    v_exp_f32 v178, v178
    v_exp_f32 v179, v179
    v_exp_f32 v180, v180
    v_exp_f32 v181, v181
    v_exp_f32 v182, v182
    v_exp_f32 v183, v183
    v_exp_f32 v184, v184
    v_exp_f32 v185, v185
    v_exp_f32 v186, v186
    v_exp_f32 v187, v187
    v_exp_f32 v188, v188
    v_exp_f32 v189, v189
    v_exp_f32 v190, v190
    v_exp_f32 v191, v191
    v_pk_add_f32 v[176:177], v[176:177], 1.0 op_sel_hi:[1,0]
    v_pk_add_f32 v[178:179], v[178:179], 1.0 op_sel_hi:[1,0]
    v_pk_add_f32 v[180:181], v[180:181], 1.0 op_sel_hi:[1,0]
    v_pk_add_f32 v[182:183], v[182:183], 1.0 op_sel_hi:[1,0]
    v_pk_add_f32 v[184:185], v[184:185], 1.0 op_sel_hi:[1,0]
    v_pk_add_f32 v[186:187], v[186:187], 1.0 op_sel_hi:[1,0]
    v_pk_add_f32 v[188:189], v[188:189], 1.0 op_sel_hi:[1,0]
    v_pk_add_f32 v[190:191], v[190:191], 1.0 op_sel_hi:[1,0]
    v_rcp_f32 v176, v176
    v_rcp_f32 v177, v177
    v_rcp_f32 v178, v178
    v_rcp_f32 v179, v179
    v_rcp_f32 v180, v180
    v_rcp_f32 v181, v181
    v_rcp_f32 v182, v182
    v_rcp_f32 v183, v183
    v_rcp_f32 v184, v184
    v_rcp_f32 v185, v185
    v_rcp_f32 v186, v186
    v_rcp_f32 v187, v187
    v_rcp_f32 v188, v188
    v_rcp_f32 v189, v189
    v_rcp_f32 v190, v190
    v_rcp_f32 v191, v191
    v_pk_mul_f32 v[128:129], v[176:177], v[128:129]
    v_pk_mul_f32 v[130:131], v[178:179], v[130:131]
    v_pk_mul_f32 v[132:133], v[180:181], v[132:133]
    v_pk_mul_f32 v[134:135], v[182:183], v[134:135]
    v_pk_mul_f32 v[136:137], v[184:185], v[136:137]
    v_pk_mul_f32 v[138:139], v[186:187], v[138:139]
    v_pk_mul_f32 v[140:141], v[188:189], v[140:141]
    v_pk_mul_f32 v[142:143], v[190:191], v[142:143]
    v_cvt_pk_bf16_f32 v192, v128, v129
    v_cvt_pk_bf16_f32 v193, v130, v131
    v_cvt_pk_bf16_f32 v194, v132, v133
    v_cvt_pk_bf16_f32 v195, v134, v135
    v_cvt_pk_bf16_f32 v196, v136, v137
    v_cvt_pk_bf16_f32 v197, v138, v139
    v_cvt_pk_bf16_f32 v198, v140, v141
    v_cvt_pk_bf16_f32 v199, v142, v143
    s_add_u32 s44, s14, 27262976
    s_cmp_lg_u32 s58, 0
    s_cbranch_scc1 L_kf_wt_43
    buffer_store_dwordx4 v[192:195], v250, s[28:31], s44 offen offset:0
    buffer_store_dwordx4 v[196:199], v250, s[28:31], s44 offen offset:1024
L_kf_wb_44:
    s_waitcnt vmcnt(0)
    s_add_u32 s44, s101, 294912
    s_mov_b64 exec, 1
    s_cmp_lg_u32 s58, 0
    s_cbranch_scc1 L_kf_wt_45
    buffer_store_dword v235, off, s[28:31], s44
L_kf_wb_46:
    s_mov_b64 exec, -1
    s_mov_b32 s59, 294912
    buffer_load_dword v255, v254, s[28:31], s59 offen sc1
    s_waitcnt lgkmcnt(0)
    s_barrier
L_kf_poll_47:
    s_waitcnt vmcnt(0)
    v_cmp_ne_u32 vcc, s51, v255
    s_cbranch_vccz L_kf_seen_48
    s_sleep 1
    buffer_load_dword v255, v254, s[28:31], s59 offen sc1
    s_sub_i32 s52, s52, 1
    s_cmp_gt_i32 s52, 0
    s_cbranch_scc1 L_kf_poll_47
    s_waitcnt vmcnt(0)
L_kf_seen_48:
    s_mov_b32 s44, 27262976
    buffer_load_dwordx4 v[64:67], v230, s[28:31], s44 offen offset:0 sc1
    buffer_load_dwordx4 v[68:71], v230, s[28:31], s44 offen offset:1024 sc1
    buffer_load_dwordx4 v[72:75], v230, s[28:31], s44 offen offset:2048 sc1
    buffer_load_dwordx4 v[76:79], v230, s[28:31], s44 offen offset:3072 sc1
    s_mov_b32 s44, 27267072
    buffer_load_dwordx4 v[80:83], v231, s[28:31], s44 offen offset:0 sc1
    buffer_load_dwordx4 v[84:87], v231, s[28:31], s44 offen offset:1024 sc1
    buffer_load_dwordx4 v[88:91], v231, s[28:31], s44 offen offset:2048 sc1
    buffer_load_dwordx4 v[92:95], v231, s[28:31], s44 offen offset:3072 sc1
    s_mov_b32 s44, 27271168
    buffer_load_dwordx4 v[96:99], v232, s[28:31], s44 offen offset:0 sc1
    buffer_load_dwordx4 v[100:103], v232, s[28:31], s44 offen offset:1024 sc1
    buffer_load_dwordx4 v[104:107], v232, s[28:31], s44 offen offset:2048 sc1
    buffer_load_dwordx4 v[108:111], v232, s[28:31], s44 offen offset:3072 sc1
    s_mov_b32 s44, 27275264
    buffer_load_dwordx4 v[112:115], v233, s[28:31], s44 offen offset:0 sc1
    buffer_load_dwordx4 v[116:119], v233, s[28:31], s44 offen offset:1024 sc1
    buffer_load_dwordx4 v[120:123], v233, s[28:31], s44 offen offset:2048 sc1
    buffer_load_dwordx4 v[124:127], v233, s[28:31], s44 offen offset:3072 sc1
    s_waitcnt vmcnt(15)
    v_mfma_f32_16x16x32_bf16 v[128:131], a[96:99], v[64:67], 0
    ds_read_b64_tr_b16 a[96:97], v244 offset:24576
    ds_read_b64_tr_b16 a[98:99], v244 offset:26624
    v_mfma_f32_16x16x32_bf16 v[132:135], a[100:103], v[64:67], 0
    ds_read_b64_tr_b16 a[100:101], v245 offset:24576
    ds_read_b64_tr_b16 a[102:103], v245 offset:26624
    s_add_u32 m0, s36, 0
    s_add_u32 s39, s79, 1376256
    buffer_load_dwordx4 v249, s[20:23], s39 offen offset:0 lds
    v_mfma_f32_16x16x32_bf16 v[136:139], a[104:107], v[64:67], 0
    ds_read_b64_tr_b16 a[104:105], v246 offset:24576
    ds_read_b64_tr_b16 a[106:107], v246 offset:26624
    v_mfma_f32_16x16x32_bf16 v[140:143], a[108:111], v[64:67], 0
    ds_read_b64_tr_b16 a[108:109], v247 offset:24576
    ds_read_b64_tr_b16 a[110:111], v247 offset:26624
    s_add_u32 s39, s79, 1403904
    buffer_load_dwordx4 v249, s[20:23], s39 offen offset:1024 lds
    s_waitcnt vmcnt(16)
    v_mfma_f32_16x16x32_bf16 v[128:131], a[112:115], v[68:71], v[128:131]
    ds_read_b64_tr_b16 a[112:113], v244 offset:28672
    ds_read_b64_tr_b16 a[114:115], v244 offset:30720
    v_mfma_f32_16x16x32_bf16 v[132:135], a[116:119], v[68:71], v[132:135]
    ds_read_b64_tr_b16 a[116:117], v245 offset:28672
    ds_read_b64_tr_b16 a[118:119], v245 offset:30720
    s_add_u32 s39, s79, 1431552
    buffer_load_dwordx4 v249, s[20:23], s39 offen offset:2048 lds
    v_mfma_f32_16x16x32_bf16 v[136:139], a[120:123], v[68:71], v[136:139]
    ds_read_b64_tr_b16 a[120:121], v246 offset:28672
    ds_read_b64_tr_b16 a[122:123], v246 offset:30720
    v_mfma_f32_16x16x32_bf16 v[140:143], a[124:127], v[68:71], v[140:143]
    ds_read_b64_tr_b16 a[124:125], v247 offset:28672
    ds_read_b64_tr_b16 a[126:127], v247 offset:30720
    s_add_u32 s39, s79, 1459200
    buffer_load_dwordx4 v249, s[20:23], s39 offen offset:3072 lds
    s_waitcnt vmcnt(17)
    v_mfma_f32_16x16x32_bf16 v[128:131], a[128:131], v[72:75], v[128:131]
    ds_read_b64_tr_b16 a[128:129], v244 offset:16384
    ds_read_b64_tr_b16 a[130:131], v244 offset:18432
    v_mfma_f32_16x16x32_bf16 v[132:135], a[132:135], v[72:75], v[132:135]
    ds_read_b64_tr_b16 a[132:133], v245 offset:16384
    ds_read_b64_tr_b16 a[134:135], v245 offset:18432
    s_add_u32 m0, s36, 4096
    s_add_u32 s39, s79, 1490944
    buffer_load_dwordx4 v249, s[20:23], s39 offen offset:0 lds
    v_mfma_f32_16x16x32_bf16 v[136:139], a[136:139], v[72:75], v[136:139]
    ds_read_b64_tr_b16 a[136:137], v246 offset:16384
    ds_read_b64_tr_b16 a[138:139], v246 offset:18432
    v_mfma_f32_16x16x32_bf16 v[140:143], a[140:143], v[72:75], v[140:143]
    ds_read_b64_tr_b16 a[140:141], v247 offset:16384
    ds_read_b64_tr_b16 a[142:143], v247 offset:18432
    s_add_u32 s39, s79, 1518592
    buffer_load_dwordx4 v249, s[20:23], s39 offen offset:1024 lds
    s_waitcnt vmcnt(18)
    v_mfma_f32_16x16x32_bf16 v[128:131], a[144:147], v[76:79], v[128:131]
    ds_read_b64_tr_b16 a[144:145], v244 offset:20480
    ds_read_b64_tr_b16 a[146:147], v244 offset:22528
    v_mfma_f32_16x16x32_bf16 v[132:135], a[148:151], v[76:79], v[132:135]
    ds_read_b64_tr_b16 a[148:149], v245 offset:20480
    ds_read_b64_tr_b16 a[150:151], v245 offset:22528
    s_add_u32 s39, s79, 1546240
    buffer_load_dwordx4 v249, s[20:23], s39 offen offset:2048 lds
    v_mfma_f32_16x16x32_bf16 v[136:139], a[152:155], v[76:79], v[136:139]
    ds_read_b64_tr_b16 a[152:153], v246 offset:20480
    ds_read_b64_tr_b16 a[154:155], v246 offset:22528
    v_mfma_f32_16x16x32_bf16 v[140:143], a[156:159], v[76:79], v[140:143]
    ds_read_b64_tr_b16 a[156:157], v247 offset:20480
    ds_read_b64_tr_b16 a[158:159], v247 offset:22528
    s_add_u32 s39, s79, 1573888
    buffer_load_dwordx4 v249, s[20:23], s39 offen offset:3072 lds
    s_waitcnt vmcnt(19)
    v_mfma_f32_16x16x32_bf16 v[128:131], a[160:163], v[80:83], v[128:131]
    ds_read_b64_tr_b16 a[160:161], v244 offset:32768
    ds_read_b64_tr_b16 a[162:163], v244 offset:34816
    v_mfma_f32_16x16x32_bf16 v[132:135], a[164:167], v[80:83], v[132:135]
    ds_read_b64_tr_b16 a[164:165], v245 offset:32768
    ds_read_b64_tr_b16 a[166:167], v245 offset:34816
    s_add_u32 m0, s36, 8192
    s_add_u32 s39, s79, 1605632
    buffer_load_dwordx4 v249, s[20:23], s39 offen offset:0 lds
    v_mfma_f32_16x16x32_bf16 v[136:139], a[168:171], v[80:83], v[136:139]
    ds_read_b64_tr_b16 a[168:169], v246 offset:32768
    ds_read_b64_tr_b16 a[170:171], v246 offset:34816
    v_mfma_f32_16x16x32_bf16 v[140:143], a[172:175], v[80:83], v[140:143]
    ds_read_b64_tr_b16 a[172:173], v247 offset:32768
    ds_read_b64_tr_b16 a[174:175], v247 offset:34816
    s_add_u32 s39, s79, 1633280
    buffer_load_dwordx4 v249, s[20:23], s39 offen offset:1024 lds
    s_waitcnt vmcnt(20)
    v_mfma_f32_16x16x32_bf16 v[128:131], a[176:179], v[84:87], v[128:131]
    ds_read_b64_tr_b16 a[176:177], v244 offset:36864
    ds_read_b64_tr_b16 a[178:179], v244 offset:38912
    v_mfma_f32_16x16x32_bf16 v[132:135], a[180:183], v[84:87], v[132:135]
    ds_read_b64_tr_b16 a[180:181], v245 offset:36864
    ds_read_b64_tr_b16 a[182:183], v245 offset:38912
    s_add_u32 s39, s79, 1660928
    buffer_load_dwordx4 v249, s[20:23], s39 offen offset:2048 lds
    v_mfma_f32_16x16x32_bf16 v[136:139], a[184:187], v[84:87], v[136:139]
    ds_read_b64_tr_b16 a[184:185], v246 offset:36864
    ds_read_b64_tr_b16 a[186:187], v246 offset:38912
    v_mfma_f32_16x16x32_bf16 v[140:143], a[188:191], v[84:87], v[140:143]
    ds_read_b64_tr_b16 a[188:189], v247 offset:36864
    ds_read_b64_tr_b16 a[190:191], v247 offset:38912
    s_add_u32 s39, s79, 1688576
    buffer_load_dwordx4 v249, s[20:23], s39 offen offset:3072 lds
    s_waitcnt vmcnt(21)
    v_mfma_f32_16x16x32_bf16 v[128:131], a[192:195], v[88:91], v[128:131]
    v_mfma_f32_16x16x32_bf16 v[132:135], a[196:199], v[88:91], v[132:135]
    s_add_u32 m0, s36, 12288
    s_add_u32 s39, s79, 1720320
    buffer_load_dwordx4 v249, s[20:23], s39 offen offset:0 lds
    v_mfma_f32_16x16x32_bf16 v[136:139], a[200:203], v[88:91], v[136:139]
    v_mfma_f32_16x16x32_bf16 v[140:143], a[204:207], v[88:91], v[140:143]
    s_add_u32 s39, s79, 1747968
    buffer_load_dwordx4 v249, s[20:23], s39 offen offset:1024 lds
    s_waitcnt vmcnt(22)
    v_mfma_f32_16x16x32_bf16 v[128:131], a[208:211], v[92:95], v[128:131]
    v_mfma_f32_16x16x32_bf16 v[132:135], a[212:215], v[92:95], v[132:135]
    s_add_u32 s39, s79, 1775616
    buffer_load_dwordx4 v249, s[20:23], s39 offen offset:2048 lds
    v_mfma_f32_16x16x32_bf16 v[136:139], a[216:219], v[92:95], v[136:139]
    v_mfma_f32_16x16x32_bf16 v[140:143], a[220:223], v[92:95], v[140:143]
    s_add_u32 s39, s79, 1803264
    buffer_load_dwordx4 v249, s[20:23], s39 offen offset:3072 lds
    s_waitcnt vmcnt(23)
    v_mfma_f32_16x16x32_bf16 v[128:131], a[224:227], v[96:99], v[128:131]
    v_mfma_f32_16x16x32_bf16 v[132:135], a[228:231], v[96:99], v[132:135]
    v_mfma_f32_16x16x32_bf16 v[136:139], a[232:235], v[96:99], v[136:139]
    v_mfma_f32_16x16x32_bf16 v[140:143], a[236:239], v[96:99], v[140:143]
    s_waitcnt vmcnt(22)
    v_mfma_f32_16x16x32_bf16 v[128:131], a[240:243], v[100:103], v[128:131]
    v_mfma_f32_16x16x32_bf16 v[132:135], a[244:247], v[100:103], v[132:135]
    v_mfma_f32_16x16x32_bf16 v[136:139], a[248:251], v[100:103], v[136:139]
    v_mfma_f32_16x16x32_bf16 v[140:143], a[252:255], v[100:103], v[140:143]
    s_waitcnt vmcnt(21)
    v_mfma_f32_16x16x32_bf16 v[128:131], v[0:3], v[104:107], v[128:131]
    v_mfma_f32_16x16x32_bf16 v[132:135], v[4:7], v[104:107], v[132:135]
    v_mfma_f32_16x16x32_bf16 v[136:139], v[8:11], v[104:107], v[136:139]
    v_mfma_f32_16x16x32_bf16 v[140:143], v[12:15], v[104:107], v[140:143]
    s_waitcnt vmcnt(20)
    v_mfma_f32_16x16x32_bf16 v[128:131], v[16:19], v[108:111], v[128:131]
    v_mfma_f32_16x16x32_bf16 v[132:135], v[20:23], v[108:111], v[132:135]
    v_mfma_f32_16x16x32_bf16 v[136:139], v[24:27], v[108:111], v[136:139]
    v_mfma_f32_16x16x32_bf16 v[140:143], v[28:31], v[108:111], v[140:143]
    s_waitcnt vmcnt(19)
    v_mfma_f32_16x16x32_bf16 v[128:131], v[32:35], v[112:115], v[128:131]
    v_mfma_f32_16x16x32_bf16 v[132:135], v[36:39], v[112:115], v[132:135]
    v_mfma_f32_16x16x32_bf16 v[136:139], v[40:43], v[112:115], v[136:139]
    v_mfma_f32_16x16x32_bf16 v[140:143], v[44:47], v[112:115], v[140:143]
    s_waitcnt vmcnt(18)
    v_mfma_f32_16x16x32_bf16 v[128:131], v[48:51], v[116:119], v[128:131]
    v_mfma_f32_16x16x32_bf16 v[132:135], v[52:55], v[116:119], v[132:135]
    v_mfma_f32_16x16x32_bf16 v[136:139], v[56:59], v[116:119], v[136:139]
    v_mfma_f32_16x16x32_bf16 v[140:143], v[60:63], v[116:119], v[140:143]
    s_waitcnt vmcnt(17)
    v_mfma_f32_16x16x32_bf16 v[128:131], v[144:147], v[120:123], v[128:131]
    v_mfma_f32_16x16x32_bf16 v[132:135], v[148:151], v[120:123], v[132:135]
    v_mfma_f32_16x16x32_bf16 v[136:139], v[152:155], v[120:123], v[136:139]
    v_mfma_f32_16x16x32_bf16 v[140:143], v[156:159], v[120:123], v[140:143]
    s_waitcnt vmcnt(16)
    v_mfma_f32_16x16x32_bf16 v[128:131], v[160:163], v[124:127], v[128:131]
    v_mfma_f32_16x16x32_bf16 v[132:135], v[164:167], v[124:127], v[132:135]
    v_mfma_f32_16x16x32_bf16 v[136:139], v[168:171], v[124:127], v[136:139]
    v_mfma_f32_16x16x32_bf16 v[140:143], v[172:175], v[124:127], v[140:143]
    v_lshlrev_b32 v176, 16, v208
    v_and_b32 v177, 0xffff0000, v208
    v_lshlrev_b32 v178, 16, v209
    v_and_b32 v179, 0xffff0000, v209
    v_lshlrev_b32 v180, 16, v210
    v_and_b32 v181, 0xffff0000, v210
    v_lshlrev_b32 v182, 16, v211
    v_and_b32 v183, 0xffff0000, v211
    v_lshlrev_b32 v184, 16, v212
    v_and_b32 v185, 0xffff0000, v212
    v_lshlrev_b32 v186, 16, v213
    v_and_b32 v187, 0xffff0000, v213
    v_lshlrev_b32 v188, 16, v214
    v_and_b32 v189, 0xffff0000, v214
    v_lshlrev_b32 v190, 16, v215
    v_and_b32 v191, 0xffff0000, v215
    v_add_f32 v128, v128, v176
    v_add_f32 v129, v129, v177
    v_add_f32 v130, v130, v178
    v_add_f32 v131, v131, v179
    v_add_f32 v132, v132, v180
    v_add_f32 v133, v133, v181
    v_add_f32 v134, v134, v182
    v_add_f32 v135, v135, v183
    v_add_f32 v136, v136, v184
    v_add_f32 v137, v137, v185
    v_add_f32 v138, v138, v186
    v_add_f32 v139, v139, v187
    v_add_f32 v140, v140, v188
    v_add_f32 v141, v141, v189
    v_add_f32 v142, v142, v190
    v_add_f32 v143, v143, v191
    v_cvt_pk_bf16_f32 v208, v128, v129
    v_cvt_pk_bf16_f32 v209, v130, v131
    v_cvt_pk_bf16_f32 v210, v132, v133
    v_cvt_pk_bf16_f32 v211, v134, v135
    v_cvt_pk_bf16_f32 v212, v136, v137
    v_cvt_pk_bf16_f32 v213, v138, v139
    v_cvt_pk_bf16_f32 v214, v140, v141
    v_cvt_pk_bf16_f32 v215, v142, v143
    s_add_u32 s44, s14, 29360128
    s_cmp_lg_u32 s53, 0
    s_cbranch_scc1 L_kf_wt_49
    buffer_store_dwordx4 v[208:211], v250, s[28:31], s44 offen offset:0
    buffer_store_dwordx4 v[212:215], v250, s[28:31], s44 offen offset:1024
L_kf_wb_50:
    v_lshlrev_b32 v176, 16, v208
    v_and_b32 v177, 0xffff0000, v208
    v_lshlrev_b32 v178, 16, v209
    v_and_b32 v179, 0xffff0000, v209
    v_lshlrev_b32 v180, 16, v210
    v_and_b32 v181, 0xffff0000, v210
    v_lshlrev_b32 v182, 16, v211
    v_and_b32 v183, 0xffff0000, v211
    v_lshlrev_b32 v184, 16, v212
    v_and_b32 v185, 0xffff0000, v212
    v_lshlrev_b32 v186, 16, v213
    v_and_b32 v187, 0xffff0000, v213
    v_lshlrev_b32 v188, 16, v214
    v_and_b32 v189, 0xffff0000, v214
    v_lshlrev_b32 v190, 16, v215
    v_and_b32 v191, 0xffff0000, v215
    v_add_f32 v192, v176, v180
    v_add_f32 v193, v177, v181
    v_add_f32 v194, v178, v182
    v_add_f32 v195, v179, v183
    v_add_f32 v192, v192, v184
    v_add_f32 v193, v193, v185
    v_add_f32 v194, v194, v186
    v_add_f32 v195, v195, v187
    v_add_f32 v192, v192, v188
    v_add_f32 v193, v193, v189
    v_add_f32 v194, v194, v190
    v_add_f32 v195, v195, v191
    v_add_f32 v192, v192, v193
    v_add_f32 v194, v194, v195
    v_add_f32 v192, v192, v194
    v_mov_b32 v198, v192
    s_nop 1
    v_permlane32_swap_b32 v192, v198
    v_add_f32 v192, v192, v198
    v_mov_b32 v198, v192
    s_nop 1
    v_permlane16_swap_b32 v192, v198
    v_add_f32 v192, v192, v198
    v_mul_f32 v192, 0x3c800000, v192
    v_sub_f32 v176, v176, v192
    v_sub_f32 v177, v177, v192
    v_sub_f32 v178, v178, v192
    v_sub_f32 v179, v179, v192
    v_sub_f32 v180, v180, v192
    v_sub_f32 v181, v181, v192
    v_sub_f32 v182, v182, v192
    v_sub_f32 v183, v183, v192
    v_sub_f32 v184, v184, v192
    v_sub_f32 v185, v185, v192
    v_sub_f32 v186, v186, v192
    v_sub_f32 v187, v187, v192
    v_sub_f32 v188, v188, v192
    v_sub_f32 v189, v189, v192
    v_sub_f32 v190, v190, v192
    v_sub_f32 v191, v191, v192
    v_mul_f32 v193, v176, v176
    v_mul_f32 v194, v177, v177
    v_mul_f32 v195, v178, v178
    v_mul_f32 v196, v179, v179
    v_fmac_f32 v193, v180, v180
    v_fmac_f32 v194, v181, v181
    v_fmac_f32 v195, v182, v182
    v_fmac_f32 v196, v183, v183
    v_fmac_f32 v193, v184, v184
    v_fmac_f32 v194, v185, v185
    v_fmac_f32 v195, v186, v186
    v_fmac_f32 v196, v187, v187
    v_fmac_f32 v193, v188, v188
    v_fmac_f32 v194, v189, v189
    v_fmac_f32 v195, v190, v190
    v_fmac_f32 v196, v191, v191
    v_add_f32 v193, v193, v194
    v_add_f32 v195, v195, v196
    v_add_f32 v193, v193, v195
    v_mov_b32 v198, v193
    s_nop 1
    v_permlane32_swap_b32 v193, v198
    v_add_f32 v193, v193, v198
    v_mov_b32 v198, v193
    s_nop 1
    v_permlane16_swap_b32 v193, v198
    v_add_f32 v193, v193, v198
    v_lshrrev_b32 v194, 1, v250
    s_lshr_b32 s45, s56, 4
    s_add_u32 s45, s45, 32768
    s_lshl_b32 s44, s55, 7
    s_add_u32 s44, s44, s45
    s_mov_b64 exec, 0xffff
    s_cmp_lg_u32 s53, 0
    s_cbranch_scc1 L_kf_wt_51
    buffer_store_dwordx2 v[192:193], v194, s[28:31], s44 offen
L_kf_wb_52:
    s_mov_b64 exec, -1
    s_waitcnt vmcnt(0)
    s_add_u32 s44, s101, 311296
    s_mov_b64 exec, 1
    s_cmp_lg_u32 s53, 0
    s_cbranch_scc1 L_kf_wt_53
    buffer_store_dword v235, off, s[28:31], s44
L_kf_wb_54:
    s_mov_b64 exec, -1
    s_add_u32 s59, s100, 311296
    buffer_load_dword v255, v234, s[28:31], s59 offen sc1
    ds_read_b64_tr_b16 a[192:193], v244 offset:0
    ds_read_b64_tr_b16 a[194:195], v244 offset:2048
    ds_read_b64_tr_b16 a[196:197], v245 offset:0
    ds_read_b64_tr_b16 a[198:199], v245 offset:2048
    ds_read_b64_tr_b16 a[200:201], v246 offset:0
    ds_read_b64_tr_b16 a[202:203], v246 offset:2048
    ds_read_b64_tr_b16 a[204:205], v247 offset:0
    ds_read_b64_tr_b16 a[206:207], v247 offset:2048
    ds_read_b64_tr_b16 a[208:209], v244 offset:4096
    ds_read_b64_tr_b16 a[210:211], v244 offset:6144
    ds_read_b64_tr_b16 a[212:213], v245 offset:4096
    ds_read_b64_tr_b16 a[214:215], v245 offset:6144
    ds_read_b64_tr_b16 a[216:217], v246 offset:4096
    ds_read_b64_tr_b16 a[218:219], v246 offset:6144
    ds_read_b64_tr_b16 a[220:221], v247 offset:4096
    ds_read_b64_tr_b16 a[222:223], v247 offset:6144
    ds_read_b64_tr_b16 a[224:225], v244 offset:8192
    ds_read_b64_tr_b16 a[226:227], v244 offset:10240
    ds_read_b64_tr_b16 a[228:229], v245 offset:8192
    ds_read_b64_tr_b16 a[230:231], v245 offset:10240
    ds_read_b64_tr_b16 a[232:233], v246 offset:8192
    ds_read_b64_tr_b16 a[234:235], v246 offset:10240
    ds_read_b64_tr_b16 a[236:237], v247 offset:8192
    ds_read_b64_tr_b16 a[238:239], v247 offset:10240
    ds_read_b64_tr_b16 a[240:241], v244 offset:12288
    ds_read_b64_tr_b16 a[242:243], v244 offset:14336
    ds_read_b64_tr_b16 a[244:245], v245 offset:12288
    ds_read_b64_tr_b16 a[246:247], v245 offset:14336
    ds_read_b64_tr_b16 a[248:249], v246 offset:12288
    ds_read_b64_tr_b16 a[250:251], v246 offset:14336
    ds_read_b64_tr_b16 a[252:253], v247 offset:12288
    ds_read_b64_tr_b16 a[254:255], v247 offset:14336
    v_and_b32 v128, 15, v253
    v_lshrrev_b32 v129, 4, v253
    v_lshlrev_b32 v129, 4, v129
    v_lshlrev_b32 v127, 3, v128
    v_lshl_add_u32 v128, v129, 4, v127
    v_add_u32 v127, 159744, v127
    s_cmp_eq_u32 s3, 3
    s_cselect_b32 s47, 7, 8
    s_cselect_b64 s[48:49], 0, -1
    s_lshl_b32 s47, s47, 12
    s_add_u32 s47, s47, s36
    s_add_u32 s44, s3, 1
    s_and_b32 s44, s44, 3
    s_lshl_b32 s46, s44, 12
    v_add_u32 v114, s46, v250
    v_add_u32 v115, s46, v251
    s_lshl_b32 s46, s44, 10
    s_add_u32 s46, s46, s47
    v_add_u32 v121, s46, v250
    s_lshl_b32 s46, s44, 7
    v_add_u32 v124, s46, v127
    s_add_u32 s44, s3, 2
    s_and_b32 s44, s44, 3
    s_lshl_b32 s46, s44, 12
    v_add_u32 v116, s46, v250
    v_add_u32 v117, s46, v251
    s_lshl_b32 s46, s44, 10
    s_add_u32 s46, s46, s47
    v_add_u32 v122, s46, v250
    s_lshl_b32 s46, s44, 7
    v_add_u32 v125, s46, v127
    s_add_u32 s44, s3, 3
    s_and_b32 s44, s44, 3
    s_lshl_b32 s46, s44, 12
    v_add_u32 v118, s46, v250
    v_add_u32 v119, s46, v251
    s_lshl_b32 s46, s44, 10
    s_add_u32 s46, s46, s47
    v_add_u32 v123, s46, v250
    s_lshl_b32 s46, s44, 7
    v_add_u32 v126, s46, v127
    s_lshl_b32 s46, s3, 12
    v_add_u32 v112, s46, v250
    v_add_u32 v113, s46, v251
    s_lshl_b32 s46, s3, 10
    s_add_u32 s46, s46, s47
    v_add_u32 v120, s46, v250
    s_lshl_b32 s46, s3, 7
    v_add_u32 v127, s46, v127
    s_waitcnt lgkmcnt(0)
    s_barrier
L_kf_poll_55:
    s_waitcnt vmcnt(0)
    v_cmp_ne_u32 vcc, s51, v255
    s_cbranch_vccz L_kf_seen_56
    s_sleep 1
    buffer_load_dword v255, v234, s[28:31], s59 offen sc1
    s_sub_i32 s52, s52, 1
    s_cmp_gt_i32 s52, 0
    s_cbranch_scc1 L_kf_poll_55
    s_waitcnt vmcnt(0)
L_kf_seen_56:
    s_lshl_b32 s46, s3, 12
    s_add_u32 m0, s46, 0
    s_add_u32 s44, s56, 29360128
    buffer_load_dwordx4 v250, s[28:31], s44 offen offset:0 sc1 lds
    buffer_load_dwordx4 v250, s[28:31], s44 offen offset:1024 sc1 lds
    buffer_load_dwordx4 v250, s[28:31], s44 offen offset:2048 sc1 lds
    buffer_load_dwordx4 v250, s[28:31], s44 offen offset:3072 sc1 lds
    s_add_u32 m0, s46, 40960
    s_add_u32 s44, s56, 29364224
    buffer_load_dwordx4 v250, s[28:31], s44 offen offset:0 sc1 lds
    buffer_load_dwordx4 v250, s[28:31], s44 offen offset:1024 sc1 lds
    buffer_load_dwordx4 v250, s[28:31], s44 offen offset:2048 sc1 lds
    buffer_load_dwordx4 v250, s[28:31], s44 offen offset:3072 sc1 lds
    buffer_load_dwordx2 v[132:133], v128, s[28:31], s45 offen offset:0 sc1
    buffer_load_dwordx2 v[134:135], v128, s[28:31], s45 offen offset:128 sc1
    s_add_u32 m0, s46, 81920
    s_add_u32 s44, s56, 29368320
    buffer_load_dwordx4 v250, s[28:31], s44 offen offset:0 sc1 lds
    buffer_load_dwordx4 v250, s[28:31], s44 offen offset:1024 sc1 lds
    buffer_load_dwordx4 v250, s[28:31], s44 offen offset:2048 sc1 lds
    buffer_load_dwordx4 v250, s[28:31], s44 offen offset:3072 sc1 lds
    s_add_u32 m0, s46, 122880
    s_add_u32 s44, s56, 29372416
    buffer_load_dwordx4 v250, s[28:31], s44 offen offset:0 sc1 lds
    buffer_load_dwordx4 v250, s[28:31], s44 offen offset:1024 sc1 lds
    buffer_load_dwordx4 v250, s[28:31], s44 offen offset:2048 sc1 lds
    buffer_load_dwordx4 v250, s[28:31], s44 offen offset:3072 sc1 lds
    s_lshl_b32 s44, s79, 1
    s_add_u32 s44, s44, 16384
    buffer_load_dwordx4 v[80:83], v129, s[28:31], s44 offen offset:0 sc1
    buffer_load_dwordx4 v[84:87], v129, s[28:31], s44 offen offset:64 sc1
    buffer_load_dwordx4 v[88:91], v129, s[28:31], s44 offen offset:128 sc1
    buffer_load_dwordx4 v[92:95], v129, s[28:31], s44 offen offset:192 sc1
    s_mov_b32 s16, s94
    s_mov_b32 s17, s95
    s_mov_b32 s18, 0x1c0000
    s_mov_b32 s19, 0x20000
    s_mul_i32 s78, s55, 229376
    s_lshl_b32 s44, s3, 8
    s_add_u32 s78, s78, s44
    s_waitcnt vmcnt(18)
    ds_read_b128 v[0:3], v112 offset:0
    ds_read_b128 v[4:7], v112 offset:1024
    ds_read_b128 v[8:11], v112 offset:2048
    ds_read_b128 v[12:15], v112 offset:3072
    s_waitcnt vmcnt(14)
    ds_read_b128 v[16:19], v112 offset:40960
    s_waitcnt lgkmcnt(4)
    v_mfma_f32_16x16x32_bf16 v[32:35], a[0:3], v[0:3], 0
    ds_read_b128 v[20:23], v112 offset:41984
    v_mfma_f32_16x16x32_bf16 v[36:39], a[4:7], v[0:3], 0
    v_mfma_f32_16x16x32_bf16 v[40:43], a[8:11], v[0:3], 0
    s_add_u32 m0, s36, 16384
    s_add_u32 s39, s78, 0
    buffer_load_dwordx4 v248, s[16:19], s39 offen offset:0 lds
    v_mfma_f32_16x16x32_bf16 v[44:47], a[12:15], v[0:3], 0
    s_waitcnt lgkmcnt(4)
    v_mfma_f32_16x16x32_bf16 v[32:35], a[16:19], v[4:7], v[32:35]
    ds_read_b128 v[24:27], v112 offset:43008
    v_mfma_f32_16x16x32_bf16 v[36:39], a[20:23], v[4:7], v[36:39]
    v_mfma_f32_16x16x32_bf16 v[40:43], a[24:27], v[4:7], v[40:43]
    s_add_u32 s39, s78, 7168
    buffer_load_dwordx4 v248, s[16:19], s39 offen offset:1024 lds
    v_mfma_f32_16x16x32_bf16 v[44:47], a[28:31], v[4:7], v[44:47]
    s_waitcnt lgkmcnt(4)
    v_mfma_f32_16x16x32_bf16 v[32:35], a[32:35], v[8:11], v[32:35]
    ds_read_b128 v[28:31], v112 offset:44032
    v_mfma_f32_16x16x32_bf16 v[36:39], a[36:39], v[8:11], v[36:39]
    v_mfma_f32_16x16x32_bf16 v[40:43], a[40:43], v[8:11], v[40:43]
    s_add_u32 s39, s78, 14336
    buffer_load_dwordx4 v248, s[16:19], s39 offen offset:2048 lds
    v_mfma_f32_16x16x32_bf16 v[44:47], a[44:47], v[8:11], v[44:47]
    s_waitcnt lgkmcnt(4)
    v_mfma_f32_16x16x32_bf16 v[32:35], a[48:51], v[12:15], v[32:35]
    s_waitcnt vmcnt(11)
    ds_read_b128 v[0:3], v113 offset:0
    v_mfma_f32_16x16x32_bf16 v[36:39], a[52:55], v[12:15], v[36:39]
    v_mfma_f32_16x16x32_bf16 v[40:43], a[56:59], v[12:15], v[40:43]
    s_add_u32 s39, s78, 21504
    buffer_load_dwordx4 v248, s[16:19], s39 offen offset:3072 lds
    v_mfma_f32_16x16x32_bf16 v[44:47], a[60:63], v[12:15], v[44:47]
    s_waitcnt lgkmcnt(4)
    v_mfma_f32_16x16x32_bf16 v[32:35], a[64:67], v[16:19], v[32:35]
    ds_read_b128 v[4:7], v113 offset:1024
    v_add_f32 v136, v132, v134
    v_mov_b32 v138, v136
    v_mfma_f32_16x16x32_bf16 v[36:39], a[68:71], v[16:19], v[36:39]
    s_nop 0
    v_permlane32_swap_b32 v136, v138
    v_add_f32 v136, v136, v138
    v_mfma_f32_16x16x32_bf16 v[40:43], a[72:75], v[16:19], v[40:43]
    s_add_u32 m0, s36, 20352
    s_add_u32 s39, s78, 0
    buffer_load_dwordx4 v248, s[16:19], s39 offen offset:128 lds
    v_mfma_f32_16x16x32_bf16 v[44:47], a[76:79], v[16:19], v[44:47]
    v_mov_b32 v138, v136
    s_nop 1
    v_permlane16_swap_b32 v136, v138
    s_waitcnt lgkmcnt(4)
    v_mfma_f32_16x16x32_bf16 v[32:35], a[80:83], v[20:23], v[32:35]
    ds_read_b128 v[8:11], v113 offset:2048
    v_add_f32 v136, v136, v138
    v_mul_f32 v136, 0x3e000000, v136
    v_mfma_f32_16x16x32_bf16 v[36:39], a[84:87], v[20:23], v[36:39]
    v_add_f32 v133, v133, v135
    v_sub_f32 v132, v132, v136
    v_mfma_f32_16x16x32_bf16 v[40:43], a[88:91], v[20:23], v[40:43]
    s_add_u32 s39, s78, 7168
    buffer_load_dwordx4 v248, s[16:19], s39 offen offset:1152 lds
    v_mfma_f32_16x16x32_bf16 v[44:47], a[92:95], v[20:23], v[44:47]
    v_sub_f32 v134, v134, v136
    v_mul_f32 v132, v132, v132
    s_waitcnt lgkmcnt(4)
    v_mfma_f32_16x16x32_bf16 v[32:35], a[96:99], v[24:27], v[32:35]
    ds_read_b128 v[12:15], v113 offset:3072
    v_fmac_f32 v132, v134, v134
    v_fmamk_f32 v133, v132, 0x42800000, v133
    v_mfma_f32_16x16x32_bf16 v[36:39], a[100:103], v[24:27], v[36:39]
    v_mov_b32 v138, v133
    s_nop 1
    v_permlane32_swap_b32 v133, v138
    v_mfma_f32_16x16x32_bf16 v[40:43], a[104:107], v[24:27], v[40:43]
    s_add_u32 s39, s78, 14336
    buffer_load_dwordx4 v248, s[16:19], s39 offen offset:2176 lds
    v_mfma_f32_16x16x32_bf16 v[44:47], a[108:111], v[24:27], v[44:47]
    v_add_f32 v133, v133, v138
    v_mov_b32 v138, v133
    s_waitcnt lgkmcnt(4)
    v_mfma_f32_16x16x32_bf16 v[32:35], a[112:115], v[28:31], v[32:35]
    s_waitcnt vmcnt(11)
    ds_read_b128 v[16:19], v113 offset:40960
    v_permlane16_swap_b32 v133, v138
    v_add_f32 v133, v133, v138
    v_mfma_f32_16x16x32_bf16 v[36:39], a[116:119], v[28:31], v[36:39]
    v_mov_b32 v134, 0x3727c5ac
    v_fmamk_f32 v133, v133, 0x3b000000, v134
    v_mfma_f32_16x16x32_bf16 v[40:43], a[120:123], v[28:31], v[40:43]
    s_add_u32 s39, s78, 21504
    buffer_load_dwordx4 v248, s[16:19], s39 offen offset:3200 lds
    v_mfma_f32_16x16x32_bf16 v[44:47], a[124:127], v[28:31], v[44:47]
    v_rsq_f32 v97, v133
    v_sub_f32 v96, 0, v136
    s_waitcnt lgkmcnt(4)
    v_mfma_f32_16x16x32_bf16 v[32:35], a[128:131], v[0:3], v[32:35]
    ds_read_b128 v[20:23], v113 offset:41984
    s_mov_b64 exec, 0xffff
    ds_write_b64 v127, v[96:97]
    s_mov_b64 exec, -1
    v_mfma_f32_16x16x32_bf16 v[36:39], a[132:135], v[0:3], v[36:39]
    v_mfma_f32_16x16x32_bf16 v[40:43], a[136:139], v[0:3], v[40:43]
    s_add_u32 m0, s36, 24576
    s_add_u32 s39, s78, 32768
    buffer_load_dwordx4 v248, s[16:19], s39 offen offset:0 lds
    v_mfma_f32_16x16x32_bf16 v[44:47], a[140:143], v[0:3], v[44:47]
    s_waitcnt lgkmcnt(5)
    v_mfma_f32_16x16x32_bf16 v[32:35], a[144:147], v[4:7], v[32:35]
    ds_read_b128 v[24:27], v113 offset:43008
    v_mfma_f32_16x16x32_bf16 v[36:39], a[148:151], v[4:7], v[36:39]
    v_mfma_f32_16x16x32_bf16 v[40:43], a[152:155], v[4:7], v[40:43]
    s_add_u32 s39, s78, 39936
    buffer_load_dwordx4 v248, s[16:19], s39 offen offset:1024 lds
    v_mfma_f32_16x16x32_bf16 v[44:47], a[156:159], v[4:7], v[44:47]
    s_waitcnt lgkmcnt(5)
    v_mfma_f32_16x16x32_bf16 v[32:35], a[160:163], v[8:11], v[32:35]
    ds_read_b128 v[28:31], v113 offset:44032
    v_mfma_f32_16x16x32_bf16 v[36:39], a[164:167], v[8:11], v[36:39]
    v_mfma_f32_16x16x32_bf16 v[40:43], a[168:171], v[8:11], v[40:43]
    s_add_u32 s39, s78, 47104
    buffer_load_dwordx4 v248, s[16:19], s39 offen offset:2048 lds
    v_mfma_f32_16x16x32_bf16 v[44:47], a[172:175], v[8:11], v[44:47]
    s_waitcnt lgkmcnt(5)
    v_mfma_f32_16x16x32_bf16 v[32:35], a[176:179], v[12:15], v[32:35]
    s_waitcnt lgkmcnt(2)
    s_barrier
    ds_read_b64 v[98:99], v124
    ds_read_b64 v[100:101], v125
    ds_read_b64 v[102:103], v126
    ds_read_b128 v[0:3], v114 offset:0
    v_mfma_f32_16x16x32_bf16 v[36:39], a[180:183], v[12:15], v[36:39]
    v_mfma_f32_16x16x32_bf16 v[40:43], a[184:187], v[12:15], v[40:43]
    s_add_u32 s39, s78, 54272
    buffer_load_dwordx4 v248, s[16:19], s39 offen offset:3072 lds
    v_mfma_f32_16x16x32_bf16 v[44:47], a[188:191], v[12:15], v[44:47]
    s_add_u32 m0, s36, 28544
    s_add_u32 s39, s78, 32768
    buffer_load_dwordx4 v248, s[16:19], s39 offen offset:128 lds
    v_mfma_f32_16x16x32_bf16 v[32:35], a[192:195], v[16:19], v[32:35]
    ds_read_b128 v[4:7], v114 offset:1024
    v_mfma_f32_16x16x32_bf16 v[36:39], a[196:199], v[16:19], v[36:39]
    v_mfma_f32_16x16x32_bf16 v[40:43], a[200:203], v[16:19], v[40:43]
    s_add_u32 s39, s78, 39936
    buffer_load_dwordx4 v248, s[16:19], s39 offen offset:1152 lds
    v_mfma_f32_16x16x32_bf16 v[44:47], a[204:207], v[16:19], v[44:47]
    s_add_u32 s39, s78, 47104
    buffer_load_dwordx4 v248, s[16:19], s39 offen offset:2176 lds
    v_mfma_f32_16x16x32_bf16 v[32:35], a[208:211], v[20:23], v[32:35]
    ds_read_b128 v[8:11], v114 offset:2048
    v_mfma_f32_16x16x32_bf16 v[36:39], a[212:215], v[20:23], v[36:39]
    v_mfma_f32_16x16x32_bf16 v[40:43], a[216:219], v[20:23], v[40:43]
    s_add_u32 s39, s78, 54272
    buffer_load_dwordx4 v248, s[16:19], s39 offen offset:3200 lds
    v_mfma_f32_16x16x32_bf16 v[44:47], a[220:223], v[20:23], v[44:47]
    s_lshl_b32 s44, s55, 21
    s_lshl_b32 s46, s54, 16
    s_add_u32 s44, s44, s46
    s_lshl_b32 s46, s3, 14
    s_add_u32 s44, s44, s46
    v_lshlrev_b32 v200, 3, v250
    s_mul_i32 s46, s53, 27262976
    s_add_u32 s46, s46, 4194304
    s_add_u32 s44, s44, s46
    buffer_load_dword v255, v200, s[28:31], s44 offen
    s_add_u32 s44, s44, 8192
    buffer_load_dword v255, v200, s[28:31], s44 offen
    s_waitcnt lgkmcnt(7)
    v_mfma_f32_16x16x32_bf16 v[32:35], a[224:227], v[24:27], v[32:35]
    ds_read_b128 v[12:15], v114 offset:3072
    v_mfma_f32_16x16x32_bf16 v[36:39], a[228:231], v[24:27], v[36:39]
    v_mfma_f32_16x16x32_bf16 v[40:43], a[232:235], v[24:27], v[40:43]
    s_lshl_b32 s44, s43, 2
    s_add_u32 s44, s44, s3
    s_mul_i32 s44, s44, 14336
    v_lshlrev_b32 v200, 3, v250
    v_add_u32 v200, s44, v200
    v_add_u32 v201, 6144, v200
    global_load_dword v255, v200, s[94:95]
    global_load_dword v255, v201, s[94:95]
    v_mfma_f32_16x16x32_bf16 v[44:47], a[236:239], v[24:27], v[44:47]
    s_waitcnt lgkmcnt(7)
    v_mfma_f32_16x16x32_bf16 v[32:35], a[240:243], v[28:31], v[32:35]
    ds_read_b128 v[16:19], v114 offset:40960
    v_mfma_f32_16x16x32_bf16 v[36:39], a[244:247], v[28:31], v[36:39]
    v_mfma_f32_16x16x32_bf16 v[40:43], a[248:251], v[28:31], v[40:43]
    v_mfma_f32_16x16x32_bf16 v[44:47], a[252:255], v[28:31], v[44:47]
    s_waitcnt lgkmcnt(4)
    v_mfma_f32_16x16x32_bf16 v[48:51], a[0:3], v[0:3], 0
    ds_read_b128 v[20:23], v114 offset:41984
    v_mfma_f32_16x16x32_bf16 v[52:55], a[4:7], v[0:3], 0
    s_waitcnt vmcnt(20)
    v_mfma_f32_16x16x32_bf16 v[56:59], a[8:11], v[0:3], 0
    v_pk_fma_f32 v[32:33], v[80:81], v[96:97], v[32:33] op_sel_hi:[1,0,1]
    v_pk_fma_f32 v[34:35], v[82:83], v[96:97], v[34:35] op_sel_hi:[1,0,1]
    v_pk_fma_f32 v[36:37], v[84:85], v[96:97], v[36:37] op_sel_hi:[1,0,1]
    v_mfma_f32_16x16x32_bf16 v[60:63], a[12:15], v[0:3], 0
    v_pk_fma_f32 v[38:39], v[86:87], v[96:97], v[38:39] op_sel_hi:[1,0,1]
    v_pk_fma_f32 v[40:41], v[88:89], v[96:97], v[40:41] op_sel_hi:[1,0,1]
    v_pk_fma_f32 v[42:43], v[90:91], v[96:97], v[42:43] op_sel_hi:[1,0,1]
    s_waitcnt lgkmcnt(4)
    v_mfma_f32_16x16x32_bf16 v[48:51], a[16:19], v[4:7], v[48:51]
    ds_read_b128 v[24:27], v114 offset:43008
    v_pk_fma_f32 v[44:45], v[92:93], v[96:97], v[44:45] op_sel_hi:[1,0,1]
    v_pk_fma_f32 v[46:47], v[94:95], v[96:97], v[46:47] op_sel_hi:[1,0,1]
    v_mfma_f32_16x16x32_bf16 v[52:55], a[20:23], v[4:7], v[52:55]
    v_mov_b32 v96, v97
    v_pk_mul_f32 v[32:33], v[32:33], v[96:97]
    v_pk_mul_f32 v[34:35], v[34:35], v[96:97]
    v_mfma_f32_16x16x32_bf16 v[56:59], a[24:27], v[4:7], v[56:59]
    v_pk_mul_f32 v[36:37], v[36:37], v[96:97]
    v_pk_mul_f32 v[38:39], v[38:39], v[96:97]
    v_pk_mul_f32 v[40:41], v[40:41], v[96:97]
    v_mfma_f32_16x16x32_bf16 v[60:63], a[28:31], v[4:7], v[60:63]
    v_pk_mul_f32 v[42:43], v[42:43], v[96:97]
    v_pk_mul_f32 v[44:45], v[44:45], v[96:97]
    v_pk_mul_f32 v[46:47], v[46:47], v[96:97]
    s_waitcnt lgkmcnt(4)
    v_mfma_f32_16x16x32_bf16 v[48:51], a[32:35], v[8:11], v[48:51]
    ds_read_b128 v[28:31], v114 offset:44032
    v_pk_mul_f32 v[64:65], v[32:33], v[32:33]
    v_pk_mul_f32 v[66:67], v[34:35], v[34:35]
    v_mfma_f32_16x16x32_bf16 v[52:55], a[36:39], v[8:11], v[52:55]
    v_pk_mul_f32 v[68:69], v[36:37], v[36:37]
    v_pk_mul_f32 v[70:71], v[38:39], v[38:39]
    v_pk_mul_f32 v[72:73], v[40:41], v[40:41]
    v_mfma_f32_16x16x32_bf16 v[56:59], a[40:43], v[8:11], v[56:59]
    v_pk_mul_f32 v[74:75], v[42:43], v[42:43]
    v_pk_mul_f32 v[76:77], v[44:45], v[44:45]
    v_pk_mul_f32 v[78:79], v[46:47], v[46:47]
    v_mfma_f32_16x16x32_bf16 v[60:63], a[44:47], v[8:11], v[60:63]
    v_pk_fma_f32 v[64:65], v[64:65], v[206:207], v[204:205]
    v_pk_fma_f32 v[66:67], v[66:67], v[206:207], v[204:205]
    v_pk_fma_f32 v[68:69], v[68:69], v[206:207], v[204:205]
    s_waitcnt lgkmcnt(4)
    v_mfma_f32_16x16x32_bf16 v[48:51], a[48:51], v[12:15], v[48:51]
    ds_read_b128 v[0:3], v115 offset:0
    v_pk_fma_f32 v[70:71], v[70:71], v[206:207], v[204:205]
    v_pk_fma_f32 v[72:73], v[72:73], v[206:207], v[204:205]
    v_mfma_f32_16x16x32_bf16 v[52:55], a[52:55], v[12:15], v[52:55]
    v_pk_fma_f32 v[74:75], v[74:75], v[206:207], v[204:205]
    v_pk_fma_f32 v[76:77], v[76:77], v[206:207], v[204:205]
    v_pk_fma_f32 v[78:79], v[78:79], v[206:207], v[204:205]
    v_mfma_f32_16x16x32_bf16 v[56:59], a[56:59], v[12:15], v[56:59]
    v_pk_mul_f32 v[64:65], v[64:65], v[32:33]
    v_pk_mul_f32 v[66:67], v[66:67], v[34:35]
    v_pk_mul_f32 v[68:69], v[68:69], v[36:37]
    v_mfma_f32_16x16x32_bf16 v[60:63], a[60:63], v[12:15], v[60:63]
    v_pk_mul_f32 v[70:71], v[70:71], v[38:39]
    v_pk_mul_f32 v[72:73], v[72:73], v[40:41]
    v_pk_mul_f32 v[74:75], v[74:75], v[42:43]
    s_waitcnt lgkmcnt(4)
    v_mfma_f32_16x16x32_bf16 v[48:51], a[64:67], v[16:19], v[48:51]
    ds_read_b128 v[4:7], v115 offset:1024
    v_pk_mul_f32 v[76:77], v[76:77], v[44:45]
    v_pk_mul_f32 v[78:79], v[78:79], v[46:47]
    v_mfma_f32_16x16x32_bf16 v[52:55], a[68:71], v[16:19], v[52:55]
    v_exp_f32 v64, v64
    v_mfma_f32_16x16x32_bf16 v[56:59], a[72:75], v[16:19], v[56:59]
    v_exp_f32 v65, v65
    v_mfma_f32_16x16x32_bf16 v[60:63], a[76:79], v[16:19], v[60:63]
    v_exp_f32 v66, v66
    s_waitcnt lgkmcnt(4)
    v_mfma_f32_16x16x32_bf16 v[48:51], a[80:83], v[20:23], v[48:51]
    ds_read_b128 v[8:11], v115 offset:2048
    v_exp_f32 v67, v67
    v_mfma_f32_16x16x32_bf16 v[52:55], a[84:87], v[20:23], v[52:55]
    v_exp_f32 v68, v68
    v_mfma_f32_16x16x32_bf16 v[56:59], a[88:91], v[20:23], v[56:59]
    v_exp_f32 v69, v69
    v_mfma_f32_16x16x32_bf16 v[60:63], a[92:95], v[20:23], v[60:63]
    v_exp_f32 v70, v70
    s_waitcnt lgkmcnt(4)
    v_mfma_f32_16x16x32_bf16 v[48:51], a[96:99], v[24:27], v[48:51]
    ds_read_b128 v[12:15], v115 offset:3072
    v_exp_f32 v71, v71
    v_mfma_f32_16x16x32_bf16 v[52:55], a[100:103], v[24:27], v[52:55]
    v_exp_f32 v72, v72
    v_mfma_f32_16x16x32_bf16 v[56:59], a[104:107], v[24:27], v[56:59]
    v_exp_f32 v73, v73
    v_mfma_f32_16x16x32_bf16 v[60:63], a[108:111], v[24:27], v[60:63]
    v_exp_f32 v74, v74
    s_waitcnt lgkmcnt(4)
    v_mfma_f32_16x16x32_bf16 v[48:51], a[112:115], v[28:31], v[48:51]
    ds_read_b128 v[16:19], v115 offset:40960
    v_exp_f32 v75, v75
    v_mfma_f32_16x16x32_bf16 v[52:55], a[116:119], v[28:31], v[52:55]
    v_exp_f32 v76, v76
    v_mfma_f32_16x16x32_bf16 v[56:59], a[120:123], v[28:31], v[56:59]
    v_exp_f32 v77, v77
    v_mfma_f32_16x16x32_bf16 v[60:63], a[124:127], v[28:31], v[60:63]
    v_exp_f32 v78, v78
    s_waitcnt lgkmcnt(4)
    v_mfma_f32_16x16x32_bf16 v[48:51], a[128:131], v[0:3], v[48:51]
    ds_read_b128 v[20:23], v115 offset:41984
    v_exp_f32 v79, v79
    v_mfma_f32_16x16x32_bf16 v[52:55], a[132:135], v[0:3], v[52:55]
    v_pk_add_f32 v[64:65], v[64:65], 1.0 op_sel_hi:[1,0]
    v_pk_add_f32 v[66:67], v[66:67], 1.0 op_sel_hi:[1,0]
    v_pk_add_f32 v[68:69], v[68:69], 1.0 op_sel_hi:[1,0]
    v_mfma_f32_16x16x32_bf16 v[56:59], a[136:139], v[0:3], v[56:59]
    v_pk_add_f32 v[70:71], v[70:71], 1.0 op_sel_hi:[1,0]
    v_pk_add_f32 v[72:73], v[72:73], 1.0 op_sel_hi:[1,0]
    v_pk_add_f32 v[74:75], v[74:75], 1.0 op_sel_hi:[1,0]
    v_mfma_f32_16x16x32_bf16 v[60:63], a[140:143], v[0:3], v[60:63]
    v_pk_add_f32 v[76:77], v[76:77], 1.0 op_sel_hi:[1,0]
    v_pk_add_f32 v[78:79], v[78:79], 1.0 op_sel_hi:[1,0]
    s_waitcnt lgkmcnt(4)
    v_mfma_f32_16x16x32_bf16 v[48:51], a[144:147], v[4:7], v[48:51]
    ds_read_b128 v[24:27], v115 offset:43008
    v_rcp_f32 v64, v64
    v_mfma_f32_16x16x32_bf16 v[52:55], a[148:151], v[4:7], v[52:55]
    v_rcp_f32 v65, v65
    v_mfma_f32_16x16x32_bf16 v[56:59], a[152:155], v[4:7], v[56:59]
    v_rcp_f32 v66, v66
    v_mfma_f32_16x16x32_bf16 v[60:63], a[156:159], v[4:7], v[60:63]
    v_rcp_f32 v67, v67
    s_waitcnt lgkmcnt(4)
    v_mfma_f32_16x16x32_bf16 v[48:51], a[160:163], v[8:11], v[48:51]
    ds_read_b128 v[28:31], v115 offset:44032
    v_rcp_f32 v68, v68
    v_mfma_f32_16x16x32_bf16 v[52:55], a[164:167], v[8:11], v[52:55]
    v_rcp_f32 v69, v69
    v_mfma_f32_16x16x32_bf16 v[56:59], a[168:171], v[8:11], v[56:59]
    v_rcp_f32 v70, v70
    v_mfma_f32_16x16x32_bf16 v[60:63], a[172:175], v[8:11], v[60:63]
    v_rcp_f32 v71, v71
    s_waitcnt lgkmcnt(4)
    v_mfma_f32_16x16x32_bf16 v[48:51], a[176:179], v[12:15], v[48:51]
    ds_read_b128 v[0:3], v116 offset:0
    v_rcp_f32 v72, v72
    v_mfma_f32_16x16x32_bf16 v[52:55], a[180:183], v[12:15], v[52:55]
    v_rcp_f32 v73, v73
    v_mfma_f32_16x16x32_bf16 v[56:59], a[184:187], v[12:15], v[56:59]
    v_rcp_f32 v74, v74
    v_mfma_f32_16x16x32_bf16 v[60:63], a[188:191], v[12:15], v[60:63]
    v_rcp_f32 v75, v75
    s_waitcnt lgkmcnt(4)
    v_mfma_f32_16x16x32_bf16 v[48:51], a[192:195], v[16:19], v[48:51]
    ds_read_b128 v[4:7], v116 offset:1024
    v_rcp_f32 v76, v76
    v_mfma_f32_16x16x32_bf16 v[52:55], a[196:199], v[16:19], v[52:55]
    v_rcp_f32 v77, v77
    v_mfma_f32_16x16x32_bf16 v[56:59], a[200:203], v[16:19], v[56:59]
    v_rcp_f32 v78, v78
    v_mfma_f32_16x16x32_bf16 v[60:63], a[204:207], v[16:19], v[60:63]
    v_rcp_f32 v79, v79
    v_pk_mul_f32 v[32:33], v[64:65], v[32:33]
    s_waitcnt lgkmcnt(4)
    v_mfma_f32_16x16x32_bf16 v[48:51], a[208:211], v[20:23], v[48:51]
    ds_read_b128 v[8:11], v116 offset:2048
    v_pk_mul_f32 v[34:35], v[66:67], v[34:35]
    v_pk_mul_f32 v[36:37], v[68:69], v[36:37]
    v_mfma_f32_16x16x32_bf16 v[52:55], a[212:215], v[20:23], v[52:55]
    v_pk_mul_f32 v[38:39], v[70:71], v[38:39]
    v_pk_mul_f32 v[40:41], v[72:73], v[40:41]
    v_pk_mul_f32 v[42:43], v[74:75], v[42:43]
    v_mfma_f32_16x16x32_bf16 v[56:59], a[216:219], v[20:23], v[56:59]
    v_pk_mul_f32 v[44:45], v[76:77], v[44:45]
    v_pk_mul_f32 v[46:47], v[78:79], v[46:47]
    v_cvt_pk_bf16_f32 v104, v32, v33
    v_mfma_f32_16x16x32_bf16 v[60:63], a[220:223], v[20:23], v[60:63]
    v_cvt_pk_bf16_f32 v105, v34, v35
    v_cvt_pk_bf16_f32 v106, v36, v37
    v_cvt_pk_bf16_f32 v107, v38, v39
    s_waitcnt lgkmcnt(4)
    v_mfma_f32_16x16x32_bf16 v[48:51], a[224:227], v[24:27], v[48:51]
    ds_read_b128 v[12:15], v116 offset:3072
    v_cvt_pk_bf16_f32 v108, v40, v41
    v_cvt_pk_bf16_f32 v109, v42, v43
    v_mfma_f32_16x16x32_bf16 v[52:55], a[228:231], v[24:27], v[52:55]
    v_cvt_pk_bf16_f32 v110, v44, v45
    v_cvt_pk_bf16_f32 v111, v46, v47
    s_mov_b64 exec, s[48:49]
    ds_write_b128 v120, v[104:107]
    s_mov_b64 exec, -1
    ds_write_b128 v120, v[108:111] offset:4096
    v_mfma_f32_16x16x32_bf16 v[56:59], a[232:235], v[24:27], v[56:59]
    v_mfma_f32_16x16x32_bf16 v[60:63], a[236:239], v[24:27], v[60:63]
    s_waitcnt lgkmcnt(6)
    v_mfma_f32_16x16x32_bf16 v[48:51], a[240:243], v[28:31], v[48:51]
    ds_read_b128 v[16:19], v116 offset:40960
    v_mfma_f32_16x16x32_bf16 v[52:55], a[244:247], v[28:31], v[52:55]
    v_mfma_f32_16x16x32_bf16 v[56:59], a[248:251], v[28:31], v[56:59]
    v_mfma_f32_16x16x32_bf16 v[60:63], a[252:255], v[28:31], v[60:63]
    s_waitcnt lgkmcnt(6)
    v_mfma_f32_16x16x32_bf16 v[32:35], a[0:3], v[0:3], 0
    ds_read_b128 v[20:23], v116 offset:41984
    v_mfma_f32_16x16x32_bf16 v[36:39], a[4:7], v[0:3], 0
    v_mfma_f32_16x16x32_bf16 v[40:43], a[8:11], v[0:3], 0
    v_pk_fma_f32 v[48:49], v[80:81], v[98:99], v[48:49] op_sel_hi:[1,0,1]
    v_pk_fma_f32 v[50:51], v[82:83], v[98:99], v[50:51] op_sel_hi:[1,0,1]
    v_pk_fma_f32 v[52:53], v[84:85], v[98:99], v[52:53] op_sel_hi:[1,0,1]
    v_mfma_f32_16x16x32_bf16 v[44:47], a[12:15], v[0:3], 0
    v_pk_fma_f32 v[54:55], v[86:87], v[98:99], v[54:55] op_sel_hi:[1,0,1]
    v_pk_fma_f32 v[56:57], v[88:89], v[98:99], v[56:57] op_sel_hi:[1,0,1]
    v_pk_fma_f32 v[58:59], v[90:91], v[98:99], v[58:59] op_sel_hi:[1,0,1]
    s_waitcnt lgkmcnt(6)
    v_mfma_f32_16x16x32_bf16 v[32:35], a[16:19], v[4:7], v[32:35]
    ds_read_b128 v[24:27], v116 offset:43008
    v_pk_fma_f32 v[60:61], v[92:93], v[98:99], v[60:61] op_sel_hi:[1,0,1]
    v_pk_fma_f32 v[62:63], v[94:95], v[98:99], v[62:63] op_sel_hi:[1,0,1]
    v_mfma_f32_16x16x32_bf16 v[36:39], a[20:23], v[4:7], v[36:39]
    v_mov_b32 v98, v99
    v_pk_mul_f32 v[48:49], v[48:49], v[98:99]
    v_pk_mul_f32 v[50:51], v[50:51], v[98:99]
    v_mfma_f32_16x16x32_bf16 v[40:43], a[24:27], v[4:7], v[40:43]
    v_pk_mul_f32 v[52:53], v[52:53], v[98:99]
    v_pk_mul_f32 v[54:55], v[54:55], v[98:99]
    v_pk_mul_f32 v[56:57], v[56:57], v[98:99]
    v_mfma_f32_16x16x32_bf16 v[44:47], a[28:31], v[4:7], v[44:47]
    v_pk_mul_f32 v[58:59], v[58:59], v[98:99]
    v_pk_mul_f32 v[60:61], v[60:61], v[98:99]
    v_pk_mul_f32 v[62:63], v[62:63], v[98:99]
    s_waitcnt lgkmcnt(6)
    v_mfma_f32_16x16x32_bf16 v[32:35], a[32:35], v[8:11], v[32:35]
    ds_read_b128 v[28:31], v116 offset:44032
    v_pk_mul_f32 v[64:65], v[48:49], v[48:49]
    v_pk_mul_f32 v[66:67], v[50:51], v[50:51]
    v_mfma_f32_16x16x32_bf16 v[36:39], a[36:39], v[8:11], v[36:39]
    v_pk_mul_f32 v[68:69], v[52:53], v[52:53]
    v_pk_mul_f32 v[70:71], v[54:55], v[54:55]
    v_pk_mul_f32 v[72:73], v[56:57], v[56:57]
    v_mfma_f32_16x16x32_bf16 v[40:43], a[40:43], v[8:11], v[40:43]
    v_pk_mul_f32 v[74:75], v[58:59], v[58:59]
    v_pk_mul_f32 v[76:77], v[60:61], v[60:61]
    v_pk_mul_f32 v[78:79], v[62:63], v[62:63]
    v_mfma_f32_16x16x32_bf16 v[44:47], a[44:47], v[8:11], v[44:47]
    v_pk_fma_f32 v[64:65], v[64:65], v[206:207], v[204:205]
    v_pk_fma_f32 v[66:67], v[66:67], v[206:207], v[204:205]
    v_pk_fma_f32 v[68:69], v[68:69], v[206:207], v[204:205]
    s_waitcnt lgkmcnt(6)
    v_mfma_f32_16x16x32_bf16 v[32:35], a[48:51], v[12:15], v[32:35]
    ds_read_b128 v[0:3], v117 offset:0
    v_pk_fma_f32 v[70:71], v[70:71], v[206:207], v[204:205]
    v_pk_fma_f32 v[72:73], v[72:73], v[206:207], v[204:205]
    v_mfma_f32_16x16x32_bf16 v[36:39], a[52:55], v[12:15], v[36:39]
    v_pk_fma_f32 v[74:75], v[74:75], v[206:207], v[204:205]
    v_pk_fma_f32 v[76:77], v[76:77], v[206:207], v[204:205]
    v_pk_fma_f32 v[78:79], v[78:79], v[206:207], v[204:205]
    v_mfma_f32_16x16x32_bf16 v[40:43], a[56:59], v[12:15], v[40:43]
    v_pk_mul_f32 v[64:65], v[64:65], v[48:49]
    v_pk_mul_f32 v[66:67], v[66:67], v[50:51]
    v_pk_mul_f32 v[68:69], v[68:69], v[52:53]
    v_mfma_f32_16x16x32_bf16 v[44:47], a[60:63], v[12:15], v[44:47]
    v_pk_mul_f32 v[70:71], v[70:71], v[54:55]
    v_pk_mul_f32 v[72:73], v[72:73], v[56:57]
    v_pk_mul_f32 v[74:75], v[74:75], v[58:59]
    s_waitcnt lgkmcnt(4)
    v_mfma_f32_16x16x32_bf16 v[32:35], a[64:67], v[16:19], v[32:35]
    ds_read_b128 v[4:7], v117 offset:1024
    v_pk_mul_f32 v[76:77], v[76:77], v[60:61]
    v_pk_mul_f32 v[78:79], v[78:79], v[62:63]
    v_mfma_f32_16x16x32_bf16 v[36:39], a[68:71], v[16:19], v[36:39]
    v_exp_f32 v64, v64
    v_mfma_f32_16x16x32_bf16 v[40:43], a[72:75], v[16:19], v[40:43]
    v_exp_f32 v65, v65
    v_mfma_f32_16x16x32_bf16 v[44:47], a[76:79], v[16:19], v[44:47]
    v_exp_f32 v66, v66
    s_waitcnt lgkmcnt(4)
    v_mfma_f32_16x16x32_bf16 v[32:35], a[80:83], v[20:23], v[32:35]
    ds_read_b128 v[8:11], v117 offset:2048
    v_exp_f32 v67, v67
    v_mfma_f32_16x16x32_bf16 v[36:39], a[84:87], v[20:23], v[36:39]
    v_exp_f32 v68, v68
    v_mfma_f32_16x16x32_bf16 v[40:43], a[88:91], v[20:23], v[40:43]
    v_exp_f32 v69, v69
    v_mfma_f32_16x16x32_bf16 v[44:47], a[92:95], v[20:23], v[44:47]
    v_exp_f32 v70, v70
    s_waitcnt lgkmcnt(4)
    v_mfma_f32_16x16x32_bf16 v[32:35], a[96:99], v[24:27], v[32:35]
    ds_read_b128 v[12:15], v117 offset:3072
    v_exp_f32 v71, v71
    v_mfma_f32_16x16x32_bf16 v[36:39], a[100:103], v[24:27], v[36:39]
    v_exp_f32 v72, v72
    v_mfma_f32_16x16x32_bf16 v[40:43], a[104:107], v[24:27], v[40:43]
    v_exp_f32 v73, v73
    v_mfma_f32_16x16x32_bf16 v[44:47], a[108:111], v[24:27], v[44:47]
    v_exp_f32 v74, v74
    s_waitcnt lgkmcnt(4)
    v_mfma_f32_16x16x32_bf16 v[32:35], a[112:115], v[28:31], v[32:35]
    ds_read_b128 v[16:19], v117 offset:40960
    v_exp_f32 v75, v75
    v_mfma_f32_16x16x32_bf16 v[36:39], a[116:119], v[28:31], v[36:39]
    v_exp_f32 v76, v76
    v_mfma_f32_16x16x32_bf16 v[40:43], a[120:123], v[28:31], v[40:43]
    v_exp_f32 v77, v77
    v_mfma_f32_16x16x32_bf16 v[44:47], a[124:127], v[28:31], v[44:47]
    v_exp_f32 v78, v78
    s_waitcnt lgkmcnt(4)
    v_mfma_f32_16x16x32_bf16 v[32:35], a[128:131], v[0:3], v[32:35]
    ds_read_b128 v[20:23], v117 offset:41984
    v_exp_f32 v79, v79
    v_mfma_f32_16x16x32_bf16 v[36:39], a[132:135], v[0:3], v[36:39]
    v_pk_add_f32 v[64:65], v[64:65], 1.0 op_sel_hi:[1,0]
    v_pk_add_f32 v[66:67], v[66:67], 1.0 op_sel_hi:[1,0]
    v_pk_add_f32 v[68:69], v[68:69], 1.0 op_sel_hi:[1,0]
    v_mfma_f32_16x16x32_bf16 v[40:43], a[136:139], v[0:3], v[40:43]
    v_pk_add_f32 v[70:71], v[70:71], 1.0 op_sel_hi:[1,0]
    v_pk_add_f32 v[72:73], v[72:73], 1.0 op_sel_hi:[1,0]
    v_pk_add_f32 v[74:75], v[74:75], 1.0 op_sel_hi:[1,0]
    v_mfma_f32_16x16x32_bf16 v[44:47], a[140:143], v[0:3], v[44:47]
    v_pk_add_f32 v[76:77], v[76:77], 1.0 op_sel_hi:[1,0]
    v_pk_add_f32 v[78:79], v[78:79], 1.0 op_sel_hi:[1,0]
    s_waitcnt lgkmcnt(4)
    v_mfma_f32_16x16x32_bf16 v[32:35], a[144:147], v[4:7], v[32:35]
    ds_read_b128 v[24:27], v117 offset:43008
    v_rcp_f32 v64, v64
    v_mfma_f32_16x16x32_bf16 v[36:39], a[148:151], v[4:7], v[36:39]
    v_rcp_f32 v65, v65
    v_mfma_f32_16x16x32_bf16 v[40:43], a[152:155], v[4:7], v[40:43]
    v_rcp_f32 v66, v66
    v_mfma_f32_16x16x32_bf16 v[44:47], a[156:159], v[4:7], v[44:47]
    v_rcp_f32 v67, v67
    s_waitcnt lgkmcnt(4)
    v_mfma_f32_16x16x32_bf16 v[32:35], a[160:163], v[8:11], v[32:35]
    ds_read_b128 v[28:31], v117 offset:44032
    v_rcp_f32 v68, v68
    v_mfma_f32_16x16x32_bf16 v[36:39], a[164:167], v[8:11], v[36:39]
    v_rcp_f32 v69, v69
    v_mfma_f32_16x16x32_bf16 v[40:43], a[168:171], v[8:11], v[40:43]
    v_rcp_f32 v70, v70
    v_mfma_f32_16x16x32_bf16 v[44:47], a[172:175], v[8:11], v[44:47]
    v_rcp_f32 v71, v71
    s_waitcnt lgkmcnt(4)
    v_mfma_f32_16x16x32_bf16 v[32:35], a[176:179], v[12:15], v[32:35]
    ds_read_b128 v[0:3], v118 offset:0
    v_rcp_f32 v72, v72
    v_mfma_f32_16x16x32_bf16 v[36:39], a[180:183], v[12:15], v[36:39]
    v_rcp_f32 v73, v73
    v_mfma_f32_16x16x32_bf16 v[40:43], a[184:187], v[12:15], v[40:43]
    v_rcp_f32 v74, v74
    v_mfma_f32_16x16x32_bf16 v[44:47], a[188:191], v[12:15], v[44:47]
    v_rcp_f32 v75, v75
    s_waitcnt lgkmcnt(4)
    v_mfma_f32_16x16x32_bf16 v[32:35], a[192:195], v[16:19], v[32:35]
    ds_read_b128 v[4:7], v118 offset:1024
    v_rcp_f32 v76, v76
    v_mfma_f32_16x16x32_bf16 v[36:39], a[196:199], v[16:19], v[36:39]
    v_rcp_f32 v77, v77
    v_mfma_f32_16x16x32_bf16 v[40:43], a[200:203], v[16:19], v[40:43]
    v_rcp_f32 v78, v78
    v_mfma_f32_16x16x32_bf16 v[44:47], a[204:207], v[16:19], v[44:47]
    v_rcp_f32 v79, v79
    v_pk_mul_f32 v[48:49], v[64:65], v[48:49]
    s_waitcnt lgkmcnt(4)
    v_mfma_f32_16x16x32_bf16 v[32:35], a[208:211], v[20:23], v[32:35]
    ds_read_b128 v[8:11], v118 offset:2048
    v_pk_mul_f32 v[50:51], v[66:67], v[50:51]
    v_pk_mul_f32 v[52:53], v[68:69], v[52:53]
    v_mfma_f32_16x16x32_bf16 v[36:39], a[212:215], v[20:23], v[36:39]
    v_pk_mul_f32 v[54:55], v[70:71], v[54:55]
    v_pk_mul_f32 v[56:57], v[72:73], v[56:57]
    v_pk_mul_f32 v[58:59], v[74:75], v[58:59]
    v_mfma_f32_16x16x32_bf16 v[40:43], a[216:219], v[20:23], v[40:43]
    v_pk_mul_f32 v[60:61], v[76:77], v[60:61]
    v_pk_mul_f32 v[62:63], v[78:79], v[62:63]
    v_cvt_pk_bf16_f32 v104, v48, v49
    v_mfma_f32_16x16x32_bf16 v[44:47], a[220:223], v[20:23], v[44:47]
    v_cvt_pk_bf16_f32 v105, v50, v51
    v_cvt_pk_bf16_f32 v106, v52, v53
    v_cvt_pk_bf16_f32 v107, v54, v55
    s_waitcnt lgkmcnt(4)
    v_mfma_f32_16x16x32_bf16 v[32:35], a[224:227], v[24:27], v[32:35]
    ds_read_b128 v[12:15], v118 offset:3072
    v_cvt_pk_bf16_f32 v108, v56, v57
    v_cvt_pk_bf16_f32 v109, v58, v59
    v_mfma_f32_16x16x32_bf16 v[36:39], a[228:231], v[24:27], v[36:39]
    v_cvt_pk_bf16_f32 v110, v60, v61
    v_cvt_pk_bf16_f32 v111, v62, v63
    s_mov_b64 exec, s[48:49]
    ds_write_b128 v121, v[104:107]
    s_mov_b64 exec, -1
    ds_write_b128 v121, v[108:111] offset:4096
    v_mfma_f32_16x16x32_bf16 v[40:43], a[232:235], v[24:27], v[40:43]
    v_mfma_f32_16x16x32_bf16 v[44:47], a[236:239], v[24:27], v[44:47]
    s_waitcnt lgkmcnt(6)
    v_mfma_f32_16x16x32_bf16 v[32:35], a[240:243], v[28:31], v[32:35]
    ds_read_b128 v[16:19], v118 offset:40960
    v_mfma_f32_16x16x32_bf16 v[36:39], a[244:247], v[28:31], v[36:39]
    v_mfma_f32_16x16x32_bf16 v[40:43], a[248:251], v[28:31], v[40:43]
    v_mfma_f32_16x16x32_bf16 v[44:47], a[252:255], v[28:31], v[44:47]
    s_waitcnt lgkmcnt(6)
    v_mfma_f32_16x16x32_bf16 v[48:51], a[0:3], v[0:3], 0
    ds_read_b128 v[20:23], v118 offset:41984
    v_mfma_f32_16x16x32_bf16 v[52:55], a[4:7], v[0:3], 0
    v_mfma_f32_16x16x32_bf16 v[56:59], a[8:11], v[0:3], 0
    v_pk_fma_f32 v[32:33], v[80:81], v[100:101], v[32:33] op_sel_hi:[1,0,1]
    v_pk_fma_f32 v[34:35], v[82:83], v[100:101], v[34:35] op_sel_hi:[1,0,1]
    v_pk_fma_f32 v[36:37], v[84:85], v[100:101], v[36:37] op_sel_hi:[1,0,1]
    v_mfma_f32_16x16x32_bf16 v[60:63], a[12:15], v[0:3], 0
    v_pk_fma_f32 v[38:39], v[86:87], v[100:101], v[38:39] op_sel_hi:[1,0,1]
    v_pk_fma_f32 v[40:41], v[88:89], v[100:101], v[40:41] op_sel_hi:[1,0,1]
    v_pk_fma_f32 v[42:43], v[90:91], v[100:101], v[42:43] op_sel_hi:[1,0,1]
    s_waitcnt lgkmcnt(6)
    v_mfma_f32_16x16x32_bf16 v[48:51], a[16:19], v[4:7], v[48:51]
    ds_read_b128 v[24:27], v118 offset:43008
    v_pk_fma_f32 v[44:45], v[92:93], v[100:101], v[44:45] op_sel_hi:[1,0,1]
    v_pk_fma_f32 v[46:47], v[94:95], v[100:101], v[46:47] op_sel_hi:[1,0,1]
    v_mfma_f32_16x16x32_bf16 v[52:55], a[20:23], v[4:7], v[52:55]
    v_mov_b32 v100, v101
    v_pk_mul_f32 v[32:33], v[32:33], v[100:101]
    v_pk_mul_f32 v[34:35], v[34:35], v[100:101]
    v_mfma_f32_16x16x32_bf16 v[56:59], a[24:27], v[4:7], v[56:59]
    v_pk_mul_f32 v[36:37], v[36:37], v[100:101]
    v_pk_mul_f32 v[38:39], v[38:39], v[100:101]
    v_pk_mul_f32 v[40:41], v[40:41], v[100:101]
    v_mfma_f32_16x16x32_bf16 v[60:63], a[28:31], v[4:7], v[60:63]
    v_pk_mul_f32 v[42:43], v[42:43], v[100:101]
    v_pk_mul_f32 v[44:45], v[44:45], v[100:101]
    v_pk_mul_f32 v[46:47], v[46:47], v[100:101]
    s_waitcnt lgkmcnt(6)
    v_mfma_f32_16x16x32_bf16 v[48:51], a[32:35], v[8:11], v[48:51]
    ds_read_b128 v[28:31], v118 offset:44032
    v_pk_mul_f32 v[64:65], v[32:33], v[32:33]
    v_pk_mul_f32 v[66:67], v[34:35], v[34:35]
    v_mfma_f32_16x16x32_bf16 v[52:55], a[36:39], v[8:11], v[52:55]
    v_pk_mul_f32 v[68:69], v[36:37], v[36:37]
    v_pk_mul_f32 v[70:71], v[38:39], v[38:39]
    v_pk_mul_f32 v[72:73], v[40:41], v[40:41]
    v_mfma_f32_16x16x32_bf16 v[56:59], a[40:43], v[8:11], v[56:59]
    v_pk_mul_f32 v[74:75], v[42:43], v[42:43]
    v_pk_mul_f32 v[76:77], v[44:45], v[44:45]
    v_pk_mul_f32 v[78:79], v[46:47], v[46:47]
    v_mfma_f32_16x16x32_bf16 v[60:63], a[44:47], v[8:11], v[60:63]
    v_pk_fma_f32 v[64:65], v[64:65], v[206:207], v[204:205]
    v_pk_fma_f32 v[66:67], v[66:67], v[206:207], v[204:205]
    v_pk_fma_f32 v[68:69], v[68:69], v[206:207], v[204:205]
    s_waitcnt lgkmcnt(6)
    v_mfma_f32_16x16x32_bf16 v[48:51], a[48:51], v[12:15], v[48:51]
    ds_read_b128 v[0:3], v119 offset:0
    v_pk_fma_f32 v[70:71], v[70:71], v[206:207], v[204:205]
    v_pk_fma_f32 v[72:73], v[72:73], v[206:207], v[204:205]
    v_mfma_f32_16x16x32_bf16 v[52:55], a[52:55], v[12:15], v[52:55]
    v_pk_fma_f32 v[74:75], v[74:75], v[206:207], v[204:205]
    v_pk_fma_f32 v[76:77], v[76:77], v[206:207], v[204:205]
    v_pk_fma_f32 v[78:79], v[78:79], v[206:207], v[204:205]
    v_mfma_f32_16x16x32_bf16 v[56:59], a[56:59], v[12:15], v[56:59]
    v_pk_mul_f32 v[64:65], v[64:65], v[32:33]
    v_pk_mul_f32 v[66:67], v[66:67], v[34:35]
    v_pk_mul_f32 v[68:69], v[68:69], v[36:37]
    v_mfma_f32_16x16x32_bf16 v[60:63], a[60:63], v[12:15], v[60:63]
    v_pk_mul_f32 v[70:71], v[70:71], v[38:39]
    v_pk_mul_f32 v[72:73], v[72:73], v[40:41]
    v_pk_mul_f32 v[74:75], v[74:75], v[42:43]
    s_waitcnt lgkmcnt(4)
    v_mfma_f32_16x16x32_bf16 v[48:51], a[64:67], v[16:19], v[48:51]
    ds_read_b128 v[4:7], v119 offset:1024
    v_pk_mul_f32 v[76:77], v[76:77], v[44:45]
    v_pk_mul_f32 v[78:79], v[78:79], v[46:47]
    v_mfma_f32_16x16x32_bf16 v[52:55], a[68:71], v[16:19], v[52:55]
    v_exp_f32 v64, v64
    v_mfma_f32_16x16x32_bf16 v[56:59], a[72:75], v[16:19], v[56:59]
    v_exp_f32 v65, v65
    v_mfma_f32_16x16x32_bf16 v[60:63], a[76:79], v[16:19], v[60:63]
    v_exp_f32 v66, v66
    s_waitcnt lgkmcnt(4)
    v_mfma_f32_16x16x32_bf16 v[48:51], a[80:83], v[20:23], v[48:51]
    ds_read_b128 v[8:11], v119 offset:2048
    v_exp_f32 v67, v67
    v_mfma_f32_16x16x32_bf16 v[52:55], a[84:87], v[20:23], v[52:55]
    v_exp_f32 v68, v68
    v_mfma_f32_16x16x32_bf16 v[56:59], a[88:91], v[20:23], v[56:59]
    v_exp_f32 v69, v69
    v_mfma_f32_16x16x32_bf16 v[60:63], a[92:95], v[20:23], v[60:63]
    v_exp_f32 v70, v70
    s_waitcnt lgkmcnt(4)
    v_mfma_f32_16x16x32_bf16 v[48:51], a[96:99], v[24:27], v[48:51]
    ds_read_b128 v[12:15], v119 offset:3072
    v_exp_f32 v71, v71
    v_mfma_f32_16x16x32_bf16 v[52:55], a[100:103], v[24:27], v[52:55]
    v_exp_f32 v72, v72
    v_mfma_f32_16x16x32_bf16 v[56:59], a[104:107], v[24:27], v[56:59]
    v_exp_f32 v73, v73
    v_mfma_f32_16x16x32_bf16 v[60:63], a[108:111], v[24:27], v[60:63]
    v_exp_f32 v74, v74
    s_waitcnt lgkmcnt(4)
    v_mfma_f32_16x16x32_bf16 v[48:51], a[112:115], v[28:31], v[48:51]
    ds_read_b128 v[16:19], v119 offset:40960
    v_exp_f32 v75, v75
    v_mfma_f32_16x16x32_bf16 v[52:55], a[116:119], v[28:31], v[52:55]
    v_exp_f32 v76, v76
    v_mfma_f32_16x16x32_bf16 v[56:59], a[120:123], v[28:31], v[56:59]
    v_exp_f32 v77, v77
    v_mfma_f32_16x16x32_bf16 v[60:63], a[124:127], v[28:31], v[60:63]
    v_exp_f32 v78, v78
    s_waitcnt lgkmcnt(4)
    v_mfma_f32_16x16x32_bf16 v[48:51], a[128:131], v[0:3], v[48:51]
    ds_read_b128 v[20:23], v119 offset:41984
    v_exp_f32 v79, v79
    v_mfma_f32_16x16x32_bf16 v[52:55], a[132:135], v[0:3], v[52:55]
    s_waitcnt vmcnt(12)
    ds_read_b64_tr_b16 v[128:129], v244 offset:16384
    v_pk_add_f32 v[64:65], v[64:65], 1.0 op_sel_hi:[1,0]
    v_pk_add_f32 v[66:67], v[66:67], 1.0 op_sel_hi:[1,0]
    v_mfma_f32_16x16x32_bf16 v[56:59], a[136:139], v[0:3], v[56:59]
    v_pk_add_f32 v[68:69], v[68:69], 1.0 op_sel_hi:[1,0]
    v_pk_add_f32 v[70:71], v[70:71], 1.0 op_sel_hi:[1,0]
    v_pk_add_f32 v[72:73], v[72:73], 1.0 op_sel_hi:[1,0]
    v_mfma_f32_16x16x32_bf16 v[60:63], a[140:143], v[0:3], v[60:63]
    ds_read_b64_tr_b16 v[130:131], v244 offset:18432
    v_pk_add_f32 v[74:75], v[74:75], 1.0 op_sel_hi:[1,0]
    v_pk_add_f32 v[76:77], v[76:77], 1.0 op_sel_hi:[1,0]
    s_waitcnt lgkmcnt(6)
    v_mfma_f32_16x16x32_bf16 v[48:51], a[144:147], v[4:7], v[48:51]
    ds_read_b128 v[24:27], v119 offset:43008
    v_pk_add_f32 v[78:79], v[78:79], 1.0 op_sel_hi:[1,0]
    v_mfma_f32_16x16x32_bf16 v[52:55], a[148:151], v[4:7], v[52:55]
    ds_read_b64_tr_b16 v[132:133], v245 offset:16384
    v_rcp_f32 v64, v64
    v_mfma_f32_16x16x32_bf16 v[56:59], a[152:155], v[4:7], v[56:59]
    v_rcp_f32 v65, v65
    v_mfma_f32_16x16x32_bf16 v[60:63], a[156:159], v[4:7], v[60:63]
    ds_read_b64_tr_b16 v[134:135], v245 offset:18432
    v_rcp_f32 v66, v66
    s_waitcnt lgkmcnt(8)
    v_mfma_f32_16x16x32_bf16 v[48:51], a[160:163], v[8:11], v[48:51]
    ds_read_b128 v[28:31], v119 offset:44032
    v_rcp_f32 v67, v67
    v_mfma_f32_16x16x32_bf16 v[52:55], a[164:167], v[8:11], v[52:55]
    ds_read_b64_tr_b16 v[136:137], v246 offset:16384
    v_rcp_f32 v68, v68
    v_mfma_f32_16x16x32_bf16 v[56:59], a[168:171], v[8:11], v[56:59]
    v_rcp_f32 v69, v69
    v_mfma_f32_16x16x32_bf16 v[60:63], a[172:175], v[8:11], v[60:63]
    ds_read_b64_tr_b16 v[138:139], v246 offset:18432
    v_rcp_f32 v70, v70
    s_waitcnt lgkmcnt(10)
    v_mfma_f32_16x16x32_bf16 v[48:51], a[176:179], v[12:15], v[48:51]
    v_rcp_f32 v71, v71
    v_mfma_f32_16x16x32_bf16 v[52:55], a[180:183], v[12:15], v[52:55]
    ds_read_b64_tr_b16 v[140:141], v247 offset:16384
    v_rcp_f32 v72, v72
    v_mfma_f32_16x16x32_bf16 v[56:59], a[184:187], v[12:15], v[56:59]
    v_rcp_f32 v73, v73
    v_mfma_f32_16x16x32_bf16 v[60:63], a[188:191], v[12:15], v[60:63]
    ds_read_b64_tr_b16 v[142:143], v247 offset:18432
    v_rcp_f32 v74, v74
    s_waitcnt lgkmcnt(11)
    v_mfma_f32_16x16x32_bf16 v[48:51], a[192:195], v[16:19], v[48:51]
    v_rcp_f32 v75, v75
    v_mfma_f32_16x16x32_bf16 v[52:55], a[196:199], v[16:19], v[52:55]
    ds_read_b64_tr_b16 v[144:145], v244 offset:20480
    v_rcp_f32 v76, v76
    v_mfma_f32_16x16x32_bf16 v[56:59], a[200:203], v[16:19], v[56:59]
    v_rcp_f32 v77, v77
    v_mfma_f32_16x16x32_bf16 v[60:63], a[204:207], v[16:19], v[60:63]
    ds_read_b64_tr_b16 v[146:147], v244 offset:22528
    v_rcp_f32 v78, v78
    s_waitcnt lgkmcnt(12)
    v_mfma_f32_16x16x32_bf16 v[48:51], a[208:211], v[20:23], v[48:51]
    v_rcp_f32 v79, v79
    v_pk_mul_f32 v[32:33], v[64:65], v[32:33]
    v_mfma_f32_16x16x32_bf16 v[52:55], a[212:215], v[20:23], v[52:55]
    ds_read_b64_tr_b16 v[148:149], v245 offset:20480
    v_pk_mul_f32 v[34:35], v[66:67], v[34:35]
    v_pk_mul_f32 v[36:37], v[68:69], v[36:37]
    v_mfma_f32_16x16x32_bf16 v[56:59], a[216:219], v[20:23], v[56:59]
    v_pk_mul_f32 v[38:39], v[70:71], v[38:39]
    v_pk_mul_f32 v[40:41], v[72:73], v[40:41]
    v_pk_mul_f32 v[42:43], v[74:75], v[42:43]
    v_mfma_f32_16x16x32_bf16 v[60:63], a[220:223], v[20:23], v[60:63]
    ds_read_b64_tr_b16 v[150:151], v245 offset:22528
    v_pk_mul_f32 v[44:45], v[76:77], v[44:45]
    v_pk_mul_f32 v[46:47], v[78:79], v[46:47]
    s_waitcnt lgkmcnt(11)
    v_mfma_f32_16x16x32_bf16 v[48:51], a[224:227], v[24:27], v[48:51]
    v_cvt_pk_bf16_f32 v104, v32, v33
    v_cvt_pk_bf16_f32 v105, v34, v35
    v_cvt_pk_bf16_f32 v106, v36, v37
    v_mfma_f32_16x16x32_bf16 v[52:55], a[228:231], v[24:27], v[52:55]
    ds_read_b64_tr_b16 v[152:153], v246 offset:20480
    v_cvt_pk_bf16_f32 v107, v38, v39
    v_cvt_pk_bf16_f32 v108, v40, v41
    v_mfma_f32_16x16x32_bf16 v[56:59], a[232:235], v[24:27], v[56:59]
    v_cvt_pk_bf16_f32 v109, v42, v43
    v_cvt_pk_bf16_f32 v110, v44, v45
    v_cvt_pk_bf16_f32 v111, v46, v47
    s_mov_b64 exec, s[48:49]
    ds_write_b128 v122, v[104:107]
    s_mov_b64 exec, -1
    ds_write_b128 v122, v[108:111] offset:4096
    v_mfma_f32_16x16x32_bf16 v[60:63], a[236:239], v[24:27], v[60:63]
    ds_read_b64_tr_b16 v[154:155], v246 offset:22528
    s_waitcnt lgkmcnt(12)
    v_mfma_f32_16x16x32_bf16 v[48:51], a[240:243], v[28:31], v[48:51]
    v_mfma_f32_16x16x32_bf16 v[52:55], a[244:247], v[28:31], v[52:55]
    ds_read_b64_tr_b16 v[156:157], v247 offset:20480
    v_mfma_f32_16x16x32_bf16 v[56:59], a[248:251], v[28:31], v[56:59]
    v_mfma_f32_16x16x32_bf16 v[60:63], a[252:255], v[28:31], v[60:63]
    ds_read_b64_tr_b16 v[158:159], v247 offset:22528
    s_nop 2
    v_pk_fma_f32 v[48:49], v[80:81], v[102:103], v[48:49] op_sel_hi:[1,0,1]
    v_pk_fma_f32 v[50:51], v[82:83], v[102:103], v[50:51] op_sel_hi:[1,0,1]
    v_pk_fma_f32 v[52:53], v[84:85], v[102:103], v[52:53] op_sel_hi:[1,0,1]
    v_pk_fma_f32 v[54:55], v[86:87], v[102:103], v[54:55] op_sel_hi:[1,0,1]
    v_pk_fma_f32 v[56:57], v[88:89], v[102:103], v[56:57] op_sel_hi:[1,0,1]
    v_pk_fma_f32 v[58:59], v[90:91], v[102:103], v[58:59] op_sel_hi:[1,0,1]
    v_pk_fma_f32 v[60:61], v[92:93], v[102:103], v[60:61] op_sel_hi:[1,0,1]
    v_pk_fma_f32 v[62:63], v[94:95], v[102:103], v[62:63] op_sel_hi:[1,0,1]
    v_mov_b32 v102, v103
    v_pk_mul_f32 v[48:49], v[48:49], v[102:103]
    v_pk_mul_f32 v[50:51], v[50:51], v[102:103]
    v_pk_mul_f32 v[52:53], v[52:53], v[102:103]
    v_pk_mul_f32 v[54:55], v[54:55], v[102:103]
    v_pk_mul_f32 v[56:57], v[56:57], v[102:103]
    v_pk_mul_f32 v[58:59], v[58:59], v[102:103]
    v_pk_mul_f32 v[60:61], v[60:61], v[102:103]
    v_pk_mul_f32 v[62:63], v[62:63], v[102:103]
    v_pk_mul_f32 v[64:65], v[48:49], v[48:49]
    v_pk_mul_f32 v[66:67], v[50:51], v[50:51]
    v_pk_mul_f32 v[68:69], v[52:53], v[52:53]
    v_pk_mul_f32 v[70:71], v[54:55], v[54:55]
    v_pk_mul_f32 v[72:73], v[56:57], v[56:57]
    v_pk_mul_f32 v[74:75], v[58:59], v[58:59]
    v_pk_mul_f32 v[76:77], v[60:61], v[60:61]
    v_pk_mul_f32 v[78:79], v[62:63], v[62:63]
    v_pk_fma_f32 v[64:65], v[64:65], v[206:207], v[204:205]
    v_pk_fma_f32 v[66:67], v[66:67], v[206:207], v[204:205]
    v_pk_fma_f32 v[68:69], v[68:69], v[206:207], v[204:205]
    v_pk_fma_f32 v[70:71], v[70:71], v[206:207], v[204:205]
    v_pk_fma_f32 v[72:73], v[72:73], v[206:207], v[204:205]
    v_pk_fma_f32 v[74:75], v[74:75], v[206:207], v[204:205]
    v_pk_fma_f32 v[76:77], v[76:77], v[206:207], v[204:205]
    v_pk_fma_f32 v[78:79], v[78:79], v[206:207], v[204:205]
    v_pk_mul_f32 v[64:65], v[64:65], v[48:49]
    v_pk_mul_f32 v[66:67], v[66:67], v[50:51]
    v_pk_mul_f32 v[68:69], v[68:69], v[52:53]
    v_pk_mul_f32 v[70:71], v[70:71], v[54:55]
    v_pk_mul_f32 v[72:73], v[72:73], v[56:57]
    v_pk_mul_f32 v[74:75], v[74:75], v[58:59]
    v_pk_mul_f32 v[76:77], v[76:77], v[60:61]
    v_pk_mul_f32 v[78:79], v[78:79], v[62:63]
    v_exp_f32 v64, v64
    v_exp_f32 v65, v65
    v_exp_f32 v66, v66
    v_exp_f32 v67, v67
    v_exp_f32 v68, v68
    v_exp_f32 v69, v69
    v_exp_f32 v70, v70
    v_exp_f32 v71, v71
    v_exp_f32 v72, v72
    v_exp_f32 v73, v73
    v_exp_f32 v74, v74
    v_exp_f32 v75, v75
    v_exp_f32 v76, v76
    v_exp_f32 v77, v77
    v_exp_f32 v78, v78
    v_exp_f32 v79, v79
    v_pk_add_f32 v[64:65], v[64:65], 1.0 op_sel_hi:[1,0]
    v_pk_add_f32 v[66:67], v[66:67], 1.0 op_sel_hi:[1,0]
    v_pk_add_f32 v[68:69], v[68:69], 1.0 op_sel_hi:[1,0]
    v_pk_add_f32 v[70:71], v[70:71], 1.0 op_sel_hi:[1,0]
    v_pk_add_f32 v[72:73], v[72:73], 1.0 op_sel_hi:[1,0]
    v_pk_add_f32 v[74:75], v[74:75], 1.0 op_sel_hi:[1,0]
    v_pk_add_f32 v[76:77], v[76:77], 1.0 op_sel_hi:[1,0]
    v_pk_add_f32 v[78:79], v[78:79], 1.0 op_sel_hi:[1,0]
    v_rcp_f32 v64, v64
    v_rcp_f32 v65, v65
    v_rcp_f32 v66, v66
    v_rcp_f32 v67, v67
    v_rcp_f32 v68, v68
    v_rcp_f32 v69, v69
    v_rcp_f32 v70, v70
    v_rcp_f32 v71, v71
    v_rcp_f32 v72, v72
    v_rcp_f32 v73, v73
    v_rcp_f32 v74, v74
    v_rcp_f32 v75, v75
    v_rcp_f32 v76, v76
    v_rcp_f32 v77, v77
    v_rcp_f32 v78, v78
    v_rcp_f32 v79, v79
    v_pk_mul_f32 v[48:49], v[64:65], v[48:49]
    v_pk_mul_f32 v[50:51], v[66:67], v[50:51]
    v_pk_mul_f32 v[52:53], v[68:69], v[52:53]
    v_pk_mul_f32 v[54:55], v[70:71], v[54:55]
    v_pk_mul_f32 v[56:57], v[72:73], v[56:57]
    v_pk_mul_f32 v[58:59], v[74:75], v[58:59]
    v_pk_mul_f32 v[60:61], v[76:77], v[60:61]
    v_pk_mul_f32 v[62:63], v[78:79], v[62:63]
    v_cvt_pk_bf16_f32 v104, v48, v49
    v_cvt_pk_bf16_f32 v105, v50, v51
    v_cvt_pk_bf16_f32 v106, v52, v53
    v_cvt_pk_bf16_f32 v107, v54, v55
    v_cvt_pk_bf16_f32 v108, v56, v57
    v_cvt_pk_bf16_f32 v109, v58, v59
    v_cvt_pk_bf16_f32 v110, v60, v61
    v_cvt_pk_bf16_f32 v111, v62, v63
    s_mov_b64 exec, s[48:49]
    ds_write_b128 v123, v[104:107]
    s_mov_b64 exec, -1
    ds_write_b128 v123, v[108:111] offset:4096
    v_add_u32 v230, 0x8000, v250
    v_add_u32 v231, 0x8000, v251
    s_waitcnt lgkmcnt(0)
    s_barrier
    ds_read_b128 v[160:163], v230 offset:0
    ds_read_b128 v[164:167], v230 offset:1024
    ds_read_b128 v[168:171], v230 offset:2048
    ds_read_b128 v[172:175], v230 offset:3072
    s_add_u32 m0, s36, 0
    s_add_u32 s39, s78, 65536
    buffer_load_dwordx4 v248, s[16:19], s39 offen offset:0 lds
    s_add_u32 s39, s78, 72704
    buffer_load_dwordx4 v248, s[16:19], s39 offen offset:1024 lds
    s_add_u32 s39, s78, 79872
    buffer_load_dwordx4 v248, s[16:19], s39 offen offset:2048 lds
    s_add_u32 s39, s78, 87040
    buffer_load_dwordx4 v248, s[16:19], s39 offen offset:3072 lds
    s_add_u32 m0, s36, 3968
    s_add_u32 s39, s78, 65536
    buffer_load_dwordx4 v248, s[16:19], s39 offen offset:128 lds
    s_add_u32 s39, s78, 72704
    buffer_load_dwordx4 v248, s[16:19], s39 offen offset:1152 lds
    s_add_u32 s39, s78, 79872
    buffer_load_dwordx4 v248, s[16:19], s39 offen offset:2176 lds
    s_add_u32 s39, s78, 87040
    buffer_load_dwordx4 v248, s[16:19], s39 offen offset:3200 lds
    v_lshrrev_b32 v232, 8, v250
    v_lshlrev_b32 v232, 4, v232
    s_lshl_b32 s44, s55, 8
    s_add_u32 s44, s44, 10240
    buffer_load_dwordx4 v[192:195], v232, s[28:31], s44 offen offset:0 sc1
    buffer_load_dwordx4 v[196:199], v232, s[28:31], s44 offen offset:64 sc1
    buffer_load_dwordx4 v[200:203], v232, s[28:31], s44 offen offset:128 sc1
    buffer_load_dwordx4 v[204:207], v232, s[28:31], s44 offen offset:192 sc1
    s_waitcnt lgkmcnt(0)
    v_mfma_f32_16x16x32_bf16 v[0:3], v[128:131], v[160:163], 0
    ds_read_b128 v[176:179], v230 offset:4096
    v_mfma_f32_16x16x32_bf16 v[4:7], v[128:131], v[164:167], 0
    s_waitcnt vmcnt(20)
    s_add_u32 m0, s36, 8192
    s_add_u32 s39, s78, 98304
    v_mfma_f32_16x16x32_bf16 v[8:11], v[128:131], v[168:171], 0
    buffer_load_dwordx4 v248, s[16:19], s39 offen offset:0 lds
    v_mfma_f32_16x16x32_bf16 v[12:15], v[128:131], v[172:175], 0
    ds_read_b64_tr_b16 v[128:129], v244 offset:24576
    ds_read_b64_tr_b16 v[130:131], v244 offset:26624
    v_mfma_f32_16x16x32_bf16 v[16:19], v[132:135], v[160:163], 0
    ds_read_b128 v[180:183], v230 offset:5120
    v_mfma_f32_16x16x32_bf16 v[20:23], v[132:135], v[164:167], 0
    s_add_u32 s39, s78, 105472
    v_mfma_f32_16x16x32_bf16 v[24:27], v[132:135], v[168:171], 0
    buffer_load_dwordx4 v248, s[16:19], s39 offen offset:1024 lds
    v_mfma_f32_16x16x32_bf16 v[28:31], v[132:135], v[172:175], 0
    ds_read_b64_tr_b16 v[132:133], v245 offset:24576
    ds_read_b64_tr_b16 v[134:135], v245 offset:26624
    v_mfma_f32_16x16x32_bf16 v[32:35], v[136:139], v[160:163], 0
    ds_read_b128 v[184:187], v230 offset:6144
    v_mfma_f32_16x16x32_bf16 v[36:39], v[136:139], v[164:167], 0
    s_add_u32 s39, s78, 112640
    v_mfma_f32_16x16x32_bf16 v[40:43], v[136:139], v[168:171], 0
    buffer_load_dwordx4 v248, s[16:19], s39 offen offset:2048 lds
    v_mfma_f32_16x16x32_bf16 v[44:47], v[136:139], v[172:175], 0
    ds_read_b64_tr_b16 v[136:137], v246 offset:24576
    ds_read_b64_tr_b16 v[138:139], v246 offset:26624
    v_mfma_f32_16x16x32_bf16 v[48:51], v[140:143], v[160:163], 0
    ds_read_b128 v[188:191], v230 offset:7168
    v_mfma_f32_16x16x32_bf16 v[52:55], v[140:143], v[164:167], 0
    s_waitcnt lgkmcnt(10)
    s_add_u32 s39, s78, 119808
    v_mfma_f32_16x16x32_bf16 v[56:59], v[140:143], v[168:171], 0
    buffer_load_dwordx4 v248, s[16:19], s39 offen offset:3072 lds
    v_mfma_f32_16x16x32_bf16 v[60:63], v[140:143], v[172:175], 0
    ds_read_b64_tr_b16 v[140:141], v247 offset:24576
    ds_read_b64_tr_b16 v[142:143], v247 offset:26624
    v_mfma_f32_16x16x32_bf16 v[64:67], v[144:147], v[160:163], 0
    v_mfma_f32_16x16x32_bf16 v[68:71], v[144:147], v[164:167], 0
    s_waitcnt vmcnt(20)
    s_add_u32 m0, s36, 12160
    s_add_u32 s39, s78, 98304
    v_mfma_f32_16x16x32_bf16 v[72:75], v[144:147], v[168:171], 0
    buffer_load_dwordx4 v248, s[16:19], s39 offen offset:128 lds
    v_mfma_f32_16x16x32_bf16 v[76:79], v[144:147], v[172:175], 0
    ds_read_b64_tr_b16 v[144:145], v244 offset:28672
    ds_read_b64_tr_b16 v[146:147], v244 offset:30720
    v_mfma_f32_16x16x32_bf16 v[80:83], v[148:151], v[160:163], 0
    v_mfma_f32_16x16x32_bf16 v[84:87], v[148:151], v[164:167], 0
    s_add_u32 s39, s78, 105472
    v_mfma_f32_16x16x32_bf16 v[88:91], v[148:151], v[168:171], 0
    buffer_load_dwordx4 v248, s[16:19], s39 offen offset:1152 lds
    v_mfma_f32_16x16x32_bf16 v[92:95], v[148:151], v[172:175], 0
    ds_read_b64_tr_b16 v[148:149], v245 offset:28672
    ds_read_b64_tr_b16 v[150:151], v245 offset:30720
    v_mfma_f32_16x16x32_bf16 v[96:99], v[152:155], v[160:163], 0
    v_mfma_f32_16x16x32_bf16 v[100:103], v[152:155], v[164:167], 0
    s_add_u32 s39, s78, 112640
    v_mfma_f32_16x16x32_bf16 v[104:107], v[152:155], v[168:171], 0
    buffer_load_dwordx4 v248, s[16:19], s39 offen offset:2176 lds
    v_mfma_f32_16x16x32_bf16 v[108:111], v[152:155], v[172:175], 0
    ds_read_b64_tr_b16 v[152:153], v246 offset:28672
    ds_read_b64_tr_b16 v[154:155], v246 offset:30720
    v_mfma_f32_16x16x32_bf16 v[112:115], v[156:159], v[160:163], 0
    v_mfma_f32_16x16x32_bf16 v[116:119], v[156:159], v[164:167], 0
    s_waitcnt lgkmcnt(6)
    s_add_u32 s39, s78, 119808
    v_mfma_f32_16x16x32_bf16 v[120:123], v[156:159], v[168:171], 0
    buffer_load_dwordx4 v248, s[16:19], s39 offen offset:3200 lds
    v_mfma_f32_16x16x32_bf16 v[124:127], v[156:159], v[172:175], 0
    ds_read_b64_tr_b16 v[156:157], v247 offset:28672
    ds_read_b64_tr_b16 v[158:159], v247 offset:30720
    v_mfma_f32_16x16x32_bf16 v[0:3], v[128:131], v[176:179], v[0:3]
    ds_read_b128 v[160:163], v230 offset:40960
    v_mfma_f32_16x16x32_bf16 v[4:7], v[128:131], v[180:183], v[4:7]
    s_waitcnt vmcnt(16)
    s_add_u32 m0, s36, 16384
    s_add_u32 s39, s78, 131072
    v_mfma_f32_16x16x32_bf16 v[8:11], v[128:131], v[184:187], v[8:11]
    buffer_load_dwordx4 v248, s[16:19], s39 offen offset:0 lds
    v_mfma_f32_16x16x32_bf16 v[12:15], v[128:131], v[188:191], v[12:15]
    ds_read_b64_tr_b16 v[128:129], v244 offset:0
    ds_read_b64_tr_b16 v[130:131], v244 offset:2048
    v_mfma_f32_16x16x32_bf16 v[16:19], v[132:135], v[176:179], v[16:19]
    ds_read_b128 v[164:167], v230 offset:41984
    v_mfma_f32_16x16x32_bf16 v[20:23], v[132:135], v[180:183], v[20:23]
    s_add_u32 s39, s78, 138240
    v_mfma_f32_16x16x32_bf16 v[24:27], v[132:135], v[184:187], v[24:27]
    buffer_load_dwordx4 v248, s[16:19], s39 offen offset:1024 lds
    v_mfma_f32_16x16x32_bf16 v[28:31], v[132:135], v[188:191], v[28:31]
    ds_read_b64_tr_b16 v[132:133], v245 offset:0
    ds_read_b64_tr_b16 v[134:135], v245 offset:2048
    v_mfma_f32_16x16x32_bf16 v[32:35], v[136:139], v[176:179], v[32:35]
    ds_read_b128 v[168:171], v230 offset:43008
    v_mfma_f32_16x16x32_bf16 v[36:39], v[136:139], v[180:183], v[36:39]
    s_add_u32 s39, s78, 145408
    v_mfma_f32_16x16x32_bf16 v[40:43], v[136:139], v[184:187], v[40:43]
    buffer_load_dwordx4 v248, s[16:19], s39 offen offset:2048 lds
    v_mfma_f32_16x16x32_bf16 v[44:47], v[136:139], v[188:191], v[44:47]
    ds_read_b64_tr_b16 v[136:137], v246 offset:0
    ds_read_b64_tr_b16 v[138:139], v246 offset:2048
    v_mfma_f32_16x16x32_bf16 v[48:51], v[140:143], v[176:179], v[48:51]
    ds_read_b128 v[172:175], v230 offset:44032
    v_mfma_f32_16x16x32_bf16 v[52:55], v[140:143], v[180:183], v[52:55]
    s_waitcnt lgkmcnt(10)
    s_add_u32 s39, s78, 152576
    v_mfma_f32_16x16x32_bf16 v[56:59], v[140:143], v[184:187], v[56:59]
    buffer_load_dwordx4 v248, s[16:19], s39 offen offset:3072 lds
    v_mfma_f32_16x16x32_bf16 v[60:63], v[140:143], v[188:191], v[60:63]
    ds_read_b64_tr_b16 v[140:141], v247 offset:0
    ds_read_b64_tr_b16 v[142:143], v247 offset:2048
    v_mfma_f32_16x16x32_bf16 v[64:67], v[144:147], v[176:179], v[64:67]
    v_mfma_f32_16x16x32_bf16 v[68:71], v[144:147], v[180:183], v[68:71]
    s_waitcnt vmcnt(16)
    s_add_u32 m0, s36, 20352
    s_add_u32 s39, s78, 131072
    v_mfma_f32_16x16x32_bf16 v[72:75], v[144:147], v[184:187], v[72:75]
    buffer_load_dwordx4 v248, s[16:19], s39 offen offset:128 lds
    v_mfma_f32_16x16x32_bf16 v[76:79], v[144:147], v[188:191], v[76:79]
    ds_read_b64_tr_b16 v[144:145], v244 offset:4096
    ds_read_b64_tr_b16 v[146:147], v244 offset:6144
    v_mfma_f32_16x16x32_bf16 v[80:83], v[148:151], v[176:179], v[80:83]
    v_mfma_f32_16x16x32_bf16 v[84:87], v[148:151], v[180:183], v[84:87]
    s_add_u32 s39, s78, 138240
    v_mfma_f32_16x16x32_bf16 v[88:91], v[148:151], v[184:187], v[88:91]
    buffer_load_dwordx4 v248, s[16:19], s39 offen offset:1152 lds
    v_mfma_f32_16x16x32_bf16 v[92:95], v[148:151], v[188:191], v[92:95]
    ds_read_b64_tr_b16 v[148:149], v245 offset:4096
    ds_read_b64_tr_b16 v[150:151], v245 offset:6144
    v_mfma_f32_16x16x32_bf16 v[96:99], v[152:155], v[176:179], v[96:99]
    v_mfma_f32_16x16x32_bf16 v[100:103], v[152:155], v[180:183], v[100:103]
    s_add_u32 s39, s78, 145408
    v_mfma_f32_16x16x32_bf16 v[104:107], v[152:155], v[184:187], v[104:107]
    buffer_load_dwordx4 v248, s[16:19], s39 offen offset:2176 lds
    v_mfma_f32_16x16x32_bf16 v[108:111], v[152:155], v[188:191], v[108:111]
    ds_read_b64_tr_b16 v[152:153], v246 offset:4096
    ds_read_b64_tr_b16 v[154:155], v246 offset:6144
    v_mfma_f32_16x16x32_bf16 v[112:115], v[156:159], v[176:179], v[112:115]
    v_mfma_f32_16x16x32_bf16 v[116:119], v[156:159], v[180:183], v[116:119]
    s_waitcnt lgkmcnt(6)
    s_add_u32 s39, s78, 152576
    v_mfma_f32_16x16x32_bf16 v[120:123], v[156:159], v[184:187], v[120:123]
    buffer_load_dwordx4 v248, s[16:19], s39 offen offset:3200 lds
    v_mfma_f32_16x16x32_bf16 v[124:127], v[156:159], v[188:191], v[124:127]
    ds_read_b64_tr_b16 v[156:157], v247 offset:4096
    ds_read_b64_tr_b16 v[158:159], v247 offset:6144
    v_mfma_f32_16x16x32_bf16 v[0:3], v[128:131], v[160:163], v[0:3]
    ds_read_b128 v[176:179], v230 offset:45056
    v_mfma_f32_16x16x32_bf16 v[4:7], v[128:131], v[164:167], v[4:7]
    s_waitcnt vmcnt(12)
    s_add_u32 m0, s36, 24576
    s_add_u32 s39, s78, 163840
    v_mfma_f32_16x16x32_bf16 v[8:11], v[128:131], v[168:171], v[8:11]
    buffer_load_dwordx4 v248, s[16:19], s39 offen offset:0 lds
    v_mfma_f32_16x16x32_bf16 v[12:15], v[128:131], v[172:175], v[12:15]
    ds_read_b64_tr_b16 v[128:129], v244 offset:8192
    ds_read_b64_tr_b16 v[130:131], v244 offset:10240
    v_mfma_f32_16x16x32_bf16 v[16:19], v[132:135], v[160:163], v[16:19]
    ds_read_b128 v[180:183], v230 offset:46080
    v_mfma_f32_16x16x32_bf16 v[20:23], v[132:135], v[164:167], v[20:23]
    s_add_u32 s39, s78, 171008
    v_mfma_f32_16x16x32_bf16 v[24:27], v[132:135], v[168:171], v[24:27]
    buffer_load_dwordx4 v248, s[16:19], s39 offen offset:1024 lds
    v_mfma_f32_16x16x32_bf16 v[28:31], v[132:135], v[172:175], v[28:31]
    ds_read_b64_tr_b16 v[132:133], v245 offset:8192
    ds_read_b64_tr_b16 v[134:135], v245 offset:10240
    v_mfma_f32_16x16x32_bf16 v[32:35], v[136:139], v[160:163], v[32:35]
    ds_read_b128 v[184:187], v230 offset:47104
    v_mfma_f32_16x16x32_bf16 v[36:39], v[136:139], v[164:167], v[36:39]
    s_add_u32 s39, s78, 178176
    v_mfma_f32_16x16x32_bf16 v[40:43], v[136:139], v[168:171], v[40:43]
    buffer_load_dwordx4 v248, s[16:19], s39 offen offset:2048 lds
    v_mfma_f32_16x16x32_bf16 v[44:47], v[136:139], v[172:175], v[44:47]
    ds_read_b64_tr_b16 v[136:137], v246 offset:8192
    ds_read_b64_tr_b16 v[138:139], v246 offset:10240
    v_mfma_f32_16x16x32_bf16 v[48:51], v[140:143], v[160:163], v[48:51]
    ds_read_b128 v[188:191], v230 offset:48128
    v_mfma_f32_16x16x32_bf16 v[52:55], v[140:143], v[164:167], v[52:55]
    s_waitcnt lgkmcnt(10)
    s_add_u32 s39, s78, 185344
    v_mfma_f32_16x16x32_bf16 v[56:59], v[140:143], v[168:171], v[56:59]
    buffer_load_dwordx4 v248, s[16:19], s39 offen offset:3072 lds
    v_mfma_f32_16x16x32_bf16 v[60:63], v[140:143], v[172:175], v[60:63]
    ds_read_b64_tr_b16 v[140:141], v247 offset:8192
    ds_read_b64_tr_b16 v[142:143], v247 offset:10240
    v_mfma_f32_16x16x32_bf16 v[64:67], v[144:147], v[160:163], v[64:67]
    v_mfma_f32_16x16x32_bf16 v[68:71], v[144:147], v[164:167], v[68:71]
    s_waitcnt vmcnt(12)
    s_add_u32 m0, s36, 28544
    s_add_u32 s39, s78, 163840
    v_mfma_f32_16x16x32_bf16 v[72:75], v[144:147], v[168:171], v[72:75]
    buffer_load_dwordx4 v248, s[16:19], s39 offen offset:128 lds
    v_mfma_f32_16x16x32_bf16 v[76:79], v[144:147], v[172:175], v[76:79]
    ds_read_b64_tr_b16 v[144:145], v244 offset:12288
    ds_read_b64_tr_b16 v[146:147], v244 offset:14336
    v_mfma_f32_16x16x32_bf16 v[80:83], v[148:151], v[160:163], v[80:83]
    v_mfma_f32_16x16x32_bf16 v[84:87], v[148:151], v[164:167], v[84:87]
    s_add_u32 s39, s78, 171008
    v_mfma_f32_16x16x32_bf16 v[88:91], v[148:151], v[168:171], v[88:91]
    buffer_load_dwordx4 v248, s[16:19], s39 offen offset:1152 lds
    v_mfma_f32_16x16x32_bf16 v[92:95], v[148:151], v[172:175], v[92:95]
    ds_read_b64_tr_b16 v[148:149], v245 offset:12288
    ds_read_b64_tr_b16 v[150:151], v245 offset:14336
    v_mfma_f32_16x16x32_bf16 v[96:99], v[152:155], v[160:163], v[96:99]
    v_mfma_f32_16x16x32_bf16 v[100:103], v[152:155], v[164:167], v[100:103]
    s_add_u32 s39, s78, 178176
    v_mfma_f32_16x16x32_bf16 v[104:107], v[152:155], v[168:171], v[104:107]
    buffer_load_dwordx4 v248, s[16:19], s39 offen offset:2176 lds
    v_mfma_f32_16x16x32_bf16 v[108:111], v[152:155], v[172:175], v[108:111]
    ds_read_b64_tr_b16 v[152:153], v246 offset:12288
    ds_read_b64_tr_b16 v[154:155], v246 offset:14336
    v_mfma_f32_16x16x32_bf16 v[112:115], v[156:159], v[160:163], v[112:115]
    v_mfma_f32_16x16x32_bf16 v[116:119], v[156:159], v[164:167], v[116:119]
    s_waitcnt lgkmcnt(6)
    s_add_u32 s39, s78, 185344
    v_mfma_f32_16x16x32_bf16 v[120:123], v[156:159], v[168:171], v[120:123]
    buffer_load_dwordx4 v248, s[16:19], s39 offen offset:3200 lds
    v_mfma_f32_16x16x32_bf16 v[124:127], v[156:159], v[172:175], v[124:127]
    ds_read_b64_tr_b16 v[156:157], v247 offset:12288
    ds_read_b64_tr_b16 v[158:159], v247 offset:14336
    v_mfma_f32_16x16x32_bf16 v[0:3], v[128:131], v[176:179], v[0:3]
    ds_read_b128 v[160:163], v231 offset:0
    v_mfma_f32_16x16x32_bf16 v[4:7], v[128:131], v[180:183], v[4:7]
    s_waitcnt vmcnt(12)
    s_add_u32 m0, s36, 0
    s_add_u32 s39, s78, 196608
    v_mfma_f32_16x16x32_bf16 v[8:11], v[128:131], v[184:187], v[8:11]
    buffer_load_dwordx4 v248, s[16:19], s39 offen offset:0 lds
    v_mfma_f32_16x16x32_bf16 v[12:15], v[128:131], v[188:191], v[12:15]
    ds_read_b64_tr_b16 v[128:129], v244 offset:16384
    ds_read_b64_tr_b16 v[130:131], v244 offset:18432
    v_mfma_f32_16x16x32_bf16 v[16:19], v[132:135], v[176:179], v[16:19]
    ds_read_b128 v[164:167], v231 offset:1024
    v_mfma_f32_16x16x32_bf16 v[20:23], v[132:135], v[180:183], v[20:23]
    s_add_u32 s39, s78, 203776
    v_mfma_f32_16x16x32_bf16 v[24:27], v[132:135], v[184:187], v[24:27]
    buffer_load_dwordx4 v248, s[16:19], s39 offen offset:1024 lds
    v_mfma_f32_16x16x32_bf16 v[28:31], v[132:135], v[188:191], v[28:31]
    ds_read_b64_tr_b16 v[132:133], v245 offset:16384
    ds_read_b64_tr_b16 v[134:135], v245 offset:18432
    v_mfma_f32_16x16x32_bf16 v[32:35], v[136:139], v[176:179], v[32:35]
    ds_read_b128 v[168:171], v231 offset:2048
    v_mfma_f32_16x16x32_bf16 v[36:39], v[136:139], v[180:183], v[36:39]
    s_add_u32 s39, s78, 210944
    v_mfma_f32_16x16x32_bf16 v[40:43], v[136:139], v[184:187], v[40:43]
    buffer_load_dwordx4 v248, s[16:19], s39 offen offset:2048 lds
    v_mfma_f32_16x16x32_bf16 v[44:47], v[136:139], v[188:191], v[44:47]
    ds_read_b64_tr_b16 v[136:137], v246 offset:16384
    ds_read_b64_tr_b16 v[138:139], v246 offset:18432
    v_mfma_f32_16x16x32_bf16 v[48:51], v[140:143], v[176:179], v[48:51]
    ds_read_b128 v[172:175], v231 offset:3072
    v_mfma_f32_16x16x32_bf16 v[52:55], v[140:143], v[180:183], v[52:55]
    s_waitcnt lgkmcnt(10)
    s_add_u32 s39, s78, 218112
    v_mfma_f32_16x16x32_bf16 v[56:59], v[140:143], v[184:187], v[56:59]
    buffer_load_dwordx4 v248, s[16:19], s39 offen offset:3072 lds
    v_mfma_f32_16x16x32_bf16 v[60:63], v[140:143], v[188:191], v[60:63]
    ds_read_b64_tr_b16 v[140:141], v247 offset:16384
    ds_read_b64_tr_b16 v[142:143], v247 offset:18432
    v_mfma_f32_16x16x32_bf16 v[64:67], v[144:147], v[176:179], v[64:67]
    v_mfma_f32_16x16x32_bf16 v[68:71], v[144:147], v[180:183], v[68:71]
    s_waitcnt vmcnt(12)
    s_add_u32 m0, s36, 3968
    s_add_u32 s39, s78, 196608
    v_mfma_f32_16x16x32_bf16 v[72:75], v[144:147], v[184:187], v[72:75]
    buffer_load_dwordx4 v248, s[16:19], s39 offen offset:128 lds
    v_mfma_f32_16x16x32_bf16 v[76:79], v[144:147], v[188:191], v[76:79]
    ds_read_b64_tr_b16 v[144:145], v244 offset:20480
    ds_read_b64_tr_b16 v[146:147], v244 offset:22528
    v_mfma_f32_16x16x32_bf16 v[80:83], v[148:151], v[176:179], v[80:83]
    v_mfma_f32_16x16x32_bf16 v[84:87], v[148:151], v[180:183], v[84:87]
    s_add_u32 s39, s78, 203776
    v_mfma_f32_16x16x32_bf16 v[88:91], v[148:151], v[184:187], v[88:91]
    buffer_load_dwordx4 v248, s[16:19], s39 offen offset:1152 lds
    v_mfma_f32_16x16x32_bf16 v[92:95], v[148:151], v[188:191], v[92:95]
    ds_read_b64_tr_b16 v[148:149], v245 offset:20480
    ds_read_b64_tr_b16 v[150:151], v245 offset:22528
    v_mfma_f32_16x16x32_bf16 v[96:99], v[152:155], v[176:179], v[96:99]
    v_mfma_f32_16x16x32_bf16 v[100:103], v[152:155], v[180:183], v[100:103]
    s_add_u32 s39, s78, 210944
    v_mfma_f32_16x16x32_bf16 v[104:107], v[152:155], v[184:187], v[104:107]
    buffer_load_dwordx4 v248, s[16:19], s39 offen offset:2176 lds
    v_mfma_f32_16x16x32_bf16 v[108:111], v[152:155], v[188:191], v[108:111]
    ds_read_b64_tr_b16 v[152:153], v246 offset:20480
    ds_read_b64_tr_b16 v[154:155], v246 offset:22528
    v_mfma_f32_16x16x32_bf16 v[112:115], v[156:159], v[176:179], v[112:115]
    v_mfma_f32_16x16x32_bf16 v[116:119], v[156:159], v[180:183], v[116:119]
    s_waitcnt lgkmcnt(6)
    s_add_u32 s39, s78, 218112
    v_mfma_f32_16x16x32_bf16 v[120:123], v[156:159], v[184:187], v[120:123]
    buffer_load_dwordx4 v248, s[16:19], s39 offen offset:3200 lds
    v_mfma_f32_16x16x32_bf16 v[124:127], v[156:159], v[188:191], v[124:127]
    ds_read_b64_tr_b16 v[156:157], v247 offset:20480
    ds_read_b64_tr_b16 v[158:159], v247 offset:22528
    v_mfma_f32_16x16x32_bf16 v[0:3], v[128:131], v[160:163], v[0:3]
    ds_read_b128 v[176:179], v231 offset:4096
    v_mfma_f32_16x16x32_bf16 v[4:7], v[128:131], v[164:167], v[4:7]
    s_waitcnt vmcnt(12)
    v_mfma_f32_16x16x32_bf16 v[8:11], v[128:131], v[168:171], v[8:11]
    v_mfma_f32_16x16x32_bf16 v[12:15], v[128:131], v[172:175], v[12:15]
    ds_read_b64_tr_b16 v[128:129], v244 offset:24576
    ds_read_b64_tr_b16 v[130:131], v244 offset:26624
    v_mfma_f32_16x16x32_bf16 v[16:19], v[132:135], v[160:163], v[16:19]
    ds_read_b128 v[180:183], v231 offset:5120
    v_mfma_f32_16x16x32_bf16 v[20:23], v[132:135], v[164:167], v[20:23]
    v_mfma_f32_16x16x32_bf16 v[24:27], v[132:135], v[168:171], v[24:27]
    v_mfma_f32_16x16x32_bf16 v[28:31], v[132:135], v[172:175], v[28:31]
    ds_read_b64_tr_b16 v[132:133], v245 offset:24576
    ds_read_b64_tr_b16 v[134:135], v245 offset:26624
    v_mfma_f32_16x16x32_bf16 v[32:35], v[136:139], v[160:163], v[32:35]
    ds_read_b128 v[184:187], v231 offset:6144
    v_mfma_f32_16x16x32_bf16 v[36:39], v[136:139], v[164:167], v[36:39]
    v_mfma_f32_16x16x32_bf16 v[40:43], v[136:139], v[168:171], v[40:43]
    v_mfma_f32_16x16x32_bf16 v[44:47], v[136:139], v[172:175], v[44:47]
    ds_read_b64_tr_b16 v[136:137], v246 offset:24576
    ds_read_b64_tr_b16 v[138:139], v246 offset:26624
    v_mfma_f32_16x16x32_bf16 v[48:51], v[140:143], v[160:163], v[48:51]
    ds_read_b128 v[188:191], v231 offset:7168
    v_mfma_f32_16x16x32_bf16 v[52:55], v[140:143], v[164:167], v[52:55]
    s_waitcnt lgkmcnt(10)
    v_mfma_f32_16x16x32_bf16 v[56:59], v[140:143], v[168:171], v[56:59]
    v_mfma_f32_16x16x32_bf16 v[60:63], v[140:143], v[172:175], v[60:63]
    ds_read_b64_tr_b16 v[140:141], v247 offset:24576
    ds_read_b64_tr_b16 v[142:143], v247 offset:26624
    v_mfma_f32_16x16x32_bf16 v[64:67], v[144:147], v[160:163], v[64:67]
    v_mfma_f32_16x16x32_bf16 v[68:71], v[144:147], v[164:167], v[68:71]
    s_waitcnt vmcnt(8)
    v_mfma_f32_16x16x32_bf16 v[72:75], v[144:147], v[168:171], v[72:75]
    v_mfma_f32_16x16x32_bf16 v[76:79], v[144:147], v[172:175], v[76:79]
    ds_read_b64_tr_b16 v[144:145], v244 offset:28672
    ds_read_b64_tr_b16 v[146:147], v244 offset:30720
    v_mfma_f32_16x16x32_bf16 v[80:83], v[148:151], v[160:163], v[80:83]
    v_mfma_f32_16x16x32_bf16 v[84:87], v[148:151], v[164:167], v[84:87]
    v_mfma_f32_16x16x32_bf16 v[88:91], v[148:151], v[168:171], v[88:91]
    v_mfma_f32_16x16x32_bf16 v[92:95], v[148:151], v[172:175], v[92:95]
    ds_read_b64_tr_b16 v[148:149], v245 offset:28672
    ds_read_b64_tr_b16 v[150:151], v245 offset:30720
    v_mfma_f32_16x16x32_bf16 v[96:99], v[152:155], v[160:163], v[96:99]
    v_mfma_f32_16x16x32_bf16 v[100:103], v[152:155], v[164:167], v[100:103]
    v_mfma_f32_16x16x32_bf16 v[104:107], v[152:155], v[168:171], v[104:107]
    v_mfma_f32_16x16x32_bf16 v[108:111], v[152:155], v[172:175], v[108:111]
    ds_read_b64_tr_b16 v[152:153], v246 offset:28672
    ds_read_b64_tr_b16 v[154:155], v246 offset:30720
    v_mfma_f32_16x16x32_bf16 v[112:115], v[156:159], v[160:163], v[112:115]
    v_mfma_f32_16x16x32_bf16 v[116:119], v[156:159], v[164:167], v[116:119]
    s_waitcnt lgkmcnt(6)
    v_mfma_f32_16x16x32_bf16 v[120:123], v[156:159], v[168:171], v[120:123]
    v_mfma_f32_16x16x32_bf16 v[124:127], v[156:159], v[172:175], v[124:127]
    ds_read_b64_tr_b16 v[156:157], v247 offset:28672
    ds_read_b64_tr_b16 v[158:159], v247 offset:30720
    v_mfma_f32_16x16x32_bf16 v[0:3], v[128:131], v[176:179], v[0:3]
    ds_read_b128 v[160:163], v231 offset:40960
    v_mfma_f32_16x16x32_bf16 v[4:7], v[128:131], v[180:183], v[4:7]
    s_waitcnt vmcnt(4)
    v_mfma_f32_16x16x32_bf16 v[8:11], v[128:131], v[184:187], v[8:11]
    v_mfma_f32_16x16x32_bf16 v[12:15], v[128:131], v[188:191], v[12:15]
    ds_read_b64_tr_b16 v[128:129], v244 offset:0
    ds_read_b64_tr_b16 v[130:131], v244 offset:2048
    v_mfma_f32_16x16x32_bf16 v[16:19], v[132:135], v[176:179], v[16:19]
    ds_read_b128 v[164:167], v231 offset:41984
    v_mfma_f32_16x16x32_bf16 v[20:23], v[132:135], v[180:183], v[20:23]
    v_mfma_f32_16x16x32_bf16 v[24:27], v[132:135], v[184:187], v[24:27]
    v_mfma_f32_16x16x32_bf16 v[28:31], v[132:135], v[188:191], v[28:31]
    ds_read_b64_tr_b16 v[132:133], v245 offset:0
    ds_read_b64_tr_b16 v[134:135], v245 offset:2048
    v_mfma_f32_16x16x32_bf16 v[32:35], v[136:139], v[176:179], v[32:35]
    ds_read_b128 v[168:171], v231 offset:43008
    v_mfma_f32_16x16x32_bf16 v[36:39], v[136:139], v[180:183], v[36:39]
    v_mfma_f32_16x16x32_bf16 v[40:43], v[136:139], v[184:187], v[40:43]
    v_mfma_f32_16x16x32_bf16 v[44:47], v[136:139], v[188:191], v[44:47]
    ds_read_b64_tr_b16 v[136:137], v246 offset:0
    ds_read_b64_tr_b16 v[138:139], v246 offset:2048
    v_mfma_f32_16x16x32_bf16 v[48:51], v[140:143], v[176:179], v[48:51]
    ds_read_b128 v[172:175], v231 offset:44032
    v_mfma_f32_16x16x32_bf16 v[52:55], v[140:143], v[180:183], v[52:55]
    s_waitcnt lgkmcnt(10)
    v_mfma_f32_16x16x32_bf16 v[56:59], v[140:143], v[184:187], v[56:59]
    v_mfma_f32_16x16x32_bf16 v[60:63], v[140:143], v[188:191], v[60:63]
    ds_read_b64_tr_b16 v[140:141], v247 offset:0
    ds_read_b64_tr_b16 v[142:143], v247 offset:2048
    v_mfma_f32_16x16x32_bf16 v[64:67], v[144:147], v[176:179], v[64:67]
    v_mfma_f32_16x16x32_bf16 v[68:71], v[144:147], v[180:183], v[68:71]
    s_waitcnt vmcnt(0)
    v_mfma_f32_16x16x32_bf16 v[72:75], v[144:147], v[184:187], v[72:75]
    v_mfma_f32_16x16x32_bf16 v[76:79], v[144:147], v[188:191], v[76:79]
    ds_read_b64_tr_b16 v[144:145], v244 offset:4096
    ds_read_b64_tr_b16 v[146:147], v244 offset:6144
    v_mfma_f32_16x16x32_bf16 v[80:83], v[148:151], v[176:179], v[80:83]
    v_mfma_f32_16x16x32_bf16 v[84:87], v[148:151], v[180:183], v[84:87]
    v_mfma_f32_16x16x32_bf16 v[88:91], v[148:151], v[184:187], v[88:91]
    v_mfma_f32_16x16x32_bf16 v[92:95], v[148:151], v[188:191], v[92:95]
    ds_read_b64_tr_b16 v[148:149], v245 offset:4096
    ds_read_b64_tr_b16 v[150:151], v245 offset:6144
    v_mfma_f32_16x16x32_bf16 v[96:99], v[152:155], v[176:179], v[96:99]
    v_mfma_f32_16x16x32_bf16 v[100:103], v[152:155], v[180:183], v[100:103]
    v_mfma_f32_16x16x32_bf16 v[104:107], v[152:155], v[184:187], v[104:107]
    v_mfma_f32_16x16x32_bf16 v[108:111], v[152:155], v[188:191], v[108:111]
    ds_read_b64_tr_b16 v[152:153], v246 offset:4096
    ds_read_b64_tr_b16 v[154:155], v246 offset:6144
    v_mfma_f32_16x16x32_bf16 v[112:115], v[156:159], v[176:179], v[112:115]
    v_mfma_f32_16x16x32_bf16 v[116:119], v[156:159], v[180:183], v[116:119]
    s_waitcnt lgkmcnt(6)
    v_mfma_f32_16x16x32_bf16 v[120:123], v[156:159], v[184:187], v[120:123]
    v_mfma_f32_16x16x32_bf16 v[124:127], v[156:159], v[188:191], v[124:127]
    ds_read_b64_tr_b16 v[156:157], v247 offset:4096
    ds_read_b64_tr_b16 v[158:159], v247 offset:6144
    v_mfma_f32_16x16x32_bf16 v[0:3], v[128:131], v[160:163], v[0:3]
    v_mfma_f32_16x16x32_bf16 v[4:7], v[128:131], v[164:167], v[4:7]
    v_mfma_f32_16x16x32_bf16 v[8:11], v[128:131], v[168:171], v[8:11]
    v_mfma_f32_16x16x32_bf16 v[12:15], v[128:131], v[172:175], v[12:15]
    v_mfma_f32_16x16x32_bf16 v[16:19], v[132:135], v[160:163], v[16:19]
    v_mfma_f32_16x16x32_bf16 v[20:23], v[132:135], v[164:167], v[20:23]
    v_mfma_f32_16x16x32_bf16 v[24:27], v[132:135], v[168:171], v[24:27]
    v_mfma_f32_16x16x32_bf16 v[28:31], v[132:135], v[172:175], v[28:31]
    v_mfma_f32_16x16x32_bf16 v[32:35], v[136:139], v[160:163], v[32:35]
    v_mfma_f32_16x16x32_bf16 v[36:39], v[136:139], v[164:167], v[36:39]
    v_mfma_f32_16x16x32_bf16 v[40:43], v[136:139], v[168:171], v[40:43]
    v_mfma_f32_16x16x32_bf16 v[44:47], v[136:139], v[172:175], v[44:47]
    v_mfma_f32_16x16x32_bf16 v[48:51], v[140:143], v[160:163], v[48:51]
    v_mfma_f32_16x16x32_bf16 v[52:55], v[140:143], v[164:167], v[52:55]
    s_waitcnt lgkmcnt(0)
    v_mfma_f32_16x16x32_bf16 v[56:59], v[140:143], v[168:171], v[56:59]
    v_mfma_f32_16x16x32_bf16 v[60:63], v[140:143], v[172:175], v[60:63]
    v_mfma_f32_16x16x32_bf16 v[64:67], v[144:147], v[160:163], v[64:67]
    v_mfma_f32_16x16x32_bf16 v[68:71], v[144:147], v[164:167], v[68:71]
    v_mfma_f32_16x16x32_bf16 v[72:75], v[144:147], v[168:171], v[72:75]
    v_mfma_f32_16x16x32_bf16 v[76:79], v[144:147], v[172:175], v[76:79]
    v_mfma_f32_16x16x32_bf16 v[80:83], v[148:151], v[160:163], v[80:83]
    v_mfma_f32_16x16x32_bf16 v[84:87], v[148:151], v[164:167], v[84:87]
    v_mfma_f32_16x16x32_bf16 v[88:91], v[148:151], v[168:171], v[88:91]
    v_mfma_f32_16x16x32_bf16 v[92:95], v[148:151], v[172:175], v[92:95]
    v_mfma_f32_16x16x32_bf16 v[96:99], v[152:155], v[160:163], v[96:99]
    v_mfma_f32_16x16x32_bf16 v[100:103], v[152:155], v[164:167], v[100:103]
    v_mfma_f32_16x16x32_bf16 v[104:107], v[152:155], v[168:171], v[104:107]
    v_mfma_f32_16x16x32_bf16 v[108:111], v[152:155], v[172:175], v[108:111]
    v_mfma_f32_16x16x32_bf16 v[112:115], v[156:159], v[160:163], v[112:115]
    v_mfma_f32_16x16x32_bf16 v[116:119], v[156:159], v[164:167], v[116:119]
    v_mfma_f32_16x16x32_bf16 v[120:123], v[156:159], v[168:171], v[120:123]
    v_mfma_f32_16x16x32_bf16 v[124:127], v[156:159], v[172:175], v[124:127]
    s_lshl_b32 s45, s55, 21
    s_lshl_b32 s46, s54, 16
    s_add_u32 s45, s45, s46
    s_lshl_b32 s46, s3, 12
    s_add_u32 s45, s45, s46
    s_mul_i32 s46, s53, 27262976
    s_add_u32 s46, s46, 4194304
    s_add_u32 s45, s45, s46
    s_cmp_lg_u32 s53, 0
    s_cbranch_scc1 L_kf_wt_57
    s_mov_b32 s44, s45
    v_cvt_pk_bf16_f32 v128, v0, v1
    v_cvt_pk_bf16_f32 v129, v2, v3
    v_cvt_pk_bf16_f32 v130, v16, v17
    v_cvt_pk_bf16_f32 v131, v18, v19
    buffer_store_dwordx4 v[128:131], v250, s[28:31], s44 offen offset:0
    v_cvt_pk_bf16_f32 v132, v32, v33
    v_cvt_pk_bf16_f32 v133, v34, v35
    v_cvt_pk_bf16_f32 v134, v48, v49
    v_cvt_pk_bf16_f32 v135, v50, v51
    buffer_store_dwordx4 v[132:135], v250, s[28:31], s44 offen offset:1024
    v_cvt_pk_bf16_f32 v136, v64, v65
    v_cvt_pk_bf16_f32 v137, v66, v67
    v_cvt_pk_bf16_f32 v138, v80, v81
    v_cvt_pk_bf16_f32 v139, v82, v83
    buffer_store_dwordx4 v[136:139], v250, s[28:31], s44 offen offset:2048
    v_cvt_pk_bf16_f32 v140, v96, v97
    v_cvt_pk_bf16_f32 v141, v98, v99
    v_cvt_pk_bf16_f32 v142, v112, v113
    v_cvt_pk_bf16_f32 v143, v114, v115
    buffer_store_dwordx4 v[140:143], v250, s[28:31], s44 offen offset:3072
    s_add_u32 s44, s44, 0x4000
    v_cvt_pk_bf16_f32 v144, v4, v5
    v_cvt_pk_bf16_f32 v145, v6, v7
    v_cvt_pk_bf16_f32 v146, v20, v21
    v_cvt_pk_bf16_f32 v147, v22, v23
    buffer_store_dwordx4 v[144:147], v250, s[28:31], s44 offen offset:0
    v_cvt_pk_bf16_f32 v148, v36, v37
    v_cvt_pk_bf16_f32 v149, v38, v39
    v_cvt_pk_bf16_f32 v150, v52, v53
    v_cvt_pk_bf16_f32 v151, v54, v55
    buffer_store_dwordx4 v[148:151], v250, s[28:31], s44 offen offset:1024
    v_cvt_pk_bf16_f32 v152, v68, v69
    v_cvt_pk_bf16_f32 v153, v70, v71
    v_cvt_pk_bf16_f32 v154, v84, v85
    v_cvt_pk_bf16_f32 v155, v86, v87
    buffer_store_dwordx4 v[152:155], v250, s[28:31], s44 offen offset:2048
    v_cvt_pk_bf16_f32 v156, v100, v101
    v_cvt_pk_bf16_f32 v157, v102, v103
    v_cvt_pk_bf16_f32 v158, v116, v117
    v_cvt_pk_bf16_f32 v159, v118, v119
    buffer_store_dwordx4 v[156:159], v250, s[28:31], s44 offen offset:3072
    s_add_u32 s44, s44, 0x4000
    v_cvt_pk_bf16_f32 v160, v8, v9
    v_cvt_pk_bf16_f32 v161, v10, v11
    v_cvt_pk_bf16_f32 v162, v24, v25
    v_cvt_pk_bf16_f32 v163, v26, v27
    buffer_store_dwordx4 v[160:163], v250, s[28:31], s44 offen offset:0
    v_cvt_pk_bf16_f32 v164, v40, v41
    v_cvt_pk_bf16_f32 v165, v42, v43
    v_cvt_pk_bf16_f32 v166, v56, v57
    v_cvt_pk_bf16_f32 v167, v58, v59
    buffer_store_dwordx4 v[164:167], v250, s[28:31], s44 offen offset:1024
    v_cvt_pk_bf16_f32 v168, v72, v73
    v_cvt_pk_bf16_f32 v169, v74, v75
    v_cvt_pk_bf16_f32 v170, v88, v89
    v_cvt_pk_bf16_f32 v171, v90, v91
    buffer_store_dwordx4 v[168:171], v250, s[28:31], s44 offen offset:2048
    v_cvt_pk_bf16_f32 v172, v104, v105
    v_cvt_pk_bf16_f32 v173, v106, v107
    v_cvt_pk_bf16_f32 v174, v120, v121
    v_cvt_pk_bf16_f32 v175, v122, v123
    buffer_store_dwordx4 v[172:175], v250, s[28:31], s44 offen offset:3072
    s_add_u32 s44, s44, 0x4000
    v_cvt_pk_bf16_f32 v176, v12, v13
    v_cvt_pk_bf16_f32 v177, v14, v15
    v_cvt_pk_bf16_f32 v178, v28, v29
    v_cvt_pk_bf16_f32 v179, v30, v31
    buffer_store_dwordx4 v[176:179], v250, s[28:31], s44 offen offset:0
    v_cvt_pk_bf16_f32 v180, v44, v45
    v_cvt_pk_bf16_f32 v181, v46, v47
    v_cvt_pk_bf16_f32 v182, v60, v61
    v_cvt_pk_bf16_f32 v183, v62, v63
    buffer_store_dwordx4 v[180:183], v250, s[28:31], s44 offen offset:1024
    v_cvt_pk_bf16_f32 v184, v76, v77
    v_cvt_pk_bf16_f32 v185, v78, v79
    v_cvt_pk_bf16_f32 v186, v92, v93
    v_cvt_pk_bf16_f32 v187, v94, v95
    buffer_store_dwordx4 v[184:187], v250, s[28:31], s44 offen offset:2048
    v_cvt_pk_bf16_f32 v188, v108, v109
    v_cvt_pk_bf16_f32 v189, v110, v111
    v_cvt_pk_bf16_f32 v190, v124, v125
    v_cvt_pk_bf16_f32 v191, v126, v127
    buffer_store_dwordx4 v[188:191], v250, s[28:31], s44 offen offset:3072
L_kf_wb_58:
    v_lshlrev_b32 v64, 16, v208
    v_and_b32 v65, 0xffff0000, v208
    v_lshlrev_b32 v66, 16, v209
    v_and_b32 v67, 0xffff0000, v209
    v_lshlrev_b32 v68, 16, v210
    v_and_b32 v69, 0xffff0000, v210
    v_lshlrev_b32 v70, 16, v211
    v_and_b32 v71, 0xffff0000, v211
    v_lshlrev_b32 v72, 16, v212
    v_and_b32 v73, 0xffff0000, v212
    v_lshlrev_b32 v74, 16, v213
    v_and_b32 v75, 0xffff0000, v213
    v_lshlrev_b32 v76, 16, v214
    v_and_b32 v77, 0xffff0000, v214
    v_lshlrev_b32 v78, 16, v215
    v_and_b32 v79, 0xffff0000, v215
    v_lshlrev_b32 v80, 16, v216
    v_and_b32 v81, 0xffff0000, v216
    v_lshlrev_b32 v82, 16, v217
    v_and_b32 v83, 0xffff0000, v217
    v_lshlrev_b32 v84, 16, v218
    v_and_b32 v85, 0xffff0000, v218
    v_lshlrev_b32 v86, 16, v219
    v_and_b32 v87, 0xffff0000, v219
    v_lshlrev_b32 v88, 16, v220
    v_and_b32 v89, 0xffff0000, v220
    v_lshlrev_b32 v90, 16, v221
    v_and_b32 v91, 0xffff0000, v221
    v_lshlrev_b32 v92, 16, v222
    v_and_b32 v93, 0xffff0000, v222
    v_lshlrev_b32 v94, 16, v223
    v_and_b32 v95, 0xffff0000, v223
    s_mov_b32 s32, s96
    s_mov_b32 s33, s97
    s_mov_b32 s34, 0x200000
    s_mov_b32 s35, 0x20000
    v_and_b32 v230, 15, v253
    v_lshlrev_b32 v230, 10, v230
    v_add_u32 v230, v230, v232
    s_lshl_b32 s45, s54, 16
    s_lshl_b32 s46, s3, 14
    s_add_u32 s45, s45, s46
    s_lshl_b32 s46, s55, 11
    s_add_u32 s45, s45, s46
    s_mul_i32 s46, s53, 27262976
    s_add_u32 s46, s46, 4194304
    s_add_u32 s45, s45, s46
    s_waitcnt vmcnt(0)
    s_add_u32 s44, s101, 327680
    s_mov_b64 exec, 1
    s_cmp_lg_u32 s53, 0
    s_cbranch_scc1 L_kf_wt_59
    buffer_store_dword v235, off, s[28:31], s44
L_kf_wb_60:
    s_mov_b64 exec, -1
    s_add_u32 s59, s15, 327680
    buffer_load_dword v255, v234, s[28:31], s59 offen sc1
L_kf_poll_61:
    s_waitcnt vmcnt(0)
    v_cmp_ne_u32 vcc, s51, v255
    s_cbranch_vccz L_kf_seen_62
    s_sleep 1
    buffer_load_dword v255, v234, s[28:31], s59 offen sc1
    s_sub_i32 s52, s52, 1
    s_cmp_gt_i32 s52, 0
    s_cbranch_scc1 L_kf_poll_61
    s_waitcnt vmcnt(0)
L_kf_seen_62:
    buffer_load_dwordx4 v[0:3], v250, s[28:31], s45 offen offset:0 sc1
    buffer_load_dwordx4 v[4:7], v250, s[28:31], s45 offen offset:1024 sc1
    s_add_u32 s45, s45, 2097152
    buffer_load_dwordx4 v[8:11], v250, s[28:31], s45 offen offset:0 sc1
    buffer_load_dwordx4 v[12:15], v250, s[28:31], s45 offen offset:1024 sc1
    s_add_u32 s45, s45, 2097152
    buffer_load_dwordx4 v[16:19], v250, s[28:31], s45 offen offset:0 sc1
    buffer_load_dwordx4 v[20:23], v250, s[28:31], s45 offen offset:1024 sc1
    s_add_u32 s45, s45, 2097152
    buffer_load_dwordx4 v[24:27], v250, s[28:31], s45 offen offset:0 sc1
    buffer_load_dwordx4 v[28:31], v250, s[28:31], s45 offen offset:1024 sc1
    s_add_u32 s45, s45, 2097152
    buffer_load_dwordx4 v[32:35], v250, s[28:31], s45 offen offset:0 sc1
    buffer_load_dwordx4 v[36:39], v250, s[28:31], s45 offen offset:1024 sc1
    s_add_u32 s45, s45, 2097152
    buffer_load_dwordx4 v[40:43], v250, s[28:31], s45 offen offset:0 sc1
    buffer_load_dwordx4 v[44:47], v250, s[28:31], s45 offen offset:1024 sc1
    s_add_u32 s45, s45, 2097152
    buffer_load_dwordx4 v[48:51], v250, s[28:31], s45 offen offset:0 sc1
    buffer_load_dwordx4 v[52:55], v250, s[28:31], s45 offen offset:1024 sc1
    s_add_u32 s45, s45, 2097152
    buffer_load_dwordx4 v[56:59], v250, s[28:31], s45 offen offset:0 sc1
    buffer_load_dwordx4 v[60:63], v250, s[28:31], s45 offen offset:1024 sc1
    s_waitcnt vmcnt(14)
    v_mfma_f32_16x16x32_bf16 v[64:67], v[226:229], v[0:3], v[64:67]
    v_mfma_f32_16x16x32_bf16 v[68:71], v[224:227], v[0:3], v[68:71]
    v_mfma_f32_16x16x32_bf16 v[72:75], v[226:229], v[4:7], v[72:75]
    v_mfma_f32_16x16x32_bf16 v[76:79], v[224:227], v[4:7], v[76:79]
    s_waitcnt vmcnt(12)
    v_mfma_f32_16x16x32_bf16 v[64:67], v[226:229], v[8:11], v[64:67]
    v_mfma_f32_16x16x32_bf16 v[68:71], v[224:227], v[8:11], v[68:71]
    v_mfma_f32_16x16x32_bf16 v[72:75], v[226:229], v[12:15], v[72:75]
    v_mfma_f32_16x16x32_bf16 v[76:79], v[224:227], v[12:15], v[76:79]
    s_waitcnt vmcnt(10)
    v_mfma_f32_16x16x32_bf16 v[64:67], v[226:229], v[16:19], v[64:67]
    v_mfma_f32_16x16x32_bf16 v[68:71], v[224:227], v[16:19], v[68:71]
    v_mfma_f32_16x16x32_bf16 v[72:75], v[226:229], v[20:23], v[72:75]
    v_mfma_f32_16x16x32_bf16 v[76:79], v[224:227], v[20:23], v[76:79]
    s_waitcnt vmcnt(8)
    v_mfma_f32_16x16x32_bf16 v[64:67], v[226:229], v[24:27], v[64:67]
    v_mfma_f32_16x16x32_bf16 v[68:71], v[224:227], v[24:27], v[68:71]
    v_mfma_f32_16x16x32_bf16 v[72:75], v[226:229], v[28:31], v[72:75]
    v_mfma_f32_16x16x32_bf16 v[76:79], v[224:227], v[28:31], v[76:79]
    s_waitcnt vmcnt(6)
    v_mfma_f32_16x16x32_bf16 v[64:67], v[226:229], v[32:35], v[64:67]
    v_mfma_f32_16x16x32_bf16 v[68:71], v[224:227], v[32:35], v[68:71]
    v_mfma_f32_16x16x32_bf16 v[72:75], v[226:229], v[36:39], v[72:75]
    v_mfma_f32_16x16x32_bf16 v[76:79], v[224:227], v[36:39], v[76:79]
    s_waitcnt vmcnt(4)
    v_mfma_f32_16x16x32_bf16 v[64:67], v[226:229], v[40:43], v[64:67]
    v_mfma_f32_16x16x32_bf16 v[68:71], v[224:227], v[40:43], v[68:71]
    v_mfma_f32_16x16x32_bf16 v[72:75], v[226:229], v[44:47], v[72:75]
    v_mfma_f32_16x16x32_bf16 v[76:79], v[224:227], v[44:47], v[76:79]
    s_waitcnt vmcnt(2)
    v_mfma_f32_16x16x32_bf16 v[64:67], v[226:229], v[48:51], v[64:67]
    v_mfma_f32_16x16x32_bf16 v[68:71], v[224:227], v[48:51], v[68:71]
    v_mfma_f32_16x16x32_bf16 v[72:75], v[226:229], v[52:55], v[72:75]
    v_mfma_f32_16x16x32_bf16 v[76:79], v[224:227], v[52:55], v[76:79]
    s_waitcnt vmcnt(0)
    v_mfma_f32_16x16x32_bf16 v[64:67], v[226:229], v[56:59], v[64:67]
    v_mfma_f32_16x16x32_bf16 v[68:71], v[224:227], v[56:59], v[68:71]
    v_mfma_f32_16x16x32_bf16 v[72:75], v[226:229], v[60:63], v[72:75]
    v_mfma_f32_16x16x32_bf16 v[76:79], v[224:227], v[60:63], v[76:79]
    s_lshl_b32 s44, s55, 7
    s_add_u32 s44, s44, s56
    s_nop 2
    v_fmac_f32 v80, v64, v192
    v_fmac_f32 v81, v65, v193
    v_fmac_f32 v82, v66, v194
    v_fmac_f32 v83, v67, v195
    v_fmac_f32 v84, v68, v196
    v_fmac_f32 v85, v69, v197
    v_fmac_f32 v86, v70, v198
    v_fmac_f32 v87, v71, v199
    v_fmac_f32 v88, v72, v200
    v_fmac_f32 v89, v73, v201
    v_fmac_f32 v90, v74, v202
    v_fmac_f32 v91, v75, v203
    v_fmac_f32 v92, v76, v204
    v_fmac_f32 v93, v77, v205
    v_fmac_f32 v94, v78, v206
    v_fmac_f32 v95, v79, v207
    v_cvt_pk_bf16_f32 v64, v80, v81
    v_cvt_pk_bf16_f32 v65, v82, v83
    v_cvt_pk_bf16_f32 v66, v84, v85
    v_cvt_pk_bf16_f32 v67, v86, v87
    v_cvt_pk_bf16_f32 v68, v88, v89
    v_cvt_pk_bf16_f32 v69, v90, v91
    v_cvt_pk_bf16_f32 v70, v92, v93
    v_cvt_pk_bf16_f32 v71, v94, v95
    v_permlane32_swap_b32 v64, v66
    v_permlane32_swap_b32 v65, v67
    v_permlane32_swap_b32 v68, v70
    v_permlane32_swap_b32 v69, v71
    v_permlane16_swap_b32 v64, v66
    v_permlane16_swap_b32 v65, v67
    v_permlane16_swap_b32 v68, v70
    v_permlane16_swap_b32 v69, v71
    buffer_store_dwordx4 v[64:67], v230, s[32:35], s44 offen offset:0
    buffer_store_dwordx4 v[68:71], v230, s[32:35], s44 offen offset:64
    s_waitcnt vmcnt(0)
L_kf_end_2:
    s_endpgm
L_kf_fb_5:
    s_mov_b32 s41, 1
    s_mov_b32 s37, 0
    s_mov_b32 s40, 32
    v_accvgpr_read_b32 v192, a196
    v_accvgpr_read_b32 v193, a197
    v_accvgpr_read_b32 v194, a198
    v_accvgpr_read_b32 v195, a199
L_kf_fbl_6:
    s_waitcnt vmcnt(0)
    s_barrier
    s_add_u32 m0, s36, 24576
    s_nop 0
    buffer_load_dwordx4 v248, s[16:19], s37 offen offset:0 lds
    buffer_load_dwordx4 v248, s[16:19], s37 offen offset:1024 lds
    buffer_load_dwordx4 v248, s[16:19], s37 offen offset:2048 lds
    buffer_load_dwordx4 v248, s[16:19], s37 offen offset:3072 lds
    s_add_u32 s37, s37, 0x4000
    s_waitcnt vmcnt(0)
    s_barrier
    ds_read_b128 a[64:67], v236 offset:24576
    ds_read_b128 a[68:71], v236 offset:25600
    ds_read_b128 a[72:75], v237 offset:24576
    ds_read_b128 a[76:79], v237 offset:25600
    ds_read_b128 a[80:83], v238 offset:24576
    ds_read_b128 a[84:87], v238 offset:25600
    ds_read_b128 a[88:91], v239 offset:24576
    ds_read_b128 a[92:95], v239 offset:25600
    s_waitcnt lgkmcnt(0)
    v_mfma_f32_16x16x32_bf16 v[128:131], a[64:67], a[0:3], 0
    v_mfma_f32_16x16x32_bf16 v[136:139], a[64:67], a[16:19], 0
    v_mfma_f32_16x16x32_bf16 v[144:147], a[64:67], a[32:35], 0
    v_mfma_f32_16x16x32_bf16 v[152:155], a[64:67], a[48:51], 0
    v_mfma_f32_16x16x32_bf16 v[132:135], a[68:71], a[0:3], 0
    v_mfma_f32_16x16x32_bf16 v[140:143], a[68:71], a[16:19], 0
    v_mfma_f32_16x16x32_bf16 v[148:151], a[68:71], a[32:35], 0
    v_mfma_f32_16x16x32_bf16 v[156:159], a[68:71], a[48:51], 0
    v_mfma_f32_16x16x32_bf16 v[128:131], a[72:75], a[4:7], v[128:131]
    v_mfma_f32_16x16x32_bf16 v[136:139], a[72:75], a[20:23], v[136:139]
    v_mfma_f32_16x16x32_bf16 v[144:147], a[72:75], a[36:39], v[144:147]
    v_mfma_f32_16x16x32_bf16 v[152:155], a[72:75], a[52:55], v[152:155]
    v_mfma_f32_16x16x32_bf16 v[132:135], a[76:79], a[4:7], v[132:135]
    v_mfma_f32_16x16x32_bf16 v[140:143], a[76:79], a[20:23], v[140:143]
    v_mfma_f32_16x16x32_bf16 v[148:151], a[76:79], a[36:39], v[148:151]
    v_mfma_f32_16x16x32_bf16 v[156:159], a[76:79], a[52:55], v[156:159]
    v_mfma_f32_16x16x32_bf16 v[128:131], a[80:83], a[8:11], v[128:131]
    v_mfma_f32_16x16x32_bf16 v[136:139], a[80:83], a[24:27], v[136:139]
    v_mfma_f32_16x16x32_bf16 v[144:147], a[80:83], a[40:43], v[144:147]
    v_mfma_f32_16x16x32_bf16 v[152:155], a[80:83], a[56:59], v[152:155]
    v_mfma_f32_16x16x32_bf16 v[132:135], a[84:87], a[8:11], v[132:135]
    v_mfma_f32_16x16x32_bf16 v[140:143], a[84:87], a[24:27], v[140:143]
    v_mfma_f32_16x16x32_bf16 v[148:151], a[84:87], a[40:43], v[148:151]
    v_mfma_f32_16x16x32_bf16 v[156:159], a[84:87], a[56:59], v[156:159]
    v_mfma_f32_16x16x32_bf16 v[128:131], a[88:91], a[12:15], v[128:131]
    v_mfma_f32_16x16x32_bf16 v[136:139], a[88:91], a[28:31], v[136:139]
    v_mfma_f32_16x16x32_bf16 v[144:147], a[88:91], a[44:47], v[144:147]
    v_mfma_f32_16x16x32_bf16 v[152:155], a[88:91], a[60:63], v[152:155]
    v_mfma_f32_16x16x32_bf16 v[132:135], a[92:95], a[12:15], v[132:135]
    v_mfma_f32_16x16x32_bf16 v[140:143], a[92:95], a[28:31], v[140:143]
    v_mfma_f32_16x16x32_bf16 v[148:151], a[92:95], a[44:47], v[148:151]
    v_mfma_f32_16x16x32_bf16 v[156:159], a[92:95], a[60:63], v[156:159]
    s_nop 0
    v_max3_f32 v192, v192, v128, v129
    v_max3_f32 v193, v193, v136, v137
    v_max3_f32 v194, v194, v144, v145
    v_max3_f32 v195, v195, v152, v153
    v_max3_f32 v192, v192, v130, v131
    v_max3_f32 v193, v193, v138, v139
    v_max3_f32 v194, v194, v146, v147
    v_max3_f32 v195, v195, v154, v155
    v_max3_f32 v192, v192, v132, v133
    v_max3_f32 v193, v193, v140, v141
    v_max3_f32 v194, v194, v148, v149
    v_max3_f32 v195, v195, v156, v157
    v_max3_f32 v192, v192, v134, v135
    v_max3_f32 v193, v193, v142, v143
    v_max3_f32 v194, v194, v150, v151
    v_max3_f32 v195, v195, v158, v159
    ds_read_b128 a[64:67], v236 offset:26624
    ds_read_b128 a[68:71], v236 offset:27648
    ds_read_b128 a[72:75], v237 offset:26624
    ds_read_b128 a[76:79], v237 offset:27648
    ds_read_b128 a[80:83], v238 offset:26624
    ds_read_b128 a[84:87], v238 offset:27648
    ds_read_b128 a[88:91], v239 offset:26624
    ds_read_b128 a[92:95], v239 offset:27648
    s_waitcnt lgkmcnt(0)
    v_mfma_f32_16x16x32_bf16 v[128:131], a[64:67], a[0:3], 0
    v_mfma_f32_16x16x32_bf16 v[136:139], a[64:67], a[16:19], 0
    v_mfma_f32_16x16x32_bf16 v[144:147], a[64:67], a[32:35], 0
    v_mfma_f32_16x16x32_bf16 v[152:155], a[64:67], a[48:51], 0
    v_mfma_f32_16x16x32_bf16 v[132:135], a[68:71], a[0:3], 0
    v_mfma_f32_16x16x32_bf16 v[140:143], a[68:71], a[16:19], 0
    v_mfma_f32_16x16x32_bf16 v[148:151], a[68:71], a[32:35], 0
    v_mfma_f32_16x16x32_bf16 v[156:159], a[68:71], a[48:51], 0
    v_mfma_f32_16x16x32_bf16 v[128:131], a[72:75], a[4:7], v[128:131]
    v_mfma_f32_16x16x32_bf16 v[136:139], a[72:75], a[20:23], v[136:139]
    v_mfma_f32_16x16x32_bf16 v[144:147], a[72:75], a[36:39], v[144:147]
    v_mfma_f32_16x16x32_bf16 v[152:155], a[72:75], a[52:55], v[152:155]
    v_mfma_f32_16x16x32_bf16 v[132:135], a[76:79], a[4:7], v[132:135]
    v_mfma_f32_16x16x32_bf16 v[140:143], a[76:79], a[20:23], v[140:143]
    v_mfma_f32_16x16x32_bf16 v[148:151], a[76:79], a[36:39], v[148:151]
    v_mfma_f32_16x16x32_bf16 v[156:159], a[76:79], a[52:55], v[156:159]
    v_mfma_f32_16x16x32_bf16 v[128:131], a[80:83], a[8:11], v[128:131]
    v_mfma_f32_16x16x32_bf16 v[136:139], a[80:83], a[24:27], v[136:139]
    v_mfma_f32_16x16x32_bf16 v[144:147], a[80:83], a[40:43], v[144:147]
    v_mfma_f32_16x16x32_bf16 v[152:155], a[80:83], a[56:59], v[152:155]
    v_mfma_f32_16x16x32_bf16 v[132:135], a[84:87], a[8:11], v[132:135]
    v_mfma_f32_16x16x32_bf16 v[140:143], a[84:87], a[24:27], v[140:143]
    v_mfma_f32_16x16x32_bf16 v[148:151], a[84:87], a[40:43], v[148:151]
    v_mfma_f32_16x16x32_bf16 v[156:159], a[84:87], a[56:59], v[156:159]
    v_mfma_f32_16x16x32_bf16 v[128:131], a[88:91], a[12:15], v[128:131]
    v_mfma_f32_16x16x32_bf16 v[136:139], a[88:91], a[28:31], v[136:139]
    v_mfma_f32_16x16x32_bf16 v[144:147], a[88:91], a[44:47], v[144:147]
    v_mfma_f32_16x16x32_bf16 v[152:155], a[88:91], a[60:63], v[152:155]
    v_mfma_f32_16x16x32_bf16 v[132:135], a[92:95], a[12:15], v[132:135]
    v_mfma_f32_16x16x32_bf16 v[140:143], a[92:95], a[28:31], v[140:143]
    v_mfma_f32_16x16x32_bf16 v[148:151], a[92:95], a[44:47], v[148:151]
    v_mfma_f32_16x16x32_bf16 v[156:159], a[92:95], a[60:63], v[156:159]
    s_nop 0
    v_max3_f32 v192, v192, v128, v129
    v_max3_f32 v193, v193, v136, v137
    v_max3_f32 v194, v194, v144, v145
    v_max3_f32 v195, v195, v152, v153
    v_max3_f32 v192, v192, v130, v131
    v_max3_f32 v193, v193, v138, v139
    v_max3_f32 v194, v194, v146, v147
    v_max3_f32 v195, v195, v154, v155
    v_max3_f32 v192, v192, v132, v133
    v_max3_f32 v193, v193, v140, v141
    v_max3_f32 v194, v194, v148, v149
    v_max3_f32 v195, v195, v156, v157
    v_max3_f32 v192, v192, v134, v135
    v_max3_f32 v193, v193, v142, v143
    v_max3_f32 v194, v194, v150, v151
    v_max3_f32 v195, v195, v158, v159
    s_sub_u32 s40, s40, 1
    s_cmp_lg_u32 s40, 0
    s_cbranch_scc1 L_kf_fbl_6
    v_accvgpr_write_b32 a196, v192
    v_accvgpr_write_b32 a197, v193
    v_accvgpr_write_b32 a198, v194
    v_accvgpr_write_b32 a199, v195
    s_mov_b32 s37, 0
    s_mov_b32 s38, 0
    s_barrier
    s_add_u32 m0, s36, 24576
    s_nop 0
    buffer_load_dwordx4 v248, s[16:19], s37 offen offset:0 lds
    buffer_load_dwordx4 v248, s[16:19], s37 offen offset:1024 lds
    buffer_load_dwordx4 v248, s[16:19], s37 offen offset:2048 lds
    buffer_load_dwordx4 v248, s[16:19], s37 offen offset:3072 lds
    s_add_u32 s37, s37, 0x4000
    s_add_u32 m0, s36, 28672
    s_nop 0
    buffer_load_dwordx4 v248, s[16:19], s37 offen offset:0 lds
    buffer_load_dwordx4 v248, s[16:19], s37 offen offset:1024 lds
    buffer_load_dwordx4 v248, s[16:19], s37 offen offset:2048 lds
    buffer_load_dwordx4 v248, s[16:19], s37 offen offset:3072 lds
    s_add_u32 s37, s37, 0x4000
    s_add_u32 m0, s36, 32768
    s_nop 0
    buffer_load_dwordx4 v249, s[20:23], s38 offen offset:0 lds
    buffer_load_dwordx4 v249, s[20:23], s38 offen offset:1024 lds
    buffer_load_dwordx4 v249, s[20:23], s38 offen offset:2048 lds
    buffer_load_dwordx4 v249, s[20:23], s38 offen offset:3072 lds
    s_add_u32 s38, s38, 0x4000
    s_add_u32 m0, s36, 36864
    s_nop 0
    buffer_load_dwordx4 v248, s[16:19], s37 offen offset:0 lds
    buffer_load_dwordx4 v248, s[16:19], s37 offen offset:1024 lds
    buffer_load_dwordx4 v248, s[16:19], s37 offen offset:2048 lds
    buffer_load_dwordx4 v248, s[16:19], s37 offen offset:3072 lds
    s_add_u32 s37, s37, 0x4000
    s_add_u32 m0, s36, 16384
    s_nop 0
    buffer_load_dwordx4 v249, s[20:23], s38 offen offset:0 lds
    buffer_load_dwordx4 v249, s[20:23], s38 offen offset:1024 lds
    buffer_load_dwordx4 v249, s[20:23], s38 offen offset:2048 lds
    buffer_load_dwordx4 v249, s[20:23], s38 offen offset:3072 lds
    s_add_u32 s38, s38, 0x4000
    s_branch L_kf_att_3
L_kf_wt_33:
    buffer_store_dwordx4 v[64:67], v192, s[28:31], s44 offen offset:0 sc1
    buffer_store_dwordx4 v[68:71], v192, s[28:31], s44 offen offset:2048 sc1
    s_branch L_kf_wb_34
L_kf_wt_35:
    buffer_store_dwordx4 v[72:75], v192, s[28:31], s44 offen offset:0 sc1
    buffer_store_dwordx4 v[76:79], v192, s[28:31], s44 offen offset:2048 sc1
    s_branch L_kf_wb_36
L_kf_wt_37:
    buffer_store_dwordx4 v[80:83], v192, s[28:31], s44 offen offset:0 sc1
    buffer_store_dwordx4 v[84:87], v192, s[28:31], s44 offen offset:2048 sc1
    s_branch L_kf_wb_38
L_kf_wt_39:
    buffer_store_dword v235, off, s[28:31], s44 sc1
    s_branch L_kf_wb_40
L_kf_wt_43:
    buffer_store_dwordx4 v[192:195], v250, s[28:31], s44 offen offset:0 sc1
    buffer_store_dwordx4 v[196:199], v250, s[28:31], s44 offen offset:1024 sc1
    s_branch L_kf_wb_44
L_kf_wt_45:
    buffer_store_dword v235, off, s[28:31], s44 sc1
    s_branch L_kf_wb_46
L_kf_wt_49:
    buffer_store_dwordx4 v[208:211], v250, s[28:31], s44 offen offset:0 sc1
    buffer_store_dwordx4 v[212:215], v250, s[28:31], s44 offen offset:1024 sc1
    s_branch L_kf_wb_50
L_kf_wt_51:
    buffer_store_dwordx2 v[192:193], v194, s[28:31], s44 offen sc1
    s_branch L_kf_wb_52
L_kf_wt_53:
    buffer_store_dword v235, off, s[28:31], s44 sc1
    s_branch L_kf_wb_54
L_kf_wt_57:
    s_mov_b32 s44, s45
    v_cvt_pk_bf16_f32 v128, v0, v1
    v_cvt_pk_bf16_f32 v129, v2, v3
    v_cvt_pk_bf16_f32 v130, v16, v17
    v_cvt_pk_bf16_f32 v131, v18, v19
    buffer_store_dwordx4 v[128:131], v250, s[28:31], s44 offen offset:0 sc1
    v_cvt_pk_bf16_f32 v132, v32, v33
    v_cvt_pk_bf16_f32 v133, v34, v35
    v_cvt_pk_bf16_f32 v134, v48, v49
    v_cvt_pk_bf16_f32 v135, v50, v51
    buffer_store_dwordx4 v[132:135], v250, s[28:31], s44 offen offset:1024 sc1
    v_cvt_pk_bf16_f32 v136, v64, v65
    v_cvt_pk_bf16_f32 v137, v66, v67
    v_cvt_pk_bf16_f32 v138, v80, v81
    v_cvt_pk_bf16_f32 v139, v82, v83
    buffer_store_dwordx4 v[136:139], v250, s[28:31], s44 offen offset:2048 sc1
    v_cvt_pk_bf16_f32 v140, v96, v97
    v_cvt_pk_bf16_f32 v141, v98, v99
    v_cvt_pk_bf16_f32 v142, v112, v113
    v_cvt_pk_bf16_f32 v143, v114, v115
    buffer_store_dwordx4 v[140:143], v250, s[28:31], s44 offen offset:3072 sc1
    s_add_u32 s44, s44, 0x4000
    v_cvt_pk_bf16_f32 v144, v4, v5
    v_cvt_pk_bf16_f32 v145, v6, v7
    v_cvt_pk_bf16_f32 v146, v20, v21
    v_cvt_pk_bf16_f32 v147, v22, v23
    buffer_store_dwordx4 v[144:147], v250, s[28:31], s44 offen offset:0 sc1
    v_cvt_pk_bf16_f32 v148, v36, v37
    v_cvt_pk_bf16_f32 v149, v38, v39
    v_cvt_pk_bf16_f32 v150, v52, v53
    v_cvt_pk_bf16_f32 v151, v54, v55
    buffer_store_dwordx4 v[148:151], v250, s[28:31], s44 offen offset:1024 sc1
    v_cvt_pk_bf16_f32 v152, v68, v69
    v_cvt_pk_bf16_f32 v153, v70, v71
    v_cvt_pk_bf16_f32 v154, v84, v85
    v_cvt_pk_bf16_f32 v155, v86, v87
    buffer_store_dwordx4 v[152:155], v250, s[28:31], s44 offen offset:2048 sc1
    v_cvt_pk_bf16_f32 v156, v100, v101
    v_cvt_pk_bf16_f32 v157, v102, v103
    v_cvt_pk_bf16_f32 v158, v116, v117
    v_cvt_pk_bf16_f32 v159, v118, v119
    buffer_store_dwordx4 v[156:159], v250, s[28:31], s44 offen offset:3072 sc1
    s_add_u32 s44, s44, 0x4000
    v_cvt_pk_bf16_f32 v160, v8, v9
    v_cvt_pk_bf16_f32 v161, v10, v11
    v_cvt_pk_bf16_f32 v162, v24, v25
    v_cvt_pk_bf16_f32 v163, v26, v27
    buffer_store_dwordx4 v[160:163], v250, s[28:31], s44 offen offset:0 sc1
    v_cvt_pk_bf16_f32 v164, v40, v41
    v_cvt_pk_bf16_f32 v165, v42, v43
    v_cvt_pk_bf16_f32 v166, v56, v57
    v_cvt_pk_bf16_f32 v167, v58, v59
    buffer_store_dwordx4 v[164:167], v250, s[28:31], s44 offen offset:1024 sc1
    v_cvt_pk_bf16_f32 v168, v72, v73
    v_cvt_pk_bf16_f32 v169, v74, v75
    v_cvt_pk_bf16_f32 v170, v88, v89
    v_cvt_pk_bf16_f32 v171, v90, v91
    buffer_store_dwordx4 v[168:171], v250, s[28:31], s44 offen offset:2048 sc1
    v_cvt_pk_bf16_f32 v172, v104, v105
    v_cvt_pk_bf16_f32 v173, v106, v107
    v_cvt_pk_bf16_f32 v174, v120, v121
    v_cvt_pk_bf16_f32 v175, v122, v123
    buffer_store_dwordx4 v[172:175], v250, s[28:31], s44 offen offset:3072 sc1
    s_add_u32 s44, s44, 0x4000
    v_cvt_pk_bf16_f32 v176, v12, v13
    v_cvt_pk_bf16_f32 v177, v14, v15
    v_cvt_pk_bf16_f32 v178, v28, v29
    v_cvt_pk_bf16_f32 v179, v30, v31
    buffer_store_dwordx4 v[176:179], v250, s[28:31], s44 offen offset:0 sc1
    v_cvt_pk_bf16_f32 v180, v44, v45
    v_cvt_pk_bf16_f32 v181, v46, v47
    v_cvt_pk_bf16_f32 v182, v60, v61
    v_cvt_pk_bf16_f32 v183, v62, v63
    buffer_store_dwordx4 v[180:183], v250, s[28:31], s44 offen offset:1024 sc1
    v_cvt_pk_bf16_f32 v184, v76, v77
    v_cvt_pk_bf16_f32 v185, v78, v79
    v_cvt_pk_bf16_f32 v186, v92, v93
    v_cvt_pk_bf16_f32 v187, v94, v95
    buffer_store_dwordx4 v[184:187], v250, s[28:31], s44 offen offset:2048 sc1
    v_cvt_pk_bf16_f32 v188, v108, v109
    v_cvt_pk_bf16_f32 v189, v110, v111
    v_cvt_pk_bf16_f32 v190, v124, v125
    v_cvt_pk_bf16_f32 v191, v126, v127
    buffer_store_dwordx4 v[188:191], v250, s[28:31], s44 offen offset:3072 sc1
    s_branch L_kf_wb_58
L_kf_wt_59:
    buffer_store_dword v235, off, s[28:31], s44 sc1
    s_branch L_kf_wb_60
L_kf_last_1:
    s_endpgm
.section .rodata,"a"
.p2align 6
.amdhsa_kernel kf_kernel
  .amdhsa_next_free_vgpr 512
  .amdhsa_next_free_sgpr 102
  .amdhsa_accum_offset 256
  .amdhsa_group_segment_fixed_size 0
  .amdhsa_kernarg_size 120
  .amdhsa_user_sgpr_count 2
  .amdhsa_user_sgpr_kernarg_segment_ptr 1
  .amdhsa_system_sgpr_workgroup_id_x 1
.end_amdhsa_kernel
```
